```python
import torch

def _softmax(x, axis=-1):
    return torch.softmax(x, dim=axis)
def _gelu(x):
    return torch.nn.functional.gelu(x, approximate="tanh")
def _silu(x):
    return torch.nn.functional.silu(x)
def _sigmoid(x):
    return torch.sigmoid(x)
def _layernorm(x, axis=-1, eps=1e-5):
    m = x.mean(dim=axis, keepdim=True)
    v = x.var(dim=axis, keepdim=True, unbiased=False)
    return (x - m) / torch.sqrt(v + eps)
def _scatter_add(tgt, idx, src, axis=0):
    return tgt.clone().index_add_(axis, idx, src)
def _segment_sum(src, seg, n):
    out = torch.zeros((n,) + src.shape[1:], dtype=src.dtype)
    return out.index_add_(0, seg, src)
def _pad(x, pw):
    flat = tuple(v for pair in reversed(pw) for v in pair)
    return torch.nn.functional.pad(x, flat)

kernel_name = 'parallel_sum__compressed_kv_cla__dense_activation_gelu__prompt'

def setup_inputs():

    _w = (lambda a: (lambda t: t.to(torch.bfloat16) if t.is_floating_point() else t)(torch.as_tensor(a)))
    def _A_setup():
        B, H, Sq, Sk, D, M = 1, 32, 2048, 2048, 128, 1024
        Dc = 4 * D
        return {
            "x": _w((lambda *s: torch.randn(*s, dtype=torch.bfloat16) * 0.05)(B, Sq, M)),
            "c_kv": _w((lambda *s: torch.randn(*s, dtype=torch.bfloat16) * 0.4)(B, Sk, Dc)),
            "w_q": _w((lambda *s: torch.randn(*s, dtype=torch.bfloat16) * 3.2)(M, H, D) * (M ** -0.5)),
            "w_uk": _w((lambda *s: torch.randn(*s, dtype=torch.bfloat16) * 3.2)(Dc, H, D) * (Dc ** -0.5)),
            "w_uv": _w((lambda *s: torch.randn(*s, dtype=torch.bfloat16) * 0.4)(Dc, H, D) * (Dc ** -0.5)),
            "w_o": _w((lambda *s: torch.randn(*s, dtype=torch.bfloat16) * 0.4)(H, D, M) * ((H * D) ** -0.5)),
        }
    _A_in = _A_setup()

    def _B_setup():
        B, S, D, F = 1, 2048, 1024, 3584
        return {
            "x": _w((lambda *s: torch.randn(*s, dtype=torch.bfloat16) * 0.05)(B, S, D)),
            "w1": _w((lambda *s: torch.randn(*s, dtype=torch.bfloat16) * 0.4)(D, F) * (D ** -0.5)),
            "b1": _w((lambda *s: torch.randn(*s, dtype=torch.bfloat16) * 12.8)(F) * 0.01),
            "w2": _w((lambda *s: torch.randn(*s, dtype=torch.bfloat16) * 0.2)(F, D) * (F ** -0.5)),
            "b2": _w((lambda *s: torch.randn(*s, dtype=torch.bfloat16) * 1.6)(D) * 0.01),
        }
    _B_in = _B_setup()

    return {
        "A_x": _A_in["x"],
        "A_c_kv": _A_in["c_kv"],
        "A_w_q": _A_in["w_q"],
        "A_w_uk": _A_in["w_uk"],
        "A_w_uv": _A_in["w_uv"],
        "A_w_o": _A_in["w_o"],
        "B_x": _B_in["x"],
        "B_w1": _B_in["w1"],
        "B_b1": _B_in["b1"],
        "B_w2": _B_in["w2"],
        "B_b2": _B_in["b2"],
    }

def reference(A_x, A_c_kv, A_w_q, A_w_uk, A_w_uv, A_w_o, B_x, B_w1, B_b1, B_w2, B_b2):
    def _A_ref(x, c_kv, w_q, w_uk, w_uv, w_o):
        B, Sq, M = x.shape[0], x.shape[1], x.shape[2]
        Sk = c_kv.shape[1]
        H, D = w_q.shape[1], w_q.shape[2]
        q = torch.einsum("bqm,mhd->bhqd", x, w_q)
        k = torch.einsum("bkc,chd->bhkd", c_kv, w_uk)
        v = torch.einsum("bkc,chd->bhkd", c_kv, w_uv)
        scores = torch.einsum("bhqd,bhkd->bhqk", q, k) * (D ** -0.5)
        off = Sk - Sq
        qi = torch.arange(Sq)[:, None]
        kj = torch.arange(Sk)[None, :]
        cmask = kj <= (qi + off)
        scores = torch.where(cmask[None, None], scores, -1e9)
        p = _softmax(scores, axis=-1)
        ctx = torch.einsum("bhqk,bhkd->bhqd", p, v)
        return torch.einsum("bhqd,hdm->bqm", ctx, w_o)

    def _B_ref(x, w1, b1, w2, b2):
        h = torch.einsum("bsd,df->bsf", x, w1) + b1
        h = _gelu(h)
        return torch.einsum("bsf,fd->bsd", h, w2) + b2

    x = A_x
    xn = _layernorm(x, axis=-1)
    return x + _A_ref(xn, A_c_kv, A_w_q, A_w_uk, A_w_uv, A_w_o) + _B_ref(xn, B_w1, B_b1, B_w2, B_b2)
```

```asm
; @launch grid=(256,1,1) block=(512,1,1) lds=163840
.amdgcn_target "amdgcn-amd-amdhsa--gfx950"
.text
.globl parallel_sum__compressed_kv_cla__dense_activation_gelu__prompt_kernel
.p2align 8
.type parallel_sum__compressed_kv_cla__dense_activation_gelu__prompt_kernel,@function
parallel_sum__compressed_kv_cla__dense_activation_gelu__prompt_kernel:
proj_kernel:
    s_cmp_ge_u32 s2, 256
    s_cbranch_scc1 fused_end
    s_load_dwordx16 s[16:31], s[0:1], 0
    s_load_dwordx8 s[32:39], s[0:1], 64
    s_load_dwordx4 s[40:43], s[0:1], 96
    v_and_b32 v1, 63, v0
    v_lshrrev_b32 v2, 6, v0
    s_nop 0
    v_readfirstlane_b32 s60, v2
    s_nop 3
    s_lshr_b32 s63, s60, 2
    s_bfe_u32 s61, s60, 0x10001
    s_and_b32 s62, s60, 1
    s_lshl_b32 s81, s60, 12
    s_and_b32 s68, s2, 7
    s_lshr_b32 s69, s2, 3
    s_and_b32 s72, s69, 7
    s_lshr_b32 s70, s69, 3
    s_lshl_b32 s73, s68, 2
    s_add_u32 s73, s73, s70
    s_cmp_lg_u32 s63, 0
    s_cselect_b64 vcc, -1, 0
    s_lshl_b32 s9, s2, 2
    s_and_b32 s68, s60, 3
    s_add_u32 s9, s9, s68
    s_lshl_b32 s10, s9, 1
    s_lshl_b32 s9, s9, 10
    v_lshlrev_b32 v120, 4, v1
    s_waitcnt lgkmcnt(0)
    s_cbranch_vccnz proj_free0
    s_setprio 1
    s_add_u32 s68, s2, s60
    s_cmp_lg_u32 s68, 0
    s_cbranch_scc1 proj_notok
    s_add_u32 s56, s40, 0
    s_addc_u32 s57, s41, 0
    s_mov_b32 s58, 256
    s_and_b32 s57, s57, 0xffff
    s_mov_b32 s59, 0x00020000
    s_memrealtime s[86:87]
    s_waitcnt lgkmcnt(0)
    s_or_b32 s86, s86, 1
    v_mov_b32 v80, s86
    v_mov_b32 v81, s87
    v_mov_b32 v82, 0
    s_mov_b64 exec, 1
    buffer_store_dwordx2 v[80:81], v82, s[56:59], 0 offen sc0 sc1
    s_mov_b64 exec, -1
proj_notok:
proj_free0:
    s_lshl_b32 s68, s72, 18
    s_add_u32 s44, s18, s68
    s_addc_u32 s45, s19, 0
    s_sub_u32 s46, 2097152, s68
    s_and_b32 s45, s45, 0xffff
    s_mov_b32 s47, 0x00020000
    s_cmp_lt_u32 s73, 16
    s_cselect_b32 s76, s22, s24
    s_cselect_b32 s77, s23, s25
    s_and_b32 s78, s73, 15
    s_lshl_b32 s68, s78, 9
    s_add_u32 s48, s76, s68
    s_addc_u32 s49, s77, 0
    s_sub_u32 s50, 4194304, s68
    s_and_b32 s49, s49, 0xffff
    s_mov_b32 s51, 0x00020000
    s_add_u32 s68, s68, 256
    s_add_u32 s96, s76, s68
    s_addc_u32 s97, s77, 0
    s_sub_u32 s98, 4194304, s68
    s_and_b32 s97, s97, 0xffff
    s_mov_b32 s99, 0x00020000
    v_lshrrev_b32 v80, 3, v1
    v_lshrrev_b32 v81, 4, v1
    v_and_b32 v82, 7, v1
    v_xor_b32 v82, v82, v81
    v_lshlrev_b32 v82, 4, v82
    v_xor_b32 v83, 64, v82
    s_lshl_b32 s68, s60, 5
    v_add_u32 v80, s68, v80
    s_mov_b32 s69, 1024
    v_mul_lo_u32 v80, v80, s69
    v_add_u32 v8, v80, v82
    v_add_u32 v80, 8192, v80
    v_add_u32 v9, v80, v83
    s_mov_b32 s4, 16384
    v_and_b32 v82, 15, v1
    v_lshlrev_b32 v83, 1, v81
    v_xor_b32 v82, v82, v83
    v_lshlrev_b32 v82, 4, v82
    v_xor_b32 v83, 128, v82
    s_lshl_b32 s68, s60, 4
    v_add_u32 v84, s68, v81
    s_mov_b32 s69, 8192
    v_mul_lo_u32 v80, v84, s69
    v_add_u32 v10, v80, v82
    v_add_u32 v80, 65536, v80
    v_add_u32 v11, v80, v83
    s_mov_b32 s5, 32768
    s_mov_b32 s7, 524288
    s_mov_b32 s69, 8192
    v_mul_lo_u32 v80, v84, s69
    v_add_u32 v12, v80, v82
    v_add_u32 v80, 65536, v80
    v_add_u32 v13, v80, v83
    s_mov_b32 s6, 32768
    s_mov_b32 s8, 524288
    s_mov_b32 s64, 0
    s_mov_b32 s65, 131072
    s_mov_b32 s66, 0
    s_mov_b32 s67, 0
    s_cbranch_vccnz proj_free1
    s_add_u32 m0, s81, 0
    s_nop 0
    buffer_load_dwordx4 v8, s[44:47], s64 offen lds
    s_add_u32 m0, s81, 1024
    s_nop 0
    buffer_load_dwordx4 v9, s[44:47], s64 offen lds
    s_add_u32 s68, s64, s4
    s_add_u32 m0, s81, 2048
    s_nop 0
    buffer_load_dwordx4 v8, s[44:47], s68 offen lds
    s_add_u32 s68, s64, s4
    s_add_u32 m0, s81, 3072
    s_nop 0
    buffer_load_dwordx4 v9, s[44:47], s68 offen lds
    s_add_u32 m0, s81, 16384
    s_nop 0
    buffer_load_dwordx4 v8, s[44:47], s65 offen lds
    s_add_u32 m0, s81, 17408
    s_nop 0
    buffer_load_dwordx4 v9, s[44:47], s65 offen lds
    s_add_u32 s68, s65, s4
    s_add_u32 m0, s81, 18432
    s_nop 0
    buffer_load_dwordx4 v8, s[44:47], s68 offen lds
    s_add_u32 s68, s65, s4
    s_add_u32 m0, s81, 19456
    s_nop 0
    buffer_load_dwordx4 v9, s[44:47], s68 offen lds
    s_add_u32 m0, s81, 65536
    s_nop 0
    buffer_load_dwordx4 v10, s[48:51], s66 offen lds
    s_add_u32 s68, s66, s5
    s_add_u32 m0, s81, 66560
    s_nop 0
    buffer_load_dwordx4 v10, s[48:51], s68 offen lds
    s_add_u32 m0, s81, 67584
    s_nop 0
    buffer_load_dwordx4 v11, s[48:51], s66 offen lds
    s_add_u32 s68, s66, s5
    s_add_u32 m0, s81, 68608
    s_nop 0
    buffer_load_dwordx4 v11, s[48:51], s68 offen lds
    s_add_u32 m0, s81, 81920
    s_nop 0
    buffer_load_dwordx4 v12, s[96:99], s67 offen lds
    s_add_u32 s68, s67, s6
    s_add_u32 m0, s81, 82944
    s_nop 0
    buffer_load_dwordx4 v12, s[96:99], s68 offen lds
    s_add_u32 m0, s81, 83968
    s_nop 0
    buffer_load_dwordx4 v13, s[96:99], s67 offen lds
    s_add_u32 s68, s67, s6
    s_add_u32 m0, s81, 84992
    s_nop 0
    buffer_load_dwordx4 v13, s[96:99], s68 offen lds
    s_add_u32 s64, s64, 128
    s_add_u32 s65, s65, 128
    s_add_u32 s66, s66, s7
    s_add_u32 s67, s67, s8
    s_add_u32 m0, s81, 32768
    s_nop 0
    buffer_load_dwordx4 v8, s[44:47], s64 offen lds
    s_add_u32 m0, s81, 33792
    s_nop 0
    buffer_load_dwordx4 v9, s[44:47], s64 offen lds
    s_add_u32 s68, s64, s4
    s_add_u32 m0, s81, 34816
    s_nop 0
    buffer_load_dwordx4 v8, s[44:47], s68 offen lds
    s_add_u32 s68, s64, s4
    s_add_u32 m0, s81, 35840
    s_nop 0
    buffer_load_dwordx4 v9, s[44:47], s68 offen lds
    s_add_u32 m0, s81, 49152
    s_nop 0
    buffer_load_dwordx4 v8, s[44:47], s65 offen lds
    s_add_u32 m0, s81, 50176
    s_nop 0
    buffer_load_dwordx4 v9, s[44:47], s65 offen lds
    s_add_u32 s68, s65, s4
    s_add_u32 m0, s81, 51200
    s_nop 0
    buffer_load_dwordx4 v8, s[44:47], s68 offen lds
    s_add_u32 s68, s65, s4
    s_add_u32 m0, s81, 52224
    s_nop 0
    buffer_load_dwordx4 v9, s[44:47], s68 offen lds
    s_add_u32 m0, s81, 98304
    s_nop 0
    buffer_load_dwordx4 v10, s[48:51], s66 offen lds
    s_add_u32 s68, s66, s5
    s_add_u32 m0, s81, 99328
    s_nop 0
    buffer_load_dwordx4 v10, s[48:51], s68 offen lds
    s_add_u32 m0, s81, 100352
    s_nop 0
    buffer_load_dwordx4 v11, s[48:51], s66 offen lds
    s_add_u32 s68, s66, s5
    s_add_u32 m0, s81, 101376
    s_nop 0
    buffer_load_dwordx4 v11, s[48:51], s68 offen lds
    s_add_u32 m0, s81, 114688
    s_nop 0
    buffer_load_dwordx4 v12, s[96:99], s67 offen lds
    s_add_u32 s68, s67, s6
    s_add_u32 m0, s81, 115712
    s_nop 0
    buffer_load_dwordx4 v12, s[96:99], s68 offen lds
    s_add_u32 m0, s81, 116736
    s_nop 0
    buffer_load_dwordx4 v13, s[96:99], s67 offen lds
    s_add_u32 s68, s67, s6
    s_add_u32 m0, s81, 117760
    s_nop 0
    buffer_load_dwordx4 v13, s[96:99], s68 offen lds
    s_add_u32 s64, s64, 128
    s_add_u32 s65, s65, 128
    s_add_u32 s66, s66, s7
    s_add_u32 s67, s67, s8
    s_branch proj_join1
proj_free1:
    s_add_u32 s64, s64, 128
    s_add_u32 s65, s65, 128
    s_add_u32 s66, s66, s7
    s_add_u32 s67, s67, s8
    s_add_u32 s64, s64, 128
    s_add_u32 s65, s65, 128
    s_add_u32 s66, s66, s7
    s_add_u32 s67, s67, s8
    s_add_u32 s56, s16, 0
    s_addc_u32 s57, s17, 0
    s_mov_b32 s58, 4194304
    s_and_b32 s57, s57, 0xffff
    s_mov_b32 s59, 0x00020000
    s_lshl_b32 s68, s10, 11
    buffer_load_dwordx4 v[104:107], v120, s[56:59], s68 offen offset:0
    buffer_load_dwordx4 v[108:111], v120, s[56:59], s68 offen offset:1024
    buffer_load_dwordx4 v[112:115], v120, s[56:59], s68 offen offset:2048
    buffer_load_dwordx4 v[116:119], v120, s[56:59], s68 offen offset:3072
    s_getpc_b64 s[86:87]
proj_pc:
    s_sub_u32 s56, s86, proj_pc-proj_kernel
    s_subb_u32 s57, s87, 0
    s_and_b32 s57, s57, 0xffff
    s_mov_b32 s58, text_end-proj_kernel
    s_mov_b32 s59, 0x00020000
    s_lshr_b32 s68, s2, 3
    s_lshl_b32 s68, s68, 2
    s_and_b32 s69, s60, 3
    s_add_u32 s68, s68, s69
    s_lshl_b32 s68, s68, 10
    buffer_load_dwordx4 v[100:103], v120, s[56:59], s68 offen
    s_add_u32 s56, s22, 0
    s_addc_u32 s57, s23, 0
    s_mov_b32 s58, 4194304
    s_and_b32 s57, s57, 0xffff
    s_mov_b32 s59, 0x00020000
    s_mul_i32 s68, s9, 4
    s_add_u32 s69, s68, 4096
    buffer_load_dwordx4 v[100:103], v120, s[56:59], s68 offen offset:0
    buffer_load_dwordx4 v[100:103], v120, s[56:59], s68 offen offset:1024
    buffer_load_dwordx4 v[100:103], v120, s[56:59], s68 offen offset:2048
    buffer_load_dwordx4 v[100:103], v120, s[56:59], s68 offen offset:3072
Lnofp_1:
    s_add_u32 s56, s24, 0
    s_addc_u32 s57, s25, 0
    s_mov_b32 s58, 4194304
    s_and_b32 s57, s57, 0xffff
    s_mov_b32 s59, 0x00020000
    s_mul_i32 s68, s9, 4
    s_add_u32 s69, s68, 4096
    buffer_load_dwordx4 v[100:103], v120, s[56:59], s68 offen offset:0
    buffer_load_dwordx4 v[100:103], v120, s[56:59], s68 offen offset:1024
    buffer_load_dwordx4 v[100:103], v120, s[56:59], s68 offen offset:2048
    buffer_load_dwordx4 v[100:103], v120, s[56:59], s68 offen offset:3072
Lnofp_2:
    s_add_u32 s56, s18, 0
    s_addc_u32 s57, s19, 0
    s_mov_b32 s58, 2097152
    s_and_b32 s57, s57, 0xffff
    s_mov_b32 s59, 0x00020000
    s_mul_i32 s68, s9, 2
    s_add_u32 s69, s68, 4096
    buffer_load_dwordx4 v[100:103], v120, s[56:59], s68 offen offset:0
    buffer_load_dwordx4 v[100:103], v120, s[56:59], s68 offen offset:1024
Lnofp_3:
proj_join1:
    s_mul_i32 s10, s10, 2176
    s_add_u32 s11, s10, 2176
    v_lshrrev_b32 v81, 4, v1
    v_and_b32 v80, 15, v1
    v_lshrrev_b32 v82, 1, v80
    v_xor_b32 v82, v82, v81
    v_lshlrev_b32 v82, 4, v82
    s_lshl_b32 s68, s61, 7
    v_add_u32 v83, s68, v80
    v_lshlrev_b32 v83, 7, v83
    v_add_u32 v2, v83, v82
    v_xor_b32 v3, 64, v2
    v_lshrrev_b32 v82, 2, v80
    v_lshlrev_b32 v83, 3, v81
    v_add_u32 v83, v83, v82
    v_lshlrev_b32 v83, 8, v83
    s_lshl_b32 s68, s63, 14
    s_add_u32 s68, s68, 0x10000
    v_add_u32 v83, s68, v83
    v_and_b32 v84, 3, v1
    v_lshlrev_b32 v84, 3, v84
    v_add_u32 v83, v83, v84
    v_and_b32 v84, 1, v81
    v_xor_b32 v84, s62, v84
    v_lshlrev_b32 v84, 7, v84
    v_add_u32 v83, v83, v84
    v_xor_b32 v84, 0, v82
    v_lshlrev_b32 v84, 5, v84
    v_add_u32 v4, v83, v84
    v_xor_b32 v84, 1, v82
    v_lshlrev_b32 v84, 5, v84
    v_add_u32 v5, v83, v84
    v_xor_b32 v84, 2, v82
    v_lshlrev_b32 v84, 5, v84
    v_add_u32 v6, v83, v84
    v_xor_b32 v84, 3, v82
    v_lshlrev_b32 v84, 5, v84
    v_add_u32 v7, v83, v84
    s_and_b32 s78, s73, 15
    s_lshl_b32 s68, s78, 1
    s_add_u32 s68, s68, s63
    s_lshl_b32 s83, s68, 19
    s_lshl_b32 s68, s72, 16
    s_add_u32 s83, s83, s68
    s_lshl_b32 s68, s61, 15
    s_add_u32 s83, s83, s68
    s_lshr_b32 s68, s73, 3
    s_sub_u32 s82, s73, s68
    s_and_b32 s68, s73, 7
    s_cmp_eq_u32 s68, 7
    s_cselect_b32 s82, 99, s82
    s_cbranch_vccnz Lw_4
    s_waitcnt vmcnt(16)
Lw_4:
    s_barrier
    ds_read_b128 v[16:19], v2 offset:0
    ds_read_b128 v[20:23], v2 offset:2048
    ds_read_b64_tr_b16 v[48:49], v4 offset:0
    ds_read_b64_tr_b16 v[50:51], v4 offset:1024
    ds_read_b64_tr_b16 v[52:53], v5 offset:0
    ds_read_b64_tr_b16 v[54:55], v5 offset:1024
    ds_read_b128 v[24:27], v2 offset:4096
    ds_read_b64_tr_b16 v[56:57], v6 offset:0
    ds_read_b64_tr_b16 v[58:59], v6 offset:1024
    ds_read_b128 v[28:31], v2 offset:6144
    ds_read_b64_tr_b16 v[60:61], v7 offset:0
    ds_read_b64_tr_b16 v[62:63], v7 offset:1024
    ds_read_b128 v[32:35], v2 offset:8192
    ds_read_b128 v[36:39], v2 offset:10240
    ds_read_b128 v[40:43], v2 offset:12288
    ds_read_b128 v[44:47], v2 offset:14336
    s_cmp_lt_u32 s73, 16
    s_cbranch_scc0 proj_vpath
    s_add_u32 s52, s42, 20971520
    s_addc_u32 s53, s43, 0
    s_mov_b32 s54, 16777216
    s_and_b32 s53, s53, 0xffff
    s_mov_b32 s55, 0x00020000
    v_and_b32 v80, 15, v1
    v_lshlrev_b32 v80, 8, v80
    v_lshrrev_b32 v81, 4, v1
    v_and_b32 v82, 1, v81
    v_lshlrev_b32 v82, 5, v82
    v_lshrrev_b32 v81, 1, v81
    v_lshlrev_b32 v81, 4, v81
    v_add3_u32 v0, v80, v81, v82
    v_and_b32 v84, 8, v1
    s_mov_b32 s68, 248
    v_mul_lo_u32 v84, v84, s68
    v_sub_u32 v0, v0, v84
    v_add_u32 v14, 2048, v0
    s_lshl_b32 s68, s62, 7
    s_mov_b32 s84, 4096
    s_mov_b32 s85, 4096
    s_add_u32 s83, s83, s68
    s_waitcnt lgkmcnt(4)
    v_mfma_f32_16x16x32_bf16 v[128:131], v[48:51], v[16:19], 0
    v_mfma_f32_16x16x32_bf16 v[132:135], v[52:55], v[16:19], 0
    v_mfma_f32_16x16x32_bf16 v[136:139], v[56:59], v[16:19], 0
    v_mfma_f32_16x16x32_bf16 v[140:143], v[60:63], v[16:19], 0
    ds_read_b128 v[16:19], v3 offset:0
    ds_read_b64_tr_b16 v[64:65], v4 offset:8192
    ds_read_b64_tr_b16 v[66:67], v4 offset:9216
    v_mfma_f32_16x16x32_bf16 v[144:147], v[48:51], v[20:23], 0
    v_mfma_f32_16x16x32_bf16 v[148:151], v[52:55], v[20:23], 0
    v_mfma_f32_16x16x32_bf16 v[152:155], v[56:59], v[20:23], 0
    v_mfma_f32_16x16x32_bf16 v[156:159], v[60:63], v[20:23], 0
    ds_read_b128 v[20:23], v3 offset:2048
    ds_read_b64_tr_b16 v[68:69], v5 offset:8192
    ds_read_b64_tr_b16 v[70:71], v5 offset:9216
    v_mfma_f32_16x16x32_bf16 v[160:163], v[48:51], v[24:27], 0
    v_mfma_f32_16x16x32_bf16 v[164:167], v[52:55], v[24:27], 0
    v_mfma_f32_16x16x32_bf16 v[168:171], v[56:59], v[24:27], 0
    v_mfma_f32_16x16x32_bf16 v[172:175], v[60:63], v[24:27], 0
    ds_read_b128 v[24:27], v3 offset:4096
    ds_read_b64_tr_b16 v[72:73], v6 offset:8192
    ds_read_b64_tr_b16 v[74:75], v6 offset:9216
    v_mfma_f32_16x16x32_bf16 v[176:179], v[48:51], v[28:31], 0
    v_mfma_f32_16x16x32_bf16 v[180:183], v[52:55], v[28:31], 0
    v_mfma_f32_16x16x32_bf16 v[184:187], v[56:59], v[28:31], 0
    v_mfma_f32_16x16x32_bf16 v[188:191], v[60:63], v[28:31], 0
    ds_read_b128 v[28:31], v3 offset:6144
    ds_read_b64_tr_b16 v[76:77], v7 offset:8192
    ds_read_b64_tr_b16 v[78:79], v7 offset:9216
    s_waitcnt lgkmcnt(12)
    v_mfma_f32_16x16x32_bf16 v[192:195], v[48:51], v[32:35], 0
    v_mfma_f32_16x16x32_bf16 v[196:199], v[52:55], v[32:35], 0
    v_mfma_f32_16x16x32_bf16 v[200:203], v[56:59], v[32:35], 0
    v_mfma_f32_16x16x32_bf16 v[204:207], v[60:63], v[32:35], 0
    ds_read_b128 v[32:35], v3 offset:8192
    v_mfma_f32_16x16x32_bf16 v[208:211], v[48:51], v[36:39], 0
    v_mfma_f32_16x16x32_bf16 v[212:215], v[52:55], v[36:39], 0
    v_mfma_f32_16x16x32_bf16 v[216:219], v[56:59], v[36:39], 0
    v_mfma_f32_16x16x32_bf16 v[220:223], v[60:63], v[36:39], 0
    ds_read_b128 v[36:39], v3 offset:10240
    v_mfma_f32_16x16x32_bf16 v[224:227], v[48:51], v[40:43], 0
    v_mfma_f32_16x16x32_bf16 v[228:231], v[52:55], v[40:43], 0
    v_mfma_f32_16x16x32_bf16 v[232:235], v[56:59], v[40:43], 0
    v_mfma_f32_16x16x32_bf16 v[236:239], v[60:63], v[40:43], 0
    ds_read_b128 v[40:43], v3 offset:12288
    v_mfma_f32_16x16x32_bf16 v[240:243], v[48:51], v[44:47], 0
    v_mfma_f32_16x16x32_bf16 v[244:247], v[52:55], v[44:47], 0
    v_mfma_f32_16x16x32_bf16 v[248:251], v[56:59], v[44:47], 0
    v_mfma_f32_16x16x32_bf16 v[252:255], v[60:63], v[44:47], 0
    ds_read_b128 v[44:47], v3 offset:14336
    s_waitcnt lgkmcnt(4)
    v_mfma_f32_16x16x32_bf16 v[128:131], v[64:67], v[16:19], v[128:131]
    v_mfma_f32_16x16x32_bf16 v[132:135], v[68:71], v[16:19], v[132:135]
    v_mfma_f32_16x16x32_bf16 v[136:139], v[72:75], v[16:19], v[136:139]
    v_mfma_f32_16x16x32_bf16 v[140:143], v[76:79], v[16:19], v[140:143]
    v_mfma_f32_16x16x32_bf16 v[144:147], v[64:67], v[20:23], v[144:147]
    v_mfma_f32_16x16x32_bf16 v[148:151], v[68:71], v[20:23], v[148:151]
    v_mfma_f32_16x16x32_bf16 v[152:155], v[72:75], v[20:23], v[152:155]
    v_mfma_f32_16x16x32_bf16 v[156:159], v[76:79], v[20:23], v[156:159]
    s_waitcnt lgkmcnt(0)
    s_cbranch_vccnz Lfw_5
    s_waitcnt vmcnt(0)
Lfw_5:
Lfw_6:
    s_barrier
    ds_read_b128 v[16:19], v2 offset:32768
    ds_read_b128 v[20:23], v2 offset:34816
    ds_read_b64_tr_b16 v[48:49], v4 offset:32768
    ds_read_b64_tr_b16 v[50:51], v4 offset:33792
    ds_read_b64_tr_b16 v[52:53], v5 offset:32768
    ds_read_b64_tr_b16 v[54:55], v5 offset:33792
    v_mfma_f32_16x16x32_bf16 v[160:163], v[64:67], v[24:27], v[160:163]
    v_mfma_f32_16x16x32_bf16 v[164:167], v[68:71], v[24:27], v[164:167]
    v_mfma_f32_16x16x32_bf16 v[168:171], v[72:75], v[24:27], v[168:171]
    v_mfma_f32_16x16x32_bf16 v[172:175], v[76:79], v[24:27], v[172:175]
    ds_read_b128 v[24:27], v2 offset:36864
    ds_read_b64_tr_b16 v[56:57], v6 offset:32768
    ds_read_b64_tr_b16 v[58:59], v6 offset:33792
    s_cbranch_vccnz Lnd_7
    s_add_u32 m0, s81, 0
    s_nop 0
    buffer_load_dwordx4 v8, s[44:47], s64 offen lds
    s_add_u32 m0, s81, 1024
    s_nop 0
    buffer_load_dwordx4 v9, s[44:47], s64 offen lds
Lnd_7:
    v_mfma_f32_16x16x32_bf16 v[176:179], v[64:67], v[28:31], v[176:179]
    v_mfma_f32_16x16x32_bf16 v[180:183], v[68:71], v[28:31], v[180:183]
    v_mfma_f32_16x16x32_bf16 v[184:187], v[72:75], v[28:31], v[184:187]
    v_mfma_f32_16x16x32_bf16 v[188:191], v[76:79], v[28:31], v[188:191]
    ds_read_b128 v[28:31], v2 offset:38912
    ds_read_b64_tr_b16 v[60:61], v7 offset:32768
    ds_read_b64_tr_b16 v[62:63], v7 offset:33792
    s_cbranch_vccnz Lnd_8
    s_add_u32 s68, s64, s4
    s_add_u32 m0, s81, 2048
    s_nop 0
    buffer_load_dwordx4 v8, s[44:47], s68 offen lds
    s_add_u32 s68, s64, s4
    s_add_u32 m0, s81, 3072
    s_nop 0
    buffer_load_dwordx4 v9, s[44:47], s68 offen lds
Lnd_8:
    v_mfma_f32_16x16x32_bf16 v[192:195], v[64:67], v[32:35], v[192:195]
    v_mfma_f32_16x16x32_bf16 v[196:199], v[68:71], v[32:35], v[196:199]
    v_mfma_f32_16x16x32_bf16 v[200:203], v[72:75], v[32:35], v[200:203]
    v_mfma_f32_16x16x32_bf16 v[204:207], v[76:79], v[32:35], v[204:207]
    ds_read_b128 v[32:35], v2 offset:40960
    s_cbranch_vccnz Lnd_9
    s_add_u32 m0, s81, 16384
    s_nop 0
    buffer_load_dwordx4 v8, s[44:47], s65 offen lds
    s_add_u32 m0, s81, 17408
    s_nop 0
    buffer_load_dwordx4 v9, s[44:47], s65 offen lds
    s_add_u32 s68, s65, s4
    s_add_u32 m0, s81, 18432
    s_nop 0
    buffer_load_dwordx4 v8, s[44:47], s68 offen lds
Lnd_9:
    v_mfma_f32_16x16x32_bf16 v[208:211], v[64:67], v[36:39], v[208:211]
    v_mfma_f32_16x16x32_bf16 v[212:215], v[68:71], v[36:39], v[212:215]
    v_mfma_f32_16x16x32_bf16 v[216:219], v[72:75], v[36:39], v[216:219]
    v_mfma_f32_16x16x32_bf16 v[220:223], v[76:79], v[36:39], v[220:223]
    ds_read_b128 v[36:39], v2 offset:43008
    s_cbranch_vccnz Lnd_10
    s_add_u32 s68, s65, s4
    s_add_u32 m0, s81, 19456
    s_nop 0
    buffer_load_dwordx4 v9, s[44:47], s68 offen lds
    s_add_u32 m0, s81, 65536
    s_nop 0
    buffer_load_dwordx4 v10, s[48:51], s66 offen lds
    s_add_u32 s68, s66, s5
    s_add_u32 m0, s81, 66560
    s_nop 0
    buffer_load_dwordx4 v10, s[48:51], s68 offen lds
Lnd_10:
    v_mfma_f32_16x16x32_bf16 v[224:227], v[64:67], v[40:43], v[224:227]
    v_mfma_f32_16x16x32_bf16 v[228:231], v[68:71], v[40:43], v[228:231]
    v_mfma_f32_16x16x32_bf16 v[232:235], v[72:75], v[40:43], v[232:235]
    v_mfma_f32_16x16x32_bf16 v[236:239], v[76:79], v[40:43], v[236:239]
    ds_read_b128 v[40:43], v2 offset:45056
    s_cbranch_vccnz Lnd_11
    s_add_u32 m0, s81, 67584
    s_nop 0
    buffer_load_dwordx4 v11, s[48:51], s66 offen lds
    s_add_u32 s68, s66, s5
    s_add_u32 m0, s81, 68608
    s_nop 0
    buffer_load_dwordx4 v11, s[48:51], s68 offen lds
    s_add_u32 m0, s81, 81920
    s_nop 0
    buffer_load_dwordx4 v12, s[96:99], s67 offen lds
Lnd_11:
    v_mfma_f32_16x16x32_bf16 v[240:243], v[64:67], v[44:47], v[240:243]
    v_mfma_f32_16x16x32_bf16 v[244:247], v[68:71], v[44:47], v[244:247]
    v_mfma_f32_16x16x32_bf16 v[248:251], v[72:75], v[44:47], v[248:251]
    v_mfma_f32_16x16x32_bf16 v[252:255], v[76:79], v[44:47], v[252:255]
    ds_read_b128 v[44:47], v2 offset:47104
    s_cbranch_vccnz Lnd_12
    s_add_u32 s68, s67, s6
    s_add_u32 m0, s81, 82944
    s_nop 0
    buffer_load_dwordx4 v12, s[96:99], s68 offen lds
    s_add_u32 m0, s81, 83968
    s_nop 0
    buffer_load_dwordx4 v13, s[96:99], s67 offen lds
    s_add_u32 s68, s67, s6
    s_add_u32 m0, s81, 84992
    s_nop 0
    buffer_load_dwordx4 v13, s[96:99], s68 offen lds
Lnd_12:
    s_add_u32 s64, s64, 128
    s_add_u32 s65, s65, 128
    s_add_u32 s66, s66, s7
    s_add_u32 s67, s67, s8
    v_mov_b32 v122, 0
    s_cmp_lg_u32 s60, 0
    s_cbranch_scc1 Lnw0_13
    s_add_u32 s56, s40, 0
    s_addc_u32 s57, s41, 0
    s_mov_b32 s58, 256
    s_and_b32 s57, s57, 0xffff
    s_mov_b32 s59, 0x00020000
    buffer_load_dwordx2 v[124:125], v122, s[56:59], 0 offen sc0 sc1
Lnw0_13:
    s_waitcnt lgkmcnt(4)
    v_mfma_f32_16x16x32_bf16 v[128:131], v[48:51], v[16:19], v[128:131]
    v_mfma_f32_16x16x32_bf16 v[132:135], v[52:55], v[16:19], v[132:135]
    v_mfma_f32_16x16x32_bf16 v[136:139], v[56:59], v[16:19], v[136:139]
    v_mfma_f32_16x16x32_bf16 v[140:143], v[60:63], v[16:19], v[140:143]
    ds_read_b128 v[16:19], v3 offset:32768
    ds_read_b64_tr_b16 v[64:65], v4 offset:40960
    ds_read_b64_tr_b16 v[66:67], v4 offset:41984
    v_mfma_f32_16x16x32_bf16 v[144:147], v[48:51], v[20:23], v[144:147]
    v_mfma_f32_16x16x32_bf16 v[148:151], v[52:55], v[20:23], v[148:151]
    v_mfma_f32_16x16x32_bf16 v[152:155], v[56:59], v[20:23], v[152:155]
    v_mfma_f32_16x16x32_bf16 v[156:159], v[60:63], v[20:23], v[156:159]
    ds_read_b128 v[20:23], v3 offset:34816
    ds_read_b64_tr_b16 v[68:69], v5 offset:40960
    ds_read_b64_tr_b16 v[70:71], v5 offset:41984
    v_mfma_f32_16x16x32_bf16 v[160:163], v[48:51], v[24:27], v[160:163]
    v_mfma_f32_16x16x32_bf16 v[164:167], v[52:55], v[24:27], v[164:167]
    v_mfma_f32_16x16x32_bf16 v[168:171], v[56:59], v[24:27], v[168:171]
    v_mfma_f32_16x16x32_bf16 v[172:175], v[60:63], v[24:27], v[172:175]
    ds_read_b128 v[24:27], v3 offset:36864
    ds_read_b64_tr_b16 v[72:73], v6 offset:40960
    ds_read_b64_tr_b16 v[74:75], v6 offset:41984
    v_mfma_f32_16x16x32_bf16 v[176:179], v[48:51], v[28:31], v[176:179]
    v_mfma_f32_16x16x32_bf16 v[180:183], v[52:55], v[28:31], v[180:183]
    v_mfma_f32_16x16x32_bf16 v[184:187], v[56:59], v[28:31], v[184:187]
    v_mfma_f32_16x16x32_bf16 v[188:191], v[60:63], v[28:31], v[188:191]
    ds_read_b128 v[28:31], v3 offset:38912
    ds_read_b64_tr_b16 v[76:77], v7 offset:40960
    ds_read_b64_tr_b16 v[78:79], v7 offset:41984
    s_waitcnt lgkmcnt(12)
    v_mfma_f32_16x16x32_bf16 v[192:195], v[48:51], v[32:35], v[192:195]
    v_mfma_f32_16x16x32_bf16 v[196:199], v[52:55], v[32:35], v[196:199]
    v_mfma_f32_16x16x32_bf16 v[200:203], v[56:59], v[32:35], v[200:203]
    v_mfma_f32_16x16x32_bf16 v[204:207], v[60:63], v[32:35], v[204:207]
    ds_read_b128 v[32:35], v3 offset:40960
    v_mfma_f32_16x16x32_bf16 v[208:211], v[48:51], v[36:39], v[208:211]
    v_mfma_f32_16x16x32_bf16 v[212:215], v[52:55], v[36:39], v[212:215]
    v_mfma_f32_16x16x32_bf16 v[216:219], v[56:59], v[36:39], v[216:219]
    v_mfma_f32_16x16x32_bf16 v[220:223], v[60:63], v[36:39], v[220:223]
    ds_read_b128 v[36:39], v3 offset:43008
    v_mfma_f32_16x16x32_bf16 v[224:227], v[48:51], v[40:43], v[224:227]
    v_mfma_f32_16x16x32_bf16 v[228:231], v[52:55], v[40:43], v[228:231]
    v_mfma_f32_16x16x32_bf16 v[232:235], v[56:59], v[40:43], v[232:235]
    v_mfma_f32_16x16x32_bf16 v[236:239], v[60:63], v[40:43], v[236:239]
    ds_read_b128 v[40:43], v3 offset:45056
    v_mfma_f32_16x16x32_bf16 v[240:243], v[48:51], v[44:47], v[240:243]
    v_mfma_f32_16x16x32_bf16 v[244:247], v[52:55], v[44:47], v[244:247]
    v_mfma_f32_16x16x32_bf16 v[248:251], v[56:59], v[44:47], v[248:251]
    v_mfma_f32_16x16x32_bf16 v[252:255], v[60:63], v[44:47], v[252:255]
    ds_read_b128 v[44:47], v3 offset:47104
    s_waitcnt lgkmcnt(4)
    v_mfma_f32_16x16x32_bf16 v[128:131], v[64:67], v[16:19], v[128:131]
    v_mfma_f32_16x16x32_bf16 v[132:135], v[68:71], v[16:19], v[132:135]
    v_mfma_f32_16x16x32_bf16 v[136:139], v[72:75], v[16:19], v[136:139]
    v_mfma_f32_16x16x32_bf16 v[140:143], v[76:79], v[16:19], v[140:143]
    v_mfma_f32_16x16x32_bf16 v[144:147], v[64:67], v[20:23], v[144:147]
    v_mfma_f32_16x16x32_bf16 v[148:151], v[68:71], v[20:23], v[148:151]
    v_mfma_f32_16x16x32_bf16 v[152:155], v[72:75], v[20:23], v[152:155]
    v_mfma_f32_16x16x32_bf16 v[156:159], v[76:79], v[20:23], v[156:159]
    s_waitcnt lgkmcnt(0)
    s_cbranch_vccnz Lfw_14
    s_waitcnt vmcnt(0)
Lfw_14:
Lfw_15:
    s_barrier
    ds_read_b128 v[16:19], v2 offset:0
    ds_read_b128 v[20:23], v2 offset:2048
    ds_read_b64_tr_b16 v[48:49], v4 offset:0
    ds_read_b64_tr_b16 v[50:51], v4 offset:1024
    ds_read_b64_tr_b16 v[52:53], v5 offset:0
    ds_read_b64_tr_b16 v[54:55], v5 offset:1024
    v_mfma_f32_16x16x32_bf16 v[160:163], v[64:67], v[24:27], v[160:163]
    v_mfma_f32_16x16x32_bf16 v[164:167], v[68:71], v[24:27], v[164:167]
    v_mfma_f32_16x16x32_bf16 v[168:171], v[72:75], v[24:27], v[168:171]
    v_mfma_f32_16x16x32_bf16 v[172:175], v[76:79], v[24:27], v[172:175]
    ds_read_b128 v[24:27], v2 offset:4096
    ds_read_b64_tr_b16 v[56:57], v6 offset:0
    ds_read_b64_tr_b16 v[58:59], v6 offset:1024
    s_cbranch_vccnz Lnd_16
    s_add_u32 m0, s81, 32768
    s_nop 0
    buffer_load_dwordx4 v8, s[44:47], s64 offen lds
    s_add_u32 m0, s81, 33792
    s_nop 0
    buffer_load_dwordx4 v9, s[44:47], s64 offen lds
    s_branch Lne_17
Lnd_16:
    s_waitcnt vmcnt(0)
    v_lshlrev_b32 v80, 16, v104
    v_and_b32 v81, 0xffff0000, v104
    v_lshlrev_b32 v82, 16, v105
    v_and_b32 v83, 0xffff0000, v105
    v_lshlrev_b32 v84, 16, v106
    v_and_b32 v85, 0xffff0000, v106
    v_lshlrev_b32 v86, 16, v107
    v_and_b32 v87, 0xffff0000, v107
    v_lshlrev_b32 v88, 16, v108
    v_and_b32 v89, 0xffff0000, v108
    v_lshlrev_b32 v90, 16, v109
    v_and_b32 v91, 0xffff0000, v109
    v_lshlrev_b32 v92, 16, v110
    v_and_b32 v93, 0xffff0000, v110
    v_lshlrev_b32 v94, 16, v111
    v_and_b32 v95, 0xffff0000, v111
    v_add_f32 v96, v80, v81
    v_add_f32 v96, v96, v82
    v_add_f32 v96, v96, v83
    v_add_f32 v96, v96, v84
    v_add_f32 v96, v96, v85
    v_add_f32 v96, v96, v86
    v_add_f32 v96, v96, v87
    v_add_f32 v96, v96, v88
    v_add_f32 v96, v96, v89
    v_add_f32 v96, v96, v90
    v_add_f32 v96, v96, v91
    v_add_f32 v96, v96, v92
    v_add_f32 v96, v96, v93
    v_add_f32 v96, v96, v94
    v_add_f32 v96, v96, v95
    s_nop 1
    v_add_f32_dpp v96, v96, v96 quad_perm:[1,0,3,2] row_mask:0xf bank_mask:0xf
    s_nop 1
    v_add_f32_dpp v96, v96, v96 quad_perm:[2,3,0,1] row_mask:0xf bank_mask:0xf
Lne_17:
    v_mfma_f32_16x16x32_bf16 v[176:179], v[64:67], v[28:31], v[176:179]
    v_mfma_f32_16x16x32_bf16 v[180:183], v[68:71], v[28:31], v[180:183]
    v_mfma_f32_16x16x32_bf16 v[184:187], v[72:75], v[28:31], v[184:187]
    v_mfma_f32_16x16x32_bf16 v[188:191], v[76:79], v[28:31], v[188:191]
    ds_read_b128 v[28:31], v2 offset:6144
    ds_read_b64_tr_b16 v[60:61], v7 offset:0
    ds_read_b64_tr_b16 v[62:63], v7 offset:1024
    s_cbranch_vccnz Lnd_18
    s_add_u32 s68, s64, s4
    s_add_u32 m0, s81, 34816
    s_nop 0
    buffer_load_dwordx4 v8, s[44:47], s68 offen lds
    s_add_u32 s68, s64, s4
    s_add_u32 m0, s81, 35840
    s_nop 0
    buffer_load_dwordx4 v9, s[44:47], s68 offen lds
    s_branch Lne_19
Lnd_18:
    s_nop 1
    v_add_f32_dpp v96, v96, v96 row_half_mirror row_mask:0xf bank_mask:0xf
    s_nop 1
    v_add_f32_dpp v96, v96, v96 row_mirror row_mask:0xf bank_mask:0xf
    s_nop 1
    v_readlane_b32 s76, v96, 0
    v_readlane_b32 s77, v96, 16
    v_readlane_b32 s78, v96, 32
    v_readlane_b32 s79, v96, 48
    s_nop 2
    v_mov_b32 v96, s76
    v_add_f32 v96, s77, v96
    v_add_f32 v96, s78, v96
    v_add_f32 v96, s79, v96
    v_mul_f32 v97, 0x3a800000, v96
    v_mov_b32 v98, 0
    v_sub_f32 v99, v80, v97
    v_fmac_f32 v98, v99, v99
    v_sub_f32 v99, v81, v97
    v_fmac_f32 v98, v99, v99
    v_sub_f32 v99, v82, v97
    v_fmac_f32 v98, v99, v99
    v_sub_f32 v99, v83, v97
    v_fmac_f32 v98, v99, v99
    v_sub_f32 v99, v84, v97
    v_fmac_f32 v98, v99, v99
    v_sub_f32 v99, v85, v97
    v_fmac_f32 v98, v99, v99
    v_sub_f32 v99, v86, v97
    v_fmac_f32 v98, v99, v99
    v_sub_f32 v99, v87, v97
    v_fmac_f32 v98, v99, v99
    v_sub_f32 v99, v88, v97
    v_fmac_f32 v98, v99, v99
    v_sub_f32 v99, v89, v97
    v_fmac_f32 v98, v99, v99
    v_sub_f32 v99, v90, v97
Lne_19:
    v_mfma_f32_16x16x32_bf16 v[192:195], v[64:67], v[32:35], v[192:195]
    v_mfma_f32_16x16x32_bf16 v[196:199], v[68:71], v[32:35], v[196:199]
    v_mfma_f32_16x16x32_bf16 v[200:203], v[72:75], v[32:35], v[200:203]
    v_mfma_f32_16x16x32_bf16 v[204:207], v[76:79], v[32:35], v[204:207]
    ds_read_b128 v[32:35], v2 offset:8192
    s_cbranch_vccnz Lnd_20
    s_add_u32 m0, s81, 49152
    s_nop 0
    buffer_load_dwordx4 v8, s[44:47], s65 offen lds
    s_add_u32 m0, s81, 50176
    s_nop 0
    buffer_load_dwordx4 v9, s[44:47], s65 offen lds
    s_add_u32 s68, s65, s4
    s_add_u32 m0, s81, 51200
    s_nop 0
    buffer_load_dwordx4 v8, s[44:47], s68 offen lds
    s_branch Lne_21
Lnd_20:
    v_fmac_f32 v98, v99, v99
    v_sub_f32 v99, v91, v97
    v_fmac_f32 v98, v99, v99
    v_sub_f32 v99, v92, v97
    v_fmac_f32 v98, v99, v99
    v_sub_f32 v99, v93, v97
    v_fmac_f32 v98, v99, v99
    v_sub_f32 v99, v94, v97
    v_fmac_f32 v98, v99, v99
    v_sub_f32 v99, v95, v97
    v_fmac_f32 v98, v99, v99
    s_nop 1
    v_add_f32_dpp v98, v98, v98 quad_perm:[1,0,3,2] row_mask:0xf bank_mask:0xf
    s_nop 1
    v_add_f32_dpp v98, v98, v98 quad_perm:[2,3,0,1] row_mask:0xf bank_mask:0xf
    s_nop 1
    v_add_f32_dpp v98, v98, v98 row_half_mirror row_mask:0xf bank_mask:0xf
    s_nop 1
    v_add_f32_dpp v98, v98, v98 row_mirror row_mask:0xf bank_mask:0xf
    s_nop 1
    v_readlane_b32 s76, v98, 0
    v_readlane_b32 s77, v98, 16
    v_readlane_b32 s78, v98, 32
    v_readlane_b32 s79, v98, 48
    s_nop 2
    v_mov_b32 v98, s76
    v_add_f32 v98, s77, v98
    v_add_f32 v98, s78, v98
    v_add_f32 v98, s79, v98
    v_mul_f32 v98, 0x3a800000, v98
    v_cvt_pk_bf16_f32 v97, v97, v97
    v_lshlrev_b32 v97, 16, v97
    v_cvt_pk_bf16_f32 v98, v98, v98
    v_lshlrev_b32 v98, 16, v98
    v_add_f32 v98, 0x3727c5ac, v98
    v_cvt_pk_bf16_f32 v98, v98, v98
Lne_21:
    v_mfma_f32_16x16x32_bf16 v[208:211], v[64:67], v[36:39], v[208:211]
    v_mfma_f32_16x16x32_bf16 v[212:215], v[68:71], v[36:39], v[212:215]
    v_mfma_f32_16x16x32_bf16 v[216:219], v[72:75], v[36:39], v[216:219]
    v_mfma_f32_16x16x32_bf16 v[220:223], v[76:79], v[36:39], v[220:223]
    ds_read_b128 v[36:39], v2 offset:10240
    s_cbranch_vccnz Lnd_22
    s_add_u32 s68, s65, s4
    s_add_u32 m0, s81, 52224
    s_nop 0
    buffer_load_dwordx4 v9, s[44:47], s68 offen lds
    s_add_u32 m0, s81, 98304
    s_nop 0
    buffer_load_dwordx4 v10, s[48:51], s66 offen lds
    s_add_u32 s68, s66, s5
    s_add_u32 m0, s81, 99328
    s_nop 0
    buffer_load_dwordx4 v10, s[48:51], s68 offen lds
    s_branch Lne_23
Lnd_22:
    v_lshlrev_b32 v98, 16, v98
    v_sqrt_f32 v98, v98
    s_nop 0
    v_cvt_pk_bf16_f32 v98, v98, v98
    v_lshlrev_b32 v98, 16, v98
    v_rcp_f32 v96, v98
    s_nop 0
    v_sub_f32 v80, v80, v97
    v_sub_f32 v81, v81, v97
    v_cvt_pk_bf16_f32 v99, v80, v81
    v_lshlrev_b32 v80, 16, v99
    v_and_b32 v81, 0xffff0000, v99
    v_mul_f32 v99, v80, v96
    v_fma_f32 v80, -v99, v98, v80
    v_fma_f32 v80, v80, v96, v99
    v_mul_f32 v99, v81, v96
    v_fma_f32 v81, -v99, v98, v81
    v_fma_f32 v81, v81, v96, v99
    v_sub_f32 v82, v82, v97
    v_sub_f32 v83, v83, v97
    v_cvt_pk_bf16_f32 v99, v82, v83
    v_lshlrev_b32 v82, 16, v99
    v_and_b32 v83, 0xffff0000, v99
    v_mul_f32 v99, v82, v96
    v_fma_f32 v82, -v99, v98, v82
    v_fma_f32 v82, v82, v96, v99
    v_mul_f32 v99, v83, v96
    v_fma_f32 v83, -v99, v98, v83
    v_fma_f32 v83, v83, v96, v99
    v_sub_f32 v84, v84, v97
    v_sub_f32 v85, v85, v97
    v_cvt_pk_bf16_f32 v99, v84, v85
    v_lshlrev_b32 v84, 16, v99
    v_and_b32 v85, 0xffff0000, v99
    v_mul_f32 v99, v84, v96
    v_fma_f32 v84, -v99, v98, v84
    v_fma_f32 v84, v84, v96, v99
Lne_23:
    v_mfma_f32_16x16x32_bf16 v[224:227], v[64:67], v[40:43], v[224:227]
    v_mfma_f32_16x16x32_bf16 v[228:231], v[68:71], v[40:43], v[228:231]
    v_mfma_f32_16x16x32_bf16 v[232:235], v[72:75], v[40:43], v[232:235]
    v_mfma_f32_16x16x32_bf16 v[236:239], v[76:79], v[40:43], v[236:239]
    ds_read_b128 v[40:43], v2 offset:12288
    s_cbranch_vccnz Lnd_24
    s_add_u32 m0, s81, 100352
    s_nop 0
    buffer_load_dwordx4 v11, s[48:51], s66 offen lds
    s_add_u32 s68, s66, s5
    s_add_u32 m0, s81, 101376
    s_nop 0
    buffer_load_dwordx4 v11, s[48:51], s68 offen lds
    s_add_u32 m0, s81, 114688
    s_nop 0
    buffer_load_dwordx4 v12, s[96:99], s67 offen lds
    s_branch Lne_25
Lnd_24:
    v_mul_f32 v99, v85, v96
    v_fma_f32 v85, -v99, v98, v85
    v_fma_f32 v85, v85, v96, v99
    v_sub_f32 v86, v86, v97
    v_sub_f32 v87, v87, v97
    v_cvt_pk_bf16_f32 v99, v86, v87
    v_lshlrev_b32 v86, 16, v99
    v_and_b32 v87, 0xffff0000, v99
    v_mul_f32 v99, v86, v96
    v_fma_f32 v86, -v99, v98, v86
    v_fma_f32 v86, v86, v96, v99
    v_mul_f32 v99, v87, v96
    v_fma_f32 v87, -v99, v98, v87
    v_fma_f32 v87, v87, v96, v99
    v_sub_f32 v88, v88, v97
    v_sub_f32 v89, v89, v97
    v_cvt_pk_bf16_f32 v99, v88, v89
    v_lshlrev_b32 v88, 16, v99
    v_and_b32 v89, 0xffff0000, v99
    v_mul_f32 v99, v88, v96
    v_fma_f32 v88, -v99, v98, v88
    v_fma_f32 v88, v88, v96, v99
    v_mul_f32 v99, v89, v96
    v_fma_f32 v89, -v99, v98, v89
    v_fma_f32 v89, v89, v96, v99
    v_sub_f32 v90, v90, v97
    v_sub_f32 v91, v91, v97
    v_cvt_pk_bf16_f32 v99, v90, v91
    v_lshlrev_b32 v90, 16, v99
    v_and_b32 v91, 0xffff0000, v99
    v_mul_f32 v99, v90, v96
    v_fma_f32 v90, -v99, v98, v90
    v_fma_f32 v90, v90, v96, v99
    v_mul_f32 v99, v91, v96
    v_fma_f32 v91, -v99, v98, v91
    v_fma_f32 v91, v91, v96, v99
Lne_25:
    v_mfma_f32_16x16x32_bf16 v[240:243], v[64:67], v[44:47], v[240:243]
    v_mfma_f32_16x16x32_bf16 v[244:247], v[68:71], v[44:47], v[244:247]
    v_mfma_f32_16x16x32_bf16 v[248:251], v[72:75], v[44:47], v[248:251]
    v_mfma_f32_16x16x32_bf16 v[252:255], v[76:79], v[44:47], v[252:255]
    ds_read_b128 v[44:47], v2 offset:14336
    s_cbranch_vccnz Lnd_26
    s_add_u32 s68, s67, s6
    s_add_u32 m0, s81, 115712
    s_nop 0
    buffer_load_dwordx4 v12, s[96:99], s68 offen lds
    s_add_u32 m0, s81, 116736
    s_nop 0
    buffer_load_dwordx4 v13, s[96:99], s67 offen lds
    s_add_u32 s68, s67, s6
    s_add_u32 m0, s81, 117760
    s_nop 0
    buffer_load_dwordx4 v13, s[96:99], s68 offen lds
    s_branch Lne_27
Lnd_26:
    v_sub_f32 v92, v92, v97
    v_sub_f32 v93, v93, v97
    v_cvt_pk_bf16_f32 v99, v92, v93
    v_lshlrev_b32 v92, 16, v99
    v_and_b32 v93, 0xffff0000, v99
    v_mul_f32 v99, v92, v96
    v_fma_f32 v92, -v99, v98, v92
    v_fma_f32 v92, v92, v96, v99
    v_mul_f32 v99, v93, v96
    v_fma_f32 v93, -v99, v98, v93
    v_fma_f32 v93, v93, v96, v99
    v_sub_f32 v94, v94, v97
    v_sub_f32 v95, v95, v97
    v_cvt_pk_bf16_f32 v99, v94, v95
    v_lshlrev_b32 v94, 16, v99
    v_and_b32 v95, 0xffff0000, v99
    v_mul_f32 v99, v94, v96
    v_fma_f32 v94, -v99, v98, v94
    v_fma_f32 v94, v94, v96, v99
    v_mul_f32 v99, v95, v96
    v_fma_f32 v95, -v99, v98, v95
    v_fma_f32 v95, v95, v96, v99
    v_cvt_pk_bf16_f32 v104, v80, v81
    v_cvt_pk_bf16_f32 v105, v82, v83
    v_cvt_pk_bf16_f32 v106, v84, v85
    v_cvt_pk_bf16_f32 v107, v86, v87
    v_cvt_pk_bf16_f32 v108, v88, v89
    v_cvt_pk_bf16_f32 v109, v90, v91
    v_cvt_pk_bf16_f32 v110, v92, v93
    v_cvt_pk_bf16_f32 v111, v94, v95
    s_add_u32 s56, s42, 220200960
    s_addc_u32 s57, s43, 0
    s_mov_b32 s58, 4456448
    s_and_b32 s57, s57, 0xffff
    s_mov_b32 s59, 0x00020000
    buffer_store_dwordx4 v[104:107], v120, s[56:59], s10 offen sc0 sc1
    buffer_store_dwordx4 v[108:111], v120, s[56:59], s10 offen offset:1024 sc0 sc1
Lne_27:
    s_add_u32 s64, s64, 128
    s_add_u32 s65, s65, 128
    s_add_u32 s66, s66, s7
    s_add_u32 s67, s67, s8
    s_cbranch_vccz Lnofp_28
    s_add_u32 s56, s20, 0
    s_addc_u32 s57, s21, 0
    s_mov_b32 s58, 8388608
    s_and_b32 s57, s57, 0xffff
    s_mov_b32 s59, 0x00020000
    s_mul_i32 s68, s9, 8
    s_add_u32 s69, s68, 4096
    buffer_load_dwordx4 v[100:103], v120, s[56:59], s68 offen offset:0
    buffer_load_dwordx4 v[100:103], v120, s[56:59], s68 offen offset:1024
    buffer_load_dwordx4 v[100:103], v120, s[56:59], s68 offen offset:2048
    buffer_load_dwordx4 v[100:103], v120, s[56:59], s68 offen offset:3072
Lnofp_28:
    s_waitcnt lgkmcnt(4)
    v_mfma_f32_16x16x32_bf16 v[128:131], v[48:51], v[16:19], v[128:131]
    v_mfma_f32_16x16x32_bf16 v[132:135], v[52:55], v[16:19], v[132:135]
    v_mfma_f32_16x16x32_bf16 v[136:139], v[56:59], v[16:19], v[136:139]
    v_mfma_f32_16x16x32_bf16 v[140:143], v[60:63], v[16:19], v[140:143]
    ds_read_b128 v[16:19], v3 offset:0
    ds_read_b64_tr_b16 v[64:65], v4 offset:8192
    ds_read_b64_tr_b16 v[66:67], v4 offset:9216
    v_mfma_f32_16x16x32_bf16 v[144:147], v[48:51], v[20:23], v[144:147]
    v_mfma_f32_16x16x32_bf16 v[148:151], v[52:55], v[20:23], v[148:151]
    v_mfma_f32_16x16x32_bf16 v[152:155], v[56:59], v[20:23], v[152:155]
    v_mfma_f32_16x16x32_bf16 v[156:159], v[60:63], v[20:23], v[156:159]
    ds_read_b128 v[20:23], v3 offset:2048
    ds_read_b64_tr_b16 v[68:69], v5 offset:8192
    ds_read_b64_tr_b16 v[70:71], v5 offset:9216
    v_mfma_f32_16x16x32_bf16 v[160:163], v[48:51], v[24:27], v[160:163]
    v_mfma_f32_16x16x32_bf16 v[164:167], v[52:55], v[24:27], v[164:167]
    v_mfma_f32_16x16x32_bf16 v[168:171], v[56:59], v[24:27], v[168:171]
    v_mfma_f32_16x16x32_bf16 v[172:175], v[60:63], v[24:27], v[172:175]
    ds_read_b128 v[24:27], v3 offset:4096
    ds_read_b64_tr_b16 v[72:73], v6 offset:8192
    ds_read_b64_tr_b16 v[74:75], v6 offset:9216
    v_mfma_f32_16x16x32_bf16 v[176:179], v[48:51], v[28:31], v[176:179]
    v_mfma_f32_16x16x32_bf16 v[180:183], v[52:55], v[28:31], v[180:183]
    v_mfma_f32_16x16x32_bf16 v[184:187], v[56:59], v[28:31], v[184:187]
    v_mfma_f32_16x16x32_bf16 v[188:191], v[60:63], v[28:31], v[188:191]
    ds_read_b128 v[28:31], v3 offset:6144
    ds_read_b64_tr_b16 v[76:77], v7 offset:8192
    ds_read_b64_tr_b16 v[78:79], v7 offset:9216
    s_waitcnt lgkmcnt(12)
    v_mfma_f32_16x16x32_bf16 v[192:195], v[48:51], v[32:35], v[192:195]
    v_mfma_f32_16x16x32_bf16 v[196:199], v[52:55], v[32:35], v[196:199]
    v_mfma_f32_16x16x32_bf16 v[200:203], v[56:59], v[32:35], v[200:203]
    v_mfma_f32_16x16x32_bf16 v[204:207], v[60:63], v[32:35], v[204:207]
    ds_read_b128 v[32:35], v3 offset:8192
    v_mfma_f32_16x16x32_bf16 v[208:211], v[48:51], v[36:39], v[208:211]
    v_mfma_f32_16x16x32_bf16 v[212:215], v[52:55], v[36:39], v[212:215]
    v_mfma_f32_16x16x32_bf16 v[216:219], v[56:59], v[36:39], v[216:219]
    v_mfma_f32_16x16x32_bf16 v[220:223], v[60:63], v[36:39], v[220:223]
    ds_read_b128 v[36:39], v3 offset:10240
    v_mfma_f32_16x16x32_bf16 v[224:227], v[48:51], v[40:43], v[224:227]
    v_mfma_f32_16x16x32_bf16 v[228:231], v[52:55], v[40:43], v[228:231]
    v_mfma_f32_16x16x32_bf16 v[232:235], v[56:59], v[40:43], v[232:235]
    v_mfma_f32_16x16x32_bf16 v[236:239], v[60:63], v[40:43], v[236:239]
    ds_read_b128 v[40:43], v3 offset:12288
    v_mfma_f32_16x16x32_bf16 v[240:243], v[48:51], v[44:47], v[240:243]
    v_mfma_f32_16x16x32_bf16 v[244:247], v[52:55], v[44:47], v[244:247]
    v_mfma_f32_16x16x32_bf16 v[248:251], v[56:59], v[44:47], v[248:251]
    v_mfma_f32_16x16x32_bf16 v[252:255], v[60:63], v[44:47], v[252:255]
    ds_read_b128 v[44:47], v3 offset:14336
    s_waitcnt lgkmcnt(4)
    v_mfma_f32_16x16x32_bf16 v[128:131], v[64:67], v[16:19], v[128:131]
    v_mfma_f32_16x16x32_bf16 v[132:135], v[68:71], v[16:19], v[132:135]
    v_mfma_f32_16x16x32_bf16 v[136:139], v[72:75], v[16:19], v[136:139]
    v_mfma_f32_16x16x32_bf16 v[140:143], v[76:79], v[16:19], v[140:143]
    v_mfma_f32_16x16x32_bf16 v[144:147], v[64:67], v[20:23], v[144:147]
    v_mfma_f32_16x16x32_bf16 v[148:151], v[68:71], v[20:23], v[148:151]
    v_mfma_f32_16x16x32_bf16 v[152:155], v[72:75], v[20:23], v[152:155]
    v_mfma_f32_16x16x32_bf16 v[156:159], v[76:79], v[20:23], v[156:159]
    s_waitcnt lgkmcnt(0)
    s_cbranch_vccnz Lfw_29
    s_waitcnt vmcnt(0)
Lfw_29:
Lfw_30:
    s_barrier
    ds_read_b128 v[16:19], v2 offset:32768
    ds_read_b128 v[20:23], v2 offset:34816
    ds_read_b64_tr_b16 v[48:49], v4 offset:32768
    ds_read_b64_tr_b16 v[50:51], v4 offset:33792
    ds_read_b64_tr_b16 v[52:53], v5 offset:32768
    ds_read_b64_tr_b16 v[54:55], v5 offset:33792
    v_mfma_f32_16x16x32_bf16 v[160:163], v[64:67], v[24:27], v[160:163]
    v_mfma_f32_16x16x32_bf16 v[164:167], v[68:71], v[24:27], v[164:167]
    v_mfma_f32_16x16x32_bf16 v[168:171], v[72:75], v[24:27], v[168:171]
    v_mfma_f32_16x16x32_bf16 v[172:175], v[76:79], v[24:27], v[172:175]
    ds_read_b128 v[24:27], v2 offset:36864
    ds_read_b64_tr_b16 v[56:57], v6 offset:32768
    ds_read_b64_tr_b16 v[58:59], v6 offset:33792
    s_cbranch_vccnz Lnd_31
    s_add_u32 m0, s81, 0
    s_nop 0
    buffer_load_dwordx4 v8, s[44:47], s64 offen lds
    s_add_u32 m0, s81, 1024
    s_nop 0
    buffer_load_dwordx4 v9, s[44:47], s64 offen lds
    s_branch Lne_32
Lnd_31:
    v_lshlrev_b32 v80, 16, v112
    v_and_b32 v81, 0xffff0000, v112
    v_lshlrev_b32 v82, 16, v113
    v_and_b32 v83, 0xffff0000, v113
    v_lshlrev_b32 v84, 16, v114
    v_and_b32 v85, 0xffff0000, v114
    v_lshlrev_b32 v86, 16, v115
    v_and_b32 v87, 0xffff0000, v115
    v_lshlrev_b32 v88, 16, v116
    v_and_b32 v89, 0xffff0000, v116
    v_lshlrev_b32 v90, 16, v117
    v_and_b32 v91, 0xffff0000, v117
    v_lshlrev_b32 v92, 16, v118
    v_and_b32 v93, 0xffff0000, v118
    v_lshlrev_b32 v94, 16, v119
    v_and_b32 v95, 0xffff0000, v119
    v_add_f32 v96, v80, v81
    v_add_f32 v96, v96, v82
    v_add_f32 v96, v96, v83
    v_add_f32 v96, v96, v84
    v_add_f32 v96, v96, v85
    v_add_f32 v96, v96, v86
    v_add_f32 v96, v96, v87
    v_add_f32 v96, v96, v88
    v_add_f32 v96, v96, v89
    v_add_f32 v96, v96, v90
    v_add_f32 v96, v96, v91
    v_add_f32 v96, v96, v92
    v_add_f32 v96, v96, v93
    v_add_f32 v96, v96, v94
    v_add_f32 v96, v96, v95
    s_nop 1
    v_add_f32_dpp v96, v96, v96 quad_perm:[1,0,3,2] row_mask:0xf bank_mask:0xf
    s_nop 1
    v_add_f32_dpp v96, v96, v96 quad_perm:[2,3,0,1] row_mask:0xf bank_mask:0xf
    s_nop 1
Lne_32:
    v_mfma_f32_16x16x32_bf16 v[176:179], v[64:67], v[28:31], v[176:179]
    v_mfma_f32_16x16x32_bf16 v[180:183], v[68:71], v[28:31], v[180:183]
    v_mfma_f32_16x16x32_bf16 v[184:187], v[72:75], v[28:31], v[184:187]
    v_mfma_f32_16x16x32_bf16 v[188:191], v[76:79], v[28:31], v[188:191]
    ds_read_b128 v[28:31], v2 offset:38912
    ds_read_b64_tr_b16 v[60:61], v7 offset:32768
    ds_read_b64_tr_b16 v[62:63], v7 offset:33792
    s_cbranch_vccnz Lnd_33
    s_add_u32 s68, s64, s4
    s_add_u32 m0, s81, 2048
    s_nop 0
    buffer_load_dwordx4 v8, s[44:47], s68 offen lds
    s_add_u32 s68, s64, s4
    s_add_u32 m0, s81, 3072
    s_nop 0
    buffer_load_dwordx4 v9, s[44:47], s68 offen lds
    s_branch Lne_34
Lnd_33:
    v_add_f32_dpp v96, v96, v96 row_half_mirror row_mask:0xf bank_mask:0xf
    s_nop 1
    v_add_f32_dpp v96, v96, v96 row_mirror row_mask:0xf bank_mask:0xf
    s_nop 1
    v_readlane_b32 s76, v96, 0
    v_readlane_b32 s77, v96, 16
    v_readlane_b32 s78, v96, 32
    v_readlane_b32 s79, v96, 48
    s_nop 2
    v_mov_b32 v96, s76
    v_add_f32 v96, s77, v96
    v_add_f32 v96, s78, v96
    v_add_f32 v96, s79, v96
    v_mul_f32 v97, 0x3a800000, v96
    v_mov_b32 v98, 0
    v_sub_f32 v99, v80, v97
    v_fmac_f32 v98, v99, v99
    v_sub_f32 v99, v81, v97
    v_fmac_f32 v98, v99, v99
    v_sub_f32 v99, v82, v97
    v_fmac_f32 v98, v99, v99
    v_sub_f32 v99, v83, v97
    v_fmac_f32 v98, v99, v99
    v_sub_f32 v99, v84, v97
    v_fmac_f32 v98, v99, v99
    v_sub_f32 v99, v85, v97
    v_fmac_f32 v98, v99, v99
    v_sub_f32 v99, v86, v97
    v_fmac_f32 v98, v99, v99
    v_sub_f32 v99, v87, v97
    v_fmac_f32 v98, v99, v99
    v_sub_f32 v99, v88, v97
    v_fmac_f32 v98, v99, v99
    v_sub_f32 v99, v89, v97
    v_fmac_f32 v98, v99, v99
    v_sub_f32 v99, v90, v97
Lne_34:
    v_mfma_f32_16x16x32_bf16 v[192:195], v[64:67], v[32:35], v[192:195]
    v_mfma_f32_16x16x32_bf16 v[196:199], v[68:71], v[32:35], v[196:199]
    v_mfma_f32_16x16x32_bf16 v[200:203], v[72:75], v[32:35], v[200:203]
    v_mfma_f32_16x16x32_bf16 v[204:207], v[76:79], v[32:35], v[204:207]
    ds_read_b128 v[32:35], v2 offset:40960
    s_cbranch_vccnz Lnd_35
    s_add_u32 m0, s81, 16384
    s_nop 0
    buffer_load_dwordx4 v8, s[44:47], s65 offen lds
    s_add_u32 m0, s81, 17408
    s_nop 0
    buffer_load_dwordx4 v9, s[44:47], s65 offen lds
    s_add_u32 s68, s65, s4
    s_add_u32 m0, s81, 18432
    s_nop 0
    buffer_load_dwordx4 v8, s[44:47], s68 offen lds
    s_branch Lne_36
Lnd_35:
    v_fmac_f32 v98, v99, v99
    v_sub_f32 v99, v91, v97
    v_fmac_f32 v98, v99, v99
    v_sub_f32 v99, v92, v97
    v_fmac_f32 v98, v99, v99
    v_sub_f32 v99, v93, v97
    v_fmac_f32 v98, v99, v99
    v_sub_f32 v99, v94, v97
    v_fmac_f32 v98, v99, v99
    v_sub_f32 v99, v95, v97
    v_fmac_f32 v98, v99, v99
    s_nop 1
    v_add_f32_dpp v98, v98, v98 quad_perm:[1,0,3,2] row_mask:0xf bank_mask:0xf
    s_nop 1
    v_add_f32_dpp v98, v98, v98 quad_perm:[2,3,0,1] row_mask:0xf bank_mask:0xf
    s_nop 1
    v_add_f32_dpp v98, v98, v98 row_half_mirror row_mask:0xf bank_mask:0xf
    s_nop 1
    v_add_f32_dpp v98, v98, v98 row_mirror row_mask:0xf bank_mask:0xf
    s_nop 1
    v_readlane_b32 s76, v98, 0
    v_readlane_b32 s77, v98, 16
    v_readlane_b32 s78, v98, 32
    v_readlane_b32 s79, v98, 48
    s_nop 2
    v_mov_b32 v98, s76
    v_add_f32 v98, s77, v98
    v_add_f32 v98, s78, v98
    v_add_f32 v98, s79, v98
    v_mul_f32 v98, 0x3a800000, v98
    v_cvt_pk_bf16_f32 v97, v97, v97
    v_lshlrev_b32 v97, 16, v97
    v_cvt_pk_bf16_f32 v98, v98, v98
    v_lshlrev_b32 v98, 16, v98
    v_add_f32 v98, 0x3727c5ac, v98
    v_cvt_pk_bf16_f32 v98, v98, v98
    v_lshlrev_b32 v98, 16, v98
Lne_36:
    v_mfma_f32_16x16x32_bf16 v[208:211], v[64:67], v[36:39], v[208:211]
    v_mfma_f32_16x16x32_bf16 v[212:215], v[68:71], v[36:39], v[212:215]
    v_mfma_f32_16x16x32_bf16 v[216:219], v[72:75], v[36:39], v[216:219]
    v_mfma_f32_16x16x32_bf16 v[220:223], v[76:79], v[36:39], v[220:223]
    ds_read_b128 v[36:39], v2 offset:43008
    s_cbranch_vccnz Lnd_37
    s_add_u32 s68, s65, s4
    s_add_u32 m0, s81, 19456
    s_nop 0
    buffer_load_dwordx4 v9, s[44:47], s68 offen lds
    s_add_u32 m0, s81, 65536
    s_nop 0
    buffer_load_dwordx4 v10, s[48:51], s66 offen lds
    s_add_u32 s68, s66, s5
    s_add_u32 m0, s81, 66560
    s_nop 0
    buffer_load_dwordx4 v10, s[48:51], s68 offen lds
    s_branch Lne_38
Lnd_37:
    v_sqrt_f32 v98, v98
    s_nop 0
    v_cvt_pk_bf16_f32 v98, v98, v98
    v_lshlrev_b32 v98, 16, v98
    v_rcp_f32 v96, v98
    s_nop 0
    v_sub_f32 v80, v80, v97
    v_sub_f32 v81, v81, v97
    v_cvt_pk_bf16_f32 v99, v80, v81
    v_lshlrev_b32 v80, 16, v99
    v_and_b32 v81, 0xffff0000, v99
    v_mul_f32 v99, v80, v96
    v_fma_f32 v80, -v99, v98, v80
    v_fma_f32 v80, v80, v96, v99
    v_mul_f32 v99, v81, v96
    v_fma_f32 v81, -v99, v98, v81
    v_fma_f32 v81, v81, v96, v99
    v_sub_f32 v82, v82, v97
    v_sub_f32 v83, v83, v97
    v_cvt_pk_bf16_f32 v99, v82, v83
    v_lshlrev_b32 v82, 16, v99
    v_and_b32 v83, 0xffff0000, v99
    v_mul_f32 v99, v82, v96
    v_fma_f32 v82, -v99, v98, v82
    v_fma_f32 v82, v82, v96, v99
    v_mul_f32 v99, v83, v96
    v_fma_f32 v83, -v99, v98, v83
    v_fma_f32 v83, v83, v96, v99
    v_sub_f32 v84, v84, v97
    v_sub_f32 v85, v85, v97
    v_cvt_pk_bf16_f32 v99, v84, v85
    v_lshlrev_b32 v84, 16, v99
    v_and_b32 v85, 0xffff0000, v99
    v_mul_f32 v99, v84, v96
    v_fma_f32 v84, -v99, v98, v84
    v_fma_f32 v84, v84, v96, v99
Lne_38:
    v_mfma_f32_16x16x32_bf16 v[224:227], v[64:67], v[40:43], v[224:227]
    v_mfma_f32_16x16x32_bf16 v[228:231], v[68:71], v[40:43], v[228:231]
    v_mfma_f32_16x16x32_bf16 v[232:235], v[72:75], v[40:43], v[232:235]
    v_mfma_f32_16x16x32_bf16 v[236:239], v[76:79], v[40:43], v[236:239]
    ds_read_b128 v[40:43], v2 offset:45056
    s_cbranch_vccnz Lnd_39
    s_add_u32 m0, s81, 67584
    s_nop 0
    buffer_load_dwordx4 v11, s[48:51], s66 offen lds
    s_add_u32 s68, s66, s5
    s_add_u32 m0, s81, 68608
    s_nop 0
    buffer_load_dwordx4 v11, s[48:51], s68 offen lds
    s_add_u32 m0, s81, 81920
    s_nop 0
    buffer_load_dwordx4 v12, s[96:99], s67 offen lds
    s_branch Lne_40
Lnd_39:
    v_mul_f32 v99, v85, v96
    v_fma_f32 v85, -v99, v98, v85
    v_fma_f32 v85, v85, v96, v99
    v_sub_f32 v86, v86, v97
    v_sub_f32 v87, v87, v97
    v_cvt_pk_bf16_f32 v99, v86, v87
    v_lshlrev_b32 v86, 16, v99
    v_and_b32 v87, 0xffff0000, v99
    v_mul_f32 v99, v86, v96
    v_fma_f32 v86, -v99, v98, v86
    v_fma_f32 v86, v86, v96, v99
    v_mul_f32 v99, v87, v96
    v_fma_f32 v87, -v99, v98, v87
    v_fma_f32 v87, v87, v96, v99
    v_sub_f32 v88, v88, v97
    v_sub_f32 v89, v89, v97
    v_cvt_pk_bf16_f32 v99, v88, v89
    v_lshlrev_b32 v88, 16, v99
    v_and_b32 v89, 0xffff0000, v99
    v_mul_f32 v99, v88, v96
    v_fma_f32 v88, -v99, v98, v88
    v_fma_f32 v88, v88, v96, v99
    v_mul_f32 v99, v89, v96
    v_fma_f32 v89, -v99, v98, v89
    v_fma_f32 v89, v89, v96, v99
    v_sub_f32 v90, v90, v97
    v_sub_f32 v91, v91, v97
    v_cvt_pk_bf16_f32 v99, v90, v91
    v_lshlrev_b32 v90, 16, v99
    v_and_b32 v91, 0xffff0000, v99
    v_mul_f32 v99, v90, v96
    v_fma_f32 v90, -v99, v98, v90
    v_fma_f32 v90, v90, v96, v99
    v_mul_f32 v99, v91, v96
    v_fma_f32 v91, -v99, v98, v91
    v_fma_f32 v91, v91, v96, v99
Lne_40:
    v_mfma_f32_16x16x32_bf16 v[240:243], v[64:67], v[44:47], v[240:243]
    v_mfma_f32_16x16x32_bf16 v[244:247], v[68:71], v[44:47], v[244:247]
    v_mfma_f32_16x16x32_bf16 v[248:251], v[72:75], v[44:47], v[248:251]
    v_mfma_f32_16x16x32_bf16 v[252:255], v[76:79], v[44:47], v[252:255]
    ds_read_b128 v[44:47], v2 offset:47104
    s_cbranch_vccnz Lnd_41
    s_add_u32 s68, s67, s6
    s_add_u32 m0, s81, 82944
    s_nop 0
    buffer_load_dwordx4 v12, s[96:99], s68 offen lds
    s_add_u32 m0, s81, 83968
    s_nop 0
    buffer_load_dwordx4 v13, s[96:99], s67 offen lds
    s_add_u32 s68, s67, s6
    s_add_u32 m0, s81, 84992
    s_nop 0
    buffer_load_dwordx4 v13, s[96:99], s68 offen lds
    s_branch Lne_42
Lnd_41:
    v_sub_f32 v92, v92, v97
    v_sub_f32 v93, v93, v97
    v_cvt_pk_bf16_f32 v99, v92, v93
    v_lshlrev_b32 v92, 16, v99
    v_and_b32 v93, 0xffff0000, v99
    v_mul_f32 v99, v92, v96
    v_fma_f32 v92, -v99, v98, v92
    v_fma_f32 v92, v92, v96, v99
    v_mul_f32 v99, v93, v96
    v_fma_f32 v93, -v99, v98, v93
    v_fma_f32 v93, v93, v96, v99
    v_sub_f32 v94, v94, v97
    v_sub_f32 v95, v95, v97
    v_cvt_pk_bf16_f32 v99, v94, v95
    v_lshlrev_b32 v94, 16, v99
    v_and_b32 v95, 0xffff0000, v99
    v_mul_f32 v99, v94, v96
    v_fma_f32 v94, -v99, v98, v94
    v_fma_f32 v94, v94, v96, v99
    v_mul_f32 v99, v95, v96
    v_fma_f32 v95, -v99, v98, v95
    v_fma_f32 v95, v95, v96, v99
    v_cvt_pk_bf16_f32 v112, v80, v81
    v_cvt_pk_bf16_f32 v113, v82, v83
    v_cvt_pk_bf16_f32 v114, v84, v85
    v_cvt_pk_bf16_f32 v115, v86, v87
    v_cvt_pk_bf16_f32 v116, v88, v89
    v_cvt_pk_bf16_f32 v117, v90, v91
    v_cvt_pk_bf16_f32 v118, v92, v93
    v_cvt_pk_bf16_f32 v119, v94, v95
    s_add_u32 s56, s42, 220200960
    s_addc_u32 s57, s43, 0
    s_mov_b32 s58, 4456448
    s_and_b32 s57, s57, 0xffff
    s_mov_b32 s59, 0x00020000
    buffer_store_dwordx4 v[112:115], v120, s[56:59], s11 offen sc0 sc1
    buffer_store_dwordx4 v[116:119], v120, s[56:59], s11 offen offset:1024 sc0 sc1
Lne_42:
    s_add_u32 s64, s64, 128
    s_add_u32 s65, s65, 128
    s_add_u32 s66, s66, s7
    s_add_u32 s67, s67, s8
    s_cbranch_vccz Lnofp_43
    s_add_u32 s56, s30, 0
    s_addc_u32 s57, s31, 0
    s_mov_b32 s58, 7340032
    s_and_b32 s57, s57, 0xffff
    s_mov_b32 s59, 0x00020000
    s_mul_i32 s68, s9, 8
    s_add_u32 s69, s68, 4096
    buffer_load_dwordx4 v[100:103], v120, s[56:59], s68 offen offset:0
    buffer_load_dwordx4 v[100:103], v120, s[56:59], s68 offen offset:1024
    buffer_load_dwordx4 v[100:103], v120, s[56:59], s68 offen offset:2048
    buffer_load_dwordx4 v[100:103], v120, s[56:59], s68 offen offset:3072
Lnofp_43:
    s_waitcnt lgkmcnt(4)
    v_mfma_f32_16x16x32_bf16 v[128:131], v[48:51], v[16:19], v[128:131]
    v_mfma_f32_16x16x32_bf16 v[132:135], v[52:55], v[16:19], v[132:135]
    v_mfma_f32_16x16x32_bf16 v[136:139], v[56:59], v[16:19], v[136:139]
    v_mfma_f32_16x16x32_bf16 v[140:143], v[60:63], v[16:19], v[140:143]
    ds_read_b128 v[16:19], v3 offset:32768
    ds_read_b64_tr_b16 v[64:65], v4 offset:40960
    ds_read_b64_tr_b16 v[66:67], v4 offset:41984
    v_mfma_f32_16x16x32_bf16 v[144:147], v[48:51], v[20:23], v[144:147]
    v_mfma_f32_16x16x32_bf16 v[148:151], v[52:55], v[20:23], v[148:151]
    v_mfma_f32_16x16x32_bf16 v[152:155], v[56:59], v[20:23], v[152:155]
    v_mfma_f32_16x16x32_bf16 v[156:159], v[60:63], v[20:23], v[156:159]
    ds_read_b128 v[20:23], v3 offset:34816
    ds_read_b64_tr_b16 v[68:69], v5 offset:40960
    ds_read_b64_tr_b16 v[70:71], v5 offset:41984
    v_mfma_f32_16x16x32_bf16 v[160:163], v[48:51], v[24:27], v[160:163]
    v_mfma_f32_16x16x32_bf16 v[164:167], v[52:55], v[24:27], v[164:167]
    v_mfma_f32_16x16x32_bf16 v[168:171], v[56:59], v[24:27], v[168:171]
    v_mfma_f32_16x16x32_bf16 v[172:175], v[60:63], v[24:27], v[172:175]
    ds_read_b128 v[24:27], v3 offset:36864
    ds_read_b64_tr_b16 v[72:73], v6 offset:40960
    ds_read_b64_tr_b16 v[74:75], v6 offset:41984
    v_mfma_f32_16x16x32_bf16 v[176:179], v[48:51], v[28:31], v[176:179]
    v_mfma_f32_16x16x32_bf16 v[180:183], v[52:55], v[28:31], v[180:183]
    v_mfma_f32_16x16x32_bf16 v[184:187], v[56:59], v[28:31], v[184:187]
    v_mfma_f32_16x16x32_bf16 v[188:191], v[60:63], v[28:31], v[188:191]
    ds_read_b128 v[28:31], v3 offset:38912
    ds_read_b64_tr_b16 v[76:77], v7 offset:40960
    ds_read_b64_tr_b16 v[78:79], v7 offset:41984
    s_waitcnt lgkmcnt(12)
    v_mfma_f32_16x16x32_bf16 v[192:195], v[48:51], v[32:35], v[192:195]
    v_mfma_f32_16x16x32_bf16 v[196:199], v[52:55], v[32:35], v[196:199]
    v_mfma_f32_16x16x32_bf16 v[200:203], v[56:59], v[32:35], v[200:203]
    v_mfma_f32_16x16x32_bf16 v[204:207], v[60:63], v[32:35], v[204:207]
    ds_read_b128 v[32:35], v3 offset:40960
    v_mfma_f32_16x16x32_bf16 v[208:211], v[48:51], v[36:39], v[208:211]
    v_mfma_f32_16x16x32_bf16 v[212:215], v[52:55], v[36:39], v[212:215]
    v_mfma_f32_16x16x32_bf16 v[216:219], v[56:59], v[36:39], v[216:219]
    v_mfma_f32_16x16x32_bf16 v[220:223], v[60:63], v[36:39], v[220:223]
    ds_read_b128 v[36:39], v3 offset:43008
    v_mfma_f32_16x16x32_bf16 v[224:227], v[48:51], v[40:43], v[224:227]
    v_mfma_f32_16x16x32_bf16 v[228:231], v[52:55], v[40:43], v[228:231]
    v_mfma_f32_16x16x32_bf16 v[232:235], v[56:59], v[40:43], v[232:235]
    v_mfma_f32_16x16x32_bf16 v[236:239], v[60:63], v[40:43], v[236:239]
    ds_read_b128 v[40:43], v3 offset:45056
    v_mfma_f32_16x16x32_bf16 v[240:243], v[48:51], v[44:47], v[240:243]
    v_mfma_f32_16x16x32_bf16 v[244:247], v[52:55], v[44:47], v[244:247]
    v_mfma_f32_16x16x32_bf16 v[248:251], v[56:59], v[44:47], v[248:251]
    v_mfma_f32_16x16x32_bf16 v[252:255], v[60:63], v[44:47], v[252:255]
    ds_read_b128 v[44:47], v3 offset:47104
    s_waitcnt lgkmcnt(4)
    v_mfma_f32_16x16x32_bf16 v[128:131], v[64:67], v[16:19], v[128:131]
    v_mfma_f32_16x16x32_bf16 v[132:135], v[68:71], v[16:19], v[132:135]
    v_mfma_f32_16x16x32_bf16 v[136:139], v[72:75], v[16:19], v[136:139]
    v_mfma_f32_16x16x32_bf16 v[140:143], v[76:79], v[16:19], v[140:143]
    v_mfma_f32_16x16x32_bf16 v[144:147], v[64:67], v[20:23], v[144:147]
    v_mfma_f32_16x16x32_bf16 v[148:151], v[68:71], v[20:23], v[148:151]
    v_mfma_f32_16x16x32_bf16 v[152:155], v[72:75], v[20:23], v[152:155]
    v_mfma_f32_16x16x32_bf16 v[156:159], v[76:79], v[20:23], v[156:159]
    s_waitcnt lgkmcnt(0)
    s_cbranch_vccnz Lfw_44
    s_waitcnt vmcnt(0)
Lfw_44:
Lfw_45:
    s_barrier
    ds_read_b128 v[16:19], v2 offset:0
    ds_read_b128 v[20:23], v2 offset:2048
    ds_read_b64_tr_b16 v[48:49], v4 offset:0
    ds_read_b64_tr_b16 v[50:51], v4 offset:1024
    ds_read_b64_tr_b16 v[52:53], v5 offset:0
    ds_read_b64_tr_b16 v[54:55], v5 offset:1024
    v_mfma_f32_16x16x32_bf16 v[160:163], v[64:67], v[24:27], v[160:163]
    v_mfma_f32_16x16x32_bf16 v[164:167], v[68:71], v[24:27], v[164:167]
    v_mfma_f32_16x16x32_bf16 v[168:171], v[72:75], v[24:27], v[168:171]
    v_mfma_f32_16x16x32_bf16 v[172:175], v[76:79], v[24:27], v[172:175]
    ds_read_b128 v[24:27], v2 offset:4096
    ds_read_b64_tr_b16 v[56:57], v6 offset:0
    ds_read_b64_tr_b16 v[58:59], v6 offset:1024
    s_cbranch_vccnz Lnd_46
    s_add_u32 m0, s81, 32768
    s_nop 0
    buffer_load_dwordx4 v8, s[44:47], s64 offen lds
    s_add_u32 m0, s81, 33792
    s_nop 0
    buffer_load_dwordx4 v9, s[44:47], s64 offen lds
Lnd_46:
    v_mfma_f32_16x16x32_bf16 v[176:179], v[64:67], v[28:31], v[176:179]
    v_mfma_f32_16x16x32_bf16 v[180:183], v[68:71], v[28:31], v[180:183]
    v_mfma_f32_16x16x32_bf16 v[184:187], v[72:75], v[28:31], v[184:187]
    v_mfma_f32_16x16x32_bf16 v[188:191], v[76:79], v[28:31], v[188:191]
    ds_read_b128 v[28:31], v2 offset:6144
    ds_read_b64_tr_b16 v[60:61], v7 offset:0
    ds_read_b64_tr_b16 v[62:63], v7 offset:1024
    s_cbranch_vccnz Lnd_47
    s_add_u32 s68, s64, s4
    s_add_u32 m0, s81, 34816
    s_nop 0
    buffer_load_dwordx4 v8, s[44:47], s68 offen lds
    s_add_u32 s68, s64, s4
    s_add_u32 m0, s81, 35840
    s_nop 0
    buffer_load_dwordx4 v9, s[44:47], s68 offen lds
Lnd_47:
    v_mfma_f32_16x16x32_bf16 v[192:195], v[64:67], v[32:35], v[192:195]
    v_mfma_f32_16x16x32_bf16 v[196:199], v[68:71], v[32:35], v[196:199]
    v_mfma_f32_16x16x32_bf16 v[200:203], v[72:75], v[32:35], v[200:203]
    v_mfma_f32_16x16x32_bf16 v[204:207], v[76:79], v[32:35], v[204:207]
    ds_read_b128 v[32:35], v2 offset:8192
    s_cbranch_vccnz Lnd_48
    s_add_u32 m0, s81, 49152
    s_nop 0
    buffer_load_dwordx4 v8, s[44:47], s65 offen lds
    s_add_u32 m0, s81, 50176
    s_nop 0
    buffer_load_dwordx4 v9, s[44:47], s65 offen lds
    s_add_u32 s68, s65, s4
    s_add_u32 m0, s81, 51200
    s_nop 0
    buffer_load_dwordx4 v8, s[44:47], s68 offen lds
Lnd_48:
    v_mfma_f32_16x16x32_bf16 v[208:211], v[64:67], v[36:39], v[208:211]
    v_mfma_f32_16x16x32_bf16 v[212:215], v[68:71], v[36:39], v[212:215]
    v_mfma_f32_16x16x32_bf16 v[216:219], v[72:75], v[36:39], v[216:219]
    v_mfma_f32_16x16x32_bf16 v[220:223], v[76:79], v[36:39], v[220:223]
    ds_read_b128 v[36:39], v2 offset:10240
    s_cbranch_vccnz Lnd_49
    s_add_u32 s68, s65, s4
    s_add_u32 m0, s81, 52224
    s_nop 0
    buffer_load_dwordx4 v9, s[44:47], s68 offen lds
    s_add_u32 m0, s81, 98304
    s_nop 0
    buffer_load_dwordx4 v10, s[48:51], s66 offen lds
    s_add_u32 s68, s66, s5
    s_add_u32 m0, s81, 99328
    s_nop 0
    buffer_load_dwordx4 v10, s[48:51], s68 offen lds
Lnd_49:
    v_mfma_f32_16x16x32_bf16 v[224:227], v[64:67], v[40:43], v[224:227]
    v_mfma_f32_16x16x32_bf16 v[228:231], v[68:71], v[40:43], v[228:231]
    v_mfma_f32_16x16x32_bf16 v[232:235], v[72:75], v[40:43], v[232:235]
    v_mfma_f32_16x16x32_bf16 v[236:239], v[76:79], v[40:43], v[236:239]
    ds_read_b128 v[40:43], v2 offset:12288
    s_cbranch_vccnz Lnd_50
    s_add_u32 m0, s81, 100352
    s_nop 0
    buffer_load_dwordx4 v11, s[48:51], s66 offen lds
    s_add_u32 s68, s66, s5
    s_add_u32 m0, s81, 101376
    s_nop 0
    buffer_load_dwordx4 v11, s[48:51], s68 offen lds
    s_add_u32 m0, s81, 114688
    s_nop 0
    buffer_load_dwordx4 v12, s[96:99], s67 offen lds
Lnd_50:
    v_mfma_f32_16x16x32_bf16 v[240:243], v[64:67], v[44:47], v[240:243]
    v_mfma_f32_16x16x32_bf16 v[244:247], v[68:71], v[44:47], v[244:247]
    v_mfma_f32_16x16x32_bf16 v[248:251], v[72:75], v[44:47], v[248:251]
    v_mfma_f32_16x16x32_bf16 v[252:255], v[76:79], v[44:47], v[252:255]
    ds_read_b128 v[44:47], v2 offset:14336
    s_cbranch_vccnz Lnd_51
    s_add_u32 s68, s67, s6
    s_add_u32 m0, s81, 115712
    s_nop 0
    buffer_load_dwordx4 v12, s[96:99], s68 offen lds
    s_add_u32 m0, s81, 116736
    s_nop 0
    buffer_load_dwordx4 v13, s[96:99], s67 offen lds
    s_add_u32 s68, s67, s6
    s_add_u32 m0, s81, 117760
    s_nop 0
    buffer_load_dwordx4 v13, s[96:99], s68 offen lds
Lnd_51:
    s_add_u32 s64, s64, 128
    s_add_u32 s65, s65, 128
    s_add_u32 s66, s66, s7
    s_add_u32 s67, s67, s8
    s_cbranch_vccz Lnofp_52
    s_add_u32 s56, s20, 0
    s_addc_u32 s57, s21, 0
    s_mov_b32 s58, 8388608
    s_and_b32 s57, s57, 0xffff
    s_mov_b32 s59, 0x00020000
    s_mul_i32 s68, s9, 8
    s_add_u32 s69, s68, 4096
    buffer_load_dwordx4 v[100:103], v120, s[56:59], s69 offen offset:0
    buffer_load_dwordx4 v[100:103], v120, s[56:59], s69 offen offset:1024
    buffer_load_dwordx4 v[100:103], v120, s[56:59], s69 offen offset:2048
    buffer_load_dwordx4 v[100:103], v120, s[56:59], s69 offen offset:3072
Lnofp_52:
    s_waitcnt lgkmcnt(4)
    v_mfma_f32_16x16x32_bf16 v[128:131], v[48:51], v[16:19], v[128:131]
    v_mfma_f32_16x16x32_bf16 v[132:135], v[52:55], v[16:19], v[132:135]
    v_mfma_f32_16x16x32_bf16 v[136:139], v[56:59], v[16:19], v[136:139]
    v_mfma_f32_16x16x32_bf16 v[140:143], v[60:63], v[16:19], v[140:143]
    ds_read_b128 v[16:19], v3 offset:0
    ds_read_b64_tr_b16 v[64:65], v4 offset:8192
    ds_read_b64_tr_b16 v[66:67], v4 offset:9216
    v_mfma_f32_16x16x32_bf16 v[144:147], v[48:51], v[20:23], v[144:147]
    v_mfma_f32_16x16x32_bf16 v[148:151], v[52:55], v[20:23], v[148:151]
    v_mfma_f32_16x16x32_bf16 v[152:155], v[56:59], v[20:23], v[152:155]
    v_mfma_f32_16x16x32_bf16 v[156:159], v[60:63], v[20:23], v[156:159]
    ds_read_b128 v[20:23], v3 offset:2048
    ds_read_b64_tr_b16 v[68:69], v5 offset:8192
    ds_read_b64_tr_b16 v[70:71], v5 offset:9216
    v_mfma_f32_16x16x32_bf16 v[160:163], v[48:51], v[24:27], v[160:163]
    v_mfma_f32_16x16x32_bf16 v[164:167], v[52:55], v[24:27], v[164:167]
    v_mfma_f32_16x16x32_bf16 v[168:171], v[56:59], v[24:27], v[168:171]
    v_mfma_f32_16x16x32_bf16 v[172:175], v[60:63], v[24:27], v[172:175]
    ds_read_b128 v[24:27], v3 offset:4096
    ds_read_b64_tr_b16 v[72:73], v6 offset:8192
    ds_read_b64_tr_b16 v[74:75], v6 offset:9216
    v_mfma_f32_16x16x32_bf16 v[176:179], v[48:51], v[28:31], v[176:179]
    v_mfma_f32_16x16x32_bf16 v[180:183], v[52:55], v[28:31], v[180:183]
    v_mfma_f32_16x16x32_bf16 v[184:187], v[56:59], v[28:31], v[184:187]
    v_mfma_f32_16x16x32_bf16 v[188:191], v[60:63], v[28:31], v[188:191]
    ds_read_b128 v[28:31], v3 offset:6144
    ds_read_b64_tr_b16 v[76:77], v7 offset:8192
    ds_read_b64_tr_b16 v[78:79], v7 offset:9216
    s_waitcnt lgkmcnt(12)
    v_mfma_f32_16x16x32_bf16 v[192:195], v[48:51], v[32:35], v[192:195]
    v_mfma_f32_16x16x32_bf16 v[196:199], v[52:55], v[32:35], v[196:199]
    v_mfma_f32_16x16x32_bf16 v[200:203], v[56:59], v[32:35], v[200:203]
    v_mfma_f32_16x16x32_bf16 v[204:207], v[60:63], v[32:35], v[204:207]
    ds_read_b128 v[32:35], v3 offset:8192
    v_mfma_f32_16x16x32_bf16 v[208:211], v[48:51], v[36:39], v[208:211]
    v_mfma_f32_16x16x32_bf16 v[212:215], v[52:55], v[36:39], v[212:215]
    v_mfma_f32_16x16x32_bf16 v[216:219], v[56:59], v[36:39], v[216:219]
    v_mfma_f32_16x16x32_bf16 v[220:223], v[60:63], v[36:39], v[220:223]
    ds_read_b128 v[36:39], v3 offset:10240
    v_mfma_f32_16x16x32_bf16 v[224:227], v[48:51], v[40:43], v[224:227]
    v_mfma_f32_16x16x32_bf16 v[228:231], v[52:55], v[40:43], v[228:231]
    v_mfma_f32_16x16x32_bf16 v[232:235], v[56:59], v[40:43], v[232:235]
    v_mfma_f32_16x16x32_bf16 v[236:239], v[60:63], v[40:43], v[236:239]
    ds_read_b128 v[40:43], v3 offset:12288
    v_mfma_f32_16x16x32_bf16 v[240:243], v[48:51], v[44:47], v[240:243]
    v_mfma_f32_16x16x32_bf16 v[244:247], v[52:55], v[44:47], v[244:247]
    v_mfma_f32_16x16x32_bf16 v[248:251], v[56:59], v[44:47], v[248:251]
    v_mfma_f32_16x16x32_bf16 v[252:255], v[60:63], v[44:47], v[252:255]
    ds_read_b128 v[44:47], v3 offset:14336
    s_waitcnt lgkmcnt(4)
    v_mfma_f32_16x16x32_bf16 v[128:131], v[64:67], v[16:19], v[128:131]
    v_mfma_f32_16x16x32_bf16 v[132:135], v[68:71], v[16:19], v[132:135]
    v_mfma_f32_16x16x32_bf16 v[136:139], v[72:75], v[16:19], v[136:139]
    v_mfma_f32_16x16x32_bf16 v[140:143], v[76:79], v[16:19], v[140:143]
    v_mfma_f32_16x16x32_bf16 v[144:147], v[64:67], v[20:23], v[144:147]
    v_mfma_f32_16x16x32_bf16 v[148:151], v[68:71], v[20:23], v[148:151]
    v_mfma_f32_16x16x32_bf16 v[152:155], v[72:75], v[20:23], v[152:155]
    v_mfma_f32_16x16x32_bf16 v[156:159], v[76:79], v[20:23], v[156:159]
    s_waitcnt lgkmcnt(0)
    s_cbranch_vccnz Lfw_53
    s_waitcnt vmcnt(0)
    s_branch Lfw_54
Lfw_53:
    s_waitcnt vmcnt(8)
Lfw_54:
    s_barrier
    ds_read_b128 v[16:19], v2 offset:32768
    ds_read_b128 v[20:23], v2 offset:34816
    ds_read_b64_tr_b16 v[48:49], v4 offset:32768
    ds_read_b64_tr_b16 v[50:51], v4 offset:33792
    ds_read_b64_tr_b16 v[52:53], v5 offset:32768
    ds_read_b64_tr_b16 v[54:55], v5 offset:33792
    v_mfma_f32_16x16x32_bf16 v[160:163], v[64:67], v[24:27], v[160:163]
    v_mfma_f32_16x16x32_bf16 v[164:167], v[68:71], v[24:27], v[164:167]
    v_mfma_f32_16x16x32_bf16 v[168:171], v[72:75], v[24:27], v[168:171]
    v_mfma_f32_16x16x32_bf16 v[172:175], v[76:79], v[24:27], v[172:175]
    ds_read_b128 v[24:27], v2 offset:36864
    ds_read_b64_tr_b16 v[56:57], v6 offset:32768
    ds_read_b64_tr_b16 v[58:59], v6 offset:33792
    s_cbranch_vccnz Lnd_55
    s_add_u32 m0, s81, 0
    s_nop 0
    buffer_load_dwordx4 v8, s[44:47], s64 offen lds
    s_add_u32 m0, s81, 1024
    s_nop 0
    buffer_load_dwordx4 v9, s[44:47], s64 offen lds
Lnd_55:
    v_mfma_f32_16x16x32_bf16 v[176:179], v[64:67], v[28:31], v[176:179]
    v_mfma_f32_16x16x32_bf16 v[180:183], v[68:71], v[28:31], v[180:183]
    v_mfma_f32_16x16x32_bf16 v[184:187], v[72:75], v[28:31], v[184:187]
    v_mfma_f32_16x16x32_bf16 v[188:191], v[76:79], v[28:31], v[188:191]
    ds_read_b128 v[28:31], v2 offset:38912
    ds_read_b64_tr_b16 v[60:61], v7 offset:32768
    ds_read_b64_tr_b16 v[62:63], v7 offset:33792
    s_cbranch_vccnz Lnd_56
    s_add_u32 s68, s64, s4
    s_add_u32 m0, s81, 2048
    s_nop 0
    buffer_load_dwordx4 v8, s[44:47], s68 offen lds
    s_add_u32 s68, s64, s4
    s_add_u32 m0, s81, 3072
    s_nop 0
    buffer_load_dwordx4 v9, s[44:47], s68 offen lds
Lnd_56:
    v_mfma_f32_16x16x32_bf16 v[192:195], v[64:67], v[32:35], v[192:195]
    v_mfma_f32_16x16x32_bf16 v[196:199], v[68:71], v[32:35], v[196:199]
    v_mfma_f32_16x16x32_bf16 v[200:203], v[72:75], v[32:35], v[200:203]
    v_mfma_f32_16x16x32_bf16 v[204:207], v[76:79], v[32:35], v[204:207]
    ds_read_b128 v[32:35], v2 offset:40960
    s_cbranch_vccnz Lnd_57
    s_add_u32 m0, s81, 16384
    s_nop 0
    buffer_load_dwordx4 v8, s[44:47], s65 offen lds
    s_add_u32 m0, s81, 17408
    s_nop 0
    buffer_load_dwordx4 v9, s[44:47], s65 offen lds
    s_add_u32 s68, s65, s4
    s_add_u32 m0, s81, 18432
    s_nop 0
    buffer_load_dwordx4 v8, s[44:47], s68 offen lds
Lnd_57:
    v_mfma_f32_16x16x32_bf16 v[208:211], v[64:67], v[36:39], v[208:211]
    v_mfma_f32_16x16x32_bf16 v[212:215], v[68:71], v[36:39], v[212:215]
    v_mfma_f32_16x16x32_bf16 v[216:219], v[72:75], v[36:39], v[216:219]
    v_mfma_f32_16x16x32_bf16 v[220:223], v[76:79], v[36:39], v[220:223]
    ds_read_b128 v[36:39], v2 offset:43008
    s_cbranch_vccnz Lnd_58
    s_add_u32 s68, s65, s4
    s_add_u32 m0, s81, 19456
    s_nop 0
    buffer_load_dwordx4 v9, s[44:47], s68 offen lds
    s_add_u32 m0, s81, 65536
    s_nop 0
    buffer_load_dwordx4 v10, s[48:51], s66 offen lds
    s_add_u32 s68, s66, s5
    s_add_u32 m0, s81, 66560
    s_nop 0
    buffer_load_dwordx4 v10, s[48:51], s68 offen lds
Lnd_58:
    v_mfma_f32_16x16x32_bf16 v[224:227], v[64:67], v[40:43], v[224:227]
    v_mfma_f32_16x16x32_bf16 v[228:231], v[68:71], v[40:43], v[228:231]
    v_mfma_f32_16x16x32_bf16 v[232:235], v[72:75], v[40:43], v[232:235]
    v_mfma_f32_16x16x32_bf16 v[236:239], v[76:79], v[40:43], v[236:239]
    ds_read_b128 v[40:43], v2 offset:45056
    s_cbranch_vccnz Lnd_59
    s_add_u32 m0, s81, 67584
    s_nop 0
    buffer_load_dwordx4 v11, s[48:51], s66 offen lds
    s_add_u32 s68, s66, s5
    s_add_u32 m0, s81, 68608
    s_nop 0
    buffer_load_dwordx4 v11, s[48:51], s68 offen lds
    s_add_u32 m0, s81, 81920
    s_nop 0
    buffer_load_dwordx4 v12, s[96:99], s67 offen lds
Lnd_59:
    v_mfma_f32_16x16x32_bf16 v[240:243], v[64:67], v[44:47], v[240:243]
    v_mfma_f32_16x16x32_bf16 v[244:247], v[68:71], v[44:47], v[244:247]
    v_mfma_f32_16x16x32_bf16 v[248:251], v[72:75], v[44:47], v[248:251]
    v_mfma_f32_16x16x32_bf16 v[252:255], v[76:79], v[44:47], v[252:255]
    ds_read_b128 v[44:47], v2 offset:47104
    s_cbranch_vccnz Lnd_60
    s_add_u32 s68, s67, s6
    s_add_u32 m0, s81, 82944
    s_nop 0
    buffer_load_dwordx4 v12, s[96:99], s68 offen lds
    s_add_u32 m0, s81, 83968
    s_nop 0
    buffer_load_dwordx4 v13, s[96:99], s67 offen lds
    s_add_u32 s68, s67, s6
    s_add_u32 m0, s81, 84992
    s_nop 0
    buffer_load_dwordx4 v13, s[96:99], s68 offen lds
Lnd_60:
    s_add_u32 s64, s64, 128
    s_add_u32 s65, s65, 128
    s_add_u32 s66, s66, s7
    s_add_u32 s67, s67, s8
    s_cmp_lg_u32 s60, 0
    s_cbranch_scc1 Lnw0_63
    s_add_u32 s56, s40, 0
    s_addc_u32 s57, s41, 0
    s_mov_b32 s58, 256
    s_and_b32 s57, s57, 0xffff
    s_mov_b32 s59, 0x00020000
    s_mov_b32 s14, 0x400000
Ltok_61:
    v_readfirstlane_b32 s12, v124
    v_readfirstlane_b32 s13, v125
    s_nop 3
    s_cmp_lg_u32 s12, 0
    s_cbranch_scc1 Ltokok_62
    s_sleep 2
    buffer_load_dwordx2 v[124:125], v122, s[56:59], 0 offen sc0 sc1
    s_waitcnt vmcnt(0)
    s_sub_u32 s14, s14, 1
    s_cmp_lg_u32 s14, 0
    s_cbranch_scc1 Ltok_61
Ltokok_62:
    s_add_u32 s56, s42, 209715200
    s_addc_u32 s57, s43, 0
    s_mov_b32 s58, 262144
    s_and_b32 s57, s57, 0xffff
    s_mov_b32 s59, 0x00020000
    s_lshl_b32 s68, s2, 7
    v_mov_b32 v124, s12
    v_mov_b32 v125, s13
    v_mov_b32 v126, 0
    s_mov_b64 exec, 1
    buffer_store_dwordx2 v[124:125], v126, s[56:59], s68 offen sc0 sc1
    s_mov_b64 exec, -1
Lnw0_63:
    s_cbranch_vccz Lnofp_64
    s_add_u32 s56, s30, 0
    s_addc_u32 s57, s31, 0
    s_mov_b32 s58, 7340032
    s_and_b32 s57, s57, 0xffff
    s_mov_b32 s59, 0x00020000
    s_mul_i32 s68, s9, 8
    s_add_u32 s69, s68, 4096
    buffer_load_dwordx4 v[100:103], v120, s[56:59], s69 offen offset:0
    buffer_load_dwordx4 v[100:103], v120, s[56:59], s69 offen offset:1024
    buffer_load_dwordx4 v[100:103], v120, s[56:59], s69 offen offset:2048
    buffer_load_dwordx4 v[100:103], v120, s[56:59], s69 offen offset:3072
Lnofp_64:
    s_waitcnt lgkmcnt(4)
    v_mfma_f32_16x16x32_bf16 v[128:131], v[48:51], v[16:19], v[128:131]
    v_mfma_f32_16x16x32_bf16 v[132:135], v[52:55], v[16:19], v[132:135]
    v_mfma_f32_16x16x32_bf16 v[136:139], v[56:59], v[16:19], v[136:139]
    v_mfma_f32_16x16x32_bf16 v[140:143], v[60:63], v[16:19], v[140:143]
    ds_read_b128 v[16:19], v3 offset:32768
    ds_read_b64_tr_b16 v[64:65], v4 offset:40960
    ds_read_b64_tr_b16 v[66:67], v4 offset:41984
    v_mfma_f32_16x16x32_bf16 v[144:147], v[48:51], v[20:23], v[144:147]
    v_mfma_f32_16x16x32_bf16 v[148:151], v[52:55], v[20:23], v[148:151]
    v_mfma_f32_16x16x32_bf16 v[152:155], v[56:59], v[20:23], v[152:155]
    v_mfma_f32_16x16x32_bf16 v[156:159], v[60:63], v[20:23], v[156:159]
    ds_read_b128 v[20:23], v3 offset:34816
    ds_read_b64_tr_b16 v[68:69], v5 offset:40960
    ds_read_b64_tr_b16 v[70:71], v5 offset:41984
    v_mfma_f32_16x16x32_bf16 v[160:163], v[48:51], v[24:27], v[160:163]
    v_mfma_f32_16x16x32_bf16 v[164:167], v[52:55], v[24:27], v[164:167]
    v_mfma_f32_16x16x32_bf16 v[168:171], v[56:59], v[24:27], v[168:171]
    v_mfma_f32_16x16x32_bf16 v[172:175], v[60:63], v[24:27], v[172:175]
    ds_read_b128 v[24:27], v3 offset:36864
    ds_read_b64_tr_b16 v[72:73], v6 offset:40960
    ds_read_b64_tr_b16 v[74:75], v6 offset:41984
    v_mfma_f32_16x16x32_bf16 v[176:179], v[48:51], v[28:31], v[176:179]
    v_mfma_f32_16x16x32_bf16 v[180:183], v[52:55], v[28:31], v[180:183]
    v_mfma_f32_16x16x32_bf16 v[184:187], v[56:59], v[28:31], v[184:187]
    v_mfma_f32_16x16x32_bf16 v[188:191], v[60:63], v[28:31], v[188:191]
    ds_read_b128 v[28:31], v3 offset:38912
    ds_read_b64_tr_b16 v[76:77], v7 offset:40960
    ds_read_b64_tr_b16 v[78:79], v7 offset:41984
    s_waitcnt lgkmcnt(12)
    v_mfma_f32_16x16x32_bf16 v[192:195], v[48:51], v[32:35], v[192:195]
    v_mfma_f32_16x16x32_bf16 v[196:199], v[52:55], v[32:35], v[196:199]
    v_mfma_f32_16x16x32_bf16 v[200:203], v[56:59], v[32:35], v[200:203]
    v_mfma_f32_16x16x32_bf16 v[204:207], v[60:63], v[32:35], v[204:207]
    ds_read_b128 v[32:35], v3 offset:40960
    v_mfma_f32_16x16x32_bf16 v[208:211], v[48:51], v[36:39], v[208:211]
    v_mfma_f32_16x16x32_bf16 v[212:215], v[52:55], v[36:39], v[212:215]
    v_mfma_f32_16x16x32_bf16 v[216:219], v[56:59], v[36:39], v[216:219]
    v_mfma_f32_16x16x32_bf16 v[220:223], v[60:63], v[36:39], v[220:223]
    ds_read_b128 v[36:39], v3 offset:43008
    v_mfma_f32_16x16x32_bf16 v[224:227], v[48:51], v[40:43], v[224:227]
    v_mfma_f32_16x16x32_bf16 v[228:231], v[52:55], v[40:43], v[228:231]
    v_mfma_f32_16x16x32_bf16 v[232:235], v[56:59], v[40:43], v[232:235]
    v_mfma_f32_16x16x32_bf16 v[236:239], v[60:63], v[40:43], v[236:239]
    ds_read_b128 v[40:43], v3 offset:45056
    v_mfma_f32_16x16x32_bf16 v[240:243], v[48:51], v[44:47], v[240:243]
    v_mfma_f32_16x16x32_bf16 v[244:247], v[52:55], v[44:47], v[244:247]
    v_mfma_f32_16x16x32_bf16 v[248:251], v[56:59], v[44:47], v[248:251]
    v_mfma_f32_16x16x32_bf16 v[252:255], v[60:63], v[44:47], v[252:255]
    ds_read_b128 v[44:47], v3 offset:47104
    s_waitcnt lgkmcnt(4)
    v_mfma_f32_16x16x32_bf16 v[128:131], v[64:67], v[16:19], v[128:131]
    v_mfma_f32_16x16x32_bf16 v[132:135], v[68:71], v[16:19], v[132:135]
    v_mfma_f32_16x16x32_bf16 v[136:139], v[72:75], v[16:19], v[136:139]
    v_mfma_f32_16x16x32_bf16 v[140:143], v[76:79], v[16:19], v[140:143]
    v_mfma_f32_16x16x32_bf16 v[144:147], v[64:67], v[20:23], v[144:147]
    v_mfma_f32_16x16x32_bf16 v[148:151], v[68:71], v[20:23], v[148:151]
    v_mfma_f32_16x16x32_bf16 v[152:155], v[72:75], v[20:23], v[152:155]
    v_mfma_f32_16x16x32_bf16 v[156:159], v[76:79], v[20:23], v[156:159]
    s_waitcnt lgkmcnt(0)
    s_cbranch_vccnz Lfw_65
    s_waitcnt vmcnt(1)
    s_cmp_eq_u32 s60, 0
    s_cbranch_scc1 Lfw_66
    s_waitcnt vmcnt(0)
Lfw_65:
Lfw_66:
    s_barrier
    ds_read_b128 v[16:19], v2 offset:0
    ds_read_b128 v[20:23], v2 offset:2048
    ds_read_b64_tr_b16 v[48:49], v4 offset:0
    ds_read_b64_tr_b16 v[50:51], v4 offset:1024
    ds_read_b64_tr_b16 v[52:53], v5 offset:0
    ds_read_b64_tr_b16 v[54:55], v5 offset:1024
    v_mfma_f32_16x16x32_bf16 v[160:163], v[64:67], v[24:27], v[160:163]
    v_mfma_f32_16x16x32_bf16 v[164:167], v[68:71], v[24:27], v[164:167]
    v_mfma_f32_16x16x32_bf16 v[168:171], v[72:75], v[24:27], v[168:171]
    v_mfma_f32_16x16x32_bf16 v[172:175], v[76:79], v[24:27], v[172:175]
    ds_read_b128 v[24:27], v2 offset:4096
    ds_read_b64_tr_b16 v[56:57], v6 offset:0
    ds_read_b64_tr_b16 v[58:59], v6 offset:1024
    s_cbranch_vccnz Lnd_67
    s_add_u32 m0, s81, 32768
    s_nop 0
    buffer_load_dwordx4 v8, s[44:47], s64 offen lds
    s_add_u32 m0, s81, 33792
    s_nop 0
    buffer_load_dwordx4 v9, s[44:47], s64 offen lds
Lnd_67:
    v_mfma_f32_16x16x32_bf16 v[176:179], v[64:67], v[28:31], v[176:179]
    v_mfma_f32_16x16x32_bf16 v[180:183], v[68:71], v[28:31], v[180:183]
    v_mfma_f32_16x16x32_bf16 v[184:187], v[72:75], v[28:31], v[184:187]
    v_mfma_f32_16x16x32_bf16 v[188:191], v[76:79], v[28:31], v[188:191]
    ds_read_b128 v[28:31], v2 offset:6144
    ds_read_b64_tr_b16 v[60:61], v7 offset:0
    ds_read_b64_tr_b16 v[62:63], v7 offset:1024
    s_cbranch_vccnz Lnd_68
    s_add_u32 s68, s64, s4
    s_add_u32 m0, s81, 34816
    s_nop 0
    buffer_load_dwordx4 v8, s[44:47], s68 offen lds
    s_add_u32 s68, s64, s4
    s_add_u32 m0, s81, 35840
    s_nop 0
    buffer_load_dwordx4 v9, s[44:47], s68 offen lds
Lnd_68:
    v_mfma_f32_16x16x32_bf16 v[192:195], v[64:67], v[32:35], v[192:195]
    v_mfma_f32_16x16x32_bf16 v[196:199], v[68:71], v[32:35], v[196:199]
    v_mfma_f32_16x16x32_bf16 v[200:203], v[72:75], v[32:35], v[200:203]
    v_mfma_f32_16x16x32_bf16 v[204:207], v[76:79], v[32:35], v[204:207]
    ds_read_b128 v[32:35], v2 offset:8192
    s_cbranch_vccnz Lnd_69
    s_add_u32 m0, s81, 49152
    s_nop 0
    buffer_load_dwordx4 v8, s[44:47], s65 offen lds
    s_add_u32 m0, s81, 50176
    s_nop 0
    buffer_load_dwordx4 v9, s[44:47], s65 offen lds
    s_add_u32 s68, s65, s4
    s_add_u32 m0, s81, 51200
    s_nop 0
    buffer_load_dwordx4 v8, s[44:47], s68 offen lds
Lnd_69:
    v_mfma_f32_16x16x32_bf16 v[208:211], v[64:67], v[36:39], v[208:211]
    v_mfma_f32_16x16x32_bf16 v[212:215], v[68:71], v[36:39], v[212:215]
    v_mfma_f32_16x16x32_bf16 v[216:219], v[72:75], v[36:39], v[216:219]
    v_mfma_f32_16x16x32_bf16 v[220:223], v[76:79], v[36:39], v[220:223]
    ds_read_b128 v[36:39], v2 offset:10240
    s_cbranch_vccnz Lnd_70
    s_add_u32 s68, s65, s4
    s_add_u32 m0, s81, 52224
    s_nop 0
    buffer_load_dwordx4 v9, s[44:47], s68 offen lds
    s_add_u32 m0, s81, 98304
    s_nop 0
    buffer_load_dwordx4 v10, s[48:51], s66 offen lds
    s_add_u32 s68, s66, s5
    s_add_u32 m0, s81, 99328
    s_nop 0
    buffer_load_dwordx4 v10, s[48:51], s68 offen lds
Lnd_70:
    v_mfma_f32_16x16x32_bf16 v[224:227], v[64:67], v[40:43], v[224:227]
    v_mfma_f32_16x16x32_bf16 v[228:231], v[68:71], v[40:43], v[228:231]
    v_mfma_f32_16x16x32_bf16 v[232:235], v[72:75], v[40:43], v[232:235]
    v_mfma_f32_16x16x32_bf16 v[236:239], v[76:79], v[40:43], v[236:239]
    ds_read_b128 v[40:43], v2 offset:12288
    s_cbranch_vccnz Lnd_71
    s_add_u32 m0, s81, 100352
    s_nop 0
    buffer_load_dwordx4 v11, s[48:51], s66 offen lds
    s_add_u32 s68, s66, s5
    s_add_u32 m0, s81, 101376
    s_nop 0
    buffer_load_dwordx4 v11, s[48:51], s68 offen lds
    s_add_u32 m0, s81, 114688
    s_nop 0
    buffer_load_dwordx4 v12, s[96:99], s67 offen lds
Lnd_71:
    v_mfma_f32_16x16x32_bf16 v[240:243], v[64:67], v[44:47], v[240:243]
    v_mfma_f32_16x16x32_bf16 v[244:247], v[68:71], v[44:47], v[244:247]
    v_mfma_f32_16x16x32_bf16 v[248:251], v[72:75], v[44:47], v[248:251]
    v_mfma_f32_16x16x32_bf16 v[252:255], v[76:79], v[44:47], v[252:255]
    ds_read_b128 v[44:47], v2 offset:14336
    s_cbranch_vccnz Lnd_72
    s_add_u32 s68, s67, s6
    s_add_u32 m0, s81, 115712
    s_nop 0
    buffer_load_dwordx4 v12, s[96:99], s68 offen lds
    s_add_u32 m0, s81, 116736
    s_nop 0
    buffer_load_dwordx4 v13, s[96:99], s67 offen lds
    s_add_u32 s68, s67, s6
    s_add_u32 m0, s81, 117760
    s_nop 0
    buffer_load_dwordx4 v13, s[96:99], s68 offen lds
Lnd_72:
    s_add_u32 s64, s64, 128
    s_add_u32 s65, s65, 128
    s_add_u32 s66, s66, s7
    s_add_u32 s67, s67, s8
    s_sub_u32 s70, 15, s72
    v_and_b32 v88, 15, v1
    v_mov_b32 v89, s70
    v_mov_b32 v90, s72
    v_and_b32 v91, 16, v1
    v_cmp_eq_u32 s[68:69], 0, v91
    s_nop 1
    v_cndmask_b32 v89, v90, v89, s[68:69]
    v_lshl_add_u32 v88, v89, 4, v88
    v_lshlrev_b32 v88, 7, v88
    s_cmp_lg_u32 s60, 0
    s_cbranch_scc1 Lnw0_73
    s_add_u32 s56, s42, 209715200
    s_addc_u32 s57, s43, 0
    s_mov_b32 s58, 262144
    s_and_b32 s57, s57, 0xffff
    s_mov_b32 s59, 0x00020000
    buffer_load_dwordx2 v[92:93], v88, s[56:59], 0 offen sc0 sc1
Lnw0_73:
    s_add_u32 s44, s42, 220200960
    s_addc_u32 s45, s43, 0
    s_mov_b32 s46, 4456448
    s_and_b32 s45, s45, 0xffff
    s_mov_b32 s47, 0x00020000
    s_mul_i32 s64, s70, 278528
    s_mul_i32 s65, s72, 278528
    s_lshl_b32 s68, s73, 8
    s_add_u32 s48, s20, s68
    s_addc_u32 s49, s21, 0
    s_sub_u32 s50, 8388608, s68
    s_and_b32 s49, s49, 0xffff
    s_mov_b32 s51, 0x00020000
    s_lshl_b32 s68, s82, 8
    s_add_u32 s96, s30, s68
    s_addc_u32 s97, s31, 0
    s_sub_u32 s98, 7340032, s68
    s_and_b32 s97, s97, 0xffff
    s_mov_b32 s99, 0x00020000
    s_cmp_eq_u32 s82, 99
    s_cselect_b32 s98, 0, s98
    v_lshrrev_b32 v80, 3, v1
    v_lshrrev_b32 v81, 4, v1
    v_and_b32 v82, 7, v1
    v_xor_b32 v82, v82, v81
    v_lshlrev_b32 v82, 4, v82
    v_xor_b32 v83, 64, v82
    s_lshl_b32 s68, s60, 5
    v_add_u32 v80, s68, v80
    s_mov_b32 s69, 2176
    v_mul_lo_u32 v80, v80, s69
    v_add_u32 v8, v80, v82
    v_add_u32 v80, 17408, v80
    v_add_u32 v9, v80, v83
    s_mov_b32 s4, 34816
    v_and_b32 v82, 15, v1
    v_lshlrev_b32 v83, 1, v81
    v_xor_b32 v82, v82, v83
    v_lshlrev_b32 v82, 4, v82
    v_xor_b32 v83, 128, v82
    s_lshl_b32 s68, s60, 4
    v_add_u32 v84, s68, v81
    s_mov_b32 s69, 8192
    v_mul_lo_u32 v80, v84, s69
    v_add_u32 v10, v80, v82
    v_add_u32 v80, 65536, v80
    v_add_u32 v11, v80, v83
    s_mov_b32 s5, 32768
    s_mov_b32 s7, 524288
    s_mov_b32 s69, 7168
    v_mul_lo_u32 v80, v84, s69
    v_add_u32 v12, v80, v82
    v_add_u32 v80, 57344, v80
    v_add_u32 v13, v80, v83
    s_mov_b32 s6, 28672
    s_mov_b32 s8, 458752
    s_mov_b32 s66, 0
    s_mov_b32 s67, 0
    s_waitcnt lgkmcnt(4)
    v_mfma_f32_16x16x32_bf16 v[128:131], v[48:51], v[16:19], v[128:131]
    v_mfma_f32_16x16x32_bf16 v[132:135], v[52:55], v[16:19], v[132:135]
    v_mfma_f32_16x16x32_bf16 v[136:139], v[56:59], v[16:19], v[136:139]
    v_mfma_f32_16x16x32_bf16 v[140:143], v[60:63], v[16:19], v[140:143]
    ds_read_b128 v[16:19], v3 offset:0
    ds_read_b64_tr_b16 v[64:65], v4 offset:8192
    ds_read_b64_tr_b16 v[66:67], v4 offset:9216
    v_mfma_f32_16x16x32_bf16 v[144:147], v[48:51], v[20:23], v[144:147]
    v_mfma_f32_16x16x32_bf16 v[148:151], v[52:55], v[20:23], v[148:151]
    v_mfma_f32_16x16x32_bf16 v[152:155], v[56:59], v[20:23], v[152:155]
    v_mfma_f32_16x16x32_bf16 v[156:159], v[60:63], v[20:23], v[156:159]
    ds_read_b128 v[20:23], v3 offset:2048
    ds_read_b64_tr_b16 v[68:69], v5 offset:8192
    ds_read_b64_tr_b16 v[70:71], v5 offset:9216
    v_mfma_f32_16x16x32_bf16 v[160:163], v[48:51], v[24:27], v[160:163]
    v_mfma_f32_16x16x32_bf16 v[164:167], v[52:55], v[24:27], v[164:167]
    v_mfma_f32_16x16x32_bf16 v[168:171], v[56:59], v[24:27], v[168:171]
    v_mfma_f32_16x16x32_bf16 v[172:175], v[60:63], v[24:27], v[172:175]
    ds_read_b128 v[24:27], v3 offset:4096
    ds_read_b64_tr_b16 v[72:73], v6 offset:8192
    ds_read_b64_tr_b16 v[74:75], v6 offset:9216
    v_mfma_f32_16x16x32_bf16 v[176:179], v[48:51], v[28:31], v[176:179]
    v_mfma_f32_16x16x32_bf16 v[180:183], v[52:55], v[28:31], v[180:183]
    v_mfma_f32_16x16x32_bf16 v[184:187], v[56:59], v[28:31], v[184:187]
    v_mfma_f32_16x16x32_bf16 v[188:191], v[60:63], v[28:31], v[188:191]
    ds_read_b128 v[28:31], v3 offset:6144
    ds_read_b64_tr_b16 v[76:77], v7 offset:8192
    ds_read_b64_tr_b16 v[78:79], v7 offset:9216
    s_waitcnt lgkmcnt(12)
    v_mfma_f32_16x16x32_bf16 v[192:195], v[48:51], v[32:35], v[192:195]
    v_mfma_f32_16x16x32_bf16 v[196:199], v[52:55], v[32:35], v[196:199]
    v_mfma_f32_16x16x32_bf16 v[200:203], v[56:59], v[32:35], v[200:203]
    v_mfma_f32_16x16x32_bf16 v[204:207], v[60:63], v[32:35], v[204:207]
    ds_read_b128 v[32:35], v3 offset:8192
    v_mfma_f32_16x16x32_bf16 v[208:211], v[48:51], v[36:39], v[208:211]
    v_mfma_f32_16x16x32_bf16 v[212:215], v[52:55], v[36:39], v[212:215]
    v_mfma_f32_16x16x32_bf16 v[216:219], v[56:59], v[36:39], v[216:219]
    v_mfma_f32_16x16x32_bf16 v[220:223], v[60:63], v[36:39], v[220:223]
    ds_read_b128 v[36:39], v3 offset:10240
    v_mfma_f32_16x16x32_bf16 v[224:227], v[48:51], v[40:43], v[224:227]
    v_mfma_f32_16x16x32_bf16 v[228:231], v[52:55], v[40:43], v[228:231]
    v_mfma_f32_16x16x32_bf16 v[232:235], v[56:59], v[40:43], v[232:235]
    v_mfma_f32_16x16x32_bf16 v[236:239], v[60:63], v[40:43], v[236:239]
    ds_read_b128 v[40:43], v3 offset:12288
    v_mfma_f32_16x16x32_bf16 v[240:243], v[48:51], v[44:47], v[240:243]
    v_mfma_f32_16x16x32_bf16 v[244:247], v[52:55], v[44:47], v[244:247]
    v_mfma_f32_16x16x32_bf16 v[248:251], v[56:59], v[44:47], v[248:251]
    v_mfma_f32_16x16x32_bf16 v[252:255], v[60:63], v[44:47], v[252:255]
    ds_read_b128 v[44:47], v3 offset:14336
    s_waitcnt lgkmcnt(4)
    v_mfma_f32_16x16x32_bf16 v[128:131], v[64:67], v[16:19], v[128:131]
    v_mfma_f32_16x16x32_bf16 v[132:135], v[68:71], v[16:19], v[132:135]
    v_mfma_f32_16x16x32_bf16 v[136:139], v[72:75], v[16:19], v[136:139]
    v_mfma_f32_16x16x32_bf16 v[140:143], v[76:79], v[16:19], v[140:143]
    v_mfma_f32_16x16x32_bf16 v[144:147], v[64:67], v[20:23], v[144:147]
    v_mfma_f32_16x16x32_bf16 v[148:151], v[68:71], v[20:23], v[148:151]
    v_mfma_f32_16x16x32_bf16 v[152:155], v[72:75], v[20:23], v[152:155]
    v_mfma_f32_16x16x32_bf16 v[156:159], v[76:79], v[20:23], v[156:159]
    s_waitcnt lgkmcnt(0)
    s_cbranch_vccnz Lfw_74
    s_waitcnt vmcnt(0)
Lfw_74:
Lfw_75:
    s_cmp_lg_u32 s60, 0
    s_cbranch_scc1 Lnw0_76
    s_add_u32 s56, s42, 209715200
    s_addc_u32 s57, s43, 0
    s_mov_b32 s58, 262144
    s_and_b32 s57, s57, 0xffff
    s_mov_b32 s59, 0x00020000
    s_mov_b32 s14, 0x400000
    s_branch Lpoll_77
Lld_79:
    buffer_load_dwordx2 v[92:93], v88, s[56:59], 0 offen sc0 sc1
    s_waitcnt vmcnt(0)
Lpoll_77:
    v_cmp_ne_u32 vcc, s12, v92
    v_cmp_ne_u32 s[68:69], s13, v93
    s_nop 3
    s_or_b64 vcc, vcc, s[68:69]
    s_cbranch_scc0 Lok_78
    s_sleep 1
    s_sub_u32 s14, s14, 1
    s_cmp_lg_u32 s14, 0
    s_cbranch_scc1 Lld_79
    s_mov_b64 vcc, 0
Lok_78:
Lnw0_76:
    s_barrier
    ds_read_b128 v[16:19], v2 offset:32768
    ds_read_b128 v[20:23], v2 offset:34816
    ds_read_b64_tr_b16 v[48:49], v4 offset:32768
    ds_read_b64_tr_b16 v[50:51], v4 offset:33792
    ds_read_b64_tr_b16 v[52:53], v5 offset:32768
    ds_read_b64_tr_b16 v[54:55], v5 offset:33792
    v_mfma_f32_16x16x32_bf16 v[160:163], v[64:67], v[24:27], v[160:163]
    v_mfma_f32_16x16x32_bf16 v[164:167], v[68:71], v[24:27], v[164:167]
    v_mfma_f32_16x16x32_bf16 v[168:171], v[72:75], v[24:27], v[168:171]
    v_mfma_f32_16x16x32_bf16 v[172:175], v[76:79], v[24:27], v[172:175]
    ds_read_b128 v[24:27], v2 offset:36864
    ds_read_b64_tr_b16 v[56:57], v6 offset:32768
    ds_read_b64_tr_b16 v[58:59], v6 offset:33792
    s_cbranch_vccnz Lnd_80
    s_add_u32 m0, s81, 0
    s_nop 0
    buffer_load_dwordx4 v8, s[44:47], s64 offen lds
    s_add_u32 m0, s81, 1024
    s_nop 0
    buffer_load_dwordx4 v9, s[44:47], s64 offen lds
Lnd_80:
    v_mfma_f32_16x16x32_bf16 v[176:179], v[64:67], v[28:31], v[176:179]
    v_mfma_f32_16x16x32_bf16 v[180:183], v[68:71], v[28:31], v[180:183]
    v_mfma_f32_16x16x32_bf16 v[184:187], v[72:75], v[28:31], v[184:187]
    v_mfma_f32_16x16x32_bf16 v[188:191], v[76:79], v[28:31], v[188:191]
    ds_read_b128 v[28:31], v2 offset:38912
    ds_read_b64_tr_b16 v[60:61], v7 offset:32768
    ds_read_b64_tr_b16 v[62:63], v7 offset:33792
    s_cbranch_vccnz Lnd_81
    s_add_u32 s68, s64, s4
    s_add_u32 m0, s81, 2048
    s_nop 0
    buffer_load_dwordx4 v8, s[44:47], s68 offen lds
    s_add_u32 s68, s64, s4
    s_add_u32 m0, s81, 3072
    s_nop 0
    buffer_load_dwordx4 v9, s[44:47], s68 offen lds
Lnd_81:
    v_mfma_f32_16x16x32_bf16 v[192:195], v[64:67], v[32:35], v[192:195]
    v_mfma_f32_16x16x32_bf16 v[196:199], v[68:71], v[32:35], v[196:199]
    v_mfma_f32_16x16x32_bf16 v[200:203], v[72:75], v[32:35], v[200:203]
    v_mfma_f32_16x16x32_bf16 v[204:207], v[76:79], v[32:35], v[204:207]
    ds_read_b128 v[32:35], v2 offset:40960
    s_cbranch_vccnz Lnd_82
    s_add_u32 m0, s81, 16384
    s_nop 0
    buffer_load_dwordx4 v8, s[44:47], s65 offen lds
    s_add_u32 m0, s81, 17408
    s_nop 0
    buffer_load_dwordx4 v9, s[44:47], s65 offen lds
    s_add_u32 s68, s65, s4
    s_add_u32 m0, s81, 18432
    s_nop 0
    buffer_load_dwordx4 v8, s[44:47], s68 offen lds
Lnd_82:
    v_mfma_f32_16x16x32_bf16 v[208:211], v[64:67], v[36:39], v[208:211]
    v_mfma_f32_16x16x32_bf16 v[212:215], v[68:71], v[36:39], v[212:215]
    v_mfma_f32_16x16x32_bf16 v[216:219], v[72:75], v[36:39], v[216:219]
    v_mfma_f32_16x16x32_bf16 v[220:223], v[76:79], v[36:39], v[220:223]
    ds_read_b128 v[36:39], v2 offset:43008
    s_cbranch_vccnz Lnd_83
    s_add_u32 s68, s65, s4
    s_add_u32 m0, s81, 19456
    s_nop 0
    buffer_load_dwordx4 v9, s[44:47], s68 offen lds
    s_add_u32 m0, s81, 65536
    s_nop 0
    buffer_load_dwordx4 v10, s[48:51], s66 offen lds
    s_add_u32 s68, s66, s5
    s_add_u32 m0, s81, 66560
    s_nop 0
    buffer_load_dwordx4 v10, s[48:51], s68 offen lds
Lnd_83:
    v_mfma_f32_16x16x32_bf16 v[224:227], v[64:67], v[40:43], v[224:227]
    v_mfma_f32_16x16x32_bf16 v[228:231], v[68:71], v[40:43], v[228:231]
    v_mfma_f32_16x16x32_bf16 v[232:235], v[72:75], v[40:43], v[232:235]
    v_mfma_f32_16x16x32_bf16 v[236:239], v[76:79], v[40:43], v[236:239]
    ds_read_b128 v[40:43], v2 offset:45056
    s_cbranch_vccnz Lnd_84
    s_add_u32 m0, s81, 67584
    s_nop 0
    buffer_load_dwordx4 v11, s[48:51], s66 offen lds
    s_add_u32 s68, s66, s5
    s_add_u32 m0, s81, 68608
    s_nop 0
    buffer_load_dwordx4 v11, s[48:51], s68 offen lds
    s_add_u32 m0, s81, 81920
    s_nop 0
    buffer_load_dwordx4 v12, s[96:99], s67 offen lds
Lnd_84:
    v_mfma_f32_16x16x32_bf16 v[240:243], v[64:67], v[44:47], v[240:243]
    v_mfma_f32_16x16x32_bf16 v[244:247], v[68:71], v[44:47], v[244:247]
    v_mfma_f32_16x16x32_bf16 v[248:251], v[72:75], v[44:47], v[248:251]
    v_mfma_f32_16x16x32_bf16 v[252:255], v[76:79], v[44:47], v[252:255]
    ds_read_b128 v[44:47], v2 offset:47104
    s_cbranch_vccnz Lnd_85
    s_add_u32 s68, s67, s6
    s_add_u32 m0, s81, 82944
    s_nop 0
    buffer_load_dwordx4 v12, s[96:99], s68 offen lds
    s_add_u32 m0, s81, 83968
    s_nop 0
    buffer_load_dwordx4 v13, s[96:99], s67 offen lds
    s_add_u32 s68, s67, s6
    s_add_u32 m0, s81, 84992
    s_nop 0
    buffer_load_dwordx4 v13, s[96:99], s68 offen lds
Lnd_85:
    s_add_u32 s64, s64, 128
    s_add_u32 s65, s65, 128
    s_add_u32 s66, s66, s7
    s_add_u32 s67, s67, s8
    s_waitcnt lgkmcnt(4)
    v_mfma_f32_16x16x32_bf16 v[128:131], v[48:51], v[16:19], v[128:131]
    v_mfma_f32_16x16x32_bf16 v[132:135], v[52:55], v[16:19], v[132:135]
    v_mfma_f32_16x16x32_bf16 v[136:139], v[56:59], v[16:19], v[136:139]
    v_mfma_f32_16x16x32_bf16 v[140:143], v[60:63], v[16:19], v[140:143]
    ds_read_b128 v[16:19], v3 offset:32768
    ds_read_b64_tr_b16 v[64:65], v4 offset:40960
    ds_read_b64_tr_b16 v[66:67], v4 offset:41984
    v_mfma_f32_16x16x32_bf16 v[144:147], v[48:51], v[20:23], v[144:147]
    v_mfma_f32_16x16x32_bf16 v[148:151], v[52:55], v[20:23], v[148:151]
    v_mfma_f32_16x16x32_bf16 v[152:155], v[56:59], v[20:23], v[152:155]
    v_mfma_f32_16x16x32_bf16 v[156:159], v[60:63], v[20:23], v[156:159]
    ds_read_b128 v[20:23], v3 offset:34816
    ds_read_b64_tr_b16 v[68:69], v5 offset:40960
    ds_read_b64_tr_b16 v[70:71], v5 offset:41984
    v_mfma_f32_16x16x32_bf16 v[160:163], v[48:51], v[24:27], v[160:163]
    v_mfma_f32_16x16x32_bf16 v[164:167], v[52:55], v[24:27], v[164:167]
    v_mfma_f32_16x16x32_bf16 v[168:171], v[56:59], v[24:27], v[168:171]
    v_mfma_f32_16x16x32_bf16 v[172:175], v[60:63], v[24:27], v[172:175]
    ds_read_b128 v[24:27], v3 offset:36864
    ds_read_b64_tr_b16 v[72:73], v6 offset:40960
    ds_read_b64_tr_b16 v[74:75], v6 offset:41984
    v_mfma_f32_16x16x32_bf16 v[176:179], v[48:51], v[28:31], v[176:179]
    v_mfma_f32_16x16x32_bf16 v[180:183], v[52:55], v[28:31], v[180:183]
    v_mfma_f32_16x16x32_bf16 v[184:187], v[56:59], v[28:31], v[184:187]
    v_mfma_f32_16x16x32_bf16 v[188:191], v[60:63], v[28:31], v[188:191]
    ds_read_b128 v[28:31], v3 offset:38912
    ds_read_b64_tr_b16 v[76:77], v7 offset:40960
    ds_read_b64_tr_b16 v[78:79], v7 offset:41984
    s_waitcnt lgkmcnt(12)
    v_mfma_f32_16x16x32_bf16 v[192:195], v[48:51], v[32:35], v[192:195]
    v_mfma_f32_16x16x32_bf16 v[196:199], v[52:55], v[32:35], v[196:199]
    v_mfma_f32_16x16x32_bf16 v[200:203], v[56:59], v[32:35], v[200:203]
    v_mfma_f32_16x16x32_bf16 v[204:207], v[60:63], v[32:35], v[204:207]
    ds_read_b128 v[32:35], v3 offset:40960
    v_mfma_f32_16x16x32_bf16 v[208:211], v[48:51], v[36:39], v[208:211]
    v_mfma_f32_16x16x32_bf16 v[212:215], v[52:55], v[36:39], v[212:215]
    v_mfma_f32_16x16x32_bf16 v[216:219], v[56:59], v[36:39], v[216:219]
    v_mfma_f32_16x16x32_bf16 v[220:223], v[60:63], v[36:39], v[220:223]
    ds_read_b128 v[36:39], v3 offset:43008
    v_mfma_f32_16x16x32_bf16 v[224:227], v[48:51], v[40:43], v[224:227]
    v_mfma_f32_16x16x32_bf16 v[228:231], v[52:55], v[40:43], v[228:231]
    v_mfma_f32_16x16x32_bf16 v[232:235], v[56:59], v[40:43], v[232:235]
    v_mfma_f32_16x16x32_bf16 v[236:239], v[60:63], v[40:43], v[236:239]
    ds_read_b128 v[40:43], v3 offset:45056
    v_mfma_f32_16x16x32_bf16 v[240:243], v[48:51], v[44:47], v[240:243]
    v_mfma_f32_16x16x32_bf16 v[244:247], v[52:55], v[44:47], v[244:247]
    v_mfma_f32_16x16x32_bf16 v[248:251], v[56:59], v[44:47], v[248:251]
    v_mfma_f32_16x16x32_bf16 v[252:255], v[60:63], v[44:47], v[252:255]
    ds_read_b128 v[44:47], v3 offset:47104
    s_waitcnt lgkmcnt(4)
    v_mfma_f32_16x16x32_bf16 v[128:131], v[64:67], v[16:19], v[128:131]
    v_mfma_f32_16x16x32_bf16 v[132:135], v[68:71], v[16:19], v[132:135]
    v_mfma_f32_16x16x32_bf16 v[136:139], v[72:75], v[16:19], v[136:139]
    v_mfma_f32_16x16x32_bf16 v[140:143], v[76:79], v[16:19], v[140:143]
    v_mfma_f32_16x16x32_bf16 v[144:147], v[64:67], v[20:23], v[144:147]
    v_mfma_f32_16x16x32_bf16 v[148:151], v[68:71], v[20:23], v[148:151]
    v_mfma_f32_16x16x32_bf16 v[152:155], v[72:75], v[20:23], v[152:155]
    v_mfma_f32_16x16x32_bf16 v[156:159], v[76:79], v[20:23], v[156:159]
    s_waitcnt lgkmcnt(0)
    s_cbranch_vccnz Lfw_86
    s_waitcnt vmcnt(0)
Lfw_86:
Lfw_87:
    s_barrier
    ds_read_b128 v[16:19], v2 offset:0
    ds_read_b128 v[20:23], v2 offset:2048
    ds_read_b64_tr_b16 v[48:49], v4 offset:0
    ds_read_b64_tr_b16 v[50:51], v4 offset:1024
    ds_read_b64_tr_b16 v[52:53], v5 offset:0
    ds_read_b64_tr_b16 v[54:55], v5 offset:1024
    v_mfma_f32_16x16x32_bf16 v[160:163], v[64:67], v[24:27], v[160:163]
    v_mfma_f32_16x16x32_bf16 v[164:167], v[68:71], v[24:27], v[164:167]
    v_mfma_f32_16x16x32_bf16 v[168:171], v[72:75], v[24:27], v[168:171]
    v_mfma_f32_16x16x32_bf16 v[172:175], v[76:79], v[24:27], v[172:175]
    ds_read_b128 v[24:27], v2 offset:4096
    ds_read_b64_tr_b16 v[56:57], v6 offset:0
    ds_read_b64_tr_b16 v[58:59], v6 offset:1024
    s_cbranch_vccnz Lnd_88
    s_add_u32 m0, s81, 32768
    s_nop 0
    buffer_load_dwordx4 v8, s[44:47], s64 offen lds
    s_add_u32 m0, s81, 33792
    s_nop 0
    buffer_load_dwordx4 v9, s[44:47], s64 offen lds
Lnd_88:
    v_mfma_f32_16x16x32_bf16 v[176:179], v[64:67], v[28:31], v[176:179]
    v_mfma_f32_16x16x32_bf16 v[180:183], v[68:71], v[28:31], v[180:183]
    v_mfma_f32_16x16x32_bf16 v[184:187], v[72:75], v[28:31], v[184:187]
    v_mfma_f32_16x16x32_bf16 v[188:191], v[76:79], v[28:31], v[188:191]
    ds_read_b128 v[28:31], v2 offset:6144
    ds_read_b64_tr_b16 v[60:61], v7 offset:0
    ds_read_b64_tr_b16 v[62:63], v7 offset:1024
    s_cbranch_vccnz Lnd_89
    s_add_u32 s68, s64, s4
    s_add_u32 m0, s81, 34816
    s_nop 0
    buffer_load_dwordx4 v8, s[44:47], s68 offen lds
    s_add_u32 s68, s64, s4
    s_add_u32 m0, s81, 35840
    s_nop 0
    buffer_load_dwordx4 v9, s[44:47], s68 offen lds
Lnd_89:
    v_mfma_f32_16x16x32_bf16 v[192:195], v[64:67], v[32:35], v[192:195]
    v_mfma_f32_16x16x32_bf16 v[196:199], v[68:71], v[32:35], v[196:199]
    v_mfma_f32_16x16x32_bf16 v[200:203], v[72:75], v[32:35], v[200:203]
    v_mfma_f32_16x16x32_bf16 v[204:207], v[76:79], v[32:35], v[204:207]
    ds_read_b128 v[32:35], v2 offset:8192
    s_cbranch_vccnz Lnd_90
    s_add_u32 m0, s81, 49152
    s_nop 0
    buffer_load_dwordx4 v8, s[44:47], s65 offen lds
    s_add_u32 m0, s81, 50176
    s_nop 0
    buffer_load_dwordx4 v9, s[44:47], s65 offen lds
    s_add_u32 s68, s65, s4
    s_add_u32 m0, s81, 51200
    s_nop 0
    buffer_load_dwordx4 v8, s[44:47], s68 offen lds
Lnd_90:
    v_mfma_f32_16x16x32_bf16 v[208:211], v[64:67], v[36:39], v[208:211]
    v_mfma_f32_16x16x32_bf16 v[212:215], v[68:71], v[36:39], v[212:215]
    v_mfma_f32_16x16x32_bf16 v[216:219], v[72:75], v[36:39], v[216:219]
    v_mfma_f32_16x16x32_bf16 v[220:223], v[76:79], v[36:39], v[220:223]
    ds_read_b128 v[36:39], v2 offset:10240
    s_cbranch_vccnz Lnd_91
    s_add_u32 s68, s65, s4
    s_add_u32 m0, s81, 52224
    s_nop 0
    buffer_load_dwordx4 v9, s[44:47], s68 offen lds
    s_add_u32 m0, s81, 98304
    s_nop 0
    buffer_load_dwordx4 v10, s[48:51], s66 offen lds
    s_add_u32 s68, s66, s5
    s_add_u32 m0, s81, 99328
    s_nop 0
    buffer_load_dwordx4 v10, s[48:51], s68 offen lds
Lnd_91:
    v_mfma_f32_16x16x32_bf16 v[224:227], v[64:67], v[40:43], v[224:227]
    v_mfma_f32_16x16x32_bf16 v[228:231], v[68:71], v[40:43], v[228:231]
    v_mfma_f32_16x16x32_bf16 v[232:235], v[72:75], v[40:43], v[232:235]
    v_mfma_f32_16x16x32_bf16 v[236:239], v[76:79], v[40:43], v[236:239]
    ds_read_b128 v[40:43], v2 offset:12288
    s_cbranch_vccnz Lnd_92
    s_add_u32 m0, s81, 100352
    s_nop 0
    buffer_load_dwordx4 v11, s[48:51], s66 offen lds
    s_add_u32 s68, s66, s5
    s_add_u32 m0, s81, 101376
    s_nop 0
    buffer_load_dwordx4 v11, s[48:51], s68 offen lds
    s_add_u32 m0, s81, 114688
    s_nop 0
    buffer_load_dwordx4 v12, s[96:99], s67 offen lds
Lnd_92:
    v_mfma_f32_16x16x32_bf16 v[240:243], v[64:67], v[44:47], v[240:243]
    v_mfma_f32_16x16x32_bf16 v[244:247], v[68:71], v[44:47], v[244:247]
    v_mfma_f32_16x16x32_bf16 v[248:251], v[72:75], v[44:47], v[248:251]
    v_mfma_f32_16x16x32_bf16 v[252:255], v[76:79], v[44:47], v[252:255]
    ds_read_b128 v[44:47], v2 offset:14336
    s_cbranch_vccnz Lnd_93
    s_add_u32 s68, s67, s6
    s_add_u32 m0, s81, 115712
    s_nop 0
    buffer_load_dwordx4 v12, s[96:99], s68 offen lds
    s_add_u32 m0, s81, 116736
    s_nop 0
    buffer_load_dwordx4 v13, s[96:99], s67 offen lds
    s_add_u32 s68, s67, s6
    s_add_u32 m0, s81, 117760
    s_nop 0
    buffer_load_dwordx4 v13, s[96:99], s68 offen lds
Lnd_93:
    s_add_u32 s64, s64, 128
    s_add_u32 s65, s65, 128
    s_add_u32 s66, s66, s7
    s_add_u32 s67, s67, s8
    s_nop 7
    s_cbranch_vccz Lpw_94
    s_waitcnt vmcnt(0)
Lpw_94:
    v_cvt_pk_bf16_f32 v80, v128, v129
    v_cvt_pk_bf16_f32 v81, v130, v131
    v_cvt_pk_bf16_f32 v82, v132, v133
    v_cvt_pk_bf16_f32 v83, v134, v135
    s_nop 1
    v_permlane16_swap_b32 v80, v82
    v_permlane16_swap_b32 v81, v83
    v_cvt_pk_bf16_f32 v84, v136, v137
    v_cvt_pk_bf16_f32 v85, v138, v139
    v_cvt_pk_bf16_f32 v86, v140, v141
    v_cvt_pk_bf16_f32 v87, v142, v143
    s_nop 1
    v_permlane16_swap_b32 v84, v86
    v_permlane16_swap_b32 v85, v87
    s_nop 0
    v_mov_b32 v128, v84
    v_mov_b32 v129, v85
    v_mov_b32 v130, v86
    v_mov_b32 v131, v87
    v_mov_b32_dpp v84, v80 row_ror:8 row_mask:0xf bank_mask:0x3
    v_mov_b32_dpp v85, v81 row_ror:8 row_mask:0xf bank_mask:0x3
    v_mov_b32_dpp v86, v82 row_ror:8 row_mask:0xf bank_mask:0x3
    v_mov_b32_dpp v87, v83 row_ror:8 row_mask:0xf bank_mask:0x3
    v_mov_b32_dpp v80, v128 row_ror:8 row_mask:0xf bank_mask:0xc
    v_mov_b32_dpp v81, v129 row_ror:8 row_mask:0xf bank_mask:0xc
    v_mov_b32_dpp v82, v130 row_ror:8 row_mask:0xf bank_mask:0xc
    v_mov_b32_dpp v83, v131 row_ror:8 row_mask:0xf bank_mask:0xc
    buffer_store_dwordx4 v[80:83], v0, s[52:55], s83 offen sc0 sc1
    buffer_store_dwordx4 v[84:87], v14, s[52:55], s83 offen sc0 sc1
    s_add_u32 s83, s83, s84
    v_cvt_pk_bf16_f32 v88, v144, v145
    v_cvt_pk_bf16_f32 v89, v146, v147
    v_cvt_pk_bf16_f32 v90, v148, v149
    v_cvt_pk_bf16_f32 v91, v150, v151
    s_nop 1
    v_permlane16_swap_b32 v88, v90
    v_permlane16_swap_b32 v89, v91
    v_cvt_pk_bf16_f32 v92, v152, v153
    v_cvt_pk_bf16_f32 v93, v154, v155
    v_cvt_pk_bf16_f32 v94, v156, v157
    v_cvt_pk_bf16_f32 v95, v158, v159
    s_nop 1
    v_permlane16_swap_b32 v92, v94
    v_permlane16_swap_b32 v93, v95
    s_nop 0
    v_mov_b32 v144, v92
    v_mov_b32 v145, v93
    v_mov_b32 v146, v94
    v_mov_b32 v147, v95
    v_mov_b32_dpp v92, v88 row_ror:8 row_mask:0xf bank_mask:0x3
    v_mov_b32_dpp v93, v89 row_ror:8 row_mask:0xf bank_mask:0x3
    v_mov_b32_dpp v94, v90 row_ror:8 row_mask:0xf bank_mask:0x3
    v_mov_b32_dpp v95, v91 row_ror:8 row_mask:0xf bank_mask:0x3
    v_mov_b32_dpp v88, v144 row_ror:8 row_mask:0xf bank_mask:0xc
    v_mov_b32_dpp v89, v145 row_ror:8 row_mask:0xf bank_mask:0xc
    v_mov_b32_dpp v90, v146 row_ror:8 row_mask:0xf bank_mask:0xc
    v_mov_b32_dpp v91, v147 row_ror:8 row_mask:0xf bank_mask:0xc
    buffer_store_dwordx4 v[88:91], v0, s[52:55], s83 offen sc0 sc1
    buffer_store_dwordx4 v[92:95], v14, s[52:55], s83 offen sc0 sc1
    s_add_u32 s83, s83, s84
    v_cvt_pk_bf16_f32 v96, v160, v161
    v_cvt_pk_bf16_f32 v97, v162, v163
    v_cvt_pk_bf16_f32 v98, v164, v165
    v_cvt_pk_bf16_f32 v99, v166, v167
    s_nop 1
    v_permlane16_swap_b32 v96, v98
    v_permlane16_swap_b32 v97, v99
    v_cvt_pk_bf16_f32 v100, v168, v169
    v_cvt_pk_bf16_f32 v101, v170, v171
    v_cvt_pk_bf16_f32 v102, v172, v173
    v_cvt_pk_bf16_f32 v103, v174, v175
    s_nop 1
    v_permlane16_swap_b32 v100, v102
    v_permlane16_swap_b32 v101, v103
    s_nop 0
    v_mov_b32 v160, v100
    v_mov_b32 v161, v101
    v_mov_b32 v162, v102
    v_mov_b32 v163, v103
    v_mov_b32_dpp v100, v96 row_ror:8 row_mask:0xf bank_mask:0x3
    v_mov_b32_dpp v101, v97 row_ror:8 row_mask:0xf bank_mask:0x3
    v_mov_b32_dpp v102, v98 row_ror:8 row_mask:0xf bank_mask:0x3
    v_mov_b32_dpp v103, v99 row_ror:8 row_mask:0xf bank_mask:0x3
    v_mov_b32_dpp v96, v160 row_ror:8 row_mask:0xf bank_mask:0xc
    v_mov_b32_dpp v97, v161 row_ror:8 row_mask:0xf bank_mask:0xc
    v_mov_b32_dpp v98, v162 row_ror:8 row_mask:0xf bank_mask:0xc
    v_mov_b32_dpp v99, v163 row_ror:8 row_mask:0xf bank_mask:0xc
    v_cvt_pk_bf16_f32 v104, v176, v177
    v_cvt_pk_bf16_f32 v105, v178, v179
    v_cvt_pk_bf16_f32 v106, v180, v181
    v_cvt_pk_bf16_f32 v107, v182, v183
    s_nop 1
    v_permlane16_swap_b32 v104, v106
    v_permlane16_swap_b32 v105, v107
    v_cvt_pk_bf16_f32 v108, v184, v185
    v_cvt_pk_bf16_f32 v109, v186, v187
    v_cvt_pk_bf16_f32 v110, v188, v189
    v_cvt_pk_bf16_f32 v111, v190, v191
    s_nop 1
    v_permlane16_swap_b32 v108, v110
    v_permlane16_swap_b32 v109, v111
    s_nop 0
    v_mov_b32 v176, v108
    v_mov_b32 v177, v109
    v_mov_b32 v178, v110
    v_mov_b32 v179, v111
    v_mov_b32_dpp v108, v104 row_ror:8 row_mask:0xf bank_mask:0x3
    v_mov_b32_dpp v109, v105 row_ror:8 row_mask:0xf bank_mask:0x3
    v_mov_b32_dpp v110, v106 row_ror:8 row_mask:0xf bank_mask:0x3
    v_mov_b32_dpp v111, v107 row_ror:8 row_mask:0xf bank_mask:0x3
    v_mov_b32_dpp v104, v176 row_ror:8 row_mask:0xf bank_mask:0xc
    v_mov_b32_dpp v105, v177 row_ror:8 row_mask:0xf bank_mask:0xc
    v_mov_b32_dpp v106, v178 row_ror:8 row_mask:0xf bank_mask:0xc
    v_mov_b32_dpp v107, v179 row_ror:8 row_mask:0xf bank_mask:0xc
    v_cvt_pk_bf16_f32 v112, v192, v193
    v_cvt_pk_bf16_f32 v113, v194, v195
    v_cvt_pk_bf16_f32 v114, v196, v197
    v_cvt_pk_bf16_f32 v115, v198, v199
    s_nop 1
    v_permlane16_swap_b32 v112, v114
    v_permlane16_swap_b32 v113, v115
    v_cvt_pk_bf16_f32 v116, v200, v201
    v_cvt_pk_bf16_f32 v117, v202, v203
    v_cvt_pk_bf16_f32 v118, v204, v205
    v_cvt_pk_bf16_f32 v119, v206, v207
    s_nop 1
    v_permlane16_swap_b32 v116, v118
    v_permlane16_swap_b32 v117, v119
    s_nop 0
    v_mov_b32 v192, v116
    v_mov_b32 v193, v117
    v_mov_b32 v194, v118
    v_mov_b32 v195, v119
    v_mov_b32_dpp v116, v112 row_ror:8 row_mask:0xf bank_mask:0x3
    v_mov_b32_dpp v117, v113 row_ror:8 row_mask:0xf bank_mask:0x3
    v_mov_b32_dpp v118, v114 row_ror:8 row_mask:0xf bank_mask:0x3
    v_mov_b32_dpp v119, v115 row_ror:8 row_mask:0xf bank_mask:0x3
    v_mov_b32_dpp v112, v192 row_ror:8 row_mask:0xf bank_mask:0xc
    v_mov_b32_dpp v113, v193 row_ror:8 row_mask:0xf bank_mask:0xc
    v_mov_b32_dpp v114, v194 row_ror:8 row_mask:0xf bank_mask:0xc
    v_mov_b32_dpp v115, v195 row_ror:8 row_mask:0xf bank_mask:0xc
    v_cvt_pk_bf16_f32 v120, v208, v209
    v_cvt_pk_bf16_f32 v121, v210, v211
    v_cvt_pk_bf16_f32 v122, v212, v213
    v_cvt_pk_bf16_f32 v123, v214, v215
    s_nop 1
    v_permlane16_swap_b32 v120, v122
    v_permlane16_swap_b32 v121, v123
    v_cvt_pk_bf16_f32 v124, v216, v217
    v_cvt_pk_bf16_f32 v125, v218, v219
    v_cvt_pk_bf16_f32 v126, v220, v221
    v_cvt_pk_bf16_f32 v127, v222, v223
    s_nop 1
    v_permlane16_swap_b32 v124, v126
    v_permlane16_swap_b32 v125, v127
    s_nop 0
    v_mov_b32 v208, v124
    v_mov_b32 v209, v125
    v_mov_b32 v210, v126
    v_mov_b32 v211, v127
    v_mov_b32_dpp v124, v120 row_ror:8 row_mask:0xf bank_mask:0x3
    v_mov_b32_dpp v125, v121 row_ror:8 row_mask:0xf bank_mask:0x3
    v_mov_b32_dpp v126, v122 row_ror:8 row_mask:0xf bank_mask:0x3
    v_mov_b32_dpp v127, v123 row_ror:8 row_mask:0xf bank_mask:0x3
    v_mov_b32_dpp v120, v208 row_ror:8 row_mask:0xf bank_mask:0xc
    v_mov_b32_dpp v121, v209 row_ror:8 row_mask:0xf bank_mask:0xc
    v_mov_b32_dpp v122, v210 row_ror:8 row_mask:0xf bank_mask:0xc
    v_mov_b32_dpp v123, v211 row_ror:8 row_mask:0xf bank_mask:0xc
    v_cvt_pk_bf16_f32 v80, v224, v225
    v_cvt_pk_bf16_f32 v81, v226, v227
    v_cvt_pk_bf16_f32 v82, v228, v229
    v_cvt_pk_bf16_f32 v83, v230, v231
    s_nop 1
    v_permlane16_swap_b32 v80, v82
    v_permlane16_swap_b32 v81, v83
    v_cvt_pk_bf16_f32 v84, v232, v233
    v_cvt_pk_bf16_f32 v85, v234, v235
    v_cvt_pk_bf16_f32 v86, v236, v237
    v_cvt_pk_bf16_f32 v87, v238, v239
    s_nop 1
    v_permlane16_swap_b32 v84, v86
    v_permlane16_swap_b32 v85, v87
    s_nop 0
    v_mov_b32 v224, v84
    v_mov_b32 v225, v85
    v_mov_b32 v226, v86
    v_mov_b32 v227, v87
    v_mov_b32_dpp v84, v80 row_ror:8 row_mask:0xf bank_mask:0x3
    v_mov_b32_dpp v85, v81 row_ror:8 row_mask:0xf bank_mask:0x3
    v_mov_b32_dpp v86, v82 row_ror:8 row_mask:0xf bank_mask:0x3
    v_mov_b32_dpp v87, v83 row_ror:8 row_mask:0xf bank_mask:0x3
    v_mov_b32_dpp v80, v224 row_ror:8 row_mask:0xf bank_mask:0xc
    v_mov_b32_dpp v81, v225 row_ror:8 row_mask:0xf bank_mask:0xc
    v_mov_b32_dpp v82, v226 row_ror:8 row_mask:0xf bank_mask:0xc
    v_mov_b32_dpp v83, v227 row_ror:8 row_mask:0xf bank_mask:0xc
    v_cvt_pk_bf16_f32 v88, v240, v241
    v_cvt_pk_bf16_f32 v89, v242, v243
    v_cvt_pk_bf16_f32 v90, v244, v245
    v_cvt_pk_bf16_f32 v91, v246, v247
    s_nop 1
    v_permlane16_swap_b32 v88, v90
    v_permlane16_swap_b32 v89, v91
    v_cvt_pk_bf16_f32 v92, v248, v249
    v_cvt_pk_bf16_f32 v93, v250, v251
    v_cvt_pk_bf16_f32 v94, v252, v253
    v_cvt_pk_bf16_f32 v95, v254, v255
    s_nop 1
    v_permlane16_swap_b32 v92, v94
    v_permlane16_swap_b32 v93, v95
    s_nop 0
    v_mov_b32 v240, v92
    v_mov_b32 v241, v93
    v_mov_b32 v242, v94
    v_mov_b32 v243, v95
    v_mov_b32_dpp v92, v88 row_ror:8 row_mask:0xf bank_mask:0x3
    v_mov_b32_dpp v93, v89 row_ror:8 row_mask:0xf bank_mask:0x3
    v_mov_b32_dpp v94, v90 row_ror:8 row_mask:0xf bank_mask:0x3
    v_mov_b32_dpp v95, v91 row_ror:8 row_mask:0xf bank_mask:0x3
    v_mov_b32_dpp v88, v240 row_ror:8 row_mask:0xf bank_mask:0xc
    v_mov_b32_dpp v89, v241 row_ror:8 row_mask:0xf bank_mask:0xc
    v_mov_b32_dpp v90, v242 row_ror:8 row_mask:0xf bank_mask:0xc
    v_mov_b32_dpp v91, v243 row_ror:8 row_mask:0xf bank_mask:0xc
    s_branch proj_qh
proj_vpath:
    s_add_u32 s52, s42, 37748736
    s_addc_u32 s53, s43, 0
    s_mov_b32 s54, 16777216
    s_and_b32 s53, s53, 0xffff
    s_mov_b32 s55, 0x00020000
    v_and_b32 v80, 15, v1
    v_lshlrev_b32 v80, 7, v80
    v_lshrrev_b32 v81, 4, v1
    v_lshlrev_b32 v81, 4, v81
    v_add_u32 v0, v80, v81
    v_and_b32 v84, 8, v1
    s_mov_b32 s68, 120
    v_mul_lo_u32 v84, v84, s68
    v_sub_u32 v0, v0, v84
    v_add_u32 v14, 1024, v0
    s_lshl_b32 s68, s62, 13
    s_mov_b32 s84, 2048
    s_mov_b32 s85, 10240
    s_add_u32 s83, s83, s68
    s_waitcnt lgkmcnt(4)
    v_mfma_f32_16x16x32_bf16 v[128:131], v[16:19], v[48:51], 0
    v_mfma_f32_16x16x32_bf16 v[132:135], v[16:19], v[52:55], 0
    v_mfma_f32_16x16x32_bf16 v[136:139], v[16:19], v[56:59], 0
    v_mfma_f32_16x16x32_bf16 v[140:143], v[16:19], v[60:63], 0
    ds_read_b128 v[16:19], v3 offset:0
    ds_read_b64_tr_b16 v[64:65], v4 offset:8192
    ds_read_b64_tr_b16 v[66:67], v4 offset:9216
    v_mfma_f32_16x16x32_bf16 v[144:147], v[20:23], v[48:51], 0
    v_mfma_f32_16x16x32_bf16 v[148:151], v[20:23], v[52:55], 0
    v_mfma_f32_16x16x32_bf16 v[152:155], v[20:23], v[56:59], 0
    v_mfma_f32_16x16x32_bf16 v[156:159], v[20:23], v[60:63], 0
    ds_read_b128 v[20:23], v3 offset:2048
    ds_read_b64_tr_b16 v[68:69], v5 offset:8192
    ds_read_b64_tr_b16 v[70:71], v5 offset:9216
    v_mfma_f32_16x16x32_bf16 v[160:163], v[24:27], v[48:51], 0
    v_mfma_f32_16x16x32_bf16 v[164:167], v[24:27], v[52:55], 0
    v_mfma_f32_16x16x32_bf16 v[168:171], v[24:27], v[56:59], 0
    v_mfma_f32_16x16x32_bf16 v[172:175], v[24:27], v[60:63], 0
    ds_read_b128 v[24:27], v3 offset:4096
    ds_read_b64_tr_b16 v[72:73], v6 offset:8192
    ds_read_b64_tr_b16 v[74:75], v6 offset:9216
    v_mfma_f32_16x16x32_bf16 v[176:179], v[28:31], v[48:51], 0
    v_mfma_f32_16x16x32_bf16 v[180:183], v[28:31], v[52:55], 0
    v_mfma_f32_16x16x32_bf16 v[184:187], v[28:31], v[56:59], 0
    v_mfma_f32_16x16x32_bf16 v[188:191], v[28:31], v[60:63], 0
    ds_read_b128 v[28:31], v3 offset:6144
    ds_read_b64_tr_b16 v[76:77], v7 offset:8192
    ds_read_b64_tr_b16 v[78:79], v7 offset:9216
    s_waitcnt lgkmcnt(12)
    v_mfma_f32_16x16x32_bf16 v[192:195], v[32:35], v[48:51], 0
    v_mfma_f32_16x16x32_bf16 v[196:199], v[32:35], v[52:55], 0
    v_mfma_f32_16x16x32_bf16 v[200:203], v[32:35], v[56:59], 0
    v_mfma_f32_16x16x32_bf16 v[204:207], v[32:35], v[60:63], 0
    ds_read_b128 v[32:35], v3 offset:8192
    v_mfma_f32_16x16x32_bf16 v[208:211], v[36:39], v[48:51], 0
    v_mfma_f32_16x16x32_bf16 v[212:215], v[36:39], v[52:55], 0
    v_mfma_f32_16x16x32_bf16 v[216:219], v[36:39], v[56:59], 0
    v_mfma_f32_16x16x32_bf16 v[220:223], v[36:39], v[60:63], 0
    ds_read_b128 v[36:39], v3 offset:10240
    v_mfma_f32_16x16x32_bf16 v[224:227], v[40:43], v[48:51], 0
    v_mfma_f32_16x16x32_bf16 v[228:231], v[40:43], v[52:55], 0
    v_mfma_f32_16x16x32_bf16 v[232:235], v[40:43], v[56:59], 0
    v_mfma_f32_16x16x32_bf16 v[236:239], v[40:43], v[60:63], 0
    ds_read_b128 v[40:43], v3 offset:12288
    v_mfma_f32_16x16x32_bf16 v[240:243], v[44:47], v[48:51], 0
    v_mfma_f32_16x16x32_bf16 v[244:247], v[44:47], v[52:55], 0
    v_mfma_f32_16x16x32_bf16 v[248:251], v[44:47], v[56:59], 0
    v_mfma_f32_16x16x32_bf16 v[252:255], v[44:47], v[60:63], 0
    ds_read_b128 v[44:47], v3 offset:14336
    s_waitcnt lgkmcnt(4)
    v_mfma_f32_16x16x32_bf16 v[128:131], v[16:19], v[64:67], v[128:131]
    v_mfma_f32_16x16x32_bf16 v[132:135], v[16:19], v[68:71], v[132:135]
    v_mfma_f32_16x16x32_bf16 v[136:139], v[16:19], v[72:75], v[136:139]
    v_mfma_f32_16x16x32_bf16 v[140:143], v[16:19], v[76:79], v[140:143]
    v_mfma_f32_16x16x32_bf16 v[144:147], v[20:23], v[64:67], v[144:147]
    v_mfma_f32_16x16x32_bf16 v[148:151], v[20:23], v[68:71], v[148:151]
    v_mfma_f32_16x16x32_bf16 v[152:155], v[20:23], v[72:75], v[152:155]
    v_mfma_f32_16x16x32_bf16 v[156:159], v[20:23], v[76:79], v[156:159]
    s_waitcnt lgkmcnt(0)
    s_cbranch_vccnz Lfw_95
    s_waitcnt vmcnt(0)
Lfw_95:
Lfw_96:
    s_barrier
    ds_read_b128 v[16:19], v2 offset:32768
    ds_read_b128 v[20:23], v2 offset:34816
    ds_read_b64_tr_b16 v[48:49], v4 offset:32768
    ds_read_b64_tr_b16 v[50:51], v4 offset:33792
    ds_read_b64_tr_b16 v[52:53], v5 offset:32768
    ds_read_b64_tr_b16 v[54:55], v5 offset:33792
    v_mfma_f32_16x16x32_bf16 v[160:163], v[24:27], v[64:67], v[160:163]
    v_mfma_f32_16x16x32_bf16 v[164:167], v[24:27], v[68:71], v[164:167]
    v_mfma_f32_16x16x32_bf16 v[168:171], v[24:27], v[72:75], v[168:171]
    v_mfma_f32_16x16x32_bf16 v[172:175], v[24:27], v[76:79], v[172:175]
    ds_read_b128 v[24:27], v2 offset:36864
    ds_read_b64_tr_b16 v[56:57], v6 offset:32768
    ds_read_b64_tr_b16 v[58:59], v6 offset:33792
    s_cbranch_vccnz Lnd_97
    s_add_u32 m0, s81, 0
    s_nop 0
    buffer_load_dwordx4 v8, s[44:47], s64 offen lds
    s_add_u32 m0, s81, 1024
    s_nop 0
    buffer_load_dwordx4 v9, s[44:47], s64 offen lds
Lnd_97:
    v_mfma_f32_16x16x32_bf16 v[176:179], v[28:31], v[64:67], v[176:179]
    v_mfma_f32_16x16x32_bf16 v[180:183], v[28:31], v[68:71], v[180:183]
    v_mfma_f32_16x16x32_bf16 v[184:187], v[28:31], v[72:75], v[184:187]
    v_mfma_f32_16x16x32_bf16 v[188:191], v[28:31], v[76:79], v[188:191]
    ds_read_b128 v[28:31], v2 offset:38912
    ds_read_b64_tr_b16 v[60:61], v7 offset:32768
    ds_read_b64_tr_b16 v[62:63], v7 offset:33792
    s_cbranch_vccnz Lnd_98
    s_add_u32 s68, s64, s4
    s_add_u32 m0, s81, 2048
    s_nop 0
    buffer_load_dwordx4 v8, s[44:47], s68 offen lds
    s_add_u32 s68, s64, s4
    s_add_u32 m0, s81, 3072
    s_nop 0
    buffer_load_dwordx4 v9, s[44:47], s68 offen lds
Lnd_98:
    v_mfma_f32_16x16x32_bf16 v[192:195], v[32:35], v[64:67], v[192:195]
    v_mfma_f32_16x16x32_bf16 v[196:199], v[32:35], v[68:71], v[196:199]
    v_mfma_f32_16x16x32_bf16 v[200:203], v[32:35], v[72:75], v[200:203]
    v_mfma_f32_16x16x32_bf16 v[204:207], v[32:35], v[76:79], v[204:207]
    ds_read_b128 v[32:35], v2 offset:40960
    s_cbranch_vccnz Lnd_99
    s_add_u32 m0, s81, 16384
    s_nop 0
    buffer_load_dwordx4 v8, s[44:47], s65 offen lds
    s_add_u32 m0, s81, 17408
    s_nop 0
    buffer_load_dwordx4 v9, s[44:47], s65 offen lds
    s_add_u32 s68, s65, s4
    s_add_u32 m0, s81, 18432
    s_nop 0
    buffer_load_dwordx4 v8, s[44:47], s68 offen lds
Lnd_99:
    v_mfma_f32_16x16x32_bf16 v[208:211], v[36:39], v[64:67], v[208:211]
    v_mfma_f32_16x16x32_bf16 v[212:215], v[36:39], v[68:71], v[212:215]
    v_mfma_f32_16x16x32_bf16 v[216:219], v[36:39], v[72:75], v[216:219]
    v_mfma_f32_16x16x32_bf16 v[220:223], v[36:39], v[76:79], v[220:223]
    ds_read_b128 v[36:39], v2 offset:43008
    s_cbranch_vccnz Lnd_100
    s_add_u32 s68, s65, s4
    s_add_u32 m0, s81, 19456
    s_nop 0
    buffer_load_dwordx4 v9, s[44:47], s68 offen lds
    s_add_u32 m0, s81, 65536
    s_nop 0
    buffer_load_dwordx4 v10, s[48:51], s66 offen lds
    s_add_u32 s68, s66, s5
    s_add_u32 m0, s81, 66560
    s_nop 0
    buffer_load_dwordx4 v10, s[48:51], s68 offen lds
Lnd_100:
    v_mfma_f32_16x16x32_bf16 v[224:227], v[40:43], v[64:67], v[224:227]
    v_mfma_f32_16x16x32_bf16 v[228:231], v[40:43], v[68:71], v[228:231]
    v_mfma_f32_16x16x32_bf16 v[232:235], v[40:43], v[72:75], v[232:235]
    v_mfma_f32_16x16x32_bf16 v[236:239], v[40:43], v[76:79], v[236:239]
    ds_read_b128 v[40:43], v2 offset:45056
    s_cbranch_vccnz Lnd_101
    s_add_u32 m0, s81, 67584
    s_nop 0
    buffer_load_dwordx4 v11, s[48:51], s66 offen lds
    s_add_u32 s68, s66, s5
    s_add_u32 m0, s81, 68608
    s_nop 0
    buffer_load_dwordx4 v11, s[48:51], s68 offen lds
    s_add_u32 m0, s81, 81920
    s_nop 0
    buffer_load_dwordx4 v12, s[96:99], s67 offen lds
Lnd_101:
    v_mfma_f32_16x16x32_bf16 v[240:243], v[44:47], v[64:67], v[240:243]
    v_mfma_f32_16x16x32_bf16 v[244:247], v[44:47], v[68:71], v[244:247]
    v_mfma_f32_16x16x32_bf16 v[248:251], v[44:47], v[72:75], v[248:251]
    v_mfma_f32_16x16x32_bf16 v[252:255], v[44:47], v[76:79], v[252:255]
    ds_read_b128 v[44:47], v2 offset:47104
    s_cbranch_vccnz Lnd_102
    s_add_u32 s68, s67, s6
    s_add_u32 m0, s81, 82944
    s_nop 0
    buffer_load_dwordx4 v12, s[96:99], s68 offen lds
    s_add_u32 m0, s81, 83968
    s_nop 0
    buffer_load_dwordx4 v13, s[96:99], s67 offen lds
    s_add_u32 s68, s67, s6
    s_add_u32 m0, s81, 84992
    s_nop 0
    buffer_load_dwordx4 v13, s[96:99], s68 offen lds
Lnd_102:
    s_add_u32 s64, s64, 128
    s_add_u32 s65, s65, 128
    s_add_u32 s66, s66, s7
    s_add_u32 s67, s67, s8
    v_mov_b32 v122, 0
    s_cmp_lg_u32 s60, 0
    s_cbranch_scc1 Lnw0_103
    s_add_u32 s56, s40, 0
    s_addc_u32 s57, s41, 0
    s_mov_b32 s58, 256
    s_and_b32 s57, s57, 0xffff
    s_mov_b32 s59, 0x00020000
    buffer_load_dwordx2 v[124:125], v122, s[56:59], 0 offen sc0 sc1
Lnw0_103:
    s_waitcnt lgkmcnt(4)
    v_mfma_f32_16x16x32_bf16 v[128:131], v[16:19], v[48:51], v[128:131]
    v_mfma_f32_16x16x32_bf16 v[132:135], v[16:19], v[52:55], v[132:135]
    v_mfma_f32_16x16x32_bf16 v[136:139], v[16:19], v[56:59], v[136:139]
    v_mfma_f32_16x16x32_bf16 v[140:143], v[16:19], v[60:63], v[140:143]
    ds_read_b128 v[16:19], v3 offset:32768
    ds_read_b64_tr_b16 v[64:65], v4 offset:40960
    ds_read_b64_tr_b16 v[66:67], v4 offset:41984
    v_mfma_f32_16x16x32_bf16 v[144:147], v[20:23], v[48:51], v[144:147]
    v_mfma_f32_16x16x32_bf16 v[148:151], v[20:23], v[52:55], v[148:151]
    v_mfma_f32_16x16x32_bf16 v[152:155], v[20:23], v[56:59], v[152:155]
    v_mfma_f32_16x16x32_bf16 v[156:159], v[20:23], v[60:63], v[156:159]
    ds_read_b128 v[20:23], v3 offset:34816
    ds_read_b64_tr_b16 v[68:69], v5 offset:40960
    ds_read_b64_tr_b16 v[70:71], v5 offset:41984
    v_mfma_f32_16x16x32_bf16 v[160:163], v[24:27], v[48:51], v[160:163]
    v_mfma_f32_16x16x32_bf16 v[164:167], v[24:27], v[52:55], v[164:167]
    v_mfma_f32_16x16x32_bf16 v[168:171], v[24:27], v[56:59], v[168:171]
    v_mfma_f32_16x16x32_bf16 v[172:175], v[24:27], v[60:63], v[172:175]
    ds_read_b128 v[24:27], v3 offset:36864
    ds_read_b64_tr_b16 v[72:73], v6 offset:40960
    ds_read_b64_tr_b16 v[74:75], v6 offset:41984
    v_mfma_f32_16x16x32_bf16 v[176:179], v[28:31], v[48:51], v[176:179]
    v_mfma_f32_16x16x32_bf16 v[180:183], v[28:31], v[52:55], v[180:183]
    v_mfma_f32_16x16x32_bf16 v[184:187], v[28:31], v[56:59], v[184:187]
    v_mfma_f32_16x16x32_bf16 v[188:191], v[28:31], v[60:63], v[188:191]
    ds_read_b128 v[28:31], v3 offset:38912
    ds_read_b64_tr_b16 v[76:77], v7 offset:40960
    ds_read_b64_tr_b16 v[78:79], v7 offset:41984
    s_waitcnt lgkmcnt(12)
    v_mfma_f32_16x16x32_bf16 v[192:195], v[32:35], v[48:51], v[192:195]
    v_mfma_f32_16x16x32_bf16 v[196:199], v[32:35], v[52:55], v[196:199]
    v_mfma_f32_16x16x32_bf16 v[200:203], v[32:35], v[56:59], v[200:203]
    v_mfma_f32_16x16x32_bf16 v[204:207], v[32:35], v[60:63], v[204:207]
    ds_read_b128 v[32:35], v3 offset:40960
    v_mfma_f32_16x16x32_bf16 v[208:211], v[36:39], v[48:51], v[208:211]
    v_mfma_f32_16x16x32_bf16 v[212:215], v[36:39], v[52:55], v[212:215]
    v_mfma_f32_16x16x32_bf16 v[216:219], v[36:39], v[56:59], v[216:219]
    v_mfma_f32_16x16x32_bf16 v[220:223], v[36:39], v[60:63], v[220:223]
    ds_read_b128 v[36:39], v3 offset:43008
    v_mfma_f32_16x16x32_bf16 v[224:227], v[40:43], v[48:51], v[224:227]
    v_mfma_f32_16x16x32_bf16 v[228:231], v[40:43], v[52:55], v[228:231]
    v_mfma_f32_16x16x32_bf16 v[232:235], v[40:43], v[56:59], v[232:235]
    v_mfma_f32_16x16x32_bf16 v[236:239], v[40:43], v[60:63], v[236:239]
    ds_read_b128 v[40:43], v3 offset:45056
    v_mfma_f32_16x16x32_bf16 v[240:243], v[44:47], v[48:51], v[240:243]
    v_mfma_f32_16x16x32_bf16 v[244:247], v[44:47], v[52:55], v[244:247]
    v_mfma_f32_16x16x32_bf16 v[248:251], v[44:47], v[56:59], v[248:251]
    v_mfma_f32_16x16x32_bf16 v[252:255], v[44:47], v[60:63], v[252:255]
    ds_read_b128 v[44:47], v3 offset:47104
    s_waitcnt lgkmcnt(4)
    v_mfma_f32_16x16x32_bf16 v[128:131], v[16:19], v[64:67], v[128:131]
    v_mfma_f32_16x16x32_bf16 v[132:135], v[16:19], v[68:71], v[132:135]
    v_mfma_f32_16x16x32_bf16 v[136:139], v[16:19], v[72:75], v[136:139]
    v_mfma_f32_16x16x32_bf16 v[140:143], v[16:19], v[76:79], v[140:143]
    v_mfma_f32_16x16x32_bf16 v[144:147], v[20:23], v[64:67], v[144:147]
    v_mfma_f32_16x16x32_bf16 v[148:151], v[20:23], v[68:71], v[148:151]
    v_mfma_f32_16x16x32_bf16 v[152:155], v[20:23], v[72:75], v[152:155]
    v_mfma_f32_16x16x32_bf16 v[156:159], v[20:23], v[76:79], v[156:159]
    s_waitcnt lgkmcnt(0)
    s_cbranch_vccnz Lfw_104
    s_waitcnt vmcnt(0)
Lfw_104:
Lfw_105:
    s_barrier
    ds_read_b128 v[16:19], v2 offset:0
    ds_read_b128 v[20:23], v2 offset:2048
    ds_read_b64_tr_b16 v[48:49], v4 offset:0
    ds_read_b64_tr_b16 v[50:51], v4 offset:1024
    ds_read_b64_tr_b16 v[52:53], v5 offset:0
    ds_read_b64_tr_b16 v[54:55], v5 offset:1024
    v_mfma_f32_16x16x32_bf16 v[160:163], v[24:27], v[64:67], v[160:163]
    v_mfma_f32_16x16x32_bf16 v[164:167], v[24:27], v[68:71], v[164:167]
    v_mfma_f32_16x16x32_bf16 v[168:171], v[24:27], v[72:75], v[168:171]
    v_mfma_f32_16x16x32_bf16 v[172:175], v[24:27], v[76:79], v[172:175]
    ds_read_b128 v[24:27], v2 offset:4096
    ds_read_b64_tr_b16 v[56:57], v6 offset:0
    ds_read_b64_tr_b16 v[58:59], v6 offset:1024
    s_cbranch_vccnz Lnd_106
    s_add_u32 m0, s81, 32768
    s_nop 0
    buffer_load_dwordx4 v8, s[44:47], s64 offen lds
    s_add_u32 m0, s81, 33792
    s_nop 0
    buffer_load_dwordx4 v9, s[44:47], s64 offen lds
    s_branch Lne_107
Lnd_106:
    s_waitcnt vmcnt(0)
    v_lshlrev_b32 v80, 16, v104
    v_and_b32 v81, 0xffff0000, v104
    v_lshlrev_b32 v82, 16, v105
    v_and_b32 v83, 0xffff0000, v105
    v_lshlrev_b32 v84, 16, v106
    v_and_b32 v85, 0xffff0000, v106
    v_lshlrev_b32 v86, 16, v107
    v_and_b32 v87, 0xffff0000, v107
    v_lshlrev_b32 v88, 16, v108
    v_and_b32 v89, 0xffff0000, v108
    v_lshlrev_b32 v90, 16, v109
    v_and_b32 v91, 0xffff0000, v109
    v_lshlrev_b32 v92, 16, v110
    v_and_b32 v93, 0xffff0000, v110
    v_lshlrev_b32 v94, 16, v111
    v_and_b32 v95, 0xffff0000, v111
    v_add_f32 v96, v80, v81
    v_add_f32 v96, v96, v82
    v_add_f32 v96, v96, v83
    v_add_f32 v96, v96, v84
    v_add_f32 v96, v96, v85
    v_add_f32 v96, v96, v86
    v_add_f32 v96, v96, v87
    v_add_f32 v96, v96, v88
    v_add_f32 v96, v96, v89
    v_add_f32 v96, v96, v90
    v_add_f32 v96, v96, v91
    v_add_f32 v96, v96, v92
    v_add_f32 v96, v96, v93
    v_add_f32 v96, v96, v94
    v_add_f32 v96, v96, v95
    s_nop 1
    v_add_f32_dpp v96, v96, v96 quad_perm:[1,0,3,2] row_mask:0xf bank_mask:0xf
    s_nop 1
    v_add_f32_dpp v96, v96, v96 quad_perm:[2,3,0,1] row_mask:0xf bank_mask:0xf
Lne_107:
    v_mfma_f32_16x16x32_bf16 v[176:179], v[28:31], v[64:67], v[176:179]
    v_mfma_f32_16x16x32_bf16 v[180:183], v[28:31], v[68:71], v[180:183]
    v_mfma_f32_16x16x32_bf16 v[184:187], v[28:31], v[72:75], v[184:187]
    v_mfma_f32_16x16x32_bf16 v[188:191], v[28:31], v[76:79], v[188:191]
    ds_read_b128 v[28:31], v2 offset:6144
    ds_read_b64_tr_b16 v[60:61], v7 offset:0
    ds_read_b64_tr_b16 v[62:63], v7 offset:1024
    s_cbranch_vccnz Lnd_108
    s_add_u32 s68, s64, s4
    s_add_u32 m0, s81, 34816
    s_nop 0
    buffer_load_dwordx4 v8, s[44:47], s68 offen lds
    s_add_u32 s68, s64, s4
    s_add_u32 m0, s81, 35840
    s_nop 0
    buffer_load_dwordx4 v9, s[44:47], s68 offen lds
    s_branch Lne_109
Lnd_108:
    s_nop 1
    v_add_f32_dpp v96, v96, v96 row_half_mirror row_mask:0xf bank_mask:0xf
    s_nop 1
    v_add_f32_dpp v96, v96, v96 row_mirror row_mask:0xf bank_mask:0xf
    s_nop 1
    v_readlane_b32 s76, v96, 0
    v_readlane_b32 s77, v96, 16
    v_readlane_b32 s78, v96, 32
    v_readlane_b32 s79, v96, 48
    s_nop 2
    v_mov_b32 v96, s76
    v_add_f32 v96, s77, v96
    v_add_f32 v96, s78, v96
    v_add_f32 v96, s79, v96
    v_mul_f32 v97, 0x3a800000, v96
    v_mov_b32 v98, 0
    v_sub_f32 v99, v80, v97
    v_fmac_f32 v98, v99, v99
    v_sub_f32 v99, v81, v97
    v_fmac_f32 v98, v99, v99
    v_sub_f32 v99, v82, v97
    v_fmac_f32 v98, v99, v99
    v_sub_f32 v99, v83, v97
    v_fmac_f32 v98, v99, v99
    v_sub_f32 v99, v84, v97
    v_fmac_f32 v98, v99, v99
    v_sub_f32 v99, v85, v97
    v_fmac_f32 v98, v99, v99
    v_sub_f32 v99, v86, v97
    v_fmac_f32 v98, v99, v99
    v_sub_f32 v99, v87, v97
    v_fmac_f32 v98, v99, v99
    v_sub_f32 v99, v88, v97
    v_fmac_f32 v98, v99, v99
    v_sub_f32 v99, v89, v97
    v_fmac_f32 v98, v99, v99
    v_sub_f32 v99, v90, v97
Lne_109:
    v_mfma_f32_16x16x32_bf16 v[192:195], v[32:35], v[64:67], v[192:195]
    v_mfma_f32_16x16x32_bf16 v[196:199], v[32:35], v[68:71], v[196:199]
    v_mfma_f32_16x16x32_bf16 v[200:203], v[32:35], v[72:75], v[200:203]
    v_mfma_f32_16x16x32_bf16 v[204:207], v[32:35], v[76:79], v[204:207]
    ds_read_b128 v[32:35], v2 offset:8192
    s_cbranch_vccnz Lnd_110
    s_add_u32 m0, s81, 49152
    s_nop 0
    buffer_load_dwordx4 v8, s[44:47], s65 offen lds
    s_add_u32 m0, s81, 50176
    s_nop 0
    buffer_load_dwordx4 v9, s[44:47], s65 offen lds
    s_add_u32 s68, s65, s4
    s_add_u32 m0, s81, 51200
    s_nop 0
    buffer_load_dwordx4 v8, s[44:47], s68 offen lds
    s_branch Lne_111
Lnd_110:
    v_fmac_f32 v98, v99, v99
    v_sub_f32 v99, v91, v97
    v_fmac_f32 v98, v99, v99
    v_sub_f32 v99, v92, v97
    v_fmac_f32 v98, v99, v99
    v_sub_f32 v99, v93, v97
    v_fmac_f32 v98, v99, v99
    v_sub_f32 v99, v94, v97
    v_fmac_f32 v98, v99, v99
    v_sub_f32 v99, v95, v97
    v_fmac_f32 v98, v99, v99
    s_nop 1
    v_add_f32_dpp v98, v98, v98 quad_perm:[1,0,3,2] row_mask:0xf bank_mask:0xf
    s_nop 1
    v_add_f32_dpp v98, v98, v98 quad_perm:[2,3,0,1] row_mask:0xf bank_mask:0xf
    s_nop 1
    v_add_f32_dpp v98, v98, v98 row_half_mirror row_mask:0xf bank_mask:0xf
    s_nop 1
    v_add_f32_dpp v98, v98, v98 row_mirror row_mask:0xf bank_mask:0xf
    s_nop 1
    v_readlane_b32 s76, v98, 0
    v_readlane_b32 s77, v98, 16
    v_readlane_b32 s78, v98, 32
    v_readlane_b32 s79, v98, 48
    s_nop 2
    v_mov_b32 v98, s76
    v_add_f32 v98, s77, v98
    v_add_f32 v98, s78, v98
    v_add_f32 v98, s79, v98
    v_mul_f32 v98, 0x3a800000, v98
    v_cvt_pk_bf16_f32 v97, v97, v97
    v_lshlrev_b32 v97, 16, v97
    v_cvt_pk_bf16_f32 v98, v98, v98
    v_lshlrev_b32 v98, 16, v98
    v_add_f32 v98, 0x3727c5ac, v98
    v_cvt_pk_bf16_f32 v98, v98, v98
Lne_111:
    v_mfma_f32_16x16x32_bf16 v[208:211], v[36:39], v[64:67], v[208:211]
    v_mfma_f32_16x16x32_bf16 v[212:215], v[36:39], v[68:71], v[212:215]
    v_mfma_f32_16x16x32_bf16 v[216:219], v[36:39], v[72:75], v[216:219]
    v_mfma_f32_16x16x32_bf16 v[220:223], v[36:39], v[76:79], v[220:223]
    ds_read_b128 v[36:39], v2 offset:10240
    s_cbranch_vccnz Lnd_112
    s_add_u32 s68, s65, s4
    s_add_u32 m0, s81, 52224
    s_nop 0
    buffer_load_dwordx4 v9, s[44:47], s68 offen lds
    s_add_u32 m0, s81, 98304
    s_nop 0
    buffer_load_dwordx4 v10, s[48:51], s66 offen lds
    s_add_u32 s68, s66, s5
    s_add_u32 m0, s81, 99328
    s_nop 0
    buffer_load_dwordx4 v10, s[48:51], s68 offen lds
    s_branch Lne_113
Lnd_112:
    v_lshlrev_b32 v98, 16, v98
    v_sqrt_f32 v98, v98
    s_nop 0
    v_cvt_pk_bf16_f32 v98, v98, v98
    v_lshlrev_b32 v98, 16, v98
    v_rcp_f32 v96, v98
    s_nop 0
    v_sub_f32 v80, v80, v97
    v_sub_f32 v81, v81, v97
    v_cvt_pk_bf16_f32 v99, v80, v81
    v_lshlrev_b32 v80, 16, v99
    v_and_b32 v81, 0xffff0000, v99
    v_mul_f32 v99, v80, v96
    v_fma_f32 v80, -v99, v98, v80
    v_fma_f32 v80, v80, v96, v99
    v_mul_f32 v99, v81, v96
    v_fma_f32 v81, -v99, v98, v81
    v_fma_f32 v81, v81, v96, v99
    v_sub_f32 v82, v82, v97
    v_sub_f32 v83, v83, v97
    v_cvt_pk_bf16_f32 v99, v82, v83
    v_lshlrev_b32 v82, 16, v99
    v_and_b32 v83, 0xffff0000, v99
    v_mul_f32 v99, v82, v96
    v_fma_f32 v82, -v99, v98, v82
    v_fma_f32 v82, v82, v96, v99
    v_mul_f32 v99, v83, v96
    v_fma_f32 v83, -v99, v98, v83
    v_fma_f32 v83, v83, v96, v99
    v_sub_f32 v84, v84, v97
    v_sub_f32 v85, v85, v97
    v_cvt_pk_bf16_f32 v99, v84, v85
    v_lshlrev_b32 v84, 16, v99
    v_and_b32 v85, 0xffff0000, v99
    v_mul_f32 v99, v84, v96
    v_fma_f32 v84, -v99, v98, v84
    v_fma_f32 v84, v84, v96, v99
Lne_113:
    v_mfma_f32_16x16x32_bf16 v[224:227], v[40:43], v[64:67], v[224:227]
    v_mfma_f32_16x16x32_bf16 v[228:231], v[40:43], v[68:71], v[228:231]
    v_mfma_f32_16x16x32_bf16 v[232:235], v[40:43], v[72:75], v[232:235]
    v_mfma_f32_16x16x32_bf16 v[236:239], v[40:43], v[76:79], v[236:239]
    ds_read_b128 v[40:43], v2 offset:12288
    s_cbranch_vccnz Lnd_114
    s_add_u32 m0, s81, 100352
    s_nop 0
    buffer_load_dwordx4 v11, s[48:51], s66 offen lds
    s_add_u32 s68, s66, s5
    s_add_u32 m0, s81, 101376
    s_nop 0
    buffer_load_dwordx4 v11, s[48:51], s68 offen lds
    s_add_u32 m0, s81, 114688
    s_nop 0
    buffer_load_dwordx4 v12, s[96:99], s67 offen lds
    s_branch Lne_115
Lnd_114:
    v_mul_f32 v99, v85, v96
    v_fma_f32 v85, -v99, v98, v85
    v_fma_f32 v85, v85, v96, v99
    v_sub_f32 v86, v86, v97
    v_sub_f32 v87, v87, v97
    v_cvt_pk_bf16_f32 v99, v86, v87
    v_lshlrev_b32 v86, 16, v99
    v_and_b32 v87, 0xffff0000, v99
    v_mul_f32 v99, v86, v96
    v_fma_f32 v86, -v99, v98, v86
    v_fma_f32 v86, v86, v96, v99
    v_mul_f32 v99, v87, v96
    v_fma_f32 v87, -v99, v98, v87
    v_fma_f32 v87, v87, v96, v99
    v_sub_f32 v88, v88, v97
    v_sub_f32 v89, v89, v97
    v_cvt_pk_bf16_f32 v99, v88, v89
    v_lshlrev_b32 v88, 16, v99
    v_and_b32 v89, 0xffff0000, v99
    v_mul_f32 v99, v88, v96
    v_fma_f32 v88, -v99, v98, v88
    v_fma_f32 v88, v88, v96, v99
    v_mul_f32 v99, v89, v96
    v_fma_f32 v89, -v99, v98, v89
    v_fma_f32 v89, v89, v96, v99
    v_sub_f32 v90, v90, v97
    v_sub_f32 v91, v91, v97
    v_cvt_pk_bf16_f32 v99, v90, v91
    v_lshlrev_b32 v90, 16, v99
    v_and_b32 v91, 0xffff0000, v99
    v_mul_f32 v99, v90, v96
    v_fma_f32 v90, -v99, v98, v90
    v_fma_f32 v90, v90, v96, v99
    v_mul_f32 v99, v91, v96
    v_fma_f32 v91, -v99, v98, v91
    v_fma_f32 v91, v91, v96, v99
Lne_115:
    v_mfma_f32_16x16x32_bf16 v[240:243], v[44:47], v[64:67], v[240:243]
    v_mfma_f32_16x16x32_bf16 v[244:247], v[44:47], v[68:71], v[244:247]
    v_mfma_f32_16x16x32_bf16 v[248:251], v[44:47], v[72:75], v[248:251]
    v_mfma_f32_16x16x32_bf16 v[252:255], v[44:47], v[76:79], v[252:255]
    ds_read_b128 v[44:47], v2 offset:14336
    s_cbranch_vccnz Lnd_116
    s_add_u32 s68, s67, s6
    s_add_u32 m0, s81, 115712
    s_nop 0
    buffer_load_dwordx4 v12, s[96:99], s68 offen lds
    s_add_u32 m0, s81, 116736
    s_nop 0
    buffer_load_dwordx4 v13, s[96:99], s67 offen lds
    s_add_u32 s68, s67, s6
    s_add_u32 m0, s81, 117760
    s_nop 0
    buffer_load_dwordx4 v13, s[96:99], s68 offen lds
    s_branch Lne_117
Lnd_116:
    v_sub_f32 v92, v92, v97
    v_sub_f32 v93, v93, v97
    v_cvt_pk_bf16_f32 v99, v92, v93
    v_lshlrev_b32 v92, 16, v99
    v_and_b32 v93, 0xffff0000, v99
    v_mul_f32 v99, v92, v96
    v_fma_f32 v92, -v99, v98, v92
    v_fma_f32 v92, v92, v96, v99
    v_mul_f32 v99, v93, v96
    v_fma_f32 v93, -v99, v98, v93
    v_fma_f32 v93, v93, v96, v99
    v_sub_f32 v94, v94, v97
    v_sub_f32 v95, v95, v97
    v_cvt_pk_bf16_f32 v99, v94, v95
    v_lshlrev_b32 v94, 16, v99
    v_and_b32 v95, 0xffff0000, v99
    v_mul_f32 v99, v94, v96
    v_fma_f32 v94, -v99, v98, v94
    v_fma_f32 v94, v94, v96, v99
    v_mul_f32 v99, v95, v96
    v_fma_f32 v95, -v99, v98, v95
    v_fma_f32 v95, v95, v96, v99
    v_cvt_pk_bf16_f32 v104, v80, v81
    v_cvt_pk_bf16_f32 v105, v82, v83
    v_cvt_pk_bf16_f32 v106, v84, v85
    v_cvt_pk_bf16_f32 v107, v86, v87
    v_cvt_pk_bf16_f32 v108, v88, v89
    v_cvt_pk_bf16_f32 v109, v90, v91
    v_cvt_pk_bf16_f32 v110, v92, v93
    v_cvt_pk_bf16_f32 v111, v94, v95
    s_add_u32 s56, s42, 220200960
    s_addc_u32 s57, s43, 0
    s_mov_b32 s58, 4456448
    s_and_b32 s57, s57, 0xffff
    s_mov_b32 s59, 0x00020000
    buffer_store_dwordx4 v[104:107], v120, s[56:59], s10 offen sc0 sc1
    buffer_store_dwordx4 v[108:111], v120, s[56:59], s10 offen offset:1024 sc0 sc1
Lne_117:
    s_add_u32 s64, s64, 128
    s_add_u32 s65, s65, 128
    s_add_u32 s66, s66, s7
    s_add_u32 s67, s67, s8
    s_cbranch_vccz Lnofp_118
    s_add_u32 s56, s20, 0
    s_addc_u32 s57, s21, 0
    s_mov_b32 s58, 8388608
    s_and_b32 s57, s57, 0xffff
    s_mov_b32 s59, 0x00020000
    s_mul_i32 s68, s9, 8
    s_add_u32 s69, s68, 4096
    buffer_load_dwordx4 v[100:103], v120, s[56:59], s68 offen offset:0
    buffer_load_dwordx4 v[100:103], v120, s[56:59], s68 offen offset:1024
    buffer_load_dwordx4 v[100:103], v120, s[56:59], s68 offen offset:2048
    buffer_load_dwordx4 v[100:103], v120, s[56:59], s68 offen offset:3072
Lnofp_118:
    s_waitcnt lgkmcnt(4)
    v_mfma_f32_16x16x32_bf16 v[128:131], v[16:19], v[48:51], v[128:131]
    v_mfma_f32_16x16x32_bf16 v[132:135], v[16:19], v[52:55], v[132:135]
    v_mfma_f32_16x16x32_bf16 v[136:139], v[16:19], v[56:59], v[136:139]
    v_mfma_f32_16x16x32_bf16 v[140:143], v[16:19], v[60:63], v[140:143]
    ds_read_b128 v[16:19], v3 offset:0
    ds_read_b64_tr_b16 v[64:65], v4 offset:8192
    ds_read_b64_tr_b16 v[66:67], v4 offset:9216
    v_mfma_f32_16x16x32_bf16 v[144:147], v[20:23], v[48:51], v[144:147]
    v_mfma_f32_16x16x32_bf16 v[148:151], v[20:23], v[52:55], v[148:151]
    v_mfma_f32_16x16x32_bf16 v[152:155], v[20:23], v[56:59], v[152:155]
    v_mfma_f32_16x16x32_bf16 v[156:159], v[20:23], v[60:63], v[156:159]
    ds_read_b128 v[20:23], v3 offset:2048
    ds_read_b64_tr_b16 v[68:69], v5 offset:8192
    ds_read_b64_tr_b16 v[70:71], v5 offset:9216
    v_mfma_f32_16x16x32_bf16 v[160:163], v[24:27], v[48:51], v[160:163]
    v_mfma_f32_16x16x32_bf16 v[164:167], v[24:27], v[52:55], v[164:167]
    v_mfma_f32_16x16x32_bf16 v[168:171], v[24:27], v[56:59], v[168:171]
    v_mfma_f32_16x16x32_bf16 v[172:175], v[24:27], v[60:63], v[172:175]
    ds_read_b128 v[24:27], v3 offset:4096
    ds_read_b64_tr_b16 v[72:73], v6 offset:8192
    ds_read_b64_tr_b16 v[74:75], v6 offset:9216
    v_mfma_f32_16x16x32_bf16 v[176:179], v[28:31], v[48:51], v[176:179]
    v_mfma_f32_16x16x32_bf16 v[180:183], v[28:31], v[52:55], v[180:183]
    v_mfma_f32_16x16x32_bf16 v[184:187], v[28:31], v[56:59], v[184:187]
    v_mfma_f32_16x16x32_bf16 v[188:191], v[28:31], v[60:63], v[188:191]
    ds_read_b128 v[28:31], v3 offset:6144
    ds_read_b64_tr_b16 v[76:77], v7 offset:8192
    ds_read_b64_tr_b16 v[78:79], v7 offset:9216
    s_waitcnt lgkmcnt(12)
    v_mfma_f32_16x16x32_bf16 v[192:195], v[32:35], v[48:51], v[192:195]
    v_mfma_f32_16x16x32_bf16 v[196:199], v[32:35], v[52:55], v[196:199]
    v_mfma_f32_16x16x32_bf16 v[200:203], v[32:35], v[56:59], v[200:203]
    v_mfma_f32_16x16x32_bf16 v[204:207], v[32:35], v[60:63], v[204:207]
    ds_read_b128 v[32:35], v3 offset:8192
    v_mfma_f32_16x16x32_bf16 v[208:211], v[36:39], v[48:51], v[208:211]
    v_mfma_f32_16x16x32_bf16 v[212:215], v[36:39], v[52:55], v[212:215]
    v_mfma_f32_16x16x32_bf16 v[216:219], v[36:39], v[56:59], v[216:219]
    v_mfma_f32_16x16x32_bf16 v[220:223], v[36:39], v[60:63], v[220:223]
    ds_read_b128 v[36:39], v3 offset:10240
    v_mfma_f32_16x16x32_bf16 v[224:227], v[40:43], v[48:51], v[224:227]
    v_mfma_f32_16x16x32_bf16 v[228:231], v[40:43], v[52:55], v[228:231]
    v_mfma_f32_16x16x32_bf16 v[232:235], v[40:43], v[56:59], v[232:235]
    v_mfma_f32_16x16x32_bf16 v[236:239], v[40:43], v[60:63], v[236:239]
    ds_read_b128 v[40:43], v3 offset:12288
    v_mfma_f32_16x16x32_bf16 v[240:243], v[44:47], v[48:51], v[240:243]
    v_mfma_f32_16x16x32_bf16 v[244:247], v[44:47], v[52:55], v[244:247]
    v_mfma_f32_16x16x32_bf16 v[248:251], v[44:47], v[56:59], v[248:251]
    v_mfma_f32_16x16x32_bf16 v[252:255], v[44:47], v[60:63], v[252:255]
    ds_read_b128 v[44:47], v3 offset:14336
    s_waitcnt lgkmcnt(4)
    v_mfma_f32_16x16x32_bf16 v[128:131], v[16:19], v[64:67], v[128:131]
    v_mfma_f32_16x16x32_bf16 v[132:135], v[16:19], v[68:71], v[132:135]
    v_mfma_f32_16x16x32_bf16 v[136:139], v[16:19], v[72:75], v[136:139]
    v_mfma_f32_16x16x32_bf16 v[140:143], v[16:19], v[76:79], v[140:143]
    v_mfma_f32_16x16x32_bf16 v[144:147], v[20:23], v[64:67], v[144:147]
    v_mfma_f32_16x16x32_bf16 v[148:151], v[20:23], v[68:71], v[148:151]
    v_mfma_f32_16x16x32_bf16 v[152:155], v[20:23], v[72:75], v[152:155]
    v_mfma_f32_16x16x32_bf16 v[156:159], v[20:23], v[76:79], v[156:159]
    s_waitcnt lgkmcnt(0)
    s_cbranch_vccnz Lfw_119
    s_waitcnt vmcnt(0)
Lfw_119:
Lfw_120:
    s_barrier
    ds_read_b128 v[16:19], v2 offset:32768
    ds_read_b128 v[20:23], v2 offset:34816
    ds_read_b64_tr_b16 v[48:49], v4 offset:32768
    ds_read_b64_tr_b16 v[50:51], v4 offset:33792
    ds_read_b64_tr_b16 v[52:53], v5 offset:32768
    ds_read_b64_tr_b16 v[54:55], v5 offset:33792
    v_mfma_f32_16x16x32_bf16 v[160:163], v[24:27], v[64:67], v[160:163]
    v_mfma_f32_16x16x32_bf16 v[164:167], v[24:27], v[68:71], v[164:167]
    v_mfma_f32_16x16x32_bf16 v[168:171], v[24:27], v[72:75], v[168:171]
    v_mfma_f32_16x16x32_bf16 v[172:175], v[24:27], v[76:79], v[172:175]
    ds_read_b128 v[24:27], v2 offset:36864
    ds_read_b64_tr_b16 v[56:57], v6 offset:32768
    ds_read_b64_tr_b16 v[58:59], v6 offset:33792
    s_cbranch_vccnz Lnd_121
    s_add_u32 m0, s81, 0
    s_nop 0
    buffer_load_dwordx4 v8, s[44:47], s64 offen lds
    s_add_u32 m0, s81, 1024
    s_nop 0
    buffer_load_dwordx4 v9, s[44:47], s64 offen lds
    s_branch Lne_122
Lnd_121:
    v_lshlrev_b32 v80, 16, v112
    v_and_b32 v81, 0xffff0000, v112
    v_lshlrev_b32 v82, 16, v113
    v_and_b32 v83, 0xffff0000, v113
    v_lshlrev_b32 v84, 16, v114
    v_and_b32 v85, 0xffff0000, v114
    v_lshlrev_b32 v86, 16, v115
    v_and_b32 v87, 0xffff0000, v115
    v_lshlrev_b32 v88, 16, v116
    v_and_b32 v89, 0xffff0000, v116
    v_lshlrev_b32 v90, 16, v117
    v_and_b32 v91, 0xffff0000, v117
    v_lshlrev_b32 v92, 16, v118
    v_and_b32 v93, 0xffff0000, v118
    v_lshlrev_b32 v94, 16, v119
    v_and_b32 v95, 0xffff0000, v119
    v_add_f32 v96, v80, v81
    v_add_f32 v96, v96, v82
    v_add_f32 v96, v96, v83
    v_add_f32 v96, v96, v84
    v_add_f32 v96, v96, v85
    v_add_f32 v96, v96, v86
    v_add_f32 v96, v96, v87
    v_add_f32 v96, v96, v88
    v_add_f32 v96, v96, v89
    v_add_f32 v96, v96, v90
    v_add_f32 v96, v96, v91
    v_add_f32 v96, v96, v92
    v_add_f32 v96, v96, v93
    v_add_f32 v96, v96, v94
    v_add_f32 v96, v96, v95
    s_nop 1
    v_add_f32_dpp v96, v96, v96 quad_perm:[1,0,3,2] row_mask:0xf bank_mask:0xf
    s_nop 1
    v_add_f32_dpp v96, v96, v96 quad_perm:[2,3,0,1] row_mask:0xf bank_mask:0xf
    s_nop 1
Lne_122:
    v_mfma_f32_16x16x32_bf16 v[176:179], v[28:31], v[64:67], v[176:179]
    v_mfma_f32_16x16x32_bf16 v[180:183], v[28:31], v[68:71], v[180:183]
    v_mfma_f32_16x16x32_bf16 v[184:187], v[28:31], v[72:75], v[184:187]
    v_mfma_f32_16x16x32_bf16 v[188:191], v[28:31], v[76:79], v[188:191]
    ds_read_b128 v[28:31], v2 offset:38912
    ds_read_b64_tr_b16 v[60:61], v7 offset:32768
    ds_read_b64_tr_b16 v[62:63], v7 offset:33792
    s_cbranch_vccnz Lnd_123
    s_add_u32 s68, s64, s4
    s_add_u32 m0, s81, 2048
    s_nop 0
    buffer_load_dwordx4 v8, s[44:47], s68 offen lds
    s_add_u32 s68, s64, s4
    s_add_u32 m0, s81, 3072
    s_nop 0
    buffer_load_dwordx4 v9, s[44:47], s68 offen lds
    s_branch Lne_124
Lnd_123:
    v_add_f32_dpp v96, v96, v96 row_half_mirror row_mask:0xf bank_mask:0xf
    s_nop 1
    v_add_f32_dpp v96, v96, v96 row_mirror row_mask:0xf bank_mask:0xf
    s_nop 1
    v_readlane_b32 s76, v96, 0
    v_readlane_b32 s77, v96, 16
    v_readlane_b32 s78, v96, 32
    v_readlane_b32 s79, v96, 48
    s_nop 2
    v_mov_b32 v96, s76
    v_add_f32 v96, s77, v96
    v_add_f32 v96, s78, v96
    v_add_f32 v96, s79, v96
    v_mul_f32 v97, 0x3a800000, v96
    v_mov_b32 v98, 0
    v_sub_f32 v99, v80, v97
    v_fmac_f32 v98, v99, v99
    v_sub_f32 v99, v81, v97
    v_fmac_f32 v98, v99, v99
    v_sub_f32 v99, v82, v97
    v_fmac_f32 v98, v99, v99
    v_sub_f32 v99, v83, v97
    v_fmac_f32 v98, v99, v99
    v_sub_f32 v99, v84, v97
    v_fmac_f32 v98, v99, v99
    v_sub_f32 v99, v85, v97
    v_fmac_f32 v98, v99, v99
    v_sub_f32 v99, v86, v97
    v_fmac_f32 v98, v99, v99
    v_sub_f32 v99, v87, v97
    v_fmac_f32 v98, v99, v99
    v_sub_f32 v99, v88, v97
    v_fmac_f32 v98, v99, v99
    v_sub_f32 v99, v89, v97
    v_fmac_f32 v98, v99, v99
    v_sub_f32 v99, v90, v97
Lne_124:
    v_mfma_f32_16x16x32_bf16 v[192:195], v[32:35], v[64:67], v[192:195]
    v_mfma_f32_16x16x32_bf16 v[196:199], v[32:35], v[68:71], v[196:199]
    v_mfma_f32_16x16x32_bf16 v[200:203], v[32:35], v[72:75], v[200:203]
    v_mfma_f32_16x16x32_bf16 v[204:207], v[32:35], v[76:79], v[204:207]
    ds_read_b128 v[32:35], v2 offset:40960
    s_cbranch_vccnz Lnd_125
    s_add_u32 m0, s81, 16384
    s_nop 0
    buffer_load_dwordx4 v8, s[44:47], s65 offen lds
    s_add_u32 m0, s81, 17408
    s_nop 0
    buffer_load_dwordx4 v9, s[44:47], s65 offen lds
    s_add_u32 s68, s65, s4
    s_add_u32 m0, s81, 18432
    s_nop 0
    buffer_load_dwordx4 v8, s[44:47], s68 offen lds
    s_branch Lne_126
Lnd_125:
    v_fmac_f32 v98, v99, v99
    v_sub_f32 v99, v91, v97
    v_fmac_f32 v98, v99, v99
    v_sub_f32 v99, v92, v97
    v_fmac_f32 v98, v99, v99
    v_sub_f32 v99, v93, v97
    v_fmac_f32 v98, v99, v99
    v_sub_f32 v99, v94, v97
    v_fmac_f32 v98, v99, v99
    v_sub_f32 v99, v95, v97
    v_fmac_f32 v98, v99, v99
    s_nop 1
    v_add_f32_dpp v98, v98, v98 quad_perm:[1,0,3,2] row_mask:0xf bank_mask:0xf
    s_nop 1
    v_add_f32_dpp v98, v98, v98 quad_perm:[2,3,0,1] row_mask:0xf bank_mask:0xf
    s_nop 1
    v_add_f32_dpp v98, v98, v98 row_half_mirror row_mask:0xf bank_mask:0xf
    s_nop 1
    v_add_f32_dpp v98, v98, v98 row_mirror row_mask:0xf bank_mask:0xf
    s_nop 1
    v_readlane_b32 s76, v98, 0
    v_readlane_b32 s77, v98, 16
    v_readlane_b32 s78, v98, 32
    v_readlane_b32 s79, v98, 48
    s_nop 2
    v_mov_b32 v98, s76
    v_add_f32 v98, s77, v98
    v_add_f32 v98, s78, v98
    v_add_f32 v98, s79, v98
    v_mul_f32 v98, 0x3a800000, v98
    v_cvt_pk_bf16_f32 v97, v97, v97
    v_lshlrev_b32 v97, 16, v97
    v_cvt_pk_bf16_f32 v98, v98, v98
    v_lshlrev_b32 v98, 16, v98
    v_add_f32 v98, 0x3727c5ac, v98
    v_cvt_pk_bf16_f32 v98, v98, v98
    v_lshlrev_b32 v98, 16, v98
Lne_126:
    v_mfma_f32_16x16x32_bf16 v[208:211], v[36:39], v[64:67], v[208:211]
    v_mfma_f32_16x16x32_bf16 v[212:215], v[36:39], v[68:71], v[212:215]
    v_mfma_f32_16x16x32_bf16 v[216:219], v[36:39], v[72:75], v[216:219]
    v_mfma_f32_16x16x32_bf16 v[220:223], v[36:39], v[76:79], v[220:223]
    ds_read_b128 v[36:39], v2 offset:43008
    s_cbranch_vccnz Lnd_127
    s_add_u32 s68, s65, s4
    s_add_u32 m0, s81, 19456
    s_nop 0
    buffer_load_dwordx4 v9, s[44:47], s68 offen lds
    s_add_u32 m0, s81, 65536
    s_nop 0
    buffer_load_dwordx4 v10, s[48:51], s66 offen lds
    s_add_u32 s68, s66, s5
    s_add_u32 m0, s81, 66560
    s_nop 0
    buffer_load_dwordx4 v10, s[48:51], s68 offen lds
    s_branch Lne_128
Lnd_127:
    v_sqrt_f32 v98, v98
    s_nop 0
    v_cvt_pk_bf16_f32 v98, v98, v98
    v_lshlrev_b32 v98, 16, v98
    v_rcp_f32 v96, v98
    s_nop 0
    v_sub_f32 v80, v80, v97
    v_sub_f32 v81, v81, v97
    v_cvt_pk_bf16_f32 v99, v80, v81
    v_lshlrev_b32 v80, 16, v99
    v_and_b32 v81, 0xffff0000, v99
    v_mul_f32 v99, v80, v96
    v_fma_f32 v80, -v99, v98, v80
    v_fma_f32 v80, v80, v96, v99
    v_mul_f32 v99, v81, v96
    v_fma_f32 v81, -v99, v98, v81
    v_fma_f32 v81, v81, v96, v99
    v_sub_f32 v82, v82, v97
    v_sub_f32 v83, v83, v97
    v_cvt_pk_bf16_f32 v99, v82, v83
    v_lshlrev_b32 v82, 16, v99
    v_and_b32 v83, 0xffff0000, v99
    v_mul_f32 v99, v82, v96
    v_fma_f32 v82, -v99, v98, v82
    v_fma_f32 v82, v82, v96, v99
    v_mul_f32 v99, v83, v96
    v_fma_f32 v83, -v99, v98, v83
    v_fma_f32 v83, v83, v96, v99
    v_sub_f32 v84, v84, v97
    v_sub_f32 v85, v85, v97
    v_cvt_pk_bf16_f32 v99, v84, v85
    v_lshlrev_b32 v84, 16, v99
    v_and_b32 v85, 0xffff0000, v99
    v_mul_f32 v99, v84, v96
    v_fma_f32 v84, -v99, v98, v84
    v_fma_f32 v84, v84, v96, v99
Lne_128:
    v_mfma_f32_16x16x32_bf16 v[224:227], v[40:43], v[64:67], v[224:227]
    v_mfma_f32_16x16x32_bf16 v[228:231], v[40:43], v[68:71], v[228:231]
    v_mfma_f32_16x16x32_bf16 v[232:235], v[40:43], v[72:75], v[232:235]
    v_mfma_f32_16x16x32_bf16 v[236:239], v[40:43], v[76:79], v[236:239]
    ds_read_b128 v[40:43], v2 offset:45056
    s_cbranch_vccnz Lnd_129
    s_add_u32 m0, s81, 67584
    s_nop 0
    buffer_load_dwordx4 v11, s[48:51], s66 offen lds
    s_add_u32 s68, s66, s5
    s_add_u32 m0, s81, 68608
    s_nop 0
    buffer_load_dwordx4 v11, s[48:51], s68 offen lds
    s_add_u32 m0, s81, 81920
    s_nop 0
    buffer_load_dwordx4 v12, s[96:99], s67 offen lds
    s_branch Lne_130
Lnd_129:
    v_mul_f32 v99, v85, v96
    v_fma_f32 v85, -v99, v98, v85
    v_fma_f32 v85, v85, v96, v99
    v_sub_f32 v86, v86, v97
    v_sub_f32 v87, v87, v97
    v_cvt_pk_bf16_f32 v99, v86, v87
    v_lshlrev_b32 v86, 16, v99
    v_and_b32 v87, 0xffff0000, v99
    v_mul_f32 v99, v86, v96
    v_fma_f32 v86, -v99, v98, v86
    v_fma_f32 v86, v86, v96, v99
    v_mul_f32 v99, v87, v96
    v_fma_f32 v87, -v99, v98, v87
    v_fma_f32 v87, v87, v96, v99
    v_sub_f32 v88, v88, v97
    v_sub_f32 v89, v89, v97
    v_cvt_pk_bf16_f32 v99, v88, v89
    v_lshlrev_b32 v88, 16, v99
    v_and_b32 v89, 0xffff0000, v99
    v_mul_f32 v99, v88, v96
    v_fma_f32 v88, -v99, v98, v88
    v_fma_f32 v88, v88, v96, v99
    v_mul_f32 v99, v89, v96
    v_fma_f32 v89, -v99, v98, v89
    v_fma_f32 v89, v89, v96, v99
    v_sub_f32 v90, v90, v97
    v_sub_f32 v91, v91, v97
    v_cvt_pk_bf16_f32 v99, v90, v91
    v_lshlrev_b32 v90, 16, v99
    v_and_b32 v91, 0xffff0000, v99
    v_mul_f32 v99, v90, v96
    v_fma_f32 v90, -v99, v98, v90
    v_fma_f32 v90, v90, v96, v99
    v_mul_f32 v99, v91, v96
    v_fma_f32 v91, -v99, v98, v91
    v_fma_f32 v91, v91, v96, v99
Lne_130:
    v_mfma_f32_16x16x32_bf16 v[240:243], v[44:47], v[64:67], v[240:243]
    v_mfma_f32_16x16x32_bf16 v[244:247], v[44:47], v[68:71], v[244:247]
    v_mfma_f32_16x16x32_bf16 v[248:251], v[44:47], v[72:75], v[248:251]
    v_mfma_f32_16x16x32_bf16 v[252:255], v[44:47], v[76:79], v[252:255]
    ds_read_b128 v[44:47], v2 offset:47104
    s_cbranch_vccnz Lnd_131
    s_add_u32 s68, s67, s6
    s_add_u32 m0, s81, 82944
    s_nop 0
    buffer_load_dwordx4 v12, s[96:99], s68 offen lds
    s_add_u32 m0, s81, 83968
    s_nop 0
    buffer_load_dwordx4 v13, s[96:99], s67 offen lds
    s_add_u32 s68, s67, s6
    s_add_u32 m0, s81, 84992
    s_nop 0
    buffer_load_dwordx4 v13, s[96:99], s68 offen lds
    s_branch Lne_132
Lnd_131:
    v_sub_f32 v92, v92, v97
    v_sub_f32 v93, v93, v97
    v_cvt_pk_bf16_f32 v99, v92, v93
    v_lshlrev_b32 v92, 16, v99
    v_and_b32 v93, 0xffff0000, v99
    v_mul_f32 v99, v92, v96
    v_fma_f32 v92, -v99, v98, v92
    v_fma_f32 v92, v92, v96, v99
    v_mul_f32 v99, v93, v96
    v_fma_f32 v93, -v99, v98, v93
    v_fma_f32 v93, v93, v96, v99
    v_sub_f32 v94, v94, v97
    v_sub_f32 v95, v95, v97
    v_cvt_pk_bf16_f32 v99, v94, v95
    v_lshlrev_b32 v94, 16, v99
    v_and_b32 v95, 0xffff0000, v99
    v_mul_f32 v99, v94, v96
    v_fma_f32 v94, -v99, v98, v94
    v_fma_f32 v94, v94, v96, v99
    v_mul_f32 v99, v95, v96
    v_fma_f32 v95, -v99, v98, v95
    v_fma_f32 v95, v95, v96, v99
    v_cvt_pk_bf16_f32 v112, v80, v81
    v_cvt_pk_bf16_f32 v113, v82, v83
    v_cvt_pk_bf16_f32 v114, v84, v85
    v_cvt_pk_bf16_f32 v115, v86, v87
    v_cvt_pk_bf16_f32 v116, v88, v89
    v_cvt_pk_bf16_f32 v117, v90, v91
    v_cvt_pk_bf16_f32 v118, v92, v93
    v_cvt_pk_bf16_f32 v119, v94, v95
    s_add_u32 s56, s42, 220200960
    s_addc_u32 s57, s43, 0
    s_mov_b32 s58, 4456448
    s_and_b32 s57, s57, 0xffff
    s_mov_b32 s59, 0x00020000
    buffer_store_dwordx4 v[112:115], v120, s[56:59], s11 offen sc0 sc1
    buffer_store_dwordx4 v[116:119], v120, s[56:59], s11 offen offset:1024 sc0 sc1
Lne_132:
    s_add_u32 s64, s64, 128
    s_add_u32 s65, s65, 128
    s_add_u32 s66, s66, s7
    s_add_u32 s67, s67, s8
    s_cbranch_vccz Lnofp_133
    s_add_u32 s56, s30, 0
    s_addc_u32 s57, s31, 0
    s_mov_b32 s58, 7340032
    s_and_b32 s57, s57, 0xffff
    s_mov_b32 s59, 0x00020000
    s_mul_i32 s68, s9, 8
    s_add_u32 s69, s68, 4096
    buffer_load_dwordx4 v[100:103], v120, s[56:59], s68 offen offset:0
    buffer_load_dwordx4 v[100:103], v120, s[56:59], s68 offen offset:1024
    buffer_load_dwordx4 v[100:103], v120, s[56:59], s68 offen offset:2048
    buffer_load_dwordx4 v[100:103], v120, s[56:59], s68 offen offset:3072
Lnofp_133:
    s_waitcnt lgkmcnt(4)
    v_mfma_f32_16x16x32_bf16 v[128:131], v[16:19], v[48:51], v[128:131]
    v_mfma_f32_16x16x32_bf16 v[132:135], v[16:19], v[52:55], v[132:135]
    v_mfma_f32_16x16x32_bf16 v[136:139], v[16:19], v[56:59], v[136:139]
    v_mfma_f32_16x16x32_bf16 v[140:143], v[16:19], v[60:63], v[140:143]
    ds_read_b128 v[16:19], v3 offset:32768
    ds_read_b64_tr_b16 v[64:65], v4 offset:40960
    ds_read_b64_tr_b16 v[66:67], v4 offset:41984
    v_mfma_f32_16x16x32_bf16 v[144:147], v[20:23], v[48:51], v[144:147]
    v_mfma_f32_16x16x32_bf16 v[148:151], v[20:23], v[52:55], v[148:151]
    v_mfma_f32_16x16x32_bf16 v[152:155], v[20:23], v[56:59], v[152:155]
    v_mfma_f32_16x16x32_bf16 v[156:159], v[20:23], v[60:63], v[156:159]
    ds_read_b128 v[20:23], v3 offset:34816
    ds_read_b64_tr_b16 v[68:69], v5 offset:40960
    ds_read_b64_tr_b16 v[70:71], v5 offset:41984
    v_mfma_f32_16x16x32_bf16 v[160:163], v[24:27], v[48:51], v[160:163]
    v_mfma_f32_16x16x32_bf16 v[164:167], v[24:27], v[52:55], v[164:167]
    v_mfma_f32_16x16x32_bf16 v[168:171], v[24:27], v[56:59], v[168:171]
    v_mfma_f32_16x16x32_bf16 v[172:175], v[24:27], v[60:63], v[172:175]
    ds_read_b128 v[24:27], v3 offset:36864
    ds_read_b64_tr_b16 v[72:73], v6 offset:40960
    ds_read_b64_tr_b16 v[74:75], v6 offset:41984
    v_mfma_f32_16x16x32_bf16 v[176:179], v[28:31], v[48:51], v[176:179]
    v_mfma_f32_16x16x32_bf16 v[180:183], v[28:31], v[52:55], v[180:183]
    v_mfma_f32_16x16x32_bf16 v[184:187], v[28:31], v[56:59], v[184:187]
    v_mfma_f32_16x16x32_bf16 v[188:191], v[28:31], v[60:63], v[188:191]
    ds_read_b128 v[28:31], v3 offset:38912
    ds_read_b64_tr_b16 v[76:77], v7 offset:40960
    ds_read_b64_tr_b16 v[78:79], v7 offset:41984
    s_waitcnt lgkmcnt(12)
    v_mfma_f32_16x16x32_bf16 v[192:195], v[32:35], v[48:51], v[192:195]
    v_mfma_f32_16x16x32_bf16 v[196:199], v[32:35], v[52:55], v[196:199]
    v_mfma_f32_16x16x32_bf16 v[200:203], v[32:35], v[56:59], v[200:203]
    v_mfma_f32_16x16x32_bf16 v[204:207], v[32:35], v[60:63], v[204:207]
    ds_read_b128 v[32:35], v3 offset:40960
    v_mfma_f32_16x16x32_bf16 v[208:211], v[36:39], v[48:51], v[208:211]
    v_mfma_f32_16x16x32_bf16 v[212:215], v[36:39], v[52:55], v[212:215]
    v_mfma_f32_16x16x32_bf16 v[216:219], v[36:39], v[56:59], v[216:219]
    v_mfma_f32_16x16x32_bf16 v[220:223], v[36:39], v[60:63], v[220:223]
    ds_read_b128 v[36:39], v3 offset:43008
    v_mfma_f32_16x16x32_bf16 v[224:227], v[40:43], v[48:51], v[224:227]
    v_mfma_f32_16x16x32_bf16 v[228:231], v[40:43], v[52:55], v[228:231]
    v_mfma_f32_16x16x32_bf16 v[232:235], v[40:43], v[56:59], v[232:235]
    v_mfma_f32_16x16x32_bf16 v[236:239], v[40:43], v[60:63], v[236:239]
    ds_read_b128 v[40:43], v3 offset:45056
    v_mfma_f32_16x16x32_bf16 v[240:243], v[44:47], v[48:51], v[240:243]
    v_mfma_f32_16x16x32_bf16 v[244:247], v[44:47], v[52:55], v[244:247]
    v_mfma_f32_16x16x32_bf16 v[248:251], v[44:47], v[56:59], v[248:251]
    v_mfma_f32_16x16x32_bf16 v[252:255], v[44:47], v[60:63], v[252:255]
    ds_read_b128 v[44:47], v3 offset:47104
    s_waitcnt lgkmcnt(4)
    v_mfma_f32_16x16x32_bf16 v[128:131], v[16:19], v[64:67], v[128:131]
    v_mfma_f32_16x16x32_bf16 v[132:135], v[16:19], v[68:71], v[132:135]
    v_mfma_f32_16x16x32_bf16 v[136:139], v[16:19], v[72:75], v[136:139]
    v_mfma_f32_16x16x32_bf16 v[140:143], v[16:19], v[76:79], v[140:143]
    v_mfma_f32_16x16x32_bf16 v[144:147], v[20:23], v[64:67], v[144:147]
    v_mfma_f32_16x16x32_bf16 v[148:151], v[20:23], v[68:71], v[148:151]
    v_mfma_f32_16x16x32_bf16 v[152:155], v[20:23], v[72:75], v[152:155]
    v_mfma_f32_16x16x32_bf16 v[156:159], v[20:23], v[76:79], v[156:159]
    s_waitcnt lgkmcnt(0)
    s_cbranch_vccnz Lfw_134
    s_waitcnt vmcnt(0)
Lfw_134:
Lfw_135:
    s_barrier
    ds_read_b128 v[16:19], v2 offset:0
    ds_read_b128 v[20:23], v2 offset:2048
    ds_read_b64_tr_b16 v[48:49], v4 offset:0
    ds_read_b64_tr_b16 v[50:51], v4 offset:1024
    ds_read_b64_tr_b16 v[52:53], v5 offset:0
    ds_read_b64_tr_b16 v[54:55], v5 offset:1024
    v_mfma_f32_16x16x32_bf16 v[160:163], v[24:27], v[64:67], v[160:163]
    v_mfma_f32_16x16x32_bf16 v[164:167], v[24:27], v[68:71], v[164:167]
    v_mfma_f32_16x16x32_bf16 v[168:171], v[24:27], v[72:75], v[168:171]
    v_mfma_f32_16x16x32_bf16 v[172:175], v[24:27], v[76:79], v[172:175]
    ds_read_b128 v[24:27], v2 offset:4096
    ds_read_b64_tr_b16 v[56:57], v6 offset:0
    ds_read_b64_tr_b16 v[58:59], v6 offset:1024
    s_cbranch_vccnz Lnd_136
    s_add_u32 m0, s81, 32768
    s_nop 0
    buffer_load_dwordx4 v8, s[44:47], s64 offen lds
    s_add_u32 m0, s81, 33792
    s_nop 0
    buffer_load_dwordx4 v9, s[44:47], s64 offen lds
Lnd_136:
    v_mfma_f32_16x16x32_bf16 v[176:179], v[28:31], v[64:67], v[176:179]
    v_mfma_f32_16x16x32_bf16 v[180:183], v[28:31], v[68:71], v[180:183]
    v_mfma_f32_16x16x32_bf16 v[184:187], v[28:31], v[72:75], v[184:187]
    v_mfma_f32_16x16x32_bf16 v[188:191], v[28:31], v[76:79], v[188:191]
    ds_read_b128 v[28:31], v2 offset:6144
    ds_read_b64_tr_b16 v[60:61], v7 offset:0
    ds_read_b64_tr_b16 v[62:63], v7 offset:1024
    s_cbranch_vccnz Lnd_137
    s_add_u32 s68, s64, s4
    s_add_u32 m0, s81, 34816
    s_nop 0
    buffer_load_dwordx4 v8, s[44:47], s68 offen lds
    s_add_u32 s68, s64, s4
    s_add_u32 m0, s81, 35840
    s_nop 0
    buffer_load_dwordx4 v9, s[44:47], s68 offen lds
Lnd_137:
    v_mfma_f32_16x16x32_bf16 v[192:195], v[32:35], v[64:67], v[192:195]
    v_mfma_f32_16x16x32_bf16 v[196:199], v[32:35], v[68:71], v[196:199]
    v_mfma_f32_16x16x32_bf16 v[200:203], v[32:35], v[72:75], v[200:203]
    v_mfma_f32_16x16x32_bf16 v[204:207], v[32:35], v[76:79], v[204:207]
    ds_read_b128 v[32:35], v2 offset:8192
    s_cbranch_vccnz Lnd_138
    s_add_u32 m0, s81, 49152
    s_nop 0
    buffer_load_dwordx4 v8, s[44:47], s65 offen lds
    s_add_u32 m0, s81, 50176
    s_nop 0
    buffer_load_dwordx4 v9, s[44:47], s65 offen lds
    s_add_u32 s68, s65, s4
    s_add_u32 m0, s81, 51200
    s_nop 0
    buffer_load_dwordx4 v8, s[44:47], s68 offen lds
Lnd_138:
    v_mfma_f32_16x16x32_bf16 v[208:211], v[36:39], v[64:67], v[208:211]
    v_mfma_f32_16x16x32_bf16 v[212:215], v[36:39], v[68:71], v[212:215]
    v_mfma_f32_16x16x32_bf16 v[216:219], v[36:39], v[72:75], v[216:219]
    v_mfma_f32_16x16x32_bf16 v[220:223], v[36:39], v[76:79], v[220:223]
    ds_read_b128 v[36:39], v2 offset:10240
    s_cbranch_vccnz Lnd_139
    s_add_u32 s68, s65, s4
    s_add_u32 m0, s81, 52224
    s_nop 0
    buffer_load_dwordx4 v9, s[44:47], s68 offen lds
    s_add_u32 m0, s81, 98304
    s_nop 0
    buffer_load_dwordx4 v10, s[48:51], s66 offen lds
    s_add_u32 s68, s66, s5
    s_add_u32 m0, s81, 99328
    s_nop 0
    buffer_load_dwordx4 v10, s[48:51], s68 offen lds
Lnd_139:
    v_mfma_f32_16x16x32_bf16 v[224:227], v[40:43], v[64:67], v[224:227]
    v_mfma_f32_16x16x32_bf16 v[228:231], v[40:43], v[68:71], v[228:231]
    v_mfma_f32_16x16x32_bf16 v[232:235], v[40:43], v[72:75], v[232:235]
    v_mfma_f32_16x16x32_bf16 v[236:239], v[40:43], v[76:79], v[236:239]
    ds_read_b128 v[40:43], v2 offset:12288
    s_cbranch_vccnz Lnd_140
    s_add_u32 m0, s81, 100352
    s_nop 0
    buffer_load_dwordx4 v11, s[48:51], s66 offen lds
    s_add_u32 s68, s66, s5
    s_add_u32 m0, s81, 101376
    s_nop 0
    buffer_load_dwordx4 v11, s[48:51], s68 offen lds
    s_add_u32 m0, s81, 114688
    s_nop 0
    buffer_load_dwordx4 v12, s[96:99], s67 offen lds
Lnd_140:
    v_mfma_f32_16x16x32_bf16 v[240:243], v[44:47], v[64:67], v[240:243]
    v_mfma_f32_16x16x32_bf16 v[244:247], v[44:47], v[68:71], v[244:247]
    v_mfma_f32_16x16x32_bf16 v[248:251], v[44:47], v[72:75], v[248:251]
    v_mfma_f32_16x16x32_bf16 v[252:255], v[44:47], v[76:79], v[252:255]
    ds_read_b128 v[44:47], v2 offset:14336
    s_cbranch_vccnz Lnd_141
    s_add_u32 s68, s67, s6
    s_add_u32 m0, s81, 115712
    s_nop 0
    buffer_load_dwordx4 v12, s[96:99], s68 offen lds
    s_add_u32 m0, s81, 116736
    s_nop 0
    buffer_load_dwordx4 v13, s[96:99], s67 offen lds
    s_add_u32 s68, s67, s6
    s_add_u32 m0, s81, 117760
    s_nop 0
    buffer_load_dwordx4 v13, s[96:99], s68 offen lds
Lnd_141:
    s_add_u32 s64, s64, 128
    s_add_u32 s65, s65, 128
    s_add_u32 s66, s66, s7
    s_add_u32 s67, s67, s8
    s_cbranch_vccz Lnofp_142
    s_add_u32 s56, s20, 0
    s_addc_u32 s57, s21, 0
    s_mov_b32 s58, 8388608
    s_and_b32 s57, s57, 0xffff
    s_mov_b32 s59, 0x00020000
    s_mul_i32 s68, s9, 8
    s_add_u32 s69, s68, 4096
    buffer_load_dwordx4 v[100:103], v120, s[56:59], s69 offen offset:0
    buffer_load_dwordx4 v[100:103], v120, s[56:59], s69 offen offset:1024
    buffer_load_dwordx4 v[100:103], v120, s[56:59], s69 offen offset:2048
    buffer_load_dwordx4 v[100:103], v120, s[56:59], s69 offen offset:3072
Lnofp_142:
    s_waitcnt lgkmcnt(4)
    v_mfma_f32_16x16x32_bf16 v[128:131], v[16:19], v[48:51], v[128:131]
    v_mfma_f32_16x16x32_bf16 v[132:135], v[16:19], v[52:55], v[132:135]
    v_mfma_f32_16x16x32_bf16 v[136:139], v[16:19], v[56:59], v[136:139]
    v_mfma_f32_16x16x32_bf16 v[140:143], v[16:19], v[60:63], v[140:143]
    ds_read_b128 v[16:19], v3 offset:0
    ds_read_b64_tr_b16 v[64:65], v4 offset:8192
    ds_read_b64_tr_b16 v[66:67], v4 offset:9216
    v_mfma_f32_16x16x32_bf16 v[144:147], v[20:23], v[48:51], v[144:147]
    v_mfma_f32_16x16x32_bf16 v[148:151], v[20:23], v[52:55], v[148:151]
    v_mfma_f32_16x16x32_bf16 v[152:155], v[20:23], v[56:59], v[152:155]
    v_mfma_f32_16x16x32_bf16 v[156:159], v[20:23], v[60:63], v[156:159]
    ds_read_b128 v[20:23], v3 offset:2048
    ds_read_b64_tr_b16 v[68:69], v5 offset:8192
    ds_read_b64_tr_b16 v[70:71], v5 offset:9216
    v_mfma_f32_16x16x32_bf16 v[160:163], v[24:27], v[48:51], v[160:163]
    v_mfma_f32_16x16x32_bf16 v[164:167], v[24:27], v[52:55], v[164:167]
    v_mfma_f32_16x16x32_bf16 v[168:171], v[24:27], v[56:59], v[168:171]
    v_mfma_f32_16x16x32_bf16 v[172:175], v[24:27], v[60:63], v[172:175]
    ds_read_b128 v[24:27], v3 offset:4096
    ds_read_b64_tr_b16 v[72:73], v6 offset:8192
    ds_read_b64_tr_b16 v[74:75], v6 offset:9216
    v_mfma_f32_16x16x32_bf16 v[176:179], v[28:31], v[48:51], v[176:179]
    v_mfma_f32_16x16x32_bf16 v[180:183], v[28:31], v[52:55], v[180:183]
    v_mfma_f32_16x16x32_bf16 v[184:187], v[28:31], v[56:59], v[184:187]
    v_mfma_f32_16x16x32_bf16 v[188:191], v[28:31], v[60:63], v[188:191]
    ds_read_b128 v[28:31], v3 offset:6144
    ds_read_b64_tr_b16 v[76:77], v7 offset:8192
    ds_read_b64_tr_b16 v[78:79], v7 offset:9216
    s_waitcnt lgkmcnt(12)
    v_mfma_f32_16x16x32_bf16 v[192:195], v[32:35], v[48:51], v[192:195]
    v_mfma_f32_16x16x32_bf16 v[196:199], v[32:35], v[52:55], v[196:199]
    v_mfma_f32_16x16x32_bf16 v[200:203], v[32:35], v[56:59], v[200:203]
    v_mfma_f32_16x16x32_bf16 v[204:207], v[32:35], v[60:63], v[204:207]
    ds_read_b128 v[32:35], v3 offset:8192
    v_mfma_f32_16x16x32_bf16 v[208:211], v[36:39], v[48:51], v[208:211]
    v_mfma_f32_16x16x32_bf16 v[212:215], v[36:39], v[52:55], v[212:215]
    v_mfma_f32_16x16x32_bf16 v[216:219], v[36:39], v[56:59], v[216:219]
    v_mfma_f32_16x16x32_bf16 v[220:223], v[36:39], v[60:63], v[220:223]
    ds_read_b128 v[36:39], v3 offset:10240
    v_mfma_f32_16x16x32_bf16 v[224:227], v[40:43], v[48:51], v[224:227]
    v_mfma_f32_16x16x32_bf16 v[228:231], v[40:43], v[52:55], v[228:231]
    v_mfma_f32_16x16x32_bf16 v[232:235], v[40:43], v[56:59], v[232:235]
    v_mfma_f32_16x16x32_bf16 v[236:239], v[40:43], v[60:63], v[236:239]
    ds_read_b128 v[40:43], v3 offset:12288
    v_mfma_f32_16x16x32_bf16 v[240:243], v[44:47], v[48:51], v[240:243]
    v_mfma_f32_16x16x32_bf16 v[244:247], v[44:47], v[52:55], v[244:247]
    v_mfma_f32_16x16x32_bf16 v[248:251], v[44:47], v[56:59], v[248:251]
    v_mfma_f32_16x16x32_bf16 v[252:255], v[44:47], v[60:63], v[252:255]
    ds_read_b128 v[44:47], v3 offset:14336
    s_waitcnt lgkmcnt(4)
    v_mfma_f32_16x16x32_bf16 v[128:131], v[16:19], v[64:67], v[128:131]
    v_mfma_f32_16x16x32_bf16 v[132:135], v[16:19], v[68:71], v[132:135]
    v_mfma_f32_16x16x32_bf16 v[136:139], v[16:19], v[72:75], v[136:139]
    v_mfma_f32_16x16x32_bf16 v[140:143], v[16:19], v[76:79], v[140:143]
    v_mfma_f32_16x16x32_bf16 v[144:147], v[20:23], v[64:67], v[144:147]
    v_mfma_f32_16x16x32_bf16 v[148:151], v[20:23], v[68:71], v[148:151]
    v_mfma_f32_16x16x32_bf16 v[152:155], v[20:23], v[72:75], v[152:155]
    v_mfma_f32_16x16x32_bf16 v[156:159], v[20:23], v[76:79], v[156:159]
    s_waitcnt lgkmcnt(0)
    s_cbranch_vccnz Lfw_143
    s_waitcnt vmcnt(0)
    s_branch Lfw_144
Lfw_143:
    s_waitcnt vmcnt(8)
Lfw_144:
    s_barrier
    ds_read_b128 v[16:19], v2 offset:32768
    ds_read_b128 v[20:23], v2 offset:34816
    ds_read_b64_tr_b16 v[48:49], v4 offset:32768
    ds_read_b64_tr_b16 v[50:51], v4 offset:33792
    ds_read_b64_tr_b16 v[52:53], v5 offset:32768
    ds_read_b64_tr_b16 v[54:55], v5 offset:33792
    v_mfma_f32_16x16x32_bf16 v[160:163], v[24:27], v[64:67], v[160:163]
    v_mfma_f32_16x16x32_bf16 v[164:167], v[24:27], v[68:71], v[164:167]
    v_mfma_f32_16x16x32_bf16 v[168:171], v[24:27], v[72:75], v[168:171]
    v_mfma_f32_16x16x32_bf16 v[172:175], v[24:27], v[76:79], v[172:175]
    ds_read_b128 v[24:27], v2 offset:36864
    ds_read_b64_tr_b16 v[56:57], v6 offset:32768
    ds_read_b64_tr_b16 v[58:59], v6 offset:33792
    s_cbranch_vccnz Lnd_145
    s_add_u32 m0, s81, 0
    s_nop 0
    buffer_load_dwordx4 v8, s[44:47], s64 offen lds
    s_add_u32 m0, s81, 1024
    s_nop 0
    buffer_load_dwordx4 v9, s[44:47], s64 offen lds
Lnd_145:
    v_mfma_f32_16x16x32_bf16 v[176:179], v[28:31], v[64:67], v[176:179]
    v_mfma_f32_16x16x32_bf16 v[180:183], v[28:31], v[68:71], v[180:183]
    v_mfma_f32_16x16x32_bf16 v[184:187], v[28:31], v[72:75], v[184:187]
    v_mfma_f32_16x16x32_bf16 v[188:191], v[28:31], v[76:79], v[188:191]
    ds_read_b128 v[28:31], v2 offset:38912
    ds_read_b64_tr_b16 v[60:61], v7 offset:32768
    ds_read_b64_tr_b16 v[62:63], v7 offset:33792
    s_cbranch_vccnz Lnd_146
    s_add_u32 s68, s64, s4
    s_add_u32 m0, s81, 2048
    s_nop 0
    buffer_load_dwordx4 v8, s[44:47], s68 offen lds
    s_add_u32 s68, s64, s4
    s_add_u32 m0, s81, 3072
    s_nop 0
    buffer_load_dwordx4 v9, s[44:47], s68 offen lds
Lnd_146:
    v_mfma_f32_16x16x32_bf16 v[192:195], v[32:35], v[64:67], v[192:195]
    v_mfma_f32_16x16x32_bf16 v[196:199], v[32:35], v[68:71], v[196:199]
    v_mfma_f32_16x16x32_bf16 v[200:203], v[32:35], v[72:75], v[200:203]
    v_mfma_f32_16x16x32_bf16 v[204:207], v[32:35], v[76:79], v[204:207]
    ds_read_b128 v[32:35], v2 offset:40960
    s_cbranch_vccnz Lnd_147
    s_add_u32 m0, s81, 16384
    s_nop 0
    buffer_load_dwordx4 v8, s[44:47], s65 offen lds
    s_add_u32 m0, s81, 17408
    s_nop 0
    buffer_load_dwordx4 v9, s[44:47], s65 offen lds
    s_add_u32 s68, s65, s4
    s_add_u32 m0, s81, 18432
    s_nop 0
    buffer_load_dwordx4 v8, s[44:47], s68 offen lds
Lnd_147:
    v_mfma_f32_16x16x32_bf16 v[208:211], v[36:39], v[64:67], v[208:211]
    v_mfma_f32_16x16x32_bf16 v[212:215], v[36:39], v[68:71], v[212:215]
    v_mfma_f32_16x16x32_bf16 v[216:219], v[36:39], v[72:75], v[216:219]
    v_mfma_f32_16x16x32_bf16 v[220:223], v[36:39], v[76:79], v[220:223]
    ds_read_b128 v[36:39], v2 offset:43008
    s_cbranch_vccnz Lnd_148
    s_add_u32 s68, s65, s4
    s_add_u32 m0, s81, 19456
    s_nop 0
    buffer_load_dwordx4 v9, s[44:47], s68 offen lds
    s_add_u32 m0, s81, 65536
    s_nop 0
    buffer_load_dwordx4 v10, s[48:51], s66 offen lds
    s_add_u32 s68, s66, s5
    s_add_u32 m0, s81, 66560
    s_nop 0
    buffer_load_dwordx4 v10, s[48:51], s68 offen lds
Lnd_148:
    v_mfma_f32_16x16x32_bf16 v[224:227], v[40:43], v[64:67], v[224:227]
    v_mfma_f32_16x16x32_bf16 v[228:231], v[40:43], v[68:71], v[228:231]
    v_mfma_f32_16x16x32_bf16 v[232:235], v[40:43], v[72:75], v[232:235]
    v_mfma_f32_16x16x32_bf16 v[236:239], v[40:43], v[76:79], v[236:239]
    ds_read_b128 v[40:43], v2 offset:45056
    s_cbranch_vccnz Lnd_149
    s_add_u32 m0, s81, 67584
    s_nop 0
    buffer_load_dwordx4 v11, s[48:51], s66 offen lds
    s_add_u32 s68, s66, s5
    s_add_u32 m0, s81, 68608
    s_nop 0
    buffer_load_dwordx4 v11, s[48:51], s68 offen lds
    s_add_u32 m0, s81, 81920
    s_nop 0
    buffer_load_dwordx4 v12, s[96:99], s67 offen lds
Lnd_149:
    v_mfma_f32_16x16x32_bf16 v[240:243], v[44:47], v[64:67], v[240:243]
    v_mfma_f32_16x16x32_bf16 v[244:247], v[44:47], v[68:71], v[244:247]
    v_mfma_f32_16x16x32_bf16 v[248:251], v[44:47], v[72:75], v[248:251]
    v_mfma_f32_16x16x32_bf16 v[252:255], v[44:47], v[76:79], v[252:255]
    ds_read_b128 v[44:47], v2 offset:47104
    s_cbranch_vccnz Lnd_150
    s_add_u32 s68, s67, s6
    s_add_u32 m0, s81, 82944
    s_nop 0
    buffer_load_dwordx4 v12, s[96:99], s68 offen lds
    s_add_u32 m0, s81, 83968
    s_nop 0
    buffer_load_dwordx4 v13, s[96:99], s67 offen lds
    s_add_u32 s68, s67, s6
    s_add_u32 m0, s81, 84992
    s_nop 0
    buffer_load_dwordx4 v13, s[96:99], s68 offen lds
Lnd_150:
    s_add_u32 s64, s64, 128
    s_add_u32 s65, s65, 128
    s_add_u32 s66, s66, s7
    s_add_u32 s67, s67, s8
    s_cmp_lg_u32 s60, 0
    s_cbranch_scc1 Lnw0_153
    s_add_u32 s56, s40, 0
    s_addc_u32 s57, s41, 0
    s_mov_b32 s58, 256
    s_and_b32 s57, s57, 0xffff
    s_mov_b32 s59, 0x00020000
    s_mov_b32 s14, 0x400000
Ltok_151:
    v_readfirstlane_b32 s12, v124
    v_readfirstlane_b32 s13, v125
    s_nop 3
    s_cmp_lg_u32 s12, 0
    s_cbranch_scc1 Ltokok_152
    s_sleep 2
    buffer_load_dwordx2 v[124:125], v122, s[56:59], 0 offen sc0 sc1
    s_waitcnt vmcnt(0)
    s_sub_u32 s14, s14, 1
    s_cmp_lg_u32 s14, 0
    s_cbranch_scc1 Ltok_151
Ltokok_152:
    s_add_u32 s56, s42, 209715200
    s_addc_u32 s57, s43, 0
    s_mov_b32 s58, 262144
    s_and_b32 s57, s57, 0xffff
    s_mov_b32 s59, 0x00020000
    s_lshl_b32 s68, s2, 7
    v_mov_b32 v124, s12
    v_mov_b32 v125, s13
    v_mov_b32 v126, 0
    s_mov_b64 exec, 1
    buffer_store_dwordx2 v[124:125], v126, s[56:59], s68 offen sc0 sc1
    s_mov_b64 exec, -1
Lnw0_153:
    s_cbranch_vccz Lnofp_154
    s_add_u32 s56, s30, 0
    s_addc_u32 s57, s31, 0
    s_mov_b32 s58, 7340032
    s_and_b32 s57, s57, 0xffff
    s_mov_b32 s59, 0x00020000
    s_mul_i32 s68, s9, 8
    s_add_u32 s69, s68, 4096
    buffer_load_dwordx4 v[100:103], v120, s[56:59], s69 offen offset:0
    buffer_load_dwordx4 v[100:103], v120, s[56:59], s69 offen offset:1024
    buffer_load_dwordx4 v[100:103], v120, s[56:59], s69 offen offset:2048
    buffer_load_dwordx4 v[100:103], v120, s[56:59], s69 offen offset:3072
Lnofp_154:
    s_waitcnt lgkmcnt(4)
    v_mfma_f32_16x16x32_bf16 v[128:131], v[16:19], v[48:51], v[128:131]
    v_mfma_f32_16x16x32_bf16 v[132:135], v[16:19], v[52:55], v[132:135]
    v_mfma_f32_16x16x32_bf16 v[136:139], v[16:19], v[56:59], v[136:139]
    v_mfma_f32_16x16x32_bf16 v[140:143], v[16:19], v[60:63], v[140:143]
    ds_read_b128 v[16:19], v3 offset:32768
    ds_read_b64_tr_b16 v[64:65], v4 offset:40960
    ds_read_b64_tr_b16 v[66:67], v4 offset:41984
    v_mfma_f32_16x16x32_bf16 v[144:147], v[20:23], v[48:51], v[144:147]
    v_mfma_f32_16x16x32_bf16 v[148:151], v[20:23], v[52:55], v[148:151]
    v_mfma_f32_16x16x32_bf16 v[152:155], v[20:23], v[56:59], v[152:155]
    v_mfma_f32_16x16x32_bf16 v[156:159], v[20:23], v[60:63], v[156:159]
    ds_read_b128 v[20:23], v3 offset:34816
    ds_read_b64_tr_b16 v[68:69], v5 offset:40960
    ds_read_b64_tr_b16 v[70:71], v5 offset:41984
    v_mfma_f32_16x16x32_bf16 v[160:163], v[24:27], v[48:51], v[160:163]
    v_mfma_f32_16x16x32_bf16 v[164:167], v[24:27], v[52:55], v[164:167]
    v_mfma_f32_16x16x32_bf16 v[168:171], v[24:27], v[56:59], v[168:171]
    v_mfma_f32_16x16x32_bf16 v[172:175], v[24:27], v[60:63], v[172:175]
    ds_read_b128 v[24:27], v3 offset:36864
    ds_read_b64_tr_b16 v[72:73], v6 offset:40960
    ds_read_b64_tr_b16 v[74:75], v6 offset:41984
    v_mfma_f32_16x16x32_bf16 v[176:179], v[28:31], v[48:51], v[176:179]
    v_mfma_f32_16x16x32_bf16 v[180:183], v[28:31], v[52:55], v[180:183]
    v_mfma_f32_16x16x32_bf16 v[184:187], v[28:31], v[56:59], v[184:187]
    v_mfma_f32_16x16x32_bf16 v[188:191], v[28:31], v[60:63], v[188:191]
    ds_read_b128 v[28:31], v3 offset:38912
    ds_read_b64_tr_b16 v[76:77], v7 offset:40960
    ds_read_b64_tr_b16 v[78:79], v7 offset:41984
    s_waitcnt lgkmcnt(12)
    v_mfma_f32_16x16x32_bf16 v[192:195], v[32:35], v[48:51], v[192:195]
    v_mfma_f32_16x16x32_bf16 v[196:199], v[32:35], v[52:55], v[196:199]
    v_mfma_f32_16x16x32_bf16 v[200:203], v[32:35], v[56:59], v[200:203]
    v_mfma_f32_16x16x32_bf16 v[204:207], v[32:35], v[60:63], v[204:207]
    ds_read_b128 v[32:35], v3 offset:40960
    v_mfma_f32_16x16x32_bf16 v[208:211], v[36:39], v[48:51], v[208:211]
    v_mfma_f32_16x16x32_bf16 v[212:215], v[36:39], v[52:55], v[212:215]
    v_mfma_f32_16x16x32_bf16 v[216:219], v[36:39], v[56:59], v[216:219]
    v_mfma_f32_16x16x32_bf16 v[220:223], v[36:39], v[60:63], v[220:223]
    ds_read_b128 v[36:39], v3 offset:43008
    v_mfma_f32_16x16x32_bf16 v[224:227], v[40:43], v[48:51], v[224:227]
    v_mfma_f32_16x16x32_bf16 v[228:231], v[40:43], v[52:55], v[228:231]
    v_mfma_f32_16x16x32_bf16 v[232:235], v[40:43], v[56:59], v[232:235]
    v_mfma_f32_16x16x32_bf16 v[236:239], v[40:43], v[60:63], v[236:239]
    ds_read_b128 v[40:43], v3 offset:45056
    v_mfma_f32_16x16x32_bf16 v[240:243], v[44:47], v[48:51], v[240:243]
    v_mfma_f32_16x16x32_bf16 v[244:247], v[44:47], v[52:55], v[244:247]
    v_mfma_f32_16x16x32_bf16 v[248:251], v[44:47], v[56:59], v[248:251]
    v_mfma_f32_16x16x32_bf16 v[252:255], v[44:47], v[60:63], v[252:255]
    ds_read_b128 v[44:47], v3 offset:47104
    s_waitcnt lgkmcnt(4)
    v_mfma_f32_16x16x32_bf16 v[128:131], v[16:19], v[64:67], v[128:131]
    v_mfma_f32_16x16x32_bf16 v[132:135], v[16:19], v[68:71], v[132:135]
    v_mfma_f32_16x16x32_bf16 v[136:139], v[16:19], v[72:75], v[136:139]
    v_mfma_f32_16x16x32_bf16 v[140:143], v[16:19], v[76:79], v[140:143]
    v_mfma_f32_16x16x32_bf16 v[144:147], v[20:23], v[64:67], v[144:147]
    v_mfma_f32_16x16x32_bf16 v[148:151], v[20:23], v[68:71], v[148:151]
    v_mfma_f32_16x16x32_bf16 v[152:155], v[20:23], v[72:75], v[152:155]
    v_mfma_f32_16x16x32_bf16 v[156:159], v[20:23], v[76:79], v[156:159]
    s_waitcnt lgkmcnt(0)
    s_cbranch_vccnz Lfw_155
    s_waitcnt vmcnt(1)
    s_cmp_eq_u32 s60, 0
    s_cbranch_scc1 Lfw_156
    s_waitcnt vmcnt(0)
Lfw_155:
Lfw_156:
    s_barrier
    ds_read_b128 v[16:19], v2 offset:0
    ds_read_b128 v[20:23], v2 offset:2048
    ds_read_b64_tr_b16 v[48:49], v4 offset:0
    ds_read_b64_tr_b16 v[50:51], v4 offset:1024
    ds_read_b64_tr_b16 v[52:53], v5 offset:0
    ds_read_b64_tr_b16 v[54:55], v5 offset:1024
    v_mfma_f32_16x16x32_bf16 v[160:163], v[24:27], v[64:67], v[160:163]
    v_mfma_f32_16x16x32_bf16 v[164:167], v[24:27], v[68:71], v[164:167]
    v_mfma_f32_16x16x32_bf16 v[168:171], v[24:27], v[72:75], v[168:171]
    v_mfma_f32_16x16x32_bf16 v[172:175], v[24:27], v[76:79], v[172:175]
    ds_read_b128 v[24:27], v2 offset:4096
    ds_read_b64_tr_b16 v[56:57], v6 offset:0
    ds_read_b64_tr_b16 v[58:59], v6 offset:1024
    s_cbranch_vccnz Lnd_157
    s_add_u32 m0, s81, 32768
    s_nop 0
    buffer_load_dwordx4 v8, s[44:47], s64 offen lds
    s_add_u32 m0, s81, 33792
    s_nop 0
    buffer_load_dwordx4 v9, s[44:47], s64 offen lds
Lnd_157:
    v_mfma_f32_16x16x32_bf16 v[176:179], v[28:31], v[64:67], v[176:179]
    v_mfma_f32_16x16x32_bf16 v[180:183], v[28:31], v[68:71], v[180:183]
    v_mfma_f32_16x16x32_bf16 v[184:187], v[28:31], v[72:75], v[184:187]
    v_mfma_f32_16x16x32_bf16 v[188:191], v[28:31], v[76:79], v[188:191]
    ds_read_b128 v[28:31], v2 offset:6144
    ds_read_b64_tr_b16 v[60:61], v7 offset:0
    ds_read_b64_tr_b16 v[62:63], v7 offset:1024
    s_cbranch_vccnz Lnd_158
    s_add_u32 s68, s64, s4
    s_add_u32 m0, s81, 34816
    s_nop 0
    buffer_load_dwordx4 v8, s[44:47], s68 offen lds
    s_add_u32 s68, s64, s4
    s_add_u32 m0, s81, 35840
    s_nop 0
    buffer_load_dwordx4 v9, s[44:47], s68 offen lds
Lnd_158:
    v_mfma_f32_16x16x32_bf16 v[192:195], v[32:35], v[64:67], v[192:195]
    v_mfma_f32_16x16x32_bf16 v[196:199], v[32:35], v[68:71], v[196:199]
    v_mfma_f32_16x16x32_bf16 v[200:203], v[32:35], v[72:75], v[200:203]
    v_mfma_f32_16x16x32_bf16 v[204:207], v[32:35], v[76:79], v[204:207]
    ds_read_b128 v[32:35], v2 offset:8192
    s_cbranch_vccnz Lnd_159
    s_add_u32 m0, s81, 49152
    s_nop 0
    buffer_load_dwordx4 v8, s[44:47], s65 offen lds
    s_add_u32 m0, s81, 50176
    s_nop 0
    buffer_load_dwordx4 v9, s[44:47], s65 offen lds
    s_add_u32 s68, s65, s4
    s_add_u32 m0, s81, 51200
    s_nop 0
    buffer_load_dwordx4 v8, s[44:47], s68 offen lds
Lnd_159:
    v_mfma_f32_16x16x32_bf16 v[208:211], v[36:39], v[64:67], v[208:211]
    v_mfma_f32_16x16x32_bf16 v[212:215], v[36:39], v[68:71], v[212:215]
    v_mfma_f32_16x16x32_bf16 v[216:219], v[36:39], v[72:75], v[216:219]
    v_mfma_f32_16x16x32_bf16 v[220:223], v[36:39], v[76:79], v[220:223]
    ds_read_b128 v[36:39], v2 offset:10240
    s_cbranch_vccnz Lnd_160
    s_add_u32 s68, s65, s4
    s_add_u32 m0, s81, 52224
    s_nop 0
    buffer_load_dwordx4 v9, s[44:47], s68 offen lds
    s_add_u32 m0, s81, 98304
    s_nop 0
    buffer_load_dwordx4 v10, s[48:51], s66 offen lds
    s_add_u32 s68, s66, s5
    s_add_u32 m0, s81, 99328
    s_nop 0
    buffer_load_dwordx4 v10, s[48:51], s68 offen lds
Lnd_160:
    v_mfma_f32_16x16x32_bf16 v[224:227], v[40:43], v[64:67], v[224:227]
    v_mfma_f32_16x16x32_bf16 v[228:231], v[40:43], v[68:71], v[228:231]
    v_mfma_f32_16x16x32_bf16 v[232:235], v[40:43], v[72:75], v[232:235]
    v_mfma_f32_16x16x32_bf16 v[236:239], v[40:43], v[76:79], v[236:239]
    ds_read_b128 v[40:43], v2 offset:12288
    s_cbranch_vccnz Lnd_161
    s_add_u32 m0, s81, 100352
    s_nop 0
    buffer_load_dwordx4 v11, s[48:51], s66 offen lds
    s_add_u32 s68, s66, s5
    s_add_u32 m0, s81, 101376
    s_nop 0
    buffer_load_dwordx4 v11, s[48:51], s68 offen lds
    s_add_u32 m0, s81, 114688
    s_nop 0
    buffer_load_dwordx4 v12, s[96:99], s67 offen lds
Lnd_161:
    v_mfma_f32_16x16x32_bf16 v[240:243], v[44:47], v[64:67], v[240:243]
    v_mfma_f32_16x16x32_bf16 v[244:247], v[44:47], v[68:71], v[244:247]
    v_mfma_f32_16x16x32_bf16 v[248:251], v[44:47], v[72:75], v[248:251]
    v_mfma_f32_16x16x32_bf16 v[252:255], v[44:47], v[76:79], v[252:255]
    ds_read_b128 v[44:47], v2 offset:14336
    s_cbranch_vccnz Lnd_162
    s_add_u32 s68, s67, s6
    s_add_u32 m0, s81, 115712
    s_nop 0
    buffer_load_dwordx4 v12, s[96:99], s68 offen lds
    s_add_u32 m0, s81, 116736
    s_nop 0
    buffer_load_dwordx4 v13, s[96:99], s67 offen lds
    s_add_u32 s68, s67, s6
    s_add_u32 m0, s81, 117760
    s_nop 0
    buffer_load_dwordx4 v13, s[96:99], s68 offen lds
Lnd_162:
    s_add_u32 s64, s64, 128
    s_add_u32 s65, s65, 128
    s_add_u32 s66, s66, s7
    s_add_u32 s67, s67, s8
    s_sub_u32 s70, 15, s72
    v_and_b32 v88, 15, v1
    v_mov_b32 v89, s70
    v_mov_b32 v90, s72
    v_and_b32 v91, 16, v1
    v_cmp_eq_u32 s[68:69], 0, v91
    s_nop 1
    v_cndmask_b32 v89, v90, v89, s[68:69]
    v_lshl_add_u32 v88, v89, 4, v88
    v_lshlrev_b32 v88, 7, v88
    s_cmp_lg_u32 s60, 0
    s_cbranch_scc1 Lnw0_163
    s_add_u32 s56, s42, 209715200
    s_addc_u32 s57, s43, 0
    s_mov_b32 s58, 262144
    s_and_b32 s57, s57, 0xffff
    s_mov_b32 s59, 0x00020000
    buffer_load_dwordx2 v[92:93], v88, s[56:59], 0 offen sc0 sc1
Lnw0_163:
    s_add_u32 s44, s42, 220200960
    s_addc_u32 s45, s43, 0
    s_mov_b32 s46, 4456448
    s_and_b32 s45, s45, 0xffff
    s_mov_b32 s47, 0x00020000
    s_mul_i32 s64, s70, 278528
    s_mul_i32 s65, s72, 278528
    s_lshl_b32 s68, s73, 8
    s_add_u32 s48, s20, s68
    s_addc_u32 s49, s21, 0
    s_sub_u32 s50, 8388608, s68
    s_and_b32 s49, s49, 0xffff
    s_mov_b32 s51, 0x00020000
    s_lshl_b32 s68, s82, 8
    s_add_u32 s96, s30, s68
    s_addc_u32 s97, s31, 0
    s_sub_u32 s98, 7340032, s68
    s_and_b32 s97, s97, 0xffff
    s_mov_b32 s99, 0x00020000
    s_cmp_eq_u32 s82, 99
    s_cselect_b32 s98, 0, s98
    v_lshrrev_b32 v80, 3, v1
    v_lshrrev_b32 v81, 4, v1
    v_and_b32 v82, 7, v1
    v_xor_b32 v82, v82, v81
    v_lshlrev_b32 v82, 4, v82
    v_xor_b32 v83, 64, v82
    s_lshl_b32 s68, s60, 5
    v_add_u32 v80, s68, v80
    s_mov_b32 s69, 2176
    v_mul_lo_u32 v80, v80, s69
    v_add_u32 v8, v80, v82
    v_add_u32 v80, 17408, v80
    v_add_u32 v9, v80, v83
    s_mov_b32 s4, 34816
    v_and_b32 v82, 15, v1
    v_lshlrev_b32 v83, 1, v81
    v_xor_b32 v82, v82, v83
    v_lshlrev_b32 v82, 4, v82
    v_xor_b32 v83, 128, v82
    s_lshl_b32 s68, s60, 4
    v_add_u32 v84, s68, v81
    s_mov_b32 s69, 8192
    v_mul_lo_u32 v80, v84, s69
    v_add_u32 v10, v80, v82
    v_add_u32 v80, 65536, v80
    v_add_u32 v11, v80, v83
    s_mov_b32 s5, 32768
    s_mov_b32 s7, 524288
    s_mov_b32 s69, 7168
    v_mul_lo_u32 v80, v84, s69
    v_add_u32 v12, v80, v82
    v_add_u32 v80, 57344, v80
    v_add_u32 v13, v80, v83
    s_mov_b32 s6, 28672
    s_mov_b32 s8, 458752
    s_mov_b32 s66, 0
    s_mov_b32 s67, 0
    s_waitcnt lgkmcnt(4)
    v_mfma_f32_16x16x32_bf16 v[128:131], v[16:19], v[48:51], v[128:131]
    v_mfma_f32_16x16x32_bf16 v[132:135], v[16:19], v[52:55], v[132:135]
    v_mfma_f32_16x16x32_bf16 v[136:139], v[16:19], v[56:59], v[136:139]
    v_mfma_f32_16x16x32_bf16 v[140:143], v[16:19], v[60:63], v[140:143]
    ds_read_b128 v[16:19], v3 offset:0
    ds_read_b64_tr_b16 v[64:65], v4 offset:8192
    ds_read_b64_tr_b16 v[66:67], v4 offset:9216
    v_mfma_f32_16x16x32_bf16 v[144:147], v[20:23], v[48:51], v[144:147]
    v_mfma_f32_16x16x32_bf16 v[148:151], v[20:23], v[52:55], v[148:151]
    v_mfma_f32_16x16x32_bf16 v[152:155], v[20:23], v[56:59], v[152:155]
    v_mfma_f32_16x16x32_bf16 v[156:159], v[20:23], v[60:63], v[156:159]
    ds_read_b128 v[20:23], v3 offset:2048
    ds_read_b64_tr_b16 v[68:69], v5 offset:8192
    ds_read_b64_tr_b16 v[70:71], v5 offset:9216
    v_mfma_f32_16x16x32_bf16 v[160:163], v[24:27], v[48:51], v[160:163]
    v_mfma_f32_16x16x32_bf16 v[164:167], v[24:27], v[52:55], v[164:167]
    v_mfma_f32_16x16x32_bf16 v[168:171], v[24:27], v[56:59], v[168:171]
    v_mfma_f32_16x16x32_bf16 v[172:175], v[24:27], v[60:63], v[172:175]
    ds_read_b128 v[24:27], v3 offset:4096
    ds_read_b64_tr_b16 v[72:73], v6 offset:8192
    ds_read_b64_tr_b16 v[74:75], v6 offset:9216
    v_mfma_f32_16x16x32_bf16 v[176:179], v[28:31], v[48:51], v[176:179]
    v_mfma_f32_16x16x32_bf16 v[180:183], v[28:31], v[52:55], v[180:183]
    v_mfma_f32_16x16x32_bf16 v[184:187], v[28:31], v[56:59], v[184:187]
    v_mfma_f32_16x16x32_bf16 v[188:191], v[28:31], v[60:63], v[188:191]
    ds_read_b128 v[28:31], v3 offset:6144
    ds_read_b64_tr_b16 v[76:77], v7 offset:8192
    ds_read_b64_tr_b16 v[78:79], v7 offset:9216
    s_waitcnt lgkmcnt(12)
    v_mfma_f32_16x16x32_bf16 v[192:195], v[32:35], v[48:51], v[192:195]
    v_mfma_f32_16x16x32_bf16 v[196:199], v[32:35], v[52:55], v[196:199]
    v_mfma_f32_16x16x32_bf16 v[200:203], v[32:35], v[56:59], v[200:203]
    v_mfma_f32_16x16x32_bf16 v[204:207], v[32:35], v[60:63], v[204:207]
    ds_read_b128 v[32:35], v3 offset:8192
    v_mfma_f32_16x16x32_bf16 v[208:211], v[36:39], v[48:51], v[208:211]
    v_mfma_f32_16x16x32_bf16 v[212:215], v[36:39], v[52:55], v[212:215]
    v_mfma_f32_16x16x32_bf16 v[216:219], v[36:39], v[56:59], v[216:219]
    v_mfma_f32_16x16x32_bf16 v[220:223], v[36:39], v[60:63], v[220:223]
    ds_read_b128 v[36:39], v3 offset:10240
    v_mfma_f32_16x16x32_bf16 v[224:227], v[40:43], v[48:51], v[224:227]
    v_mfma_f32_16x16x32_bf16 v[228:231], v[40:43], v[52:55], v[228:231]
    v_mfma_f32_16x16x32_bf16 v[232:235], v[40:43], v[56:59], v[232:235]
    v_mfma_f32_16x16x32_bf16 v[236:239], v[40:43], v[60:63], v[236:239]
    ds_read_b128 v[40:43], v3 offset:12288
    v_mfma_f32_16x16x32_bf16 v[240:243], v[44:47], v[48:51], v[240:243]
    v_mfma_f32_16x16x32_bf16 v[244:247], v[44:47], v[52:55], v[244:247]
    v_mfma_f32_16x16x32_bf16 v[248:251], v[44:47], v[56:59], v[248:251]
    v_mfma_f32_16x16x32_bf16 v[252:255], v[44:47], v[60:63], v[252:255]
    ds_read_b128 v[44:47], v3 offset:14336
    s_waitcnt lgkmcnt(4)
    v_mfma_f32_16x16x32_bf16 v[128:131], v[16:19], v[64:67], v[128:131]
    v_mfma_f32_16x16x32_bf16 v[132:135], v[16:19], v[68:71], v[132:135]
    v_mfma_f32_16x16x32_bf16 v[136:139], v[16:19], v[72:75], v[136:139]
    v_mfma_f32_16x16x32_bf16 v[140:143], v[16:19], v[76:79], v[140:143]
    v_mfma_f32_16x16x32_bf16 v[144:147], v[20:23], v[64:67], v[144:147]
    v_mfma_f32_16x16x32_bf16 v[148:151], v[20:23], v[68:71], v[148:151]
    v_mfma_f32_16x16x32_bf16 v[152:155], v[20:23], v[72:75], v[152:155]
    v_mfma_f32_16x16x32_bf16 v[156:159], v[20:23], v[76:79], v[156:159]
    s_waitcnt lgkmcnt(0)
    s_cbranch_vccnz Lfw_164
    s_waitcnt vmcnt(0)
Lfw_164:
Lfw_165:
    s_cmp_lg_u32 s60, 0
    s_cbranch_scc1 Lnw0_166
    s_add_u32 s56, s42, 209715200
    s_addc_u32 s57, s43, 0
    s_mov_b32 s58, 262144
    s_and_b32 s57, s57, 0xffff
    s_mov_b32 s59, 0x00020000
    s_mov_b32 s14, 0x400000
    s_branch Lpoll_167
Lld_169:
    buffer_load_dwordx2 v[92:93], v88, s[56:59], 0 offen sc0 sc1
    s_waitcnt vmcnt(0)
Lpoll_167:
    v_cmp_ne_u32 vcc, s12, v92
    v_cmp_ne_u32 s[68:69], s13, v93
    s_nop 3
    s_or_b64 vcc, vcc, s[68:69]
    s_cbranch_scc0 Lok_168
    s_sleep 1
    s_sub_u32 s14, s14, 1
    s_cmp_lg_u32 s14, 0
    s_cbranch_scc1 Lld_169
    s_mov_b64 vcc, 0
Lok_168:
Lnw0_166:
    s_barrier
    ds_read_b128 v[16:19], v2 offset:32768
    ds_read_b128 v[20:23], v2 offset:34816
    ds_read_b64_tr_b16 v[48:49], v4 offset:32768
    ds_read_b64_tr_b16 v[50:51], v4 offset:33792
    ds_read_b64_tr_b16 v[52:53], v5 offset:32768
    ds_read_b64_tr_b16 v[54:55], v5 offset:33792
    v_mfma_f32_16x16x32_bf16 v[160:163], v[24:27], v[64:67], v[160:163]
    v_mfma_f32_16x16x32_bf16 v[164:167], v[24:27], v[68:71], v[164:167]
    v_mfma_f32_16x16x32_bf16 v[168:171], v[24:27], v[72:75], v[168:171]
    v_mfma_f32_16x16x32_bf16 v[172:175], v[24:27], v[76:79], v[172:175]
    ds_read_b128 v[24:27], v2 offset:36864
    ds_read_b64_tr_b16 v[56:57], v6 offset:32768
    ds_read_b64_tr_b16 v[58:59], v6 offset:33792
    s_cbranch_vccnz Lnd_170
    s_add_u32 m0, s81, 0
    s_nop 0
    buffer_load_dwordx4 v8, s[44:47], s64 offen lds
    s_add_u32 m0, s81, 1024
    s_nop 0
    buffer_load_dwordx4 v9, s[44:47], s64 offen lds
Lnd_170:
    v_mfma_f32_16x16x32_bf16 v[176:179], v[28:31], v[64:67], v[176:179]
    v_mfma_f32_16x16x32_bf16 v[180:183], v[28:31], v[68:71], v[180:183]
    v_mfma_f32_16x16x32_bf16 v[184:187], v[28:31], v[72:75], v[184:187]
    v_mfma_f32_16x16x32_bf16 v[188:191], v[28:31], v[76:79], v[188:191]
    ds_read_b128 v[28:31], v2 offset:38912
    ds_read_b64_tr_b16 v[60:61], v7 offset:32768
    ds_read_b64_tr_b16 v[62:63], v7 offset:33792
    s_cbranch_vccnz Lnd_171
    s_add_u32 s68, s64, s4
    s_add_u32 m0, s81, 2048
    s_nop 0
    buffer_load_dwordx4 v8, s[44:47], s68 offen lds
    s_add_u32 s68, s64, s4
    s_add_u32 m0, s81, 3072
    s_nop 0
    buffer_load_dwordx4 v9, s[44:47], s68 offen lds
Lnd_171:
    v_mfma_f32_16x16x32_bf16 v[192:195], v[32:35], v[64:67], v[192:195]
    v_mfma_f32_16x16x32_bf16 v[196:199], v[32:35], v[68:71], v[196:199]
    v_mfma_f32_16x16x32_bf16 v[200:203], v[32:35], v[72:75], v[200:203]
    v_mfma_f32_16x16x32_bf16 v[204:207], v[32:35], v[76:79], v[204:207]
    ds_read_b128 v[32:35], v2 offset:40960
    s_cbranch_vccnz Lnd_172
    s_add_u32 m0, s81, 16384
    s_nop 0
    buffer_load_dwordx4 v8, s[44:47], s65 offen lds
    s_add_u32 m0, s81, 17408
    s_nop 0
    buffer_load_dwordx4 v9, s[44:47], s65 offen lds
    s_add_u32 s68, s65, s4
    s_add_u32 m0, s81, 18432
    s_nop 0
    buffer_load_dwordx4 v8, s[44:47], s68 offen lds
Lnd_172:
    v_mfma_f32_16x16x32_bf16 v[208:211], v[36:39], v[64:67], v[208:211]
    v_mfma_f32_16x16x32_bf16 v[212:215], v[36:39], v[68:71], v[212:215]
    v_mfma_f32_16x16x32_bf16 v[216:219], v[36:39], v[72:75], v[216:219]
    v_mfma_f32_16x16x32_bf16 v[220:223], v[36:39], v[76:79], v[220:223]
    ds_read_b128 v[36:39], v2 offset:43008
    s_cbranch_vccnz Lnd_173
    s_add_u32 s68, s65, s4
    s_add_u32 m0, s81, 19456
    s_nop 0
    buffer_load_dwordx4 v9, s[44:47], s68 offen lds
    s_add_u32 m0, s81, 65536
    s_nop 0
    buffer_load_dwordx4 v10, s[48:51], s66 offen lds
    s_add_u32 s68, s66, s5
    s_add_u32 m0, s81, 66560
    s_nop 0
    buffer_load_dwordx4 v10, s[48:51], s68 offen lds
Lnd_173:
    v_mfma_f32_16x16x32_bf16 v[224:227], v[40:43], v[64:67], v[224:227]
    v_mfma_f32_16x16x32_bf16 v[228:231], v[40:43], v[68:71], v[228:231]
    v_mfma_f32_16x16x32_bf16 v[232:235], v[40:43], v[72:75], v[232:235]
    v_mfma_f32_16x16x32_bf16 v[236:239], v[40:43], v[76:79], v[236:239]
    ds_read_b128 v[40:43], v2 offset:45056
    s_cbranch_vccnz Lnd_174
    s_add_u32 m0, s81, 67584
    s_nop 0
    buffer_load_dwordx4 v11, s[48:51], s66 offen lds
    s_add_u32 s68, s66, s5
    s_add_u32 m0, s81, 68608
    s_nop 0
    buffer_load_dwordx4 v11, s[48:51], s68 offen lds
    s_add_u32 m0, s81, 81920
    s_nop 0
    buffer_load_dwordx4 v12, s[96:99], s67 offen lds
Lnd_174:
    v_mfma_f32_16x16x32_bf16 v[240:243], v[44:47], v[64:67], v[240:243]
    v_mfma_f32_16x16x32_bf16 v[244:247], v[44:47], v[68:71], v[244:247]
    v_mfma_f32_16x16x32_bf16 v[248:251], v[44:47], v[72:75], v[248:251]
    v_mfma_f32_16x16x32_bf16 v[252:255], v[44:47], v[76:79], v[252:255]
    ds_read_b128 v[44:47], v2 offset:47104
    s_cbranch_vccnz Lnd_175
    s_add_u32 s68, s67, s6
    s_add_u32 m0, s81, 82944
    s_nop 0
    buffer_load_dwordx4 v12, s[96:99], s68 offen lds
    s_add_u32 m0, s81, 83968
    s_nop 0
    buffer_load_dwordx4 v13, s[96:99], s67 offen lds
    s_add_u32 s68, s67, s6
    s_add_u32 m0, s81, 84992
    s_nop 0
    buffer_load_dwordx4 v13, s[96:99], s68 offen lds
Lnd_175:
    s_add_u32 s64, s64, 128
    s_add_u32 s65, s65, 128
    s_add_u32 s66, s66, s7
    s_add_u32 s67, s67, s8
    s_waitcnt lgkmcnt(4)
    v_mfma_f32_16x16x32_bf16 v[128:131], v[16:19], v[48:51], v[128:131]
    v_mfma_f32_16x16x32_bf16 v[132:135], v[16:19], v[52:55], v[132:135]
    v_mfma_f32_16x16x32_bf16 v[136:139], v[16:19], v[56:59], v[136:139]
    v_mfma_f32_16x16x32_bf16 v[140:143], v[16:19], v[60:63], v[140:143]
    ds_read_b128 v[16:19], v3 offset:32768
    ds_read_b64_tr_b16 v[64:65], v4 offset:40960
    ds_read_b64_tr_b16 v[66:67], v4 offset:41984
    v_mfma_f32_16x16x32_bf16 v[144:147], v[20:23], v[48:51], v[144:147]
    v_mfma_f32_16x16x32_bf16 v[148:151], v[20:23], v[52:55], v[148:151]
    v_mfma_f32_16x16x32_bf16 v[152:155], v[20:23], v[56:59], v[152:155]
    v_mfma_f32_16x16x32_bf16 v[156:159], v[20:23], v[60:63], v[156:159]
    ds_read_b128 v[20:23], v3 offset:34816
    ds_read_b64_tr_b16 v[68:69], v5 offset:40960
    ds_read_b64_tr_b16 v[70:71], v5 offset:41984
    v_mfma_f32_16x16x32_bf16 v[160:163], v[24:27], v[48:51], v[160:163]
    v_mfma_f32_16x16x32_bf16 v[164:167], v[24:27], v[52:55], v[164:167]
    v_mfma_f32_16x16x32_bf16 v[168:171], v[24:27], v[56:59], v[168:171]
    v_mfma_f32_16x16x32_bf16 v[172:175], v[24:27], v[60:63], v[172:175]
    ds_read_b128 v[24:27], v3 offset:36864
    ds_read_b64_tr_b16 v[72:73], v6 offset:40960
    ds_read_b64_tr_b16 v[74:75], v6 offset:41984
    v_mfma_f32_16x16x32_bf16 v[176:179], v[28:31], v[48:51], v[176:179]
    v_mfma_f32_16x16x32_bf16 v[180:183], v[28:31], v[52:55], v[180:183]
    v_mfma_f32_16x16x32_bf16 v[184:187], v[28:31], v[56:59], v[184:187]
    v_mfma_f32_16x16x32_bf16 v[188:191], v[28:31], v[60:63], v[188:191]
    ds_read_b128 v[28:31], v3 offset:38912
    ds_read_b64_tr_b16 v[76:77], v7 offset:40960
    ds_read_b64_tr_b16 v[78:79], v7 offset:41984
    s_waitcnt lgkmcnt(12)
    v_mfma_f32_16x16x32_bf16 v[192:195], v[32:35], v[48:51], v[192:195]
    v_mfma_f32_16x16x32_bf16 v[196:199], v[32:35], v[52:55], v[196:199]
    v_mfma_f32_16x16x32_bf16 v[200:203], v[32:35], v[56:59], v[200:203]
    v_mfma_f32_16x16x32_bf16 v[204:207], v[32:35], v[60:63], v[204:207]
    ds_read_b128 v[32:35], v3 offset:40960
    v_mfma_f32_16x16x32_bf16 v[208:211], v[36:39], v[48:51], v[208:211]
    v_mfma_f32_16x16x32_bf16 v[212:215], v[36:39], v[52:55], v[212:215]
    v_mfma_f32_16x16x32_bf16 v[216:219], v[36:39], v[56:59], v[216:219]
    v_mfma_f32_16x16x32_bf16 v[220:223], v[36:39], v[60:63], v[220:223]
    ds_read_b128 v[36:39], v3 offset:43008
    v_mfma_f32_16x16x32_bf16 v[224:227], v[40:43], v[48:51], v[224:227]
    v_mfma_f32_16x16x32_bf16 v[228:231], v[40:43], v[52:55], v[228:231]
    v_mfma_f32_16x16x32_bf16 v[232:235], v[40:43], v[56:59], v[232:235]
    v_mfma_f32_16x16x32_bf16 v[236:239], v[40:43], v[60:63], v[236:239]
    ds_read_b128 v[40:43], v3 offset:45056
    v_mfma_f32_16x16x32_bf16 v[240:243], v[44:47], v[48:51], v[240:243]
    v_mfma_f32_16x16x32_bf16 v[244:247], v[44:47], v[52:55], v[244:247]
    v_mfma_f32_16x16x32_bf16 v[248:251], v[44:47], v[56:59], v[248:251]
    v_mfma_f32_16x16x32_bf16 v[252:255], v[44:47], v[60:63], v[252:255]
    ds_read_b128 v[44:47], v3 offset:47104
    s_waitcnt lgkmcnt(4)
    v_mfma_f32_16x16x32_bf16 v[128:131], v[16:19], v[64:67], v[128:131]
    v_mfma_f32_16x16x32_bf16 v[132:135], v[16:19], v[68:71], v[132:135]
    v_mfma_f32_16x16x32_bf16 v[136:139], v[16:19], v[72:75], v[136:139]
    v_mfma_f32_16x16x32_bf16 v[140:143], v[16:19], v[76:79], v[140:143]
    v_mfma_f32_16x16x32_bf16 v[144:147], v[20:23], v[64:67], v[144:147]
    v_mfma_f32_16x16x32_bf16 v[148:151], v[20:23], v[68:71], v[148:151]
    v_mfma_f32_16x16x32_bf16 v[152:155], v[20:23], v[72:75], v[152:155]
    v_mfma_f32_16x16x32_bf16 v[156:159], v[20:23], v[76:79], v[156:159]
    s_waitcnt lgkmcnt(0)
    s_cbranch_vccnz Lfw_176
    s_waitcnt vmcnt(0)
Lfw_176:
Lfw_177:
    s_barrier
    ds_read_b128 v[16:19], v2 offset:0
    ds_read_b128 v[20:23], v2 offset:2048
    ds_read_b64_tr_b16 v[48:49], v4 offset:0
    ds_read_b64_tr_b16 v[50:51], v4 offset:1024
    ds_read_b64_tr_b16 v[52:53], v5 offset:0
    ds_read_b64_tr_b16 v[54:55], v5 offset:1024
    v_mfma_f32_16x16x32_bf16 v[160:163], v[24:27], v[64:67], v[160:163]
    v_mfma_f32_16x16x32_bf16 v[164:167], v[24:27], v[68:71], v[164:167]
    v_mfma_f32_16x16x32_bf16 v[168:171], v[24:27], v[72:75], v[168:171]
    v_mfma_f32_16x16x32_bf16 v[172:175], v[24:27], v[76:79], v[172:175]
    ds_read_b128 v[24:27], v2 offset:4096
    ds_read_b64_tr_b16 v[56:57], v6 offset:0
    ds_read_b64_tr_b16 v[58:59], v6 offset:1024
    s_cbranch_vccnz Lnd_178
    s_add_u32 m0, s81, 32768
    s_nop 0
    buffer_load_dwordx4 v8, s[44:47], s64 offen lds
    s_add_u32 m0, s81, 33792
    s_nop 0
    buffer_load_dwordx4 v9, s[44:47], s64 offen lds
Lnd_178:
    v_mfma_f32_16x16x32_bf16 v[176:179], v[28:31], v[64:67], v[176:179]
    v_mfma_f32_16x16x32_bf16 v[180:183], v[28:31], v[68:71], v[180:183]
    v_mfma_f32_16x16x32_bf16 v[184:187], v[28:31], v[72:75], v[184:187]
    v_mfma_f32_16x16x32_bf16 v[188:191], v[28:31], v[76:79], v[188:191]
    ds_read_b128 v[28:31], v2 offset:6144
    ds_read_b64_tr_b16 v[60:61], v7 offset:0
    ds_read_b64_tr_b16 v[62:63], v7 offset:1024
    s_cbranch_vccnz Lnd_179
    s_add_u32 s68, s64, s4
    s_add_u32 m0, s81, 34816
    s_nop 0
    buffer_load_dwordx4 v8, s[44:47], s68 offen lds
    s_add_u32 s68, s64, s4
    s_add_u32 m0, s81, 35840
    s_nop 0
    buffer_load_dwordx4 v9, s[44:47], s68 offen lds
Lnd_179:
    v_mfma_f32_16x16x32_bf16 v[192:195], v[32:35], v[64:67], v[192:195]
    v_mfma_f32_16x16x32_bf16 v[196:199], v[32:35], v[68:71], v[196:199]
    v_mfma_f32_16x16x32_bf16 v[200:203], v[32:35], v[72:75], v[200:203]
    v_mfma_f32_16x16x32_bf16 v[204:207], v[32:35], v[76:79], v[204:207]
    ds_read_b128 v[32:35], v2 offset:8192
    s_cbranch_vccnz Lnd_180
    s_add_u32 m0, s81, 49152
    s_nop 0
    buffer_load_dwordx4 v8, s[44:47], s65 offen lds
    s_add_u32 m0, s81, 50176
    s_nop 0
    buffer_load_dwordx4 v9, s[44:47], s65 offen lds
    s_add_u32 s68, s65, s4
    s_add_u32 m0, s81, 51200
    s_nop 0
    buffer_load_dwordx4 v8, s[44:47], s68 offen lds
Lnd_180:
    v_mfma_f32_16x16x32_bf16 v[208:211], v[36:39], v[64:67], v[208:211]
    v_mfma_f32_16x16x32_bf16 v[212:215], v[36:39], v[68:71], v[212:215]
    v_mfma_f32_16x16x32_bf16 v[216:219], v[36:39], v[72:75], v[216:219]
    v_mfma_f32_16x16x32_bf16 v[220:223], v[36:39], v[76:79], v[220:223]
    ds_read_b128 v[36:39], v2 offset:10240
    s_cbranch_vccnz Lnd_181
    s_add_u32 s68, s65, s4
    s_add_u32 m0, s81, 52224
    s_nop 0
    buffer_load_dwordx4 v9, s[44:47], s68 offen lds
    s_add_u32 m0, s81, 98304
    s_nop 0
    buffer_load_dwordx4 v10, s[48:51], s66 offen lds
    s_add_u32 s68, s66, s5
    s_add_u32 m0, s81, 99328
    s_nop 0
    buffer_load_dwordx4 v10, s[48:51], s68 offen lds
Lnd_181:
    v_mfma_f32_16x16x32_bf16 v[224:227], v[40:43], v[64:67], v[224:227]
    v_mfma_f32_16x16x32_bf16 v[228:231], v[40:43], v[68:71], v[228:231]
    v_mfma_f32_16x16x32_bf16 v[232:235], v[40:43], v[72:75], v[232:235]
    v_mfma_f32_16x16x32_bf16 v[236:239], v[40:43], v[76:79], v[236:239]
    ds_read_b128 v[40:43], v2 offset:12288
    s_cbranch_vccnz Lnd_182
    s_add_u32 m0, s81, 100352
    s_nop 0
    buffer_load_dwordx4 v11, s[48:51], s66 offen lds
    s_add_u32 s68, s66, s5
    s_add_u32 m0, s81, 101376
    s_nop 0
    buffer_load_dwordx4 v11, s[48:51], s68 offen lds
    s_add_u32 m0, s81, 114688
    s_nop 0
    buffer_load_dwordx4 v12, s[96:99], s67 offen lds
Lnd_182:
    v_mfma_f32_16x16x32_bf16 v[240:243], v[44:47], v[64:67], v[240:243]
    v_mfma_f32_16x16x32_bf16 v[244:247], v[44:47], v[68:71], v[244:247]
    v_mfma_f32_16x16x32_bf16 v[248:251], v[44:47], v[72:75], v[248:251]
    v_mfma_f32_16x16x32_bf16 v[252:255], v[44:47], v[76:79], v[252:255]
    ds_read_b128 v[44:47], v2 offset:14336
    s_cbranch_vccnz Lnd_183
    s_add_u32 s68, s67, s6
    s_add_u32 m0, s81, 115712
    s_nop 0
    buffer_load_dwordx4 v12, s[96:99], s68 offen lds
    s_add_u32 m0, s81, 116736
    s_nop 0
    buffer_load_dwordx4 v13, s[96:99], s67 offen lds
    s_add_u32 s68, s67, s6
    s_add_u32 m0, s81, 117760
    s_nop 0
    buffer_load_dwordx4 v13, s[96:99], s68 offen lds
Lnd_183:
    s_add_u32 s64, s64, 128
    s_add_u32 s65, s65, 128
    s_add_u32 s66, s66, s7
    s_add_u32 s67, s67, s8
    s_nop 7
    s_cbranch_vccz Lpw_184
    s_waitcnt vmcnt(0)
Lpw_184:
    v_cvt_pk_bf16_f32 v80, v128, v129
    v_cvt_pk_bf16_f32 v81, v130, v131
    v_cvt_pk_bf16_f32 v82, v144, v145
    v_cvt_pk_bf16_f32 v83, v146, v147
    v_cvt_pk_bf16_f32 v84, v160, v161
    v_cvt_pk_bf16_f32 v85, v162, v163
    v_cvt_pk_bf16_f32 v86, v176, v177
    v_cvt_pk_bf16_f32 v87, v178, v179
    s_nop 0
    v_mov_b32 v128, v84
    v_mov_b32 v129, v85
    v_mov_b32 v130, v86
    v_mov_b32 v131, v87
    v_mov_b32_dpp v84, v80 row_ror:8 row_mask:0xf bank_mask:0x3
    v_mov_b32_dpp v85, v81 row_ror:8 row_mask:0xf bank_mask:0x3
    v_mov_b32_dpp v86, v82 row_ror:8 row_mask:0xf bank_mask:0x3
    v_mov_b32_dpp v87, v83 row_ror:8 row_mask:0xf bank_mask:0x3
    v_mov_b32_dpp v80, v128 row_ror:8 row_mask:0xf bank_mask:0xc
    v_mov_b32_dpp v81, v129 row_ror:8 row_mask:0xf bank_mask:0xc
    v_mov_b32_dpp v82, v130 row_ror:8 row_mask:0xf bank_mask:0xc
    v_mov_b32_dpp v83, v131 row_ror:8 row_mask:0xf bank_mask:0xc
    buffer_store_dwordx4 v[80:83], v0, s[52:55], s83 offen sc0 sc1
    buffer_store_dwordx4 v[84:87], v14, s[52:55], s83 offen sc0 sc1
    s_add_u32 s83, s83, s84
    v_cvt_pk_bf16_f32 v88, v132, v133
    v_cvt_pk_bf16_f32 v89, v134, v135
    v_cvt_pk_bf16_f32 v90, v148, v149
    v_cvt_pk_bf16_f32 v91, v150, v151
    v_cvt_pk_bf16_f32 v92, v164, v165
    v_cvt_pk_bf16_f32 v93, v166, v167
    v_cvt_pk_bf16_f32 v94, v180, v181
    v_cvt_pk_bf16_f32 v95, v182, v183
    s_nop 0
    v_mov_b32 v132, v92
    v_mov_b32 v133, v93
    v_mov_b32 v134, v94
    v_mov_b32 v135, v95
    v_mov_b32_dpp v92, v88 row_ror:8 row_mask:0xf bank_mask:0x3
    v_mov_b32_dpp v93, v89 row_ror:8 row_mask:0xf bank_mask:0x3
    v_mov_b32_dpp v94, v90 row_ror:8 row_mask:0xf bank_mask:0x3
    v_mov_b32_dpp v95, v91 row_ror:8 row_mask:0xf bank_mask:0x3
    v_mov_b32_dpp v88, v132 row_ror:8 row_mask:0xf bank_mask:0xc
    v_mov_b32_dpp v89, v133 row_ror:8 row_mask:0xf bank_mask:0xc
    v_mov_b32_dpp v90, v134 row_ror:8 row_mask:0xf bank_mask:0xc
    v_mov_b32_dpp v91, v135 row_ror:8 row_mask:0xf bank_mask:0xc
    buffer_store_dwordx4 v[88:91], v0, s[52:55], s83 offen sc0 sc1
    buffer_store_dwordx4 v[92:95], v14, s[52:55], s83 offen sc0 sc1
    s_add_u32 s83, s83, s84
    v_cvt_pk_bf16_f32 v96, v136, v137
    v_cvt_pk_bf16_f32 v97, v138, v139
    v_cvt_pk_bf16_f32 v98, v152, v153
    v_cvt_pk_bf16_f32 v99, v154, v155
    v_cvt_pk_bf16_f32 v100, v168, v169
    v_cvt_pk_bf16_f32 v101, v170, v171
    v_cvt_pk_bf16_f32 v102, v184, v185
    v_cvt_pk_bf16_f32 v103, v186, v187
    s_nop 0
    v_mov_b32 v136, v100
    v_mov_b32 v137, v101
    v_mov_b32 v138, v102
    v_mov_b32 v139, v103
    v_mov_b32_dpp v100, v96 row_ror:8 row_mask:0xf bank_mask:0x3
    v_mov_b32_dpp v101, v97 row_ror:8 row_mask:0xf bank_mask:0x3
    v_mov_b32_dpp v102, v98 row_ror:8 row_mask:0xf bank_mask:0x3
    v_mov_b32_dpp v103, v99 row_ror:8 row_mask:0xf bank_mask:0x3
    v_mov_b32_dpp v96, v136 row_ror:8 row_mask:0xf bank_mask:0xc
    v_mov_b32_dpp v97, v137 row_ror:8 row_mask:0xf bank_mask:0xc
    v_mov_b32_dpp v98, v138 row_ror:8 row_mask:0xf bank_mask:0xc
    v_mov_b32_dpp v99, v139 row_ror:8 row_mask:0xf bank_mask:0xc
    v_cvt_pk_bf16_f32 v104, v140, v141
    v_cvt_pk_bf16_f32 v105, v142, v143
    v_cvt_pk_bf16_f32 v106, v156, v157
    v_cvt_pk_bf16_f32 v107, v158, v159
    v_cvt_pk_bf16_f32 v108, v172, v173
    v_cvt_pk_bf16_f32 v109, v174, v175
    v_cvt_pk_bf16_f32 v110, v188, v189
    v_cvt_pk_bf16_f32 v111, v190, v191
    s_nop 0
    v_mov_b32 v140, v108
    v_mov_b32 v141, v109
    v_mov_b32 v142, v110
    v_mov_b32 v143, v111
    v_mov_b32_dpp v108, v104 row_ror:8 row_mask:0xf bank_mask:0x3
    v_mov_b32_dpp v109, v105 row_ror:8 row_mask:0xf bank_mask:0x3
    v_mov_b32_dpp v110, v106 row_ror:8 row_mask:0xf bank_mask:0x3
    v_mov_b32_dpp v111, v107 row_ror:8 row_mask:0xf bank_mask:0x3
    v_mov_b32_dpp v104, v140 row_ror:8 row_mask:0xf bank_mask:0xc
    v_mov_b32_dpp v105, v141 row_ror:8 row_mask:0xf bank_mask:0xc
    v_mov_b32_dpp v106, v142 row_ror:8 row_mask:0xf bank_mask:0xc
    v_mov_b32_dpp v107, v143 row_ror:8 row_mask:0xf bank_mask:0xc
    v_cvt_pk_bf16_f32 v112, v192, v193
    v_cvt_pk_bf16_f32 v113, v194, v195
    v_cvt_pk_bf16_f32 v114, v208, v209
    v_cvt_pk_bf16_f32 v115, v210, v211
    v_cvt_pk_bf16_f32 v116, v224, v225
    v_cvt_pk_bf16_f32 v117, v226, v227
    v_cvt_pk_bf16_f32 v118, v240, v241
    v_cvt_pk_bf16_f32 v119, v242, v243
    s_nop 0
    v_mov_b32 v192, v116
    v_mov_b32 v193, v117
    v_mov_b32 v194, v118
    v_mov_b32 v195, v119
    v_mov_b32_dpp v116, v112 row_ror:8 row_mask:0xf bank_mask:0x3
    v_mov_b32_dpp v117, v113 row_ror:8 row_mask:0xf bank_mask:0x3
    v_mov_b32_dpp v118, v114 row_ror:8 row_mask:0xf bank_mask:0x3
    v_mov_b32_dpp v119, v115 row_ror:8 row_mask:0xf bank_mask:0x3
    v_mov_b32_dpp v112, v192 row_ror:8 row_mask:0xf bank_mask:0xc
    v_mov_b32_dpp v113, v193 row_ror:8 row_mask:0xf bank_mask:0xc
    v_mov_b32_dpp v114, v194 row_ror:8 row_mask:0xf bank_mask:0xc
    v_mov_b32_dpp v115, v195 row_ror:8 row_mask:0xf bank_mask:0xc
    v_cvt_pk_bf16_f32 v120, v196, v197
    v_cvt_pk_bf16_f32 v121, v198, v199
    v_cvt_pk_bf16_f32 v122, v212, v213
    v_cvt_pk_bf16_f32 v123, v214, v215
    v_cvt_pk_bf16_f32 v124, v228, v229
    v_cvt_pk_bf16_f32 v125, v230, v231
    v_cvt_pk_bf16_f32 v126, v244, v245
    v_cvt_pk_bf16_f32 v127, v246, v247
    s_nop 0
    v_mov_b32 v196, v124
    v_mov_b32 v197, v125
    v_mov_b32 v198, v126
    v_mov_b32 v199, v127
    v_mov_b32_dpp v124, v120 row_ror:8 row_mask:0xf bank_mask:0x3
    v_mov_b32_dpp v125, v121 row_ror:8 row_mask:0xf bank_mask:0x3
    v_mov_b32_dpp v126, v122 row_ror:8 row_mask:0xf bank_mask:0x3
    v_mov_b32_dpp v127, v123 row_ror:8 row_mask:0xf bank_mask:0x3
    v_mov_b32_dpp v120, v196 row_ror:8 row_mask:0xf bank_mask:0xc
    v_mov_b32_dpp v121, v197 row_ror:8 row_mask:0xf bank_mask:0xc
    v_mov_b32_dpp v122, v198 row_ror:8 row_mask:0xf bank_mask:0xc
    v_mov_b32_dpp v123, v199 row_ror:8 row_mask:0xf bank_mask:0xc
    v_cvt_pk_bf16_f32 v80, v200, v201
    v_cvt_pk_bf16_f32 v81, v202, v203
    v_cvt_pk_bf16_f32 v82, v216, v217
    v_cvt_pk_bf16_f32 v83, v218, v219
    v_cvt_pk_bf16_f32 v84, v232, v233
    v_cvt_pk_bf16_f32 v85, v234, v235
    v_cvt_pk_bf16_f32 v86, v248, v249
    v_cvt_pk_bf16_f32 v87, v250, v251
    s_nop 0
    v_mov_b32 v200, v84
    v_mov_b32 v201, v85
    v_mov_b32 v202, v86
    v_mov_b32 v203, v87
    v_mov_b32_dpp v84, v80 row_ror:8 row_mask:0xf bank_mask:0x3
    v_mov_b32_dpp v85, v81 row_ror:8 row_mask:0xf bank_mask:0x3
    v_mov_b32_dpp v86, v82 row_ror:8 row_mask:0xf bank_mask:0x3
    v_mov_b32_dpp v87, v83 row_ror:8 row_mask:0xf bank_mask:0x3
    v_mov_b32_dpp v80, v200 row_ror:8 row_mask:0xf bank_mask:0xc
    v_mov_b32_dpp v81, v201 row_ror:8 row_mask:0xf bank_mask:0xc
    v_mov_b32_dpp v82, v202 row_ror:8 row_mask:0xf bank_mask:0xc
    v_mov_b32_dpp v83, v203 row_ror:8 row_mask:0xf bank_mask:0xc
    v_cvt_pk_bf16_f32 v88, v204, v205
    v_cvt_pk_bf16_f32 v89, v206, v207
    v_cvt_pk_bf16_f32 v90, v220, v221
    v_cvt_pk_bf16_f32 v91, v222, v223
    v_cvt_pk_bf16_f32 v92, v236, v237
    v_cvt_pk_bf16_f32 v93, v238, v239
    v_cvt_pk_bf16_f32 v94, v252, v253
    v_cvt_pk_bf16_f32 v95, v254, v255
    s_nop 0
    v_mov_b32 v204, v92
    v_mov_b32 v205, v93
    v_mov_b32 v206, v94
    v_mov_b32 v207, v95
    v_mov_b32_dpp v92, v88 row_ror:8 row_mask:0xf bank_mask:0x3
    v_mov_b32_dpp v93, v89 row_ror:8 row_mask:0xf bank_mask:0x3
    v_mov_b32_dpp v94, v90 row_ror:8 row_mask:0xf bank_mask:0x3
    v_mov_b32_dpp v95, v91 row_ror:8 row_mask:0xf bank_mask:0x3
    v_mov_b32_dpp v88, v204 row_ror:8 row_mask:0xf bank_mask:0xc
    v_mov_b32_dpp v89, v205 row_ror:8 row_mask:0xf bank_mask:0xc
    v_mov_b32_dpp v90, v206 row_ror:8 row_mask:0xf bank_mask:0xc
    v_mov_b32_dpp v91, v207 row_ror:8 row_mask:0xf bank_mask:0xc
proj_qh:
    s_lshl_b32 s68, s63, 8
    s_add_u32 s68, s68, s82
    s_cmp_eq_u32 s68, 355
    s_cbranch_scc1 proj_noh
    s_waitcnt lgkmcnt(4)
    v_mfma_f32_16x16x32_bf16 v[128:131], v[48:51], v[16:19], 0
    v_mfma_f32_16x16x32_bf16 v[132:135], v[52:55], v[16:19], 0
    v_mfma_f32_16x16x32_bf16 v[136:139], v[56:59], v[16:19], 0
    v_mfma_f32_16x16x32_bf16 v[140:143], v[60:63], v[16:19], 0
    ds_read_b128 v[16:19], v3 offset:0
    ds_read_b64_tr_b16 v[64:65], v4 offset:8192
    ds_read_b64_tr_b16 v[66:67], v4 offset:9216
    v_mfma_f32_16x16x32_bf16 v[144:147], v[48:51], v[20:23], 0
    v_mfma_f32_16x16x32_bf16 v[148:151], v[52:55], v[20:23], 0
    v_mfma_f32_16x16x32_bf16 v[152:155], v[56:59], v[20:23], 0
    v_mfma_f32_16x16x32_bf16 v[156:159], v[60:63], v[20:23], 0
    ds_read_b128 v[20:23], v3 offset:2048
    ds_read_b64_tr_b16 v[68:69], v5 offset:8192
    ds_read_b64_tr_b16 v[70:71], v5 offset:9216
    v_mfma_f32_16x16x32_bf16 v[160:163], v[48:51], v[24:27], 0
    v_mfma_f32_16x16x32_bf16 v[164:167], v[52:55], v[24:27], 0
    v_mfma_f32_16x16x32_bf16 v[168:171], v[56:59], v[24:27], 0
    v_mfma_f32_16x16x32_bf16 v[172:175], v[60:63], v[24:27], 0
    ds_read_b128 v[24:27], v3 offset:4096
    ds_read_b64_tr_b16 v[72:73], v6 offset:8192
    ds_read_b64_tr_b16 v[74:75], v6 offset:9216
    v_mfma_f32_16x16x32_bf16 v[176:179], v[48:51], v[28:31], 0
    v_mfma_f32_16x16x32_bf16 v[180:183], v[52:55], v[28:31], 0
    v_mfma_f32_16x16x32_bf16 v[184:187], v[56:59], v[28:31], 0
    v_mfma_f32_16x16x32_bf16 v[188:191], v[60:63], v[28:31], 0
    ds_read_b128 v[28:31], v3 offset:6144
    ds_read_b64_tr_b16 v[76:77], v7 offset:8192
    ds_read_b64_tr_b16 v[78:79], v7 offset:9216
    s_waitcnt lgkmcnt(12)
    v_mfma_f32_16x16x32_bf16 v[192:195], v[48:51], v[32:35], 0
    v_mfma_f32_16x16x32_bf16 v[196:199], v[52:55], v[32:35], 0
    v_mfma_f32_16x16x32_bf16 v[200:203], v[56:59], v[32:35], 0
    v_mfma_f32_16x16x32_bf16 v[204:207], v[60:63], v[32:35], 0
    ds_read_b128 v[32:35], v3 offset:8192
    v_mfma_f32_16x16x32_bf16 v[208:211], v[48:51], v[36:39], 0
    v_mfma_f32_16x16x32_bf16 v[212:215], v[52:55], v[36:39], 0
    v_mfma_f32_16x16x32_bf16 v[216:219], v[56:59], v[36:39], 0
    v_mfma_f32_16x16x32_bf16 v[220:223], v[60:63], v[36:39], 0
    ds_read_b128 v[36:39], v3 offset:10240
    v_mfma_f32_16x16x32_bf16 v[224:227], v[48:51], v[40:43], 0
    v_mfma_f32_16x16x32_bf16 v[228:231], v[52:55], v[40:43], 0
    v_mfma_f32_16x16x32_bf16 v[232:235], v[56:59], v[40:43], 0
    v_mfma_f32_16x16x32_bf16 v[236:239], v[60:63], v[40:43], 0
    ds_read_b128 v[40:43], v3 offset:12288
    v_mfma_f32_16x16x32_bf16 v[240:243], v[48:51], v[44:47], 0
    v_mfma_f32_16x16x32_bf16 v[244:247], v[52:55], v[44:47], 0
    v_mfma_f32_16x16x32_bf16 v[248:251], v[56:59], v[44:47], 0
    v_mfma_f32_16x16x32_bf16 v[252:255], v[60:63], v[44:47], 0
    ds_read_b128 v[44:47], v3 offset:14336
    s_waitcnt lgkmcnt(4)
    v_mfma_f32_16x16x32_bf16 v[128:131], v[64:67], v[16:19], v[128:131]
    v_mfma_f32_16x16x32_bf16 v[132:135], v[68:71], v[16:19], v[132:135]
    v_mfma_f32_16x16x32_bf16 v[136:139], v[72:75], v[16:19], v[136:139]
    v_mfma_f32_16x16x32_bf16 v[140:143], v[76:79], v[16:19], v[140:143]
    v_mfma_f32_16x16x32_bf16 v[144:147], v[64:67], v[20:23], v[144:147]
    v_mfma_f32_16x16x32_bf16 v[148:151], v[68:71], v[20:23], v[148:151]
    v_mfma_f32_16x16x32_bf16 v[152:155], v[72:75], v[20:23], v[152:155]
    v_mfma_f32_16x16x32_bf16 v[156:159], v[76:79], v[20:23], v[156:159]
    s_waitcnt lgkmcnt(0)
    s_cbranch_vccnz Lfw_185
    s_waitcnt vmcnt(4)
Lfw_185:
Lfw_186:
    s_barrier
    ds_read_b128 v[16:19], v2 offset:32768
    ds_read_b128 v[20:23], v2 offset:34816
    ds_read_b64_tr_b16 v[48:49], v4 offset:32768
    ds_read_b64_tr_b16 v[50:51], v4 offset:33792
    ds_read_b64_tr_b16 v[52:53], v5 offset:32768
    ds_read_b64_tr_b16 v[54:55], v5 offset:33792
    v_mfma_f32_16x16x32_bf16 v[160:163], v[64:67], v[24:27], v[160:163]
    v_mfma_f32_16x16x32_bf16 v[164:167], v[68:71], v[24:27], v[164:167]
    v_mfma_f32_16x16x32_bf16 v[168:171], v[72:75], v[24:27], v[168:171]
    v_mfma_f32_16x16x32_bf16 v[172:175], v[76:79], v[24:27], v[172:175]
    ds_read_b128 v[24:27], v2 offset:36864
    ds_read_b64_tr_b16 v[56:57], v6 offset:32768
    ds_read_b64_tr_b16 v[58:59], v6 offset:33792
    s_cbranch_vccnz Lnd_187
    s_add_u32 m0, s81, 0
    s_nop 0
    buffer_load_dwordx4 v8, s[44:47], s64 offen lds
    s_add_u32 m0, s81, 1024
    s_nop 0
    buffer_load_dwordx4 v9, s[44:47], s64 offen lds
Lnd_187:
    v_mfma_f32_16x16x32_bf16 v[176:179], v[64:67], v[28:31], v[176:179]
    v_mfma_f32_16x16x32_bf16 v[180:183], v[68:71], v[28:31], v[180:183]
    v_mfma_f32_16x16x32_bf16 v[184:187], v[72:75], v[28:31], v[184:187]
    v_mfma_f32_16x16x32_bf16 v[188:191], v[76:79], v[28:31], v[188:191]
    ds_read_b128 v[28:31], v2 offset:38912
    ds_read_b64_tr_b16 v[60:61], v7 offset:32768
    ds_read_b64_tr_b16 v[62:63], v7 offset:33792
    s_cbranch_vccnz Lnd_188
    s_add_u32 s68, s64, s4
    s_add_u32 m0, s81, 2048
    s_nop 0
    buffer_load_dwordx4 v8, s[44:47], s68 offen lds
    s_add_u32 s68, s64, s4
    s_add_u32 m0, s81, 3072
    s_nop 0
    buffer_load_dwordx4 v9, s[44:47], s68 offen lds
Lnd_188:
    v_mfma_f32_16x16x32_bf16 v[192:195], v[64:67], v[32:35], v[192:195]
    v_mfma_f32_16x16x32_bf16 v[196:199], v[68:71], v[32:35], v[196:199]
    v_mfma_f32_16x16x32_bf16 v[200:203], v[72:75], v[32:35], v[200:203]
    v_mfma_f32_16x16x32_bf16 v[204:207], v[76:79], v[32:35], v[204:207]
    ds_read_b128 v[32:35], v2 offset:40960
    s_cbranch_vccnz Lnd_189
    s_add_u32 m0, s81, 16384
    s_nop 0
    buffer_load_dwordx4 v8, s[44:47], s65 offen lds
    s_add_u32 m0, s81, 17408
    s_nop 0
    buffer_load_dwordx4 v9, s[44:47], s65 offen lds
    s_add_u32 s68, s65, s4
    s_add_u32 m0, s81, 18432
    s_nop 0
    buffer_load_dwordx4 v8, s[44:47], s68 offen lds
Lnd_189:
    v_mfma_f32_16x16x32_bf16 v[208:211], v[64:67], v[36:39], v[208:211]
    v_mfma_f32_16x16x32_bf16 v[212:215], v[68:71], v[36:39], v[212:215]
    v_mfma_f32_16x16x32_bf16 v[216:219], v[72:75], v[36:39], v[216:219]
    v_mfma_f32_16x16x32_bf16 v[220:223], v[76:79], v[36:39], v[220:223]
    ds_read_b128 v[36:39], v2 offset:43008
    s_cbranch_vccnz Lnd_190
    s_add_u32 s68, s65, s4
    s_add_u32 m0, s81, 19456
    s_nop 0
    buffer_load_dwordx4 v9, s[44:47], s68 offen lds
    s_add_u32 m0, s81, 65536
    s_nop 0
    buffer_load_dwordx4 v10, s[48:51], s66 offen lds
    s_add_u32 s68, s66, s5
    s_add_u32 m0, s81, 66560
    s_nop 0
    buffer_load_dwordx4 v10, s[48:51], s68 offen lds
Lnd_190:
    v_mfma_f32_16x16x32_bf16 v[224:227], v[64:67], v[40:43], v[224:227]
    v_mfma_f32_16x16x32_bf16 v[228:231], v[68:71], v[40:43], v[228:231]
    v_mfma_f32_16x16x32_bf16 v[232:235], v[72:75], v[40:43], v[232:235]
    v_mfma_f32_16x16x32_bf16 v[236:239], v[76:79], v[40:43], v[236:239]
    ds_read_b128 v[40:43], v2 offset:45056
    s_cbranch_vccnz Lnd_191
    s_add_u32 m0, s81, 67584
    s_nop 0
    buffer_load_dwordx4 v11, s[48:51], s66 offen lds
    s_add_u32 s68, s66, s5
    s_add_u32 m0, s81, 68608
    s_nop 0
    buffer_load_dwordx4 v11, s[48:51], s68 offen lds
    s_add_u32 m0, s81, 81920
    s_nop 0
    buffer_load_dwordx4 v12, s[96:99], s67 offen lds
Lnd_191:
    v_mfma_f32_16x16x32_bf16 v[240:243], v[64:67], v[44:47], v[240:243]
    v_mfma_f32_16x16x32_bf16 v[244:247], v[68:71], v[44:47], v[244:247]
    v_mfma_f32_16x16x32_bf16 v[248:251], v[72:75], v[44:47], v[248:251]
    v_mfma_f32_16x16x32_bf16 v[252:255], v[76:79], v[44:47], v[252:255]
    ds_read_b128 v[44:47], v2 offset:47104
    s_cbranch_vccnz Lnd_192
    s_add_u32 s68, s67, s6
    s_add_u32 m0, s81, 82944
    s_nop 0
    buffer_load_dwordx4 v12, s[96:99], s68 offen lds
    s_add_u32 m0, s81, 83968
    s_nop 0
    buffer_load_dwordx4 v13, s[96:99], s67 offen lds
    s_add_u32 s68, s67, s6
    s_add_u32 m0, s81, 84992
    s_nop 0
    buffer_load_dwordx4 v13, s[96:99], s68 offen lds
Lnd_192:
    s_add_u32 s64, s64, 128
    s_add_u32 s65, s65, 128
    s_add_u32 s66, s66, s7
    s_add_u32 s67, s67, s8
    buffer_store_dwordx4 v[96:99], v0, s[52:55], s83 offen sc0 sc1
    s_waitcnt lgkmcnt(4)
    v_mfma_f32_16x16x32_bf16 v[128:131], v[48:51], v[16:19], v[128:131]
    v_mfma_f32_16x16x32_bf16 v[132:135], v[52:55], v[16:19], v[132:135]
    v_mfma_f32_16x16x32_bf16 v[136:139], v[56:59], v[16:19], v[136:139]
    v_mfma_f32_16x16x32_bf16 v[140:143], v[60:63], v[16:19], v[140:143]
    ds_read_b128 v[16:19], v3 offset:32768
    ds_read_b64_tr_b16 v[64:65], v4 offset:40960
    ds_read_b64_tr_b16 v[66:67], v4 offset:41984
    v_mfma_f32_16x16x32_bf16 v[144:147], v[48:51], v[20:23], v[144:147]
    v_mfma_f32_16x16x32_bf16 v[148:151], v[52:55], v[20:23], v[148:151]
    v_mfma_f32_16x16x32_bf16 v[152:155], v[56:59], v[20:23], v[152:155]
    v_mfma_f32_16x16x32_bf16 v[156:159], v[60:63], v[20:23], v[156:159]
    ds_read_b128 v[20:23], v3 offset:34816
    ds_read_b64_tr_b16 v[68:69], v5 offset:40960
    ds_read_b64_tr_b16 v[70:71], v5 offset:41984
    v_mfma_f32_16x16x32_bf16 v[160:163], v[48:51], v[24:27], v[160:163]
    v_mfma_f32_16x16x32_bf16 v[164:167], v[52:55], v[24:27], v[164:167]
    v_mfma_f32_16x16x32_bf16 v[168:171], v[56:59], v[24:27], v[168:171]
    v_mfma_f32_16x16x32_bf16 v[172:175], v[60:63], v[24:27], v[172:175]
    ds_read_b128 v[24:27], v3 offset:36864
    ds_read_b64_tr_b16 v[72:73], v6 offset:40960
    ds_read_b64_tr_b16 v[74:75], v6 offset:41984
    v_mfma_f32_16x16x32_bf16 v[176:179], v[48:51], v[28:31], v[176:179]
    v_mfma_f32_16x16x32_bf16 v[180:183], v[52:55], v[28:31], v[180:183]
    v_mfma_f32_16x16x32_bf16 v[184:187], v[56:59], v[28:31], v[184:187]
    v_mfma_f32_16x16x32_bf16 v[188:191], v[60:63], v[28:31], v[188:191]
    ds_read_b128 v[28:31], v3 offset:38912
    ds_read_b64_tr_b16 v[76:77], v7 offset:40960
    ds_read_b64_tr_b16 v[78:79], v7 offset:41984
    s_waitcnt lgkmcnt(12)
    v_mfma_f32_16x16x32_bf16 v[192:195], v[48:51], v[32:35], v[192:195]
    v_mfma_f32_16x16x32_bf16 v[196:199], v[52:55], v[32:35], v[196:199]
    v_mfma_f32_16x16x32_bf16 v[200:203], v[56:59], v[32:35], v[200:203]
    v_mfma_f32_16x16x32_bf16 v[204:207], v[60:63], v[32:35], v[204:207]
    ds_read_b128 v[32:35], v3 offset:40960
    v_mfma_f32_16x16x32_bf16 v[208:211], v[48:51], v[36:39], v[208:211]
    v_mfma_f32_16x16x32_bf16 v[212:215], v[52:55], v[36:39], v[212:215]
    v_mfma_f32_16x16x32_bf16 v[216:219], v[56:59], v[36:39], v[216:219]
    v_mfma_f32_16x16x32_bf16 v[220:223], v[60:63], v[36:39], v[220:223]
    ds_read_b128 v[36:39], v3 offset:43008
    v_mfma_f32_16x16x32_bf16 v[224:227], v[48:51], v[40:43], v[224:227]
    v_mfma_f32_16x16x32_bf16 v[228:231], v[52:55], v[40:43], v[228:231]
    v_mfma_f32_16x16x32_bf16 v[232:235], v[56:59], v[40:43], v[232:235]
    v_mfma_f32_16x16x32_bf16 v[236:239], v[60:63], v[40:43], v[236:239]
    ds_read_b128 v[40:43], v3 offset:45056
    v_mfma_f32_16x16x32_bf16 v[240:243], v[48:51], v[44:47], v[240:243]
    v_mfma_f32_16x16x32_bf16 v[244:247], v[52:55], v[44:47], v[244:247]
    v_mfma_f32_16x16x32_bf16 v[248:251], v[56:59], v[44:47], v[248:251]
    v_mfma_f32_16x16x32_bf16 v[252:255], v[60:63], v[44:47], v[252:255]
    ds_read_b128 v[44:47], v3 offset:47104
    s_waitcnt lgkmcnt(4)
    v_mfma_f32_16x16x32_bf16 v[128:131], v[64:67], v[16:19], v[128:131]
    v_mfma_f32_16x16x32_bf16 v[132:135], v[68:71], v[16:19], v[132:135]
    v_mfma_f32_16x16x32_bf16 v[136:139], v[72:75], v[16:19], v[136:139]
    v_mfma_f32_16x16x32_bf16 v[140:143], v[76:79], v[16:19], v[140:143]
    v_mfma_f32_16x16x32_bf16 v[144:147], v[64:67], v[20:23], v[144:147]
    v_mfma_f32_16x16x32_bf16 v[148:151], v[68:71], v[20:23], v[148:151]
    v_mfma_f32_16x16x32_bf16 v[152:155], v[72:75], v[20:23], v[152:155]
    v_mfma_f32_16x16x32_bf16 v[156:159], v[76:79], v[20:23], v[156:159]
    s_waitcnt lgkmcnt(0)
    s_cbranch_vccnz Lfw_193
    s_waitcnt vmcnt(1)
Lfw_193:
Lfw_194:
    s_barrier
    ds_read_b128 v[16:19], v2 offset:0
    ds_read_b128 v[20:23], v2 offset:2048
    ds_read_b64_tr_b16 v[48:49], v4 offset:0
    ds_read_b64_tr_b16 v[50:51], v4 offset:1024
    ds_read_b64_tr_b16 v[52:53], v5 offset:0
    ds_read_b64_tr_b16 v[54:55], v5 offset:1024
    v_mfma_f32_16x16x32_bf16 v[160:163], v[64:67], v[24:27], v[160:163]
    v_mfma_f32_16x16x32_bf16 v[164:167], v[68:71], v[24:27], v[164:167]
    v_mfma_f32_16x16x32_bf16 v[168:171], v[72:75], v[24:27], v[168:171]
    v_mfma_f32_16x16x32_bf16 v[172:175], v[76:79], v[24:27], v[172:175]
    ds_read_b128 v[24:27], v2 offset:4096
    ds_read_b64_tr_b16 v[56:57], v6 offset:0
    ds_read_b64_tr_b16 v[58:59], v6 offset:1024
    s_cbranch_vccnz Lnd_195
    s_add_u32 m0, s81, 32768
    s_nop 0
    buffer_load_dwordx4 v8, s[44:47], s64 offen lds
    s_add_u32 m0, s81, 33792
    s_nop 0
    buffer_load_dwordx4 v9, s[44:47], s64 offen lds
Lnd_195:
    v_mfma_f32_16x16x32_bf16 v[176:179], v[64:67], v[28:31], v[176:179]
    v_mfma_f32_16x16x32_bf16 v[180:183], v[68:71], v[28:31], v[180:183]
    v_mfma_f32_16x16x32_bf16 v[184:187], v[72:75], v[28:31], v[184:187]
    v_mfma_f32_16x16x32_bf16 v[188:191], v[76:79], v[28:31], v[188:191]
    ds_read_b128 v[28:31], v2 offset:6144
    ds_read_b64_tr_b16 v[60:61], v7 offset:0
    ds_read_b64_tr_b16 v[62:63], v7 offset:1024
    s_cbranch_vccnz Lnd_196
    s_add_u32 s68, s64, s4
    s_add_u32 m0, s81, 34816
    s_nop 0
    buffer_load_dwordx4 v8, s[44:47], s68 offen lds
    s_add_u32 s68, s64, s4
    s_add_u32 m0, s81, 35840
    s_nop 0
    buffer_load_dwordx4 v9, s[44:47], s68 offen lds
Lnd_196:
    v_mfma_f32_16x16x32_bf16 v[192:195], v[64:67], v[32:35], v[192:195]
    v_mfma_f32_16x16x32_bf16 v[196:199], v[68:71], v[32:35], v[196:199]
    v_mfma_f32_16x16x32_bf16 v[200:203], v[72:75], v[32:35], v[200:203]
    v_mfma_f32_16x16x32_bf16 v[204:207], v[76:79], v[32:35], v[204:207]
    ds_read_b128 v[32:35], v2 offset:8192
    s_cbranch_vccnz Lnd_197
    s_add_u32 m0, s81, 49152
    s_nop 0
    buffer_load_dwordx4 v8, s[44:47], s65 offen lds
    s_add_u32 m0, s81, 50176
    s_nop 0
    buffer_load_dwordx4 v9, s[44:47], s65 offen lds
    s_add_u32 s68, s65, s4
    s_add_u32 m0, s81, 51200
    s_nop 0
    buffer_load_dwordx4 v8, s[44:47], s68 offen lds
Lnd_197:
    v_mfma_f32_16x16x32_bf16 v[208:211], v[64:67], v[36:39], v[208:211]
    v_mfma_f32_16x16x32_bf16 v[212:215], v[68:71], v[36:39], v[212:215]
    v_mfma_f32_16x16x32_bf16 v[216:219], v[72:75], v[36:39], v[216:219]
    v_mfma_f32_16x16x32_bf16 v[220:223], v[76:79], v[36:39], v[220:223]
    ds_read_b128 v[36:39], v2 offset:10240
    s_cbranch_vccnz Lnd_198
    s_add_u32 s68, s65, s4
    s_add_u32 m0, s81, 52224
    s_nop 0
    buffer_load_dwordx4 v9, s[44:47], s68 offen lds
    s_add_u32 m0, s81, 98304
    s_nop 0
    buffer_load_dwordx4 v10, s[48:51], s66 offen lds
    s_add_u32 s68, s66, s5
    s_add_u32 m0, s81, 99328
    s_nop 0
    buffer_load_dwordx4 v10, s[48:51], s68 offen lds
Lnd_198:
    v_mfma_f32_16x16x32_bf16 v[224:227], v[64:67], v[40:43], v[224:227]
    v_mfma_f32_16x16x32_bf16 v[228:231], v[68:71], v[40:43], v[228:231]
    v_mfma_f32_16x16x32_bf16 v[232:235], v[72:75], v[40:43], v[232:235]
    v_mfma_f32_16x16x32_bf16 v[236:239], v[76:79], v[40:43], v[236:239]
    ds_read_b128 v[40:43], v2 offset:12288
    s_cbranch_vccnz Lnd_199
    s_add_u32 m0, s81, 100352
    s_nop 0
    buffer_load_dwordx4 v11, s[48:51], s66 offen lds
    s_add_u32 s68, s66, s5
    s_add_u32 m0, s81, 101376
    s_nop 0
    buffer_load_dwordx4 v11, s[48:51], s68 offen lds
    s_add_u32 m0, s81, 114688
    s_nop 0
    buffer_load_dwordx4 v12, s[96:99], s67 offen lds
Lnd_199:
    v_mfma_f32_16x16x32_bf16 v[240:243], v[64:67], v[44:47], v[240:243]
    v_mfma_f32_16x16x32_bf16 v[244:247], v[68:71], v[44:47], v[244:247]
    v_mfma_f32_16x16x32_bf16 v[248:251], v[72:75], v[44:47], v[248:251]
    v_mfma_f32_16x16x32_bf16 v[252:255], v[76:79], v[44:47], v[252:255]
    ds_read_b128 v[44:47], v2 offset:14336
    s_cbranch_vccnz Lnd_200
    s_add_u32 s68, s67, s6
    s_add_u32 m0, s81, 115712
    s_nop 0
    buffer_load_dwordx4 v12, s[96:99], s68 offen lds
    s_add_u32 m0, s81, 116736
    s_nop 0
    buffer_load_dwordx4 v13, s[96:99], s67 offen lds
    s_add_u32 s68, s67, s6
    s_add_u32 m0, s81, 117760
    s_nop 0
    buffer_load_dwordx4 v13, s[96:99], s68 offen lds
Lnd_200:
    s_add_u32 s64, s64, 128
    s_add_u32 s65, s65, 128
    s_add_u32 s66, s66, s7
    s_add_u32 s67, s67, s8
    buffer_store_dwordx4 v[100:103], v14, s[52:55], s83 offen sc0 sc1
    s_add_u32 s83, s83, s84
    s_waitcnt lgkmcnt(4)
    v_mfma_f32_16x16x32_bf16 v[128:131], v[48:51], v[16:19], v[128:131]
    v_mfma_f32_16x16x32_bf16 v[132:135], v[52:55], v[16:19], v[132:135]
    v_mfma_f32_16x16x32_bf16 v[136:139], v[56:59], v[16:19], v[136:139]
    v_mfma_f32_16x16x32_bf16 v[140:143], v[60:63], v[16:19], v[140:143]
    ds_read_b128 v[16:19], v3 offset:0
    ds_read_b64_tr_b16 v[64:65], v4 offset:8192
    ds_read_b64_tr_b16 v[66:67], v4 offset:9216
    v_mfma_f32_16x16x32_bf16 v[144:147], v[48:51], v[20:23], v[144:147]
    v_mfma_f32_16x16x32_bf16 v[148:151], v[52:55], v[20:23], v[148:151]
    v_mfma_f32_16x16x32_bf16 v[152:155], v[56:59], v[20:23], v[152:155]
    v_mfma_f32_16x16x32_bf16 v[156:159], v[60:63], v[20:23], v[156:159]
    ds_read_b128 v[20:23], v3 offset:2048
    ds_read_b64_tr_b16 v[68:69], v5 offset:8192
    ds_read_b64_tr_b16 v[70:71], v5 offset:9216
    v_mfma_f32_16x16x32_bf16 v[160:163], v[48:51], v[24:27], v[160:163]
    v_mfma_f32_16x16x32_bf16 v[164:167], v[52:55], v[24:27], v[164:167]
    v_mfma_f32_16x16x32_bf16 v[168:171], v[56:59], v[24:27], v[168:171]
    v_mfma_f32_16x16x32_bf16 v[172:175], v[60:63], v[24:27], v[172:175]
    ds_read_b128 v[24:27], v3 offset:4096
    ds_read_b64_tr_b16 v[72:73], v6 offset:8192
    ds_read_b64_tr_b16 v[74:75], v6 offset:9216
    v_mfma_f32_16x16x32_bf16 v[176:179], v[48:51], v[28:31], v[176:179]
    v_mfma_f32_16x16x32_bf16 v[180:183], v[52:55], v[28:31], v[180:183]
    v_mfma_f32_16x16x32_bf16 v[184:187], v[56:59], v[28:31], v[184:187]
    v_mfma_f32_16x16x32_bf16 v[188:191], v[60:63], v[28:31], v[188:191]
    ds_read_b128 v[28:31], v3 offset:6144
    ds_read_b64_tr_b16 v[76:77], v7 offset:8192
    ds_read_b64_tr_b16 v[78:79], v7 offset:9216
    s_waitcnt lgkmcnt(12)
    v_mfma_f32_16x16x32_bf16 v[192:195], v[48:51], v[32:35], v[192:195]
    v_mfma_f32_16x16x32_bf16 v[196:199], v[52:55], v[32:35], v[196:199]
    v_mfma_f32_16x16x32_bf16 v[200:203], v[56:59], v[32:35], v[200:203]
    v_mfma_f32_16x16x32_bf16 v[204:207], v[60:63], v[32:35], v[204:207]
    ds_read_b128 v[32:35], v3 offset:8192
    v_mfma_f32_16x16x32_bf16 v[208:211], v[48:51], v[36:39], v[208:211]
    v_mfma_f32_16x16x32_bf16 v[212:215], v[52:55], v[36:39], v[212:215]
    v_mfma_f32_16x16x32_bf16 v[216:219], v[56:59], v[36:39], v[216:219]
    v_mfma_f32_16x16x32_bf16 v[220:223], v[60:63], v[36:39], v[220:223]
    ds_read_b128 v[36:39], v3 offset:10240
    v_mfma_f32_16x16x32_bf16 v[224:227], v[48:51], v[40:43], v[224:227]
    v_mfma_f32_16x16x32_bf16 v[228:231], v[52:55], v[40:43], v[228:231]
    v_mfma_f32_16x16x32_bf16 v[232:235], v[56:59], v[40:43], v[232:235]
    v_mfma_f32_16x16x32_bf16 v[236:239], v[60:63], v[40:43], v[236:239]
    ds_read_b128 v[40:43], v3 offset:12288
    v_mfma_f32_16x16x32_bf16 v[240:243], v[48:51], v[44:47], v[240:243]
    v_mfma_f32_16x16x32_bf16 v[244:247], v[52:55], v[44:47], v[244:247]
    v_mfma_f32_16x16x32_bf16 v[248:251], v[56:59], v[44:47], v[248:251]
    v_mfma_f32_16x16x32_bf16 v[252:255], v[60:63], v[44:47], v[252:255]
    ds_read_b128 v[44:47], v3 offset:14336
    s_waitcnt lgkmcnt(4)
    v_mfma_f32_16x16x32_bf16 v[128:131], v[64:67], v[16:19], v[128:131]
    v_mfma_f32_16x16x32_bf16 v[132:135], v[68:71], v[16:19], v[132:135]
    v_mfma_f32_16x16x32_bf16 v[136:139], v[72:75], v[16:19], v[136:139]
    v_mfma_f32_16x16x32_bf16 v[140:143], v[76:79], v[16:19], v[140:143]
    v_mfma_f32_16x16x32_bf16 v[144:147], v[64:67], v[20:23], v[144:147]
    v_mfma_f32_16x16x32_bf16 v[148:151], v[68:71], v[20:23], v[148:151]
    v_mfma_f32_16x16x32_bf16 v[152:155], v[72:75], v[20:23], v[152:155]
    v_mfma_f32_16x16x32_bf16 v[156:159], v[76:79], v[20:23], v[156:159]
    s_waitcnt lgkmcnt(0)
    s_cbranch_vccnz Lfw_201
    s_waitcnt vmcnt(1)
Lfw_201:
Lfw_202:
    s_barrier
    ds_read_b128 v[16:19], v2 offset:32768
    ds_read_b128 v[20:23], v2 offset:34816
    ds_read_b64_tr_b16 v[48:49], v4 offset:32768
    ds_read_b64_tr_b16 v[50:51], v4 offset:33792
    ds_read_b64_tr_b16 v[52:53], v5 offset:32768
    ds_read_b64_tr_b16 v[54:55], v5 offset:33792
    v_mfma_f32_16x16x32_bf16 v[160:163], v[64:67], v[24:27], v[160:163]
    v_mfma_f32_16x16x32_bf16 v[164:167], v[68:71], v[24:27], v[164:167]
    v_mfma_f32_16x16x32_bf16 v[168:171], v[72:75], v[24:27], v[168:171]
    v_mfma_f32_16x16x32_bf16 v[172:175], v[76:79], v[24:27], v[172:175]
    ds_read_b128 v[24:27], v2 offset:36864
    ds_read_b64_tr_b16 v[56:57], v6 offset:32768
    ds_read_b64_tr_b16 v[58:59], v6 offset:33792
    s_cbranch_vccnz Lnd_203
    s_add_u32 m0, s81, 0
    s_nop 0
    buffer_load_dwordx4 v8, s[44:47], s64 offen lds
    s_add_u32 m0, s81, 1024
    s_nop 0
    buffer_load_dwordx4 v9, s[44:47], s64 offen lds
Lnd_203:
    v_mfma_f32_16x16x32_bf16 v[176:179], v[64:67], v[28:31], v[176:179]
    v_mfma_f32_16x16x32_bf16 v[180:183], v[68:71], v[28:31], v[180:183]
    v_mfma_f32_16x16x32_bf16 v[184:187], v[72:75], v[28:31], v[184:187]
    v_mfma_f32_16x16x32_bf16 v[188:191], v[76:79], v[28:31], v[188:191]
    ds_read_b128 v[28:31], v2 offset:38912
    ds_read_b64_tr_b16 v[60:61], v7 offset:32768
    ds_read_b64_tr_b16 v[62:63], v7 offset:33792
    s_cbranch_vccnz Lnd_204
    s_add_u32 s68, s64, s4
    s_add_u32 m0, s81, 2048
    s_nop 0
    buffer_load_dwordx4 v8, s[44:47], s68 offen lds
    s_add_u32 s68, s64, s4
    s_add_u32 m0, s81, 3072
    s_nop 0
    buffer_load_dwordx4 v9, s[44:47], s68 offen lds
Lnd_204:
    v_mfma_f32_16x16x32_bf16 v[192:195], v[64:67], v[32:35], v[192:195]
    v_mfma_f32_16x16x32_bf16 v[196:199], v[68:71], v[32:35], v[196:199]
    v_mfma_f32_16x16x32_bf16 v[200:203], v[72:75], v[32:35], v[200:203]
    v_mfma_f32_16x16x32_bf16 v[204:207], v[76:79], v[32:35], v[204:207]
    ds_read_b128 v[32:35], v2 offset:40960
    s_cbranch_vccnz Lnd_205
    s_add_u32 m0, s81, 16384
    s_nop 0
    buffer_load_dwordx4 v8, s[44:47], s65 offen lds
    s_add_u32 m0, s81, 17408
    s_nop 0
    buffer_load_dwordx4 v9, s[44:47], s65 offen lds
    s_add_u32 s68, s65, s4
    s_add_u32 m0, s81, 18432
    s_nop 0
    buffer_load_dwordx4 v8, s[44:47], s68 offen lds
Lnd_205:
    v_mfma_f32_16x16x32_bf16 v[208:211], v[64:67], v[36:39], v[208:211]
    v_mfma_f32_16x16x32_bf16 v[212:215], v[68:71], v[36:39], v[212:215]
    v_mfma_f32_16x16x32_bf16 v[216:219], v[72:75], v[36:39], v[216:219]
    v_mfma_f32_16x16x32_bf16 v[220:223], v[76:79], v[36:39], v[220:223]
    ds_read_b128 v[36:39], v2 offset:43008
    s_cbranch_vccnz Lnd_206
    s_add_u32 s68, s65, s4
    s_add_u32 m0, s81, 19456
    s_nop 0
    buffer_load_dwordx4 v9, s[44:47], s68 offen lds
    s_add_u32 m0, s81, 65536
    s_nop 0
    buffer_load_dwordx4 v10, s[48:51], s66 offen lds
    s_add_u32 s68, s66, s5
    s_add_u32 m0, s81, 66560
    s_nop 0
    buffer_load_dwordx4 v10, s[48:51], s68 offen lds
Lnd_206:
    v_mfma_f32_16x16x32_bf16 v[224:227], v[64:67], v[40:43], v[224:227]
    v_mfma_f32_16x16x32_bf16 v[228:231], v[68:71], v[40:43], v[228:231]
    v_mfma_f32_16x16x32_bf16 v[232:235], v[72:75], v[40:43], v[232:235]
    v_mfma_f32_16x16x32_bf16 v[236:239], v[76:79], v[40:43], v[236:239]
    ds_read_b128 v[40:43], v2 offset:45056
    s_cbranch_vccnz Lnd_207
    s_add_u32 m0, s81, 67584
    s_nop 0
    buffer_load_dwordx4 v11, s[48:51], s66 offen lds
    s_add_u32 s68, s66, s5
    s_add_u32 m0, s81, 68608
    s_nop 0
    buffer_load_dwordx4 v11, s[48:51], s68 offen lds
    s_add_u32 m0, s81, 81920
    s_nop 0
    buffer_load_dwordx4 v12, s[96:99], s67 offen lds
Lnd_207:
    v_mfma_f32_16x16x32_bf16 v[240:243], v[64:67], v[44:47], v[240:243]
    v_mfma_f32_16x16x32_bf16 v[244:247], v[68:71], v[44:47], v[244:247]
    v_mfma_f32_16x16x32_bf16 v[248:251], v[72:75], v[44:47], v[248:251]
    v_mfma_f32_16x16x32_bf16 v[252:255], v[76:79], v[44:47], v[252:255]
    ds_read_b128 v[44:47], v2 offset:47104
    s_cbranch_vccnz Lnd_208
    s_add_u32 s68, s67, s6
    s_add_u32 m0, s81, 82944
    s_nop 0
    buffer_load_dwordx4 v12, s[96:99], s68 offen lds
    s_add_u32 m0, s81, 83968
    s_nop 0
    buffer_load_dwordx4 v13, s[96:99], s67 offen lds
    s_add_u32 s68, s67, s6
    s_add_u32 m0, s81, 84992
    s_nop 0
    buffer_load_dwordx4 v13, s[96:99], s68 offen lds
Lnd_208:
    s_add_u32 s64, s64, 128
    s_add_u32 s65, s65, 128
    s_add_u32 s66, s66, s7
    s_add_u32 s67, s67, s8
    buffer_store_dwordx4 v[104:107], v0, s[52:55], s83 offen sc0 sc1
    s_waitcnt lgkmcnt(4)
    v_mfma_f32_16x16x32_bf16 v[128:131], v[48:51], v[16:19], v[128:131]
    v_mfma_f32_16x16x32_bf16 v[132:135], v[52:55], v[16:19], v[132:135]
    v_mfma_f32_16x16x32_bf16 v[136:139], v[56:59], v[16:19], v[136:139]
    v_mfma_f32_16x16x32_bf16 v[140:143], v[60:63], v[16:19], v[140:143]
    ds_read_b128 v[16:19], v3 offset:32768
    ds_read_b64_tr_b16 v[64:65], v4 offset:40960
    ds_read_b64_tr_b16 v[66:67], v4 offset:41984
    v_mfma_f32_16x16x32_bf16 v[144:147], v[48:51], v[20:23], v[144:147]
    v_mfma_f32_16x16x32_bf16 v[148:151], v[52:55], v[20:23], v[148:151]
    v_mfma_f32_16x16x32_bf16 v[152:155], v[56:59], v[20:23], v[152:155]
    v_mfma_f32_16x16x32_bf16 v[156:159], v[60:63], v[20:23], v[156:159]
    ds_read_b128 v[20:23], v3 offset:34816
    ds_read_b64_tr_b16 v[68:69], v5 offset:40960
    ds_read_b64_tr_b16 v[70:71], v5 offset:41984
    v_mfma_f32_16x16x32_bf16 v[160:163], v[48:51], v[24:27], v[160:163]
    v_mfma_f32_16x16x32_bf16 v[164:167], v[52:55], v[24:27], v[164:167]
    v_mfma_f32_16x16x32_bf16 v[168:171], v[56:59], v[24:27], v[168:171]
    v_mfma_f32_16x16x32_bf16 v[172:175], v[60:63], v[24:27], v[172:175]
    ds_read_b128 v[24:27], v3 offset:36864
    ds_read_b64_tr_b16 v[72:73], v6 offset:40960
    ds_read_b64_tr_b16 v[74:75], v6 offset:41984
    v_mfma_f32_16x16x32_bf16 v[176:179], v[48:51], v[28:31], v[176:179]
    v_mfma_f32_16x16x32_bf16 v[180:183], v[52:55], v[28:31], v[180:183]
    v_mfma_f32_16x16x32_bf16 v[184:187], v[56:59], v[28:31], v[184:187]
    v_mfma_f32_16x16x32_bf16 v[188:191], v[60:63], v[28:31], v[188:191]
    ds_read_b128 v[28:31], v3 offset:38912
    ds_read_b64_tr_b16 v[76:77], v7 offset:40960
    ds_read_b64_tr_b16 v[78:79], v7 offset:41984
    s_waitcnt lgkmcnt(12)
    v_mfma_f32_16x16x32_bf16 v[192:195], v[48:51], v[32:35], v[192:195]
    v_mfma_f32_16x16x32_bf16 v[196:199], v[52:55], v[32:35], v[196:199]
    v_mfma_f32_16x16x32_bf16 v[200:203], v[56:59], v[32:35], v[200:203]
    v_mfma_f32_16x16x32_bf16 v[204:207], v[60:63], v[32:35], v[204:207]
    ds_read_b128 v[32:35], v3 offset:40960
    v_mfma_f32_16x16x32_bf16 v[208:211], v[48:51], v[36:39], v[208:211]
    v_mfma_f32_16x16x32_bf16 v[212:215], v[52:55], v[36:39], v[212:215]
    v_mfma_f32_16x16x32_bf16 v[216:219], v[56:59], v[36:39], v[216:219]
    v_mfma_f32_16x16x32_bf16 v[220:223], v[60:63], v[36:39], v[220:223]
    ds_read_b128 v[36:39], v3 offset:43008
    v_mfma_f32_16x16x32_bf16 v[224:227], v[48:51], v[40:43], v[224:227]
    v_mfma_f32_16x16x32_bf16 v[228:231], v[52:55], v[40:43], v[228:231]
    v_mfma_f32_16x16x32_bf16 v[232:235], v[56:59], v[40:43], v[232:235]
    v_mfma_f32_16x16x32_bf16 v[236:239], v[60:63], v[40:43], v[236:239]
    ds_read_b128 v[40:43], v3 offset:45056
    v_mfma_f32_16x16x32_bf16 v[240:243], v[48:51], v[44:47], v[240:243]
    v_mfma_f32_16x16x32_bf16 v[244:247], v[52:55], v[44:47], v[244:247]
    v_mfma_f32_16x16x32_bf16 v[248:251], v[56:59], v[44:47], v[248:251]
    v_mfma_f32_16x16x32_bf16 v[252:255], v[60:63], v[44:47], v[252:255]
    ds_read_b128 v[44:47], v3 offset:47104
    s_waitcnt lgkmcnt(4)
    v_mfma_f32_16x16x32_bf16 v[128:131], v[64:67], v[16:19], v[128:131]
    v_mfma_f32_16x16x32_bf16 v[132:135], v[68:71], v[16:19], v[132:135]
    v_mfma_f32_16x16x32_bf16 v[136:139], v[72:75], v[16:19], v[136:139]
    v_mfma_f32_16x16x32_bf16 v[140:143], v[76:79], v[16:19], v[140:143]
    v_mfma_f32_16x16x32_bf16 v[144:147], v[64:67], v[20:23], v[144:147]
    v_mfma_f32_16x16x32_bf16 v[148:151], v[68:71], v[20:23], v[148:151]
    v_mfma_f32_16x16x32_bf16 v[152:155], v[72:75], v[20:23], v[152:155]
    v_mfma_f32_16x16x32_bf16 v[156:159], v[76:79], v[20:23], v[156:159]
    s_waitcnt lgkmcnt(0)
    s_cbranch_vccnz Lfw_209
    s_waitcnt vmcnt(1)
Lfw_209:
Lfw_210:
    s_barrier
    ds_read_b128 v[16:19], v2 offset:0
    ds_read_b128 v[20:23], v2 offset:2048
    ds_read_b64_tr_b16 v[48:49], v4 offset:0
    ds_read_b64_tr_b16 v[50:51], v4 offset:1024
    ds_read_b64_tr_b16 v[52:53], v5 offset:0
    ds_read_b64_tr_b16 v[54:55], v5 offset:1024
    v_mfma_f32_16x16x32_bf16 v[160:163], v[64:67], v[24:27], v[160:163]
    v_mfma_f32_16x16x32_bf16 v[164:167], v[68:71], v[24:27], v[164:167]
    v_mfma_f32_16x16x32_bf16 v[168:171], v[72:75], v[24:27], v[168:171]
    v_mfma_f32_16x16x32_bf16 v[172:175], v[76:79], v[24:27], v[172:175]
    ds_read_b128 v[24:27], v2 offset:4096
    ds_read_b64_tr_b16 v[56:57], v6 offset:0
    ds_read_b64_tr_b16 v[58:59], v6 offset:1024
    s_cbranch_vccnz Lnd_211
    s_add_u32 m0, s81, 32768
    s_nop 0
    buffer_load_dwordx4 v8, s[44:47], s64 offen lds
    s_add_u32 m0, s81, 33792
    s_nop 0
    buffer_load_dwordx4 v9, s[44:47], s64 offen lds
Lnd_211:
    v_mfma_f32_16x16x32_bf16 v[176:179], v[64:67], v[28:31], v[176:179]
    v_mfma_f32_16x16x32_bf16 v[180:183], v[68:71], v[28:31], v[180:183]
    v_mfma_f32_16x16x32_bf16 v[184:187], v[72:75], v[28:31], v[184:187]
    v_mfma_f32_16x16x32_bf16 v[188:191], v[76:79], v[28:31], v[188:191]
    ds_read_b128 v[28:31], v2 offset:6144
    ds_read_b64_tr_b16 v[60:61], v7 offset:0
    ds_read_b64_tr_b16 v[62:63], v7 offset:1024
    s_cbranch_vccnz Lnd_212
    s_add_u32 s68, s64, s4
    s_add_u32 m0, s81, 34816
    s_nop 0
    buffer_load_dwordx4 v8, s[44:47], s68 offen lds
    s_add_u32 s68, s64, s4
    s_add_u32 m0, s81, 35840
    s_nop 0
    buffer_load_dwordx4 v9, s[44:47], s68 offen lds
Lnd_212:
    v_mfma_f32_16x16x32_bf16 v[192:195], v[64:67], v[32:35], v[192:195]
    v_mfma_f32_16x16x32_bf16 v[196:199], v[68:71], v[32:35], v[196:199]
    v_mfma_f32_16x16x32_bf16 v[200:203], v[72:75], v[32:35], v[200:203]
    v_mfma_f32_16x16x32_bf16 v[204:207], v[76:79], v[32:35], v[204:207]
    ds_read_b128 v[32:35], v2 offset:8192
    s_cbranch_vccnz Lnd_213
    s_add_u32 m0, s81, 49152
    s_nop 0
    buffer_load_dwordx4 v8, s[44:47], s65 offen lds
    s_add_u32 m0, s81, 50176
    s_nop 0
    buffer_load_dwordx4 v9, s[44:47], s65 offen lds
    s_add_u32 s68, s65, s4
    s_add_u32 m0, s81, 51200
    s_nop 0
    buffer_load_dwordx4 v8, s[44:47], s68 offen lds
Lnd_213:
    v_mfma_f32_16x16x32_bf16 v[208:211], v[64:67], v[36:39], v[208:211]
    v_mfma_f32_16x16x32_bf16 v[212:215], v[68:71], v[36:39], v[212:215]
    v_mfma_f32_16x16x32_bf16 v[216:219], v[72:75], v[36:39], v[216:219]
    v_mfma_f32_16x16x32_bf16 v[220:223], v[76:79], v[36:39], v[220:223]
    ds_read_b128 v[36:39], v2 offset:10240
    s_cbranch_vccnz Lnd_214
    s_add_u32 s68, s65, s4
    s_add_u32 m0, s81, 52224
    s_nop 0
    buffer_load_dwordx4 v9, s[44:47], s68 offen lds
    s_add_u32 m0, s81, 98304
    s_nop 0
    buffer_load_dwordx4 v10, s[48:51], s66 offen lds
    s_add_u32 s68, s66, s5
    s_add_u32 m0, s81, 99328
    s_nop 0
    buffer_load_dwordx4 v10, s[48:51], s68 offen lds
Lnd_214:
    v_mfma_f32_16x16x32_bf16 v[224:227], v[64:67], v[40:43], v[224:227]
    v_mfma_f32_16x16x32_bf16 v[228:231], v[68:71], v[40:43], v[228:231]
    v_mfma_f32_16x16x32_bf16 v[232:235], v[72:75], v[40:43], v[232:235]
    v_mfma_f32_16x16x32_bf16 v[236:239], v[76:79], v[40:43], v[236:239]
    ds_read_b128 v[40:43], v2 offset:12288
    s_cbranch_vccnz Lnd_215
    s_add_u32 m0, s81, 100352
    s_nop 0
    buffer_load_dwordx4 v11, s[48:51], s66 offen lds
    s_add_u32 s68, s66, s5
    s_add_u32 m0, s81, 101376
    s_nop 0
    buffer_load_dwordx4 v11, s[48:51], s68 offen lds
    s_add_u32 m0, s81, 114688
    s_nop 0
    buffer_load_dwordx4 v12, s[96:99], s67 offen lds
Lnd_215:
    v_mfma_f32_16x16x32_bf16 v[240:243], v[64:67], v[44:47], v[240:243]
    v_mfma_f32_16x16x32_bf16 v[244:247], v[68:71], v[44:47], v[244:247]
    v_mfma_f32_16x16x32_bf16 v[248:251], v[72:75], v[44:47], v[248:251]
    v_mfma_f32_16x16x32_bf16 v[252:255], v[76:79], v[44:47], v[252:255]
    ds_read_b128 v[44:47], v2 offset:14336
    s_cbranch_vccnz Lnd_216
    s_add_u32 s68, s67, s6
    s_add_u32 m0, s81, 115712
    s_nop 0
    buffer_load_dwordx4 v12, s[96:99], s68 offen lds
    s_add_u32 m0, s81, 116736
    s_nop 0
    buffer_load_dwordx4 v13, s[96:99], s67 offen lds
    s_add_u32 s68, s67, s6
    s_add_u32 m0, s81, 117760
    s_nop 0
    buffer_load_dwordx4 v13, s[96:99], s68 offen lds
Lnd_216:
    s_add_u32 s64, s64, 128
    s_add_u32 s65, s65, 128
    s_add_u32 s66, s66, s7
    s_add_u32 s67, s67, s8
    buffer_store_dwordx4 v[108:111], v14, s[52:55], s83 offen sc0 sc1
    s_add_u32 s83, s83, s85
    s_waitcnt lgkmcnt(4)
    v_mfma_f32_16x16x32_bf16 v[128:131], v[48:51], v[16:19], v[128:131]
    v_mfma_f32_16x16x32_bf16 v[132:135], v[52:55], v[16:19], v[132:135]
    v_mfma_f32_16x16x32_bf16 v[136:139], v[56:59], v[16:19], v[136:139]
    v_mfma_f32_16x16x32_bf16 v[140:143], v[60:63], v[16:19], v[140:143]
    ds_read_b128 v[16:19], v3 offset:0
    ds_read_b64_tr_b16 v[64:65], v4 offset:8192
    ds_read_b64_tr_b16 v[66:67], v4 offset:9216
    v_mfma_f32_16x16x32_bf16 v[144:147], v[48:51], v[20:23], v[144:147]
    v_mfma_f32_16x16x32_bf16 v[148:151], v[52:55], v[20:23], v[148:151]
    v_mfma_f32_16x16x32_bf16 v[152:155], v[56:59], v[20:23], v[152:155]
    v_mfma_f32_16x16x32_bf16 v[156:159], v[60:63], v[20:23], v[156:159]
    ds_read_b128 v[20:23], v3 offset:2048
    ds_read_b64_tr_b16 v[68:69], v5 offset:8192
    ds_read_b64_tr_b16 v[70:71], v5 offset:9216
    v_mfma_f32_16x16x32_bf16 v[160:163], v[48:51], v[24:27], v[160:163]
    v_mfma_f32_16x16x32_bf16 v[164:167], v[52:55], v[24:27], v[164:167]
    v_mfma_f32_16x16x32_bf16 v[168:171], v[56:59], v[24:27], v[168:171]
    v_mfma_f32_16x16x32_bf16 v[172:175], v[60:63], v[24:27], v[172:175]
    ds_read_b128 v[24:27], v3 offset:4096
    ds_read_b64_tr_b16 v[72:73], v6 offset:8192
    ds_read_b64_tr_b16 v[74:75], v6 offset:9216
    v_mfma_f32_16x16x32_bf16 v[176:179], v[48:51], v[28:31], v[176:179]
    v_mfma_f32_16x16x32_bf16 v[180:183], v[52:55], v[28:31], v[180:183]
    v_mfma_f32_16x16x32_bf16 v[184:187], v[56:59], v[28:31], v[184:187]
    v_mfma_f32_16x16x32_bf16 v[188:191], v[60:63], v[28:31], v[188:191]
    ds_read_b128 v[28:31], v3 offset:6144
    ds_read_b64_tr_b16 v[76:77], v7 offset:8192
    ds_read_b64_tr_b16 v[78:79], v7 offset:9216
    s_waitcnt lgkmcnt(12)
    v_mfma_f32_16x16x32_bf16 v[192:195], v[48:51], v[32:35], v[192:195]
    v_mfma_f32_16x16x32_bf16 v[196:199], v[52:55], v[32:35], v[196:199]
    v_mfma_f32_16x16x32_bf16 v[200:203], v[56:59], v[32:35], v[200:203]
    v_mfma_f32_16x16x32_bf16 v[204:207], v[60:63], v[32:35], v[204:207]
    ds_read_b128 v[32:35], v3 offset:8192
    v_mfma_f32_16x16x32_bf16 v[208:211], v[48:51], v[36:39], v[208:211]
    v_mfma_f32_16x16x32_bf16 v[212:215], v[52:55], v[36:39], v[212:215]
    v_mfma_f32_16x16x32_bf16 v[216:219], v[56:59], v[36:39], v[216:219]
    v_mfma_f32_16x16x32_bf16 v[220:223], v[60:63], v[36:39], v[220:223]
    ds_read_b128 v[36:39], v3 offset:10240
    v_mfma_f32_16x16x32_bf16 v[224:227], v[48:51], v[40:43], v[224:227]
    v_mfma_f32_16x16x32_bf16 v[228:231], v[52:55], v[40:43], v[228:231]
    v_mfma_f32_16x16x32_bf16 v[232:235], v[56:59], v[40:43], v[232:235]
    v_mfma_f32_16x16x32_bf16 v[236:239], v[60:63], v[40:43], v[236:239]
    ds_read_b128 v[40:43], v3 offset:12288
    v_mfma_f32_16x16x32_bf16 v[240:243], v[48:51], v[44:47], v[240:243]
    v_mfma_f32_16x16x32_bf16 v[244:247], v[52:55], v[44:47], v[244:247]
    v_mfma_f32_16x16x32_bf16 v[248:251], v[56:59], v[44:47], v[248:251]
    v_mfma_f32_16x16x32_bf16 v[252:255], v[60:63], v[44:47], v[252:255]
    ds_read_b128 v[44:47], v3 offset:14336
    s_waitcnt lgkmcnt(4)
    v_mfma_f32_16x16x32_bf16 v[128:131], v[64:67], v[16:19], v[128:131]
    v_mfma_f32_16x16x32_bf16 v[132:135], v[68:71], v[16:19], v[132:135]
    v_mfma_f32_16x16x32_bf16 v[136:139], v[72:75], v[16:19], v[136:139]
    v_mfma_f32_16x16x32_bf16 v[140:143], v[76:79], v[16:19], v[140:143]
    v_mfma_f32_16x16x32_bf16 v[144:147], v[64:67], v[20:23], v[144:147]
    v_mfma_f32_16x16x32_bf16 v[148:151], v[68:71], v[20:23], v[148:151]
    v_mfma_f32_16x16x32_bf16 v[152:155], v[72:75], v[20:23], v[152:155]
    v_mfma_f32_16x16x32_bf16 v[156:159], v[76:79], v[20:23], v[156:159]
    s_waitcnt lgkmcnt(0)
    s_cbranch_vccnz Lfw_217
    s_waitcnt vmcnt(1)
Lfw_217:
Lfw_218:
    s_barrier
    ds_read_b128 v[16:19], v2 offset:32768
    ds_read_b128 v[20:23], v2 offset:34816
    ds_read_b64_tr_b16 v[48:49], v4 offset:32768
    ds_read_b64_tr_b16 v[50:51], v4 offset:33792
    ds_read_b64_tr_b16 v[52:53], v5 offset:32768
    ds_read_b64_tr_b16 v[54:55], v5 offset:33792
    v_mfma_f32_16x16x32_bf16 v[160:163], v[64:67], v[24:27], v[160:163]
    v_mfma_f32_16x16x32_bf16 v[164:167], v[68:71], v[24:27], v[164:167]
    v_mfma_f32_16x16x32_bf16 v[168:171], v[72:75], v[24:27], v[168:171]
    v_mfma_f32_16x16x32_bf16 v[172:175], v[76:79], v[24:27], v[172:175]
    ds_read_b128 v[24:27], v2 offset:36864
    ds_read_b64_tr_b16 v[56:57], v6 offset:32768
    ds_read_b64_tr_b16 v[58:59], v6 offset:33792
    s_cbranch_vccnz Lnd_219
    s_add_u32 m0, s81, 0
    s_nop 0
    buffer_load_dwordx4 v8, s[44:47], s64 offen lds
    s_add_u32 m0, s81, 1024
    s_nop 0
    buffer_load_dwordx4 v9, s[44:47], s64 offen lds
Lnd_219:
    v_mfma_f32_16x16x32_bf16 v[176:179], v[64:67], v[28:31], v[176:179]
    v_mfma_f32_16x16x32_bf16 v[180:183], v[68:71], v[28:31], v[180:183]
    v_mfma_f32_16x16x32_bf16 v[184:187], v[72:75], v[28:31], v[184:187]
    v_mfma_f32_16x16x32_bf16 v[188:191], v[76:79], v[28:31], v[188:191]
    ds_read_b128 v[28:31], v2 offset:38912
    ds_read_b64_tr_b16 v[60:61], v7 offset:32768
    ds_read_b64_tr_b16 v[62:63], v7 offset:33792
    s_cbranch_vccnz Lnd_220
    s_add_u32 s68, s64, s4
    s_add_u32 m0, s81, 2048
    s_nop 0
    buffer_load_dwordx4 v8, s[44:47], s68 offen lds
    s_add_u32 s68, s64, s4
    s_add_u32 m0, s81, 3072
    s_nop 0
    buffer_load_dwordx4 v9, s[44:47], s68 offen lds
Lnd_220:
    v_mfma_f32_16x16x32_bf16 v[192:195], v[64:67], v[32:35], v[192:195]
    v_mfma_f32_16x16x32_bf16 v[196:199], v[68:71], v[32:35], v[196:199]
    v_mfma_f32_16x16x32_bf16 v[200:203], v[72:75], v[32:35], v[200:203]
    v_mfma_f32_16x16x32_bf16 v[204:207], v[76:79], v[32:35], v[204:207]
    ds_read_b128 v[32:35], v2 offset:40960
    s_cbranch_vccnz Lnd_221
    s_add_u32 m0, s81, 16384
    s_nop 0
    buffer_load_dwordx4 v8, s[44:47], s65 offen lds
    s_add_u32 m0, s81, 17408
    s_nop 0
    buffer_load_dwordx4 v9, s[44:47], s65 offen lds
    s_add_u32 s68, s65, s4
    s_add_u32 m0, s81, 18432
    s_nop 0
    buffer_load_dwordx4 v8, s[44:47], s68 offen lds
Lnd_221:
    v_mfma_f32_16x16x32_bf16 v[208:211], v[64:67], v[36:39], v[208:211]
    v_mfma_f32_16x16x32_bf16 v[212:215], v[68:71], v[36:39], v[212:215]
    v_mfma_f32_16x16x32_bf16 v[216:219], v[72:75], v[36:39], v[216:219]
    v_mfma_f32_16x16x32_bf16 v[220:223], v[76:79], v[36:39], v[220:223]
    ds_read_b128 v[36:39], v2 offset:43008
    s_cbranch_vccnz Lnd_222
    s_add_u32 s68, s65, s4
    s_add_u32 m0, s81, 19456
    s_nop 0
    buffer_load_dwordx4 v9, s[44:47], s68 offen lds
    s_add_u32 m0, s81, 65536
    s_nop 0
    buffer_load_dwordx4 v10, s[48:51], s66 offen lds
    s_add_u32 s68, s66, s5
    s_add_u32 m0, s81, 66560
    s_nop 0
    buffer_load_dwordx4 v10, s[48:51], s68 offen lds
Lnd_222:
    v_mfma_f32_16x16x32_bf16 v[224:227], v[64:67], v[40:43], v[224:227]
    v_mfma_f32_16x16x32_bf16 v[228:231], v[68:71], v[40:43], v[228:231]
    v_mfma_f32_16x16x32_bf16 v[232:235], v[72:75], v[40:43], v[232:235]
    v_mfma_f32_16x16x32_bf16 v[236:239], v[76:79], v[40:43], v[236:239]
    ds_read_b128 v[40:43], v2 offset:45056
    s_cbranch_vccnz Lnd_223
    s_add_u32 m0, s81, 67584
    s_nop 0
    buffer_load_dwordx4 v11, s[48:51], s66 offen lds
    s_add_u32 s68, s66, s5
    s_add_u32 m0, s81, 68608
    s_nop 0
    buffer_load_dwordx4 v11, s[48:51], s68 offen lds
    s_add_u32 m0, s81, 81920
    s_nop 0
    buffer_load_dwordx4 v12, s[96:99], s67 offen lds
Lnd_223:
    v_mfma_f32_16x16x32_bf16 v[240:243], v[64:67], v[44:47], v[240:243]
    v_mfma_f32_16x16x32_bf16 v[244:247], v[68:71], v[44:47], v[244:247]
    v_mfma_f32_16x16x32_bf16 v[248:251], v[72:75], v[44:47], v[248:251]
    v_mfma_f32_16x16x32_bf16 v[252:255], v[76:79], v[44:47], v[252:255]
    ds_read_b128 v[44:47], v2 offset:47104
    s_cbranch_vccnz Lnd_224
    s_add_u32 s68, s67, s6
    s_add_u32 m0, s81, 82944
    s_nop 0
    buffer_load_dwordx4 v12, s[96:99], s68 offen lds
    s_add_u32 m0, s81, 83968
    s_nop 0
    buffer_load_dwordx4 v13, s[96:99], s67 offen lds
    s_add_u32 s68, s67, s6
    s_add_u32 m0, s81, 84992
    s_nop 0
    buffer_load_dwordx4 v13, s[96:99], s68 offen lds
Lnd_224:
    s_add_u32 s64, s64, 128
    s_add_u32 s65, s65, 128
    s_add_u32 s66, s66, s7
    s_add_u32 s67, s67, s8
    buffer_store_dwordx4 v[112:115], v0, s[52:55], s83 offen sc0 sc1
    s_waitcnt lgkmcnt(4)
    v_mfma_f32_16x16x32_bf16 v[128:131], v[48:51], v[16:19], v[128:131]
    v_mfma_f32_16x16x32_bf16 v[132:135], v[52:55], v[16:19], v[132:135]
    v_mfma_f32_16x16x32_bf16 v[136:139], v[56:59], v[16:19], v[136:139]
    v_mfma_f32_16x16x32_bf16 v[140:143], v[60:63], v[16:19], v[140:143]
    ds_read_b128 v[16:19], v3 offset:32768
    ds_read_b64_tr_b16 v[64:65], v4 offset:40960
    ds_read_b64_tr_b16 v[66:67], v4 offset:41984
    v_mfma_f32_16x16x32_bf16 v[144:147], v[48:51], v[20:23], v[144:147]
    v_mfma_f32_16x16x32_bf16 v[148:151], v[52:55], v[20:23], v[148:151]
    v_mfma_f32_16x16x32_bf16 v[152:155], v[56:59], v[20:23], v[152:155]
    v_mfma_f32_16x16x32_bf16 v[156:159], v[60:63], v[20:23], v[156:159]
    ds_read_b128 v[20:23], v3 offset:34816
    ds_read_b64_tr_b16 v[68:69], v5 offset:40960
    ds_read_b64_tr_b16 v[70:71], v5 offset:41984
    v_mfma_f32_16x16x32_bf16 v[160:163], v[48:51], v[24:27], v[160:163]
    v_mfma_f32_16x16x32_bf16 v[164:167], v[52:55], v[24:27], v[164:167]
    v_mfma_f32_16x16x32_bf16 v[168:171], v[56:59], v[24:27], v[168:171]
    v_mfma_f32_16x16x32_bf16 v[172:175], v[60:63], v[24:27], v[172:175]
    ds_read_b128 v[24:27], v3 offset:36864
    ds_read_b64_tr_b16 v[72:73], v6 offset:40960
    ds_read_b64_tr_b16 v[74:75], v6 offset:41984
    v_mfma_f32_16x16x32_bf16 v[176:179], v[48:51], v[28:31], v[176:179]
    v_mfma_f32_16x16x32_bf16 v[180:183], v[52:55], v[28:31], v[180:183]
    v_mfma_f32_16x16x32_bf16 v[184:187], v[56:59], v[28:31], v[184:187]
    v_mfma_f32_16x16x32_bf16 v[188:191], v[60:63], v[28:31], v[188:191]
    ds_read_b128 v[28:31], v3 offset:38912
    ds_read_b64_tr_b16 v[76:77], v7 offset:40960
    ds_read_b64_tr_b16 v[78:79], v7 offset:41984
    s_waitcnt lgkmcnt(12)
    v_mfma_f32_16x16x32_bf16 v[192:195], v[48:51], v[32:35], v[192:195]
    v_mfma_f32_16x16x32_bf16 v[196:199], v[52:55], v[32:35], v[196:199]
    v_mfma_f32_16x16x32_bf16 v[200:203], v[56:59], v[32:35], v[200:203]
    v_mfma_f32_16x16x32_bf16 v[204:207], v[60:63], v[32:35], v[204:207]
    ds_read_b128 v[32:35], v3 offset:40960
    v_mfma_f32_16x16x32_bf16 v[208:211], v[48:51], v[36:39], v[208:211]
    v_mfma_f32_16x16x32_bf16 v[212:215], v[52:55], v[36:39], v[212:215]
    v_mfma_f32_16x16x32_bf16 v[216:219], v[56:59], v[36:39], v[216:219]
    v_mfma_f32_16x16x32_bf16 v[220:223], v[60:63], v[36:39], v[220:223]
    ds_read_b128 v[36:39], v3 offset:43008
    v_mfma_f32_16x16x32_bf16 v[224:227], v[48:51], v[40:43], v[224:227]
    v_mfma_f32_16x16x32_bf16 v[228:231], v[52:55], v[40:43], v[228:231]
    v_mfma_f32_16x16x32_bf16 v[232:235], v[56:59], v[40:43], v[232:235]
    v_mfma_f32_16x16x32_bf16 v[236:239], v[60:63], v[40:43], v[236:239]
    ds_read_b128 v[40:43], v3 offset:45056
    v_mfma_f32_16x16x32_bf16 v[240:243], v[48:51], v[44:47], v[240:243]
    v_mfma_f32_16x16x32_bf16 v[244:247], v[52:55], v[44:47], v[244:247]
    v_mfma_f32_16x16x32_bf16 v[248:251], v[56:59], v[44:47], v[248:251]
    v_mfma_f32_16x16x32_bf16 v[252:255], v[60:63], v[44:47], v[252:255]
    ds_read_b128 v[44:47], v3 offset:47104
    s_waitcnt lgkmcnt(4)
    v_mfma_f32_16x16x32_bf16 v[128:131], v[64:67], v[16:19], v[128:131]
    v_mfma_f32_16x16x32_bf16 v[132:135], v[68:71], v[16:19], v[132:135]
    v_mfma_f32_16x16x32_bf16 v[136:139], v[72:75], v[16:19], v[136:139]
    v_mfma_f32_16x16x32_bf16 v[140:143], v[76:79], v[16:19], v[140:143]
    v_mfma_f32_16x16x32_bf16 v[144:147], v[64:67], v[20:23], v[144:147]
    v_mfma_f32_16x16x32_bf16 v[148:151], v[68:71], v[20:23], v[148:151]
    v_mfma_f32_16x16x32_bf16 v[152:155], v[72:75], v[20:23], v[152:155]
    v_mfma_f32_16x16x32_bf16 v[156:159], v[76:79], v[20:23], v[156:159]
    s_waitcnt lgkmcnt(0)
    s_cbranch_vccnz Lfw_225
    s_waitcnt vmcnt(1)
Lfw_225:
Lfw_226:
    s_barrier
    ds_read_b128 v[16:19], v2 offset:0
    ds_read_b128 v[20:23], v2 offset:2048
    ds_read_b64_tr_b16 v[48:49], v4 offset:0
    ds_read_b64_tr_b16 v[50:51], v4 offset:1024
    ds_read_b64_tr_b16 v[52:53], v5 offset:0
    ds_read_b64_tr_b16 v[54:55], v5 offset:1024
    v_mfma_f32_16x16x32_bf16 v[160:163], v[64:67], v[24:27], v[160:163]
    v_mfma_f32_16x16x32_bf16 v[164:167], v[68:71], v[24:27], v[164:167]
    v_mfma_f32_16x16x32_bf16 v[168:171], v[72:75], v[24:27], v[168:171]
    v_mfma_f32_16x16x32_bf16 v[172:175], v[76:79], v[24:27], v[172:175]
    ds_read_b128 v[24:27], v2 offset:4096
    ds_read_b64_tr_b16 v[56:57], v6 offset:0
    ds_read_b64_tr_b16 v[58:59], v6 offset:1024
    s_cbranch_vccnz Lnd_227
    s_add_u32 m0, s81, 32768
    s_nop 0
    buffer_load_dwordx4 v8, s[44:47], s64 offen lds
    s_add_u32 m0, s81, 33792
    s_nop 0
    buffer_load_dwordx4 v9, s[44:47], s64 offen lds
Lnd_227:
    v_mfma_f32_16x16x32_bf16 v[176:179], v[64:67], v[28:31], v[176:179]
    v_mfma_f32_16x16x32_bf16 v[180:183], v[68:71], v[28:31], v[180:183]
    v_mfma_f32_16x16x32_bf16 v[184:187], v[72:75], v[28:31], v[184:187]
    v_mfma_f32_16x16x32_bf16 v[188:191], v[76:79], v[28:31], v[188:191]
    ds_read_b128 v[28:31], v2 offset:6144
    ds_read_b64_tr_b16 v[60:61], v7 offset:0
    ds_read_b64_tr_b16 v[62:63], v7 offset:1024
    s_cbranch_vccnz Lnd_228
    s_add_u32 s68, s64, s4
    s_add_u32 m0, s81, 34816
    s_nop 0
    buffer_load_dwordx4 v8, s[44:47], s68 offen lds
    s_add_u32 s68, s64, s4
    s_add_u32 m0, s81, 35840
    s_nop 0
    buffer_load_dwordx4 v9, s[44:47], s68 offen lds
Lnd_228:
    v_mfma_f32_16x16x32_bf16 v[192:195], v[64:67], v[32:35], v[192:195]
    v_mfma_f32_16x16x32_bf16 v[196:199], v[68:71], v[32:35], v[196:199]
    v_mfma_f32_16x16x32_bf16 v[200:203], v[72:75], v[32:35], v[200:203]
    v_mfma_f32_16x16x32_bf16 v[204:207], v[76:79], v[32:35], v[204:207]
    ds_read_b128 v[32:35], v2 offset:8192
    s_cbranch_vccnz Lnd_229
    s_add_u32 m0, s81, 49152
    s_nop 0
    buffer_load_dwordx4 v8, s[44:47], s65 offen lds
    s_add_u32 m0, s81, 50176
    s_nop 0
    buffer_load_dwordx4 v9, s[44:47], s65 offen lds
    s_add_u32 s68, s65, s4
    s_add_u32 m0, s81, 51200
    s_nop 0
    buffer_load_dwordx4 v8, s[44:47], s68 offen lds
Lnd_229:
    v_mfma_f32_16x16x32_bf16 v[208:211], v[64:67], v[36:39], v[208:211]
    v_mfma_f32_16x16x32_bf16 v[212:215], v[68:71], v[36:39], v[212:215]
    v_mfma_f32_16x16x32_bf16 v[216:219], v[72:75], v[36:39], v[216:219]
    v_mfma_f32_16x16x32_bf16 v[220:223], v[76:79], v[36:39], v[220:223]
    ds_read_b128 v[36:39], v2 offset:10240
    s_cbranch_vccnz Lnd_230
    s_add_u32 s68, s65, s4
    s_add_u32 m0, s81, 52224
    s_nop 0
    buffer_load_dwordx4 v9, s[44:47], s68 offen lds
    s_add_u32 m0, s81, 98304
    s_nop 0
    buffer_load_dwordx4 v10, s[48:51], s66 offen lds
    s_add_u32 s68, s66, s5
    s_add_u32 m0, s81, 99328
    s_nop 0
    buffer_load_dwordx4 v10, s[48:51], s68 offen lds
Lnd_230:
    v_mfma_f32_16x16x32_bf16 v[224:227], v[64:67], v[40:43], v[224:227]
    v_mfma_f32_16x16x32_bf16 v[228:231], v[68:71], v[40:43], v[228:231]
    v_mfma_f32_16x16x32_bf16 v[232:235], v[72:75], v[40:43], v[232:235]
    v_mfma_f32_16x16x32_bf16 v[236:239], v[76:79], v[40:43], v[236:239]
    ds_read_b128 v[40:43], v2 offset:12288
    s_cbranch_vccnz Lnd_231
    s_add_u32 m0, s81, 100352
    s_nop 0
    buffer_load_dwordx4 v11, s[48:51], s66 offen lds
    s_add_u32 s68, s66, s5
    s_add_u32 m0, s81, 101376
    s_nop 0
    buffer_load_dwordx4 v11, s[48:51], s68 offen lds
    s_add_u32 m0, s81, 114688
    s_nop 0
    buffer_load_dwordx4 v12, s[96:99], s67 offen lds
Lnd_231:
    v_mfma_f32_16x16x32_bf16 v[240:243], v[64:67], v[44:47], v[240:243]
    v_mfma_f32_16x16x32_bf16 v[244:247], v[68:71], v[44:47], v[244:247]
    v_mfma_f32_16x16x32_bf16 v[248:251], v[72:75], v[44:47], v[248:251]
    v_mfma_f32_16x16x32_bf16 v[252:255], v[76:79], v[44:47], v[252:255]
    ds_read_b128 v[44:47], v2 offset:14336
    s_cbranch_vccnz Lnd_232
    s_add_u32 s68, s67, s6
    s_add_u32 m0, s81, 115712
    s_nop 0
    buffer_load_dwordx4 v12, s[96:99], s68 offen lds
    s_add_u32 m0, s81, 116736
    s_nop 0
    buffer_load_dwordx4 v13, s[96:99], s67 offen lds
    s_add_u32 s68, s67, s6
    s_add_u32 m0, s81, 117760
    s_nop 0
    buffer_load_dwordx4 v13, s[96:99], s68 offen lds
Lnd_232:
    s_add_u32 s64, s64, 128
    s_add_u32 s65, s65, 128
    s_add_u32 s66, s66, s7
    s_add_u32 s67, s67, s8
    buffer_store_dwordx4 v[116:119], v14, s[52:55], s83 offen sc0 sc1
    s_add_u32 s83, s83, s84
    s_waitcnt lgkmcnt(4)
    v_mfma_f32_16x16x32_bf16 v[128:131], v[48:51], v[16:19], v[128:131]
    v_mfma_f32_16x16x32_bf16 v[132:135], v[52:55], v[16:19], v[132:135]
    v_mfma_f32_16x16x32_bf16 v[136:139], v[56:59], v[16:19], v[136:139]
    v_mfma_f32_16x16x32_bf16 v[140:143], v[60:63], v[16:19], v[140:143]
    ds_read_b128 v[16:19], v3 offset:0
    ds_read_b64_tr_b16 v[64:65], v4 offset:8192
    ds_read_b64_tr_b16 v[66:67], v4 offset:9216
    v_mfma_f32_16x16x32_bf16 v[144:147], v[48:51], v[20:23], v[144:147]
    v_mfma_f32_16x16x32_bf16 v[148:151], v[52:55], v[20:23], v[148:151]
    v_mfma_f32_16x16x32_bf16 v[152:155], v[56:59], v[20:23], v[152:155]
    v_mfma_f32_16x16x32_bf16 v[156:159], v[60:63], v[20:23], v[156:159]
    ds_read_b128 v[20:23], v3 offset:2048
    ds_read_b64_tr_b16 v[68:69], v5 offset:8192
    ds_read_b64_tr_b16 v[70:71], v5 offset:9216
    v_mfma_f32_16x16x32_bf16 v[160:163], v[48:51], v[24:27], v[160:163]
    v_mfma_f32_16x16x32_bf16 v[164:167], v[52:55], v[24:27], v[164:167]
    v_mfma_f32_16x16x32_bf16 v[168:171], v[56:59], v[24:27], v[168:171]
    v_mfma_f32_16x16x32_bf16 v[172:175], v[60:63], v[24:27], v[172:175]
    ds_read_b128 v[24:27], v3 offset:4096
    ds_read_b64_tr_b16 v[72:73], v6 offset:8192
    ds_read_b64_tr_b16 v[74:75], v6 offset:9216
    v_mfma_f32_16x16x32_bf16 v[176:179], v[48:51], v[28:31], v[176:179]
    v_mfma_f32_16x16x32_bf16 v[180:183], v[52:55], v[28:31], v[180:183]
    v_mfma_f32_16x16x32_bf16 v[184:187], v[56:59], v[28:31], v[184:187]
    v_mfma_f32_16x16x32_bf16 v[188:191], v[60:63], v[28:31], v[188:191]
    ds_read_b128 v[28:31], v3 offset:6144
    ds_read_b64_tr_b16 v[76:77], v7 offset:8192
    ds_read_b64_tr_b16 v[78:79], v7 offset:9216
    s_waitcnt lgkmcnt(12)
    v_mfma_f32_16x16x32_bf16 v[192:195], v[48:51], v[32:35], v[192:195]
    v_mfma_f32_16x16x32_bf16 v[196:199], v[52:55], v[32:35], v[196:199]
    v_mfma_f32_16x16x32_bf16 v[200:203], v[56:59], v[32:35], v[200:203]
    v_mfma_f32_16x16x32_bf16 v[204:207], v[60:63], v[32:35], v[204:207]
    ds_read_b128 v[32:35], v3 offset:8192
    v_mfma_f32_16x16x32_bf16 v[208:211], v[48:51], v[36:39], v[208:211]
    v_mfma_f32_16x16x32_bf16 v[212:215], v[52:55], v[36:39], v[212:215]
    v_mfma_f32_16x16x32_bf16 v[216:219], v[56:59], v[36:39], v[216:219]
    v_mfma_f32_16x16x32_bf16 v[220:223], v[60:63], v[36:39], v[220:223]
    ds_read_b128 v[36:39], v3 offset:10240
    v_mfma_f32_16x16x32_bf16 v[224:227], v[48:51], v[40:43], v[224:227]
    v_mfma_f32_16x16x32_bf16 v[228:231], v[52:55], v[40:43], v[228:231]
    v_mfma_f32_16x16x32_bf16 v[232:235], v[56:59], v[40:43], v[232:235]
    v_mfma_f32_16x16x32_bf16 v[236:239], v[60:63], v[40:43], v[236:239]
    ds_read_b128 v[40:43], v3 offset:12288
    v_mfma_f32_16x16x32_bf16 v[240:243], v[48:51], v[44:47], v[240:243]
    v_mfma_f32_16x16x32_bf16 v[244:247], v[52:55], v[44:47], v[244:247]
    v_mfma_f32_16x16x32_bf16 v[248:251], v[56:59], v[44:47], v[248:251]
    v_mfma_f32_16x16x32_bf16 v[252:255], v[60:63], v[44:47], v[252:255]
    ds_read_b128 v[44:47], v3 offset:14336
    s_waitcnt lgkmcnt(4)
    v_mfma_f32_16x16x32_bf16 v[128:131], v[64:67], v[16:19], v[128:131]
    v_mfma_f32_16x16x32_bf16 v[132:135], v[68:71], v[16:19], v[132:135]
    v_mfma_f32_16x16x32_bf16 v[136:139], v[72:75], v[16:19], v[136:139]
    v_mfma_f32_16x16x32_bf16 v[140:143], v[76:79], v[16:19], v[140:143]
    v_mfma_f32_16x16x32_bf16 v[144:147], v[64:67], v[20:23], v[144:147]
    v_mfma_f32_16x16x32_bf16 v[148:151], v[68:71], v[20:23], v[148:151]
    v_mfma_f32_16x16x32_bf16 v[152:155], v[72:75], v[20:23], v[152:155]
    v_mfma_f32_16x16x32_bf16 v[156:159], v[76:79], v[20:23], v[156:159]
    s_waitcnt lgkmcnt(0)
    s_cbranch_vccnz Lfw_233
    s_waitcnt vmcnt(1)
Lfw_233:
Lfw_234:
    s_barrier
    ds_read_b128 v[16:19], v2 offset:32768
    ds_read_b128 v[20:23], v2 offset:34816
    ds_read_b64_tr_b16 v[48:49], v4 offset:32768
    ds_read_b64_tr_b16 v[50:51], v4 offset:33792
    ds_read_b64_tr_b16 v[52:53], v5 offset:32768
    ds_read_b64_tr_b16 v[54:55], v5 offset:33792
    v_mfma_f32_16x16x32_bf16 v[160:163], v[64:67], v[24:27], v[160:163]
    v_mfma_f32_16x16x32_bf16 v[164:167], v[68:71], v[24:27], v[164:167]
    v_mfma_f32_16x16x32_bf16 v[168:171], v[72:75], v[24:27], v[168:171]
    v_mfma_f32_16x16x32_bf16 v[172:175], v[76:79], v[24:27], v[172:175]
    ds_read_b128 v[24:27], v2 offset:36864
    ds_read_b64_tr_b16 v[56:57], v6 offset:32768
    ds_read_b64_tr_b16 v[58:59], v6 offset:33792
    s_cbranch_vccnz Lnd_235
    s_add_u32 m0, s81, 0
    s_nop 0
    buffer_load_dwordx4 v8, s[44:47], s64 offen lds
    s_add_u32 m0, s81, 1024
    s_nop 0
    buffer_load_dwordx4 v9, s[44:47], s64 offen lds
Lnd_235:
    v_mfma_f32_16x16x32_bf16 v[176:179], v[64:67], v[28:31], v[176:179]
    v_mfma_f32_16x16x32_bf16 v[180:183], v[68:71], v[28:31], v[180:183]
    v_mfma_f32_16x16x32_bf16 v[184:187], v[72:75], v[28:31], v[184:187]
    v_mfma_f32_16x16x32_bf16 v[188:191], v[76:79], v[28:31], v[188:191]
    ds_read_b128 v[28:31], v2 offset:38912
    ds_read_b64_tr_b16 v[60:61], v7 offset:32768
    ds_read_b64_tr_b16 v[62:63], v7 offset:33792
    s_cbranch_vccnz Lnd_236
    s_add_u32 s68, s64, s4
    s_add_u32 m0, s81, 2048
    s_nop 0
    buffer_load_dwordx4 v8, s[44:47], s68 offen lds
    s_add_u32 s68, s64, s4
    s_add_u32 m0, s81, 3072
    s_nop 0
    buffer_load_dwordx4 v9, s[44:47], s68 offen lds
Lnd_236:
    v_mfma_f32_16x16x32_bf16 v[192:195], v[64:67], v[32:35], v[192:195]
    v_mfma_f32_16x16x32_bf16 v[196:199], v[68:71], v[32:35], v[196:199]
    v_mfma_f32_16x16x32_bf16 v[200:203], v[72:75], v[32:35], v[200:203]
    v_mfma_f32_16x16x32_bf16 v[204:207], v[76:79], v[32:35], v[204:207]
    ds_read_b128 v[32:35], v2 offset:40960
    s_cbranch_vccnz Lnd_237
    s_add_u32 m0, s81, 16384
    s_nop 0
    buffer_load_dwordx4 v8, s[44:47], s65 offen lds
    s_add_u32 m0, s81, 17408
    s_nop 0
    buffer_load_dwordx4 v9, s[44:47], s65 offen lds
    s_add_u32 s68, s65, s4
    s_add_u32 m0, s81, 18432
    s_nop 0
    buffer_load_dwordx4 v8, s[44:47], s68 offen lds
Lnd_237:
    v_mfma_f32_16x16x32_bf16 v[208:211], v[64:67], v[36:39], v[208:211]
    v_mfma_f32_16x16x32_bf16 v[212:215], v[68:71], v[36:39], v[212:215]
    v_mfma_f32_16x16x32_bf16 v[216:219], v[72:75], v[36:39], v[216:219]
    v_mfma_f32_16x16x32_bf16 v[220:223], v[76:79], v[36:39], v[220:223]
    ds_read_b128 v[36:39], v2 offset:43008
    s_cbranch_vccnz Lnd_238
    s_add_u32 s68, s65, s4
    s_add_u32 m0, s81, 19456
    s_nop 0
    buffer_load_dwordx4 v9, s[44:47], s68 offen lds
    s_add_u32 m0, s81, 65536
    s_nop 0
    buffer_load_dwordx4 v10, s[48:51], s66 offen lds
    s_add_u32 s68, s66, s5
    s_add_u32 m0, s81, 66560
    s_nop 0
    buffer_load_dwordx4 v10, s[48:51], s68 offen lds
Lnd_238:
    v_mfma_f32_16x16x32_bf16 v[224:227], v[64:67], v[40:43], v[224:227]
    v_mfma_f32_16x16x32_bf16 v[228:231], v[68:71], v[40:43], v[228:231]
    v_mfma_f32_16x16x32_bf16 v[232:235], v[72:75], v[40:43], v[232:235]
    v_mfma_f32_16x16x32_bf16 v[236:239], v[76:79], v[40:43], v[236:239]
    ds_read_b128 v[40:43], v2 offset:45056
    s_cbranch_vccnz Lnd_239
    s_add_u32 m0, s81, 67584
    s_nop 0
    buffer_load_dwordx4 v11, s[48:51], s66 offen lds
    s_add_u32 s68, s66, s5
    s_add_u32 m0, s81, 68608
    s_nop 0
    buffer_load_dwordx4 v11, s[48:51], s68 offen lds
    s_add_u32 m0, s81, 81920
    s_nop 0
    buffer_load_dwordx4 v12, s[96:99], s67 offen lds
Lnd_239:
    v_mfma_f32_16x16x32_bf16 v[240:243], v[64:67], v[44:47], v[240:243]
    v_mfma_f32_16x16x32_bf16 v[244:247], v[68:71], v[44:47], v[244:247]
    v_mfma_f32_16x16x32_bf16 v[248:251], v[72:75], v[44:47], v[248:251]
    v_mfma_f32_16x16x32_bf16 v[252:255], v[76:79], v[44:47], v[252:255]
    ds_read_b128 v[44:47], v2 offset:47104
    s_cbranch_vccnz Lnd_240
    s_add_u32 s68, s67, s6
    s_add_u32 m0, s81, 82944
    s_nop 0
    buffer_load_dwordx4 v12, s[96:99], s68 offen lds
    s_add_u32 m0, s81, 83968
    s_nop 0
    buffer_load_dwordx4 v13, s[96:99], s67 offen lds
    s_add_u32 s68, s67, s6
    s_add_u32 m0, s81, 84992
    s_nop 0
    buffer_load_dwordx4 v13, s[96:99], s68 offen lds
Lnd_240:
    s_add_u32 s64, s64, 128
    s_add_u32 s65, s65, 128
    s_add_u32 s66, s66, s7
    s_add_u32 s67, s67, s8
    buffer_store_dwordx4 v[120:123], v0, s[52:55], s83 offen sc0 sc1
    s_waitcnt lgkmcnt(4)
    v_mfma_f32_16x16x32_bf16 v[128:131], v[48:51], v[16:19], v[128:131]
    v_mfma_f32_16x16x32_bf16 v[132:135], v[52:55], v[16:19], v[132:135]
    v_mfma_f32_16x16x32_bf16 v[136:139], v[56:59], v[16:19], v[136:139]
    v_mfma_f32_16x16x32_bf16 v[140:143], v[60:63], v[16:19], v[140:143]
    ds_read_b128 v[16:19], v3 offset:32768
    ds_read_b64_tr_b16 v[64:65], v4 offset:40960
    ds_read_b64_tr_b16 v[66:67], v4 offset:41984
    v_mfma_f32_16x16x32_bf16 v[144:147], v[48:51], v[20:23], v[144:147]
    v_mfma_f32_16x16x32_bf16 v[148:151], v[52:55], v[20:23], v[148:151]
    v_mfma_f32_16x16x32_bf16 v[152:155], v[56:59], v[20:23], v[152:155]
    v_mfma_f32_16x16x32_bf16 v[156:159], v[60:63], v[20:23], v[156:159]
    ds_read_b128 v[20:23], v3 offset:34816
    ds_read_b64_tr_b16 v[68:69], v5 offset:40960
    ds_read_b64_tr_b16 v[70:71], v5 offset:41984
    v_mfma_f32_16x16x32_bf16 v[160:163], v[48:51], v[24:27], v[160:163]
    v_mfma_f32_16x16x32_bf16 v[164:167], v[52:55], v[24:27], v[164:167]
    v_mfma_f32_16x16x32_bf16 v[168:171], v[56:59], v[24:27], v[168:171]
    v_mfma_f32_16x16x32_bf16 v[172:175], v[60:63], v[24:27], v[172:175]
    ds_read_b128 v[24:27], v3 offset:36864
    ds_read_b64_tr_b16 v[72:73], v6 offset:40960
    ds_read_b64_tr_b16 v[74:75], v6 offset:41984
    v_mfma_f32_16x16x32_bf16 v[176:179], v[48:51], v[28:31], v[176:179]
    v_mfma_f32_16x16x32_bf16 v[180:183], v[52:55], v[28:31], v[180:183]
    v_mfma_f32_16x16x32_bf16 v[184:187], v[56:59], v[28:31], v[184:187]
    v_mfma_f32_16x16x32_bf16 v[188:191], v[60:63], v[28:31], v[188:191]
    ds_read_b128 v[28:31], v3 offset:38912
    ds_read_b64_tr_b16 v[76:77], v7 offset:40960
    ds_read_b64_tr_b16 v[78:79], v7 offset:41984
    s_waitcnt lgkmcnt(12)
    v_mfma_f32_16x16x32_bf16 v[192:195], v[48:51], v[32:35], v[192:195]
    v_mfma_f32_16x16x32_bf16 v[196:199], v[52:55], v[32:35], v[196:199]
    v_mfma_f32_16x16x32_bf16 v[200:203], v[56:59], v[32:35], v[200:203]
    v_mfma_f32_16x16x32_bf16 v[204:207], v[60:63], v[32:35], v[204:207]
    ds_read_b128 v[32:35], v3 offset:40960
    v_mfma_f32_16x16x32_bf16 v[208:211], v[48:51], v[36:39], v[208:211]
    v_mfma_f32_16x16x32_bf16 v[212:215], v[52:55], v[36:39], v[212:215]
    v_mfma_f32_16x16x32_bf16 v[216:219], v[56:59], v[36:39], v[216:219]
    v_mfma_f32_16x16x32_bf16 v[220:223], v[60:63], v[36:39], v[220:223]
    ds_read_b128 v[36:39], v3 offset:43008
    v_mfma_f32_16x16x32_bf16 v[224:227], v[48:51], v[40:43], v[224:227]
    v_mfma_f32_16x16x32_bf16 v[228:231], v[52:55], v[40:43], v[228:231]
    v_mfma_f32_16x16x32_bf16 v[232:235], v[56:59], v[40:43], v[232:235]
    v_mfma_f32_16x16x32_bf16 v[236:239], v[60:63], v[40:43], v[236:239]
    ds_read_b128 v[40:43], v3 offset:45056
    v_mfma_f32_16x16x32_bf16 v[240:243], v[48:51], v[44:47], v[240:243]
    v_mfma_f32_16x16x32_bf16 v[244:247], v[52:55], v[44:47], v[244:247]
    v_mfma_f32_16x16x32_bf16 v[248:251], v[56:59], v[44:47], v[248:251]
    v_mfma_f32_16x16x32_bf16 v[252:255], v[60:63], v[44:47], v[252:255]
    ds_read_b128 v[44:47], v3 offset:47104
    s_waitcnt lgkmcnt(4)
    v_mfma_f32_16x16x32_bf16 v[128:131], v[64:67], v[16:19], v[128:131]
    v_mfma_f32_16x16x32_bf16 v[132:135], v[68:71], v[16:19], v[132:135]
    v_mfma_f32_16x16x32_bf16 v[136:139], v[72:75], v[16:19], v[136:139]
    v_mfma_f32_16x16x32_bf16 v[140:143], v[76:79], v[16:19], v[140:143]
    v_mfma_f32_16x16x32_bf16 v[144:147], v[64:67], v[20:23], v[144:147]
    v_mfma_f32_16x16x32_bf16 v[148:151], v[68:71], v[20:23], v[148:151]
    v_mfma_f32_16x16x32_bf16 v[152:155], v[72:75], v[20:23], v[152:155]
    v_mfma_f32_16x16x32_bf16 v[156:159], v[76:79], v[20:23], v[156:159]
    s_waitcnt lgkmcnt(0)
    s_cbranch_vccnz Lfw_241
    s_waitcnt vmcnt(1)
Lfw_241:
Lfw_242:
    s_barrier
    ds_read_b128 v[16:19], v2 offset:0
    ds_read_b128 v[20:23], v2 offset:2048
    ds_read_b64_tr_b16 v[48:49], v4 offset:0
    ds_read_b64_tr_b16 v[50:51], v4 offset:1024
    ds_read_b64_tr_b16 v[52:53], v5 offset:0
    ds_read_b64_tr_b16 v[54:55], v5 offset:1024
    v_mfma_f32_16x16x32_bf16 v[160:163], v[64:67], v[24:27], v[160:163]
    v_mfma_f32_16x16x32_bf16 v[164:167], v[68:71], v[24:27], v[164:167]
    v_mfma_f32_16x16x32_bf16 v[168:171], v[72:75], v[24:27], v[168:171]
    v_mfma_f32_16x16x32_bf16 v[172:175], v[76:79], v[24:27], v[172:175]
    ds_read_b128 v[24:27], v2 offset:4096
    ds_read_b64_tr_b16 v[56:57], v6 offset:0
    ds_read_b64_tr_b16 v[58:59], v6 offset:1024
    s_cbranch_vccnz Lnd_243
    s_add_u32 m0, s81, 32768
    s_nop 0
    buffer_load_dwordx4 v8, s[44:47], s64 offen lds
    s_add_u32 m0, s81, 33792
    s_nop 0
    buffer_load_dwordx4 v9, s[44:47], s64 offen lds
Lnd_243:
    v_mfma_f32_16x16x32_bf16 v[176:179], v[64:67], v[28:31], v[176:179]
    v_mfma_f32_16x16x32_bf16 v[180:183], v[68:71], v[28:31], v[180:183]
    v_mfma_f32_16x16x32_bf16 v[184:187], v[72:75], v[28:31], v[184:187]
    v_mfma_f32_16x16x32_bf16 v[188:191], v[76:79], v[28:31], v[188:191]
    ds_read_b128 v[28:31], v2 offset:6144
    ds_read_b64_tr_b16 v[60:61], v7 offset:0
    ds_read_b64_tr_b16 v[62:63], v7 offset:1024
    s_cbranch_vccnz Lnd_244
    s_add_u32 s68, s64, s4
    s_add_u32 m0, s81, 34816
    s_nop 0
    buffer_load_dwordx4 v8, s[44:47], s68 offen lds
    s_add_u32 s68, s64, s4
    s_add_u32 m0, s81, 35840
    s_nop 0
    buffer_load_dwordx4 v9, s[44:47], s68 offen lds
Lnd_244:
    v_mfma_f32_16x16x32_bf16 v[192:195], v[64:67], v[32:35], v[192:195]
    v_mfma_f32_16x16x32_bf16 v[196:199], v[68:71], v[32:35], v[196:199]
    v_mfma_f32_16x16x32_bf16 v[200:203], v[72:75], v[32:35], v[200:203]
    v_mfma_f32_16x16x32_bf16 v[204:207], v[76:79], v[32:35], v[204:207]
    ds_read_b128 v[32:35], v2 offset:8192
    s_cbranch_vccnz Lnd_245
    s_add_u32 m0, s81, 49152
    s_nop 0
    buffer_load_dwordx4 v8, s[44:47], s65 offen lds
    s_add_u32 m0, s81, 50176
    s_nop 0
    buffer_load_dwordx4 v9, s[44:47], s65 offen lds
    s_add_u32 s68, s65, s4
    s_add_u32 m0, s81, 51200
    s_nop 0
    buffer_load_dwordx4 v8, s[44:47], s68 offen lds
Lnd_245:
    v_mfma_f32_16x16x32_bf16 v[208:211], v[64:67], v[36:39], v[208:211]
    v_mfma_f32_16x16x32_bf16 v[212:215], v[68:71], v[36:39], v[212:215]
    v_mfma_f32_16x16x32_bf16 v[216:219], v[72:75], v[36:39], v[216:219]
    v_mfma_f32_16x16x32_bf16 v[220:223], v[76:79], v[36:39], v[220:223]
    ds_read_b128 v[36:39], v2 offset:10240
    s_cbranch_vccnz Lnd_246
    s_add_u32 s68, s65, s4
    s_add_u32 m0, s81, 52224
    s_nop 0
    buffer_load_dwordx4 v9, s[44:47], s68 offen lds
    s_add_u32 m0, s81, 98304
    s_nop 0
    buffer_load_dwordx4 v10, s[48:51], s66 offen lds
    s_add_u32 s68, s66, s5
    s_add_u32 m0, s81, 99328
    s_nop 0
    buffer_load_dwordx4 v10, s[48:51], s68 offen lds
Lnd_246:
    v_mfma_f32_16x16x32_bf16 v[224:227], v[64:67], v[40:43], v[224:227]
    v_mfma_f32_16x16x32_bf16 v[228:231], v[68:71], v[40:43], v[228:231]
    v_mfma_f32_16x16x32_bf16 v[232:235], v[72:75], v[40:43], v[232:235]
    v_mfma_f32_16x16x32_bf16 v[236:239], v[76:79], v[40:43], v[236:239]
    ds_read_b128 v[40:43], v2 offset:12288
    s_cbranch_vccnz Lnd_247
    s_add_u32 m0, s81, 100352
    s_nop 0
    buffer_load_dwordx4 v11, s[48:51], s66 offen lds
    s_add_u32 s68, s66, s5
    s_add_u32 m0, s81, 101376
    s_nop 0
    buffer_load_dwordx4 v11, s[48:51], s68 offen lds
    s_add_u32 m0, s81, 114688
    s_nop 0
    buffer_load_dwordx4 v12, s[96:99], s67 offen lds
Lnd_247:
    v_mfma_f32_16x16x32_bf16 v[240:243], v[64:67], v[44:47], v[240:243]
    v_mfma_f32_16x16x32_bf16 v[244:247], v[68:71], v[44:47], v[244:247]
    v_mfma_f32_16x16x32_bf16 v[248:251], v[72:75], v[44:47], v[248:251]
    v_mfma_f32_16x16x32_bf16 v[252:255], v[76:79], v[44:47], v[252:255]
    ds_read_b128 v[44:47], v2 offset:14336
    s_cbranch_vccnz Lnd_248
    s_add_u32 s68, s67, s6
    s_add_u32 m0, s81, 115712
    s_nop 0
    buffer_load_dwordx4 v12, s[96:99], s68 offen lds
    s_add_u32 m0, s81, 116736
    s_nop 0
    buffer_load_dwordx4 v13, s[96:99], s67 offen lds
    s_add_u32 s68, s67, s6
    s_add_u32 m0, s81, 117760
    s_nop 0
    buffer_load_dwordx4 v13, s[96:99], s68 offen lds
Lnd_248:
    s_add_u32 s64, s64, 128
    s_add_u32 s65, s65, 128
    s_add_u32 s66, s66, s7
    s_add_u32 s67, s67, s8
    buffer_store_dwordx4 v[124:127], v14, s[52:55], s83 offen sc0 sc1
    s_add_u32 s83, s83, s84
    s_waitcnt lgkmcnt(4)
    v_mfma_f32_16x16x32_bf16 v[128:131], v[48:51], v[16:19], v[128:131]
    v_mfma_f32_16x16x32_bf16 v[132:135], v[52:55], v[16:19], v[132:135]
    v_mfma_f32_16x16x32_bf16 v[136:139], v[56:59], v[16:19], v[136:139]
    v_mfma_f32_16x16x32_bf16 v[140:143], v[60:63], v[16:19], v[140:143]
    ds_read_b128 v[16:19], v3 offset:0
    ds_read_b64_tr_b16 v[64:65], v4 offset:8192
    ds_read_b64_tr_b16 v[66:67], v4 offset:9216
    v_mfma_f32_16x16x32_bf16 v[144:147], v[48:51], v[20:23], v[144:147]
    v_mfma_f32_16x16x32_bf16 v[148:151], v[52:55], v[20:23], v[148:151]
    v_mfma_f32_16x16x32_bf16 v[152:155], v[56:59], v[20:23], v[152:155]
    v_mfma_f32_16x16x32_bf16 v[156:159], v[60:63], v[20:23], v[156:159]
    ds_read_b128 v[20:23], v3 offset:2048
    ds_read_b64_tr_b16 v[68:69], v5 offset:8192
    ds_read_b64_tr_b16 v[70:71], v5 offset:9216
    v_mfma_f32_16x16x32_bf16 v[160:163], v[48:51], v[24:27], v[160:163]
    v_mfma_f32_16x16x32_bf16 v[164:167], v[52:55], v[24:27], v[164:167]
    v_mfma_f32_16x16x32_bf16 v[168:171], v[56:59], v[24:27], v[168:171]
    v_mfma_f32_16x16x32_bf16 v[172:175], v[60:63], v[24:27], v[172:175]
    ds_read_b128 v[24:27], v3 offset:4096
    ds_read_b64_tr_b16 v[72:73], v6 offset:8192
    ds_read_b64_tr_b16 v[74:75], v6 offset:9216
    v_mfma_f32_16x16x32_bf16 v[176:179], v[48:51], v[28:31], v[176:179]
    v_mfma_f32_16x16x32_bf16 v[180:183], v[52:55], v[28:31], v[180:183]
    v_mfma_f32_16x16x32_bf16 v[184:187], v[56:59], v[28:31], v[184:187]
    v_mfma_f32_16x16x32_bf16 v[188:191], v[60:63], v[28:31], v[188:191]
    ds_read_b128 v[28:31], v3 offset:6144
    ds_read_b64_tr_b16 v[76:77], v7 offset:8192
    ds_read_b64_tr_b16 v[78:79], v7 offset:9216
    s_waitcnt lgkmcnt(12)
    v_mfma_f32_16x16x32_bf16 v[192:195], v[48:51], v[32:35], v[192:195]
    v_mfma_f32_16x16x32_bf16 v[196:199], v[52:55], v[32:35], v[196:199]
    v_mfma_f32_16x16x32_bf16 v[200:203], v[56:59], v[32:35], v[200:203]
    v_mfma_f32_16x16x32_bf16 v[204:207], v[60:63], v[32:35], v[204:207]
    ds_read_b128 v[32:35], v3 offset:8192
    v_mfma_f32_16x16x32_bf16 v[208:211], v[48:51], v[36:39], v[208:211]
    v_mfma_f32_16x16x32_bf16 v[212:215], v[52:55], v[36:39], v[212:215]
    v_mfma_f32_16x16x32_bf16 v[216:219], v[56:59], v[36:39], v[216:219]
    v_mfma_f32_16x16x32_bf16 v[220:223], v[60:63], v[36:39], v[220:223]
    ds_read_b128 v[36:39], v3 offset:10240
    v_mfma_f32_16x16x32_bf16 v[224:227], v[48:51], v[40:43], v[224:227]
    v_mfma_f32_16x16x32_bf16 v[228:231], v[52:55], v[40:43], v[228:231]
    v_mfma_f32_16x16x32_bf16 v[232:235], v[56:59], v[40:43], v[232:235]
    v_mfma_f32_16x16x32_bf16 v[236:239], v[60:63], v[40:43], v[236:239]
    ds_read_b128 v[40:43], v3 offset:12288
    v_mfma_f32_16x16x32_bf16 v[240:243], v[48:51], v[44:47], v[240:243]
    v_mfma_f32_16x16x32_bf16 v[244:247], v[52:55], v[44:47], v[244:247]
    v_mfma_f32_16x16x32_bf16 v[248:251], v[56:59], v[44:47], v[248:251]
    v_mfma_f32_16x16x32_bf16 v[252:255], v[60:63], v[44:47], v[252:255]
    ds_read_b128 v[44:47], v3 offset:14336
    s_waitcnt lgkmcnt(4)
    v_mfma_f32_16x16x32_bf16 v[128:131], v[64:67], v[16:19], v[128:131]
    v_mfma_f32_16x16x32_bf16 v[132:135], v[68:71], v[16:19], v[132:135]
    v_mfma_f32_16x16x32_bf16 v[136:139], v[72:75], v[16:19], v[136:139]
    v_mfma_f32_16x16x32_bf16 v[140:143], v[76:79], v[16:19], v[140:143]
    v_mfma_f32_16x16x32_bf16 v[144:147], v[64:67], v[20:23], v[144:147]
    v_mfma_f32_16x16x32_bf16 v[148:151], v[68:71], v[20:23], v[148:151]
    v_mfma_f32_16x16x32_bf16 v[152:155], v[72:75], v[20:23], v[152:155]
    v_mfma_f32_16x16x32_bf16 v[156:159], v[76:79], v[20:23], v[156:159]
    s_waitcnt lgkmcnt(0)
    s_cbranch_vccnz Lfw_249
    s_waitcnt vmcnt(1)
Lfw_249:
Lfw_250:
    s_barrier
    ds_read_b128 v[16:19], v2 offset:32768
    ds_read_b128 v[20:23], v2 offset:34816
    ds_read_b64_tr_b16 v[48:49], v4 offset:32768
    ds_read_b64_tr_b16 v[50:51], v4 offset:33792
    ds_read_b64_tr_b16 v[52:53], v5 offset:32768
    ds_read_b64_tr_b16 v[54:55], v5 offset:33792
    v_mfma_f32_16x16x32_bf16 v[160:163], v[64:67], v[24:27], v[160:163]
    v_mfma_f32_16x16x32_bf16 v[164:167], v[68:71], v[24:27], v[164:167]
    v_mfma_f32_16x16x32_bf16 v[168:171], v[72:75], v[24:27], v[168:171]
    v_mfma_f32_16x16x32_bf16 v[172:175], v[76:79], v[24:27], v[172:175]
    ds_read_b128 v[24:27], v2 offset:36864
    ds_read_b64_tr_b16 v[56:57], v6 offset:32768
    ds_read_b64_tr_b16 v[58:59], v6 offset:33792
    s_cbranch_vccnz Lnd_251
    s_add_u32 m0, s81, 0
    s_nop 0
    buffer_load_dwordx4 v8, s[44:47], s64 offen lds
    s_add_u32 m0, s81, 1024
    s_nop 0
    buffer_load_dwordx4 v9, s[44:47], s64 offen lds
Lnd_251:
    v_mfma_f32_16x16x32_bf16 v[176:179], v[64:67], v[28:31], v[176:179]
    v_mfma_f32_16x16x32_bf16 v[180:183], v[68:71], v[28:31], v[180:183]
    v_mfma_f32_16x16x32_bf16 v[184:187], v[72:75], v[28:31], v[184:187]
    v_mfma_f32_16x16x32_bf16 v[188:191], v[76:79], v[28:31], v[188:191]
    ds_read_b128 v[28:31], v2 offset:38912
    ds_read_b64_tr_b16 v[60:61], v7 offset:32768
    ds_read_b64_tr_b16 v[62:63], v7 offset:33792
    s_cbranch_vccnz Lnd_252
    s_add_u32 s68, s64, s4
    s_add_u32 m0, s81, 2048
    s_nop 0
    buffer_load_dwordx4 v8, s[44:47], s68 offen lds
    s_add_u32 s68, s64, s4
    s_add_u32 m0, s81, 3072
    s_nop 0
    buffer_load_dwordx4 v9, s[44:47], s68 offen lds
Lnd_252:
    v_mfma_f32_16x16x32_bf16 v[192:195], v[64:67], v[32:35], v[192:195]
    v_mfma_f32_16x16x32_bf16 v[196:199], v[68:71], v[32:35], v[196:199]
    v_mfma_f32_16x16x32_bf16 v[200:203], v[72:75], v[32:35], v[200:203]
    v_mfma_f32_16x16x32_bf16 v[204:207], v[76:79], v[32:35], v[204:207]
    ds_read_b128 v[32:35], v2 offset:40960
    s_cbranch_vccnz Lnd_253
    s_add_u32 m0, s81, 16384
    s_nop 0
    buffer_load_dwordx4 v8, s[44:47], s65 offen lds
    s_add_u32 m0, s81, 17408
    s_nop 0
    buffer_load_dwordx4 v9, s[44:47], s65 offen lds
    s_add_u32 s68, s65, s4
    s_add_u32 m0, s81, 18432
    s_nop 0
    buffer_load_dwordx4 v8, s[44:47], s68 offen lds
Lnd_253:
    v_mfma_f32_16x16x32_bf16 v[208:211], v[64:67], v[36:39], v[208:211]
    v_mfma_f32_16x16x32_bf16 v[212:215], v[68:71], v[36:39], v[212:215]
    v_mfma_f32_16x16x32_bf16 v[216:219], v[72:75], v[36:39], v[216:219]
    v_mfma_f32_16x16x32_bf16 v[220:223], v[76:79], v[36:39], v[220:223]
    ds_read_b128 v[36:39], v2 offset:43008
    s_cbranch_vccnz Lnd_254
    s_add_u32 s68, s65, s4
    s_add_u32 m0, s81, 19456
    s_nop 0
    buffer_load_dwordx4 v9, s[44:47], s68 offen lds
    s_add_u32 m0, s81, 65536
    s_nop 0
    buffer_load_dwordx4 v10, s[48:51], s66 offen lds
    s_add_u32 s68, s66, s5
    s_add_u32 m0, s81, 66560
    s_nop 0
    buffer_load_dwordx4 v10, s[48:51], s68 offen lds
Lnd_254:
    v_mfma_f32_16x16x32_bf16 v[224:227], v[64:67], v[40:43], v[224:227]
    v_mfma_f32_16x16x32_bf16 v[228:231], v[68:71], v[40:43], v[228:231]
    v_mfma_f32_16x16x32_bf16 v[232:235], v[72:75], v[40:43], v[232:235]
    v_mfma_f32_16x16x32_bf16 v[236:239], v[76:79], v[40:43], v[236:239]
    ds_read_b128 v[40:43], v2 offset:45056
    s_cbranch_vccnz Lnd_255
    s_add_u32 m0, s81, 67584
    s_nop 0
    buffer_load_dwordx4 v11, s[48:51], s66 offen lds
    s_add_u32 s68, s66, s5
    s_add_u32 m0, s81, 68608
    s_nop 0
    buffer_load_dwordx4 v11, s[48:51], s68 offen lds
    s_add_u32 m0, s81, 81920
    s_nop 0
    buffer_load_dwordx4 v12, s[96:99], s67 offen lds
Lnd_255:
    v_mfma_f32_16x16x32_bf16 v[240:243], v[64:67], v[44:47], v[240:243]
    v_mfma_f32_16x16x32_bf16 v[244:247], v[68:71], v[44:47], v[244:247]
    v_mfma_f32_16x16x32_bf16 v[248:251], v[72:75], v[44:47], v[248:251]
    v_mfma_f32_16x16x32_bf16 v[252:255], v[76:79], v[44:47], v[252:255]
    ds_read_b128 v[44:47], v2 offset:47104
    s_cbranch_vccnz Lnd_256
    s_add_u32 s68, s67, s6
    s_add_u32 m0, s81, 82944
    s_nop 0
    buffer_load_dwordx4 v12, s[96:99], s68 offen lds
    s_add_u32 m0, s81, 83968
    s_nop 0
    buffer_load_dwordx4 v13, s[96:99], s67 offen lds
    s_add_u32 s68, s67, s6
    s_add_u32 m0, s81, 84992
    s_nop 0
    buffer_load_dwordx4 v13, s[96:99], s68 offen lds
Lnd_256:
    s_add_u32 s64, s64, 128
    s_add_u32 s65, s65, 128
    s_add_u32 s66, s66, s7
    s_add_u32 s67, s67, s8
    buffer_store_dwordx4 v[80:83], v0, s[52:55], s83 offen sc0 sc1
    s_waitcnt lgkmcnt(4)
    v_mfma_f32_16x16x32_bf16 v[128:131], v[48:51], v[16:19], v[128:131]
    v_mfma_f32_16x16x32_bf16 v[132:135], v[52:55], v[16:19], v[132:135]
    v_mfma_f32_16x16x32_bf16 v[136:139], v[56:59], v[16:19], v[136:139]
    v_mfma_f32_16x16x32_bf16 v[140:143], v[60:63], v[16:19], v[140:143]
    ds_read_b128 v[16:19], v3 offset:32768
    ds_read_b64_tr_b16 v[64:65], v4 offset:40960
    ds_read_b64_tr_b16 v[66:67], v4 offset:41984
    v_mfma_f32_16x16x32_bf16 v[144:147], v[48:51], v[20:23], v[144:147]
    v_mfma_f32_16x16x32_bf16 v[148:151], v[52:55], v[20:23], v[148:151]
    v_mfma_f32_16x16x32_bf16 v[152:155], v[56:59], v[20:23], v[152:155]
    v_mfma_f32_16x16x32_bf16 v[156:159], v[60:63], v[20:23], v[156:159]
    ds_read_b128 v[20:23], v3 offset:34816
    ds_read_b64_tr_b16 v[68:69], v5 offset:40960
    ds_read_b64_tr_b16 v[70:71], v5 offset:41984
    v_mfma_f32_16x16x32_bf16 v[160:163], v[48:51], v[24:27], v[160:163]
    v_mfma_f32_16x16x32_bf16 v[164:167], v[52:55], v[24:27], v[164:167]
    v_mfma_f32_16x16x32_bf16 v[168:171], v[56:59], v[24:27], v[168:171]
    v_mfma_f32_16x16x32_bf16 v[172:175], v[60:63], v[24:27], v[172:175]
    ds_read_b128 v[24:27], v3 offset:36864
    ds_read_b64_tr_b16 v[72:73], v6 offset:40960
    ds_read_b64_tr_b16 v[74:75], v6 offset:41984
    v_mfma_f32_16x16x32_bf16 v[176:179], v[48:51], v[28:31], v[176:179]
    v_mfma_f32_16x16x32_bf16 v[180:183], v[52:55], v[28:31], v[180:183]
    v_mfma_f32_16x16x32_bf16 v[184:187], v[56:59], v[28:31], v[184:187]
    v_mfma_f32_16x16x32_bf16 v[188:191], v[60:63], v[28:31], v[188:191]
    ds_read_b128 v[28:31], v3 offset:38912
    ds_read_b64_tr_b16 v[76:77], v7 offset:40960
    ds_read_b64_tr_b16 v[78:79], v7 offset:41984
    s_waitcnt lgkmcnt(12)
    v_mfma_f32_16x16x32_bf16 v[192:195], v[48:51], v[32:35], v[192:195]
    v_mfma_f32_16x16x32_bf16 v[196:199], v[52:55], v[32:35], v[196:199]
    v_mfma_f32_16x16x32_bf16 v[200:203], v[56:59], v[32:35], v[200:203]
    v_mfma_f32_16x16x32_bf16 v[204:207], v[60:63], v[32:35], v[204:207]
    ds_read_b128 v[32:35], v3 offset:40960
    v_mfma_f32_16x16x32_bf16 v[208:211], v[48:51], v[36:39], v[208:211]
    v_mfma_f32_16x16x32_bf16 v[212:215], v[52:55], v[36:39], v[212:215]
    v_mfma_f32_16x16x32_bf16 v[216:219], v[56:59], v[36:39], v[216:219]
    v_mfma_f32_16x16x32_bf16 v[220:223], v[60:63], v[36:39], v[220:223]
    ds_read_b128 v[36:39], v3 offset:43008
    v_mfma_f32_16x16x32_bf16 v[224:227], v[48:51], v[40:43], v[224:227]
    v_mfma_f32_16x16x32_bf16 v[228:231], v[52:55], v[40:43], v[228:231]
    v_mfma_f32_16x16x32_bf16 v[232:235], v[56:59], v[40:43], v[232:235]
    v_mfma_f32_16x16x32_bf16 v[236:239], v[60:63], v[40:43], v[236:239]
    ds_read_b128 v[40:43], v3 offset:45056
    v_mfma_f32_16x16x32_bf16 v[240:243], v[48:51], v[44:47], v[240:243]
    v_mfma_f32_16x16x32_bf16 v[244:247], v[52:55], v[44:47], v[244:247]
    v_mfma_f32_16x16x32_bf16 v[248:251], v[56:59], v[44:47], v[248:251]
    v_mfma_f32_16x16x32_bf16 v[252:255], v[60:63], v[44:47], v[252:255]
    ds_read_b128 v[44:47], v3 offset:47104
    s_waitcnt lgkmcnt(4)
    v_mfma_f32_16x16x32_bf16 v[128:131], v[64:67], v[16:19], v[128:131]
    v_mfma_f32_16x16x32_bf16 v[132:135], v[68:71], v[16:19], v[132:135]
    v_mfma_f32_16x16x32_bf16 v[136:139], v[72:75], v[16:19], v[136:139]
    v_mfma_f32_16x16x32_bf16 v[140:143], v[76:79], v[16:19], v[140:143]
    v_mfma_f32_16x16x32_bf16 v[144:147], v[64:67], v[20:23], v[144:147]
    v_mfma_f32_16x16x32_bf16 v[148:151], v[68:71], v[20:23], v[148:151]
    v_mfma_f32_16x16x32_bf16 v[152:155], v[72:75], v[20:23], v[152:155]
    v_mfma_f32_16x16x32_bf16 v[156:159], v[76:79], v[20:23], v[156:159]
    s_waitcnt lgkmcnt(0)
    s_cbranch_vccnz Lfw_257
    s_waitcnt vmcnt(1)
Lfw_257:
Lfw_258:
    s_barrier
    ds_read_b128 v[16:19], v2 offset:0
    ds_read_b128 v[20:23], v2 offset:2048
    ds_read_b64_tr_b16 v[48:49], v4 offset:0
    ds_read_b64_tr_b16 v[50:51], v4 offset:1024
    ds_read_b64_tr_b16 v[52:53], v5 offset:0
    ds_read_b64_tr_b16 v[54:55], v5 offset:1024
    v_mfma_f32_16x16x32_bf16 v[160:163], v[64:67], v[24:27], v[160:163]
    v_mfma_f32_16x16x32_bf16 v[164:167], v[68:71], v[24:27], v[164:167]
    v_mfma_f32_16x16x32_bf16 v[168:171], v[72:75], v[24:27], v[168:171]
    v_mfma_f32_16x16x32_bf16 v[172:175], v[76:79], v[24:27], v[172:175]
    ds_read_b128 v[24:27], v2 offset:4096
    ds_read_b64_tr_b16 v[56:57], v6 offset:0
    ds_read_b64_tr_b16 v[58:59], v6 offset:1024
    s_cbranch_vccnz Lnd_259
    s_add_u32 m0, s81, 32768
    s_nop 0
    buffer_load_dwordx4 v8, s[44:47], s64 offen lds
    s_add_u32 m0, s81, 33792
    s_nop 0
    buffer_load_dwordx4 v9, s[44:47], s64 offen lds
Lnd_259:
    v_mfma_f32_16x16x32_bf16 v[176:179], v[64:67], v[28:31], v[176:179]
    v_mfma_f32_16x16x32_bf16 v[180:183], v[68:71], v[28:31], v[180:183]
    v_mfma_f32_16x16x32_bf16 v[184:187], v[72:75], v[28:31], v[184:187]
    v_mfma_f32_16x16x32_bf16 v[188:191], v[76:79], v[28:31], v[188:191]
    ds_read_b128 v[28:31], v2 offset:6144
    ds_read_b64_tr_b16 v[60:61], v7 offset:0
    ds_read_b64_tr_b16 v[62:63], v7 offset:1024
    s_cbranch_vccnz Lnd_260
    s_add_u32 s68, s64, s4
    s_add_u32 m0, s81, 34816
    s_nop 0
    buffer_load_dwordx4 v8, s[44:47], s68 offen lds
    s_add_u32 s68, s64, s4
    s_add_u32 m0, s81, 35840
    s_nop 0
    buffer_load_dwordx4 v9, s[44:47], s68 offen lds
Lnd_260:
    v_mfma_f32_16x16x32_bf16 v[192:195], v[64:67], v[32:35], v[192:195]
    v_mfma_f32_16x16x32_bf16 v[196:199], v[68:71], v[32:35], v[196:199]
    v_mfma_f32_16x16x32_bf16 v[200:203], v[72:75], v[32:35], v[200:203]
    v_mfma_f32_16x16x32_bf16 v[204:207], v[76:79], v[32:35], v[204:207]
    ds_read_b128 v[32:35], v2 offset:8192
    s_cbranch_vccnz Lnd_261
    s_add_u32 m0, s81, 49152
    s_nop 0
    buffer_load_dwordx4 v8, s[44:47], s65 offen lds
    s_add_u32 m0, s81, 50176
    s_nop 0
    buffer_load_dwordx4 v9, s[44:47], s65 offen lds
    s_add_u32 s68, s65, s4
    s_add_u32 m0, s81, 51200
    s_nop 0
    buffer_load_dwordx4 v8, s[44:47], s68 offen lds
Lnd_261:
    v_mfma_f32_16x16x32_bf16 v[208:211], v[64:67], v[36:39], v[208:211]
    v_mfma_f32_16x16x32_bf16 v[212:215], v[68:71], v[36:39], v[212:215]
    v_mfma_f32_16x16x32_bf16 v[216:219], v[72:75], v[36:39], v[216:219]
    v_mfma_f32_16x16x32_bf16 v[220:223], v[76:79], v[36:39], v[220:223]
    ds_read_b128 v[36:39], v2 offset:10240
    s_cbranch_vccnz Lnd_262
    s_add_u32 s68, s65, s4
    s_add_u32 m0, s81, 52224
    s_nop 0
    buffer_load_dwordx4 v9, s[44:47], s68 offen lds
    s_add_u32 m0, s81, 98304
    s_nop 0
    buffer_load_dwordx4 v10, s[48:51], s66 offen lds
    s_add_u32 s68, s66, s5
    s_add_u32 m0, s81, 99328
    s_nop 0
    buffer_load_dwordx4 v10, s[48:51], s68 offen lds
Lnd_262:
    v_mfma_f32_16x16x32_bf16 v[224:227], v[64:67], v[40:43], v[224:227]
    v_mfma_f32_16x16x32_bf16 v[228:231], v[68:71], v[40:43], v[228:231]
    v_mfma_f32_16x16x32_bf16 v[232:235], v[72:75], v[40:43], v[232:235]
    v_mfma_f32_16x16x32_bf16 v[236:239], v[76:79], v[40:43], v[236:239]
    ds_read_b128 v[40:43], v2 offset:12288
    s_cbranch_vccnz Lnd_263
    s_add_u32 m0, s81, 100352
    s_nop 0
    buffer_load_dwordx4 v11, s[48:51], s66 offen lds
    s_add_u32 s68, s66, s5
    s_add_u32 m0, s81, 101376
    s_nop 0
    buffer_load_dwordx4 v11, s[48:51], s68 offen lds
    s_add_u32 m0, s81, 114688
    s_nop 0
    buffer_load_dwordx4 v12, s[96:99], s67 offen lds
Lnd_263:
    v_mfma_f32_16x16x32_bf16 v[240:243], v[64:67], v[44:47], v[240:243]
    v_mfma_f32_16x16x32_bf16 v[244:247], v[68:71], v[44:47], v[244:247]
    v_mfma_f32_16x16x32_bf16 v[248:251], v[72:75], v[44:47], v[248:251]
    v_mfma_f32_16x16x32_bf16 v[252:255], v[76:79], v[44:47], v[252:255]
    ds_read_b128 v[44:47], v2 offset:14336
    s_cbranch_vccnz Lnd_264
    s_add_u32 s68, s67, s6
    s_add_u32 m0, s81, 115712
    s_nop 0
    buffer_load_dwordx4 v12, s[96:99], s68 offen lds
    s_add_u32 m0, s81, 116736
    s_nop 0
    buffer_load_dwordx4 v13, s[96:99], s67 offen lds
    s_add_u32 s68, s67, s6
    s_add_u32 m0, s81, 117760
    s_nop 0
    buffer_load_dwordx4 v13, s[96:99], s68 offen lds
Lnd_264:
    s_add_u32 s64, s64, 128
    s_add_u32 s65, s65, 128
    s_add_u32 s66, s66, s7
    s_add_u32 s67, s67, s8
    buffer_store_dwordx4 v[84:87], v14, s[52:55], s83 offen sc0 sc1
    s_add_u32 s83, s83, s84
    s_waitcnt lgkmcnt(4)
    v_mfma_f32_16x16x32_bf16 v[128:131], v[48:51], v[16:19], v[128:131]
    v_mfma_f32_16x16x32_bf16 v[132:135], v[52:55], v[16:19], v[132:135]
    v_mfma_f32_16x16x32_bf16 v[136:139], v[56:59], v[16:19], v[136:139]
    v_mfma_f32_16x16x32_bf16 v[140:143], v[60:63], v[16:19], v[140:143]
    ds_read_b128 v[16:19], v3 offset:0
    ds_read_b64_tr_b16 v[64:65], v4 offset:8192
    ds_read_b64_tr_b16 v[66:67], v4 offset:9216
    v_mfma_f32_16x16x32_bf16 v[144:147], v[48:51], v[20:23], v[144:147]
    v_mfma_f32_16x16x32_bf16 v[148:151], v[52:55], v[20:23], v[148:151]
    v_mfma_f32_16x16x32_bf16 v[152:155], v[56:59], v[20:23], v[152:155]
    v_mfma_f32_16x16x32_bf16 v[156:159], v[60:63], v[20:23], v[156:159]
    ds_read_b128 v[20:23], v3 offset:2048
    ds_read_b64_tr_b16 v[68:69], v5 offset:8192
    ds_read_b64_tr_b16 v[70:71], v5 offset:9216
    v_mfma_f32_16x16x32_bf16 v[160:163], v[48:51], v[24:27], v[160:163]
    v_mfma_f32_16x16x32_bf16 v[164:167], v[52:55], v[24:27], v[164:167]
    v_mfma_f32_16x16x32_bf16 v[168:171], v[56:59], v[24:27], v[168:171]
    v_mfma_f32_16x16x32_bf16 v[172:175], v[60:63], v[24:27], v[172:175]
    ds_read_b128 v[24:27], v3 offset:4096
    ds_read_b64_tr_b16 v[72:73], v6 offset:8192
    ds_read_b64_tr_b16 v[74:75], v6 offset:9216
    v_mfma_f32_16x16x32_bf16 v[176:179], v[48:51], v[28:31], v[176:179]
    v_mfma_f32_16x16x32_bf16 v[180:183], v[52:55], v[28:31], v[180:183]
    v_mfma_f32_16x16x32_bf16 v[184:187], v[56:59], v[28:31], v[184:187]
    v_mfma_f32_16x16x32_bf16 v[188:191], v[60:63], v[28:31], v[188:191]
    ds_read_b128 v[28:31], v3 offset:6144
    ds_read_b64_tr_b16 v[76:77], v7 offset:8192
    ds_read_b64_tr_b16 v[78:79], v7 offset:9216
    s_waitcnt lgkmcnt(12)
    v_mfma_f32_16x16x32_bf16 v[192:195], v[48:51], v[32:35], v[192:195]
    v_mfma_f32_16x16x32_bf16 v[196:199], v[52:55], v[32:35], v[196:199]
    v_mfma_f32_16x16x32_bf16 v[200:203], v[56:59], v[32:35], v[200:203]
    v_mfma_f32_16x16x32_bf16 v[204:207], v[60:63], v[32:35], v[204:207]
    ds_read_b128 v[32:35], v3 offset:8192
    v_mfma_f32_16x16x32_bf16 v[208:211], v[48:51], v[36:39], v[208:211]
    v_mfma_f32_16x16x32_bf16 v[212:215], v[52:55], v[36:39], v[212:215]
    v_mfma_f32_16x16x32_bf16 v[216:219], v[56:59], v[36:39], v[216:219]
    v_mfma_f32_16x16x32_bf16 v[220:223], v[60:63], v[36:39], v[220:223]
    ds_read_b128 v[36:39], v3 offset:10240
    v_mfma_f32_16x16x32_bf16 v[224:227], v[48:51], v[40:43], v[224:227]
    v_mfma_f32_16x16x32_bf16 v[228:231], v[52:55], v[40:43], v[228:231]
    v_mfma_f32_16x16x32_bf16 v[232:235], v[56:59], v[40:43], v[232:235]
    v_mfma_f32_16x16x32_bf16 v[236:239], v[60:63], v[40:43], v[236:239]
    ds_read_b128 v[40:43], v3 offset:12288
    v_mfma_f32_16x16x32_bf16 v[240:243], v[48:51], v[44:47], v[240:243]
    v_mfma_f32_16x16x32_bf16 v[244:247], v[52:55], v[44:47], v[244:247]
    v_mfma_f32_16x16x32_bf16 v[248:251], v[56:59], v[44:47], v[248:251]
    v_mfma_f32_16x16x32_bf16 v[252:255], v[60:63], v[44:47], v[252:255]
    ds_read_b128 v[44:47], v3 offset:14336
    s_waitcnt lgkmcnt(4)
    v_mfma_f32_16x16x32_bf16 v[128:131], v[64:67], v[16:19], v[128:131]
    v_mfma_f32_16x16x32_bf16 v[132:135], v[68:71], v[16:19], v[132:135]
    v_mfma_f32_16x16x32_bf16 v[136:139], v[72:75], v[16:19], v[136:139]
    v_mfma_f32_16x16x32_bf16 v[140:143], v[76:79], v[16:19], v[140:143]
    v_mfma_f32_16x16x32_bf16 v[144:147], v[64:67], v[20:23], v[144:147]
    v_mfma_f32_16x16x32_bf16 v[148:151], v[68:71], v[20:23], v[148:151]
    v_mfma_f32_16x16x32_bf16 v[152:155], v[72:75], v[20:23], v[152:155]
    v_mfma_f32_16x16x32_bf16 v[156:159], v[76:79], v[20:23], v[156:159]
    s_waitcnt lgkmcnt(0)
    s_cbranch_vccnz Lfw_265
    s_waitcnt vmcnt(1)
Lfw_265:
Lfw_266:
    s_barrier
    ds_read_b128 v[16:19], v2 offset:32768
    ds_read_b128 v[20:23], v2 offset:34816
    ds_read_b64_tr_b16 v[48:49], v4 offset:32768
    ds_read_b64_tr_b16 v[50:51], v4 offset:33792
    ds_read_b64_tr_b16 v[52:53], v5 offset:32768
    ds_read_b64_tr_b16 v[54:55], v5 offset:33792
    v_mfma_f32_16x16x32_bf16 v[160:163], v[64:67], v[24:27], v[160:163]
    v_mfma_f32_16x16x32_bf16 v[164:167], v[68:71], v[24:27], v[164:167]
    v_mfma_f32_16x16x32_bf16 v[168:171], v[72:75], v[24:27], v[168:171]
    v_mfma_f32_16x16x32_bf16 v[172:175], v[76:79], v[24:27], v[172:175]
    ds_read_b128 v[24:27], v2 offset:36864
    ds_read_b64_tr_b16 v[56:57], v6 offset:32768
    ds_read_b64_tr_b16 v[58:59], v6 offset:33792
    s_cbranch_vccnz Lnd_267
    s_add_u32 m0, s81, 0
    s_nop 0
    buffer_load_dwordx4 v8, s[44:47], s64 offen lds
    s_add_u32 m0, s81, 1024
    s_nop 0
    buffer_load_dwordx4 v9, s[44:47], s64 offen lds
Lnd_267:
    v_mfma_f32_16x16x32_bf16 v[176:179], v[64:67], v[28:31], v[176:179]
    v_mfma_f32_16x16x32_bf16 v[180:183], v[68:71], v[28:31], v[180:183]
    v_mfma_f32_16x16x32_bf16 v[184:187], v[72:75], v[28:31], v[184:187]
    v_mfma_f32_16x16x32_bf16 v[188:191], v[76:79], v[28:31], v[188:191]
    ds_read_b128 v[28:31], v2 offset:38912
    ds_read_b64_tr_b16 v[60:61], v7 offset:32768
    ds_read_b64_tr_b16 v[62:63], v7 offset:33792
    s_cbranch_vccnz Lnd_268
    s_add_u32 s68, s64, s4
    s_add_u32 m0, s81, 2048
    s_nop 0
    buffer_load_dwordx4 v8, s[44:47], s68 offen lds
    s_add_u32 s68, s64, s4
    s_add_u32 m0, s81, 3072
    s_nop 0
    buffer_load_dwordx4 v9, s[44:47], s68 offen lds
Lnd_268:
    v_mfma_f32_16x16x32_bf16 v[192:195], v[64:67], v[32:35], v[192:195]
    v_mfma_f32_16x16x32_bf16 v[196:199], v[68:71], v[32:35], v[196:199]
    v_mfma_f32_16x16x32_bf16 v[200:203], v[72:75], v[32:35], v[200:203]
    v_mfma_f32_16x16x32_bf16 v[204:207], v[76:79], v[32:35], v[204:207]
    ds_read_b128 v[32:35], v2 offset:40960
    s_cbranch_vccnz Lnd_269
    s_add_u32 m0, s81, 16384
    s_nop 0
    buffer_load_dwordx4 v8, s[44:47], s65 offen lds
    s_add_u32 m0, s81, 17408
    s_nop 0
    buffer_load_dwordx4 v9, s[44:47], s65 offen lds
    s_add_u32 s68, s65, s4
    s_add_u32 m0, s81, 18432
    s_nop 0
    buffer_load_dwordx4 v8, s[44:47], s68 offen lds
Lnd_269:
    v_mfma_f32_16x16x32_bf16 v[208:211], v[64:67], v[36:39], v[208:211]
    v_mfma_f32_16x16x32_bf16 v[212:215], v[68:71], v[36:39], v[212:215]
    v_mfma_f32_16x16x32_bf16 v[216:219], v[72:75], v[36:39], v[216:219]
    v_mfma_f32_16x16x32_bf16 v[220:223], v[76:79], v[36:39], v[220:223]
    ds_read_b128 v[36:39], v2 offset:43008
    s_cbranch_vccnz Lnd_270
    s_add_u32 s68, s65, s4
    s_add_u32 m0, s81, 19456
    s_nop 0
    buffer_load_dwordx4 v9, s[44:47], s68 offen lds
    s_add_u32 m0, s81, 65536
    s_nop 0
    buffer_load_dwordx4 v10, s[48:51], s66 offen lds
    s_add_u32 s68, s66, s5
    s_add_u32 m0, s81, 66560
    s_nop 0
    buffer_load_dwordx4 v10, s[48:51], s68 offen lds
Lnd_270:
    v_mfma_f32_16x16x32_bf16 v[224:227], v[64:67], v[40:43], v[224:227]
    v_mfma_f32_16x16x32_bf16 v[228:231], v[68:71], v[40:43], v[228:231]
    v_mfma_f32_16x16x32_bf16 v[232:235], v[72:75], v[40:43], v[232:235]
    v_mfma_f32_16x16x32_bf16 v[236:239], v[76:79], v[40:43], v[236:239]
    ds_read_b128 v[40:43], v2 offset:45056
    s_cbranch_vccnz Lnd_271
    s_add_u32 m0, s81, 67584
    s_nop 0
    buffer_load_dwordx4 v11, s[48:51], s66 offen lds
    s_add_u32 s68, s66, s5
    s_add_u32 m0, s81, 68608
    s_nop 0
    buffer_load_dwordx4 v11, s[48:51], s68 offen lds
    s_add_u32 m0, s81, 81920
    s_nop 0
    buffer_load_dwordx4 v12, s[96:99], s67 offen lds
Lnd_271:
    v_mfma_f32_16x16x32_bf16 v[240:243], v[64:67], v[44:47], v[240:243]
    v_mfma_f32_16x16x32_bf16 v[244:247], v[68:71], v[44:47], v[244:247]
    v_mfma_f32_16x16x32_bf16 v[248:251], v[72:75], v[44:47], v[248:251]
    v_mfma_f32_16x16x32_bf16 v[252:255], v[76:79], v[44:47], v[252:255]
    ds_read_b128 v[44:47], v2 offset:47104
    s_cbranch_vccnz Lnd_272
    s_add_u32 s68, s67, s6
    s_add_u32 m0, s81, 82944
    s_nop 0
    buffer_load_dwordx4 v12, s[96:99], s68 offen lds
    s_add_u32 m0, s81, 83968
    s_nop 0
    buffer_load_dwordx4 v13, s[96:99], s67 offen lds
    s_add_u32 s68, s67, s6
    s_add_u32 m0, s81, 84992
    s_nop 0
    buffer_load_dwordx4 v13, s[96:99], s68 offen lds
Lnd_272:
    s_add_u32 s64, s64, 128
    s_add_u32 s65, s65, 128
    s_add_u32 s66, s66, s7
    s_add_u32 s67, s67, s8
    buffer_store_dwordx4 v[88:91], v0, s[52:55], s83 offen sc0 sc1
    s_waitcnt lgkmcnt(4)
    v_mfma_f32_16x16x32_bf16 v[128:131], v[48:51], v[16:19], v[128:131]
    v_mfma_f32_16x16x32_bf16 v[132:135], v[52:55], v[16:19], v[132:135]
    v_mfma_f32_16x16x32_bf16 v[136:139], v[56:59], v[16:19], v[136:139]
    v_mfma_f32_16x16x32_bf16 v[140:143], v[60:63], v[16:19], v[140:143]
    ds_read_b128 v[16:19], v3 offset:32768
    ds_read_b64_tr_b16 v[64:65], v4 offset:40960
    ds_read_b64_tr_b16 v[66:67], v4 offset:41984
    v_mfma_f32_16x16x32_bf16 v[144:147], v[48:51], v[20:23], v[144:147]
    v_mfma_f32_16x16x32_bf16 v[148:151], v[52:55], v[20:23], v[148:151]
    v_mfma_f32_16x16x32_bf16 v[152:155], v[56:59], v[20:23], v[152:155]
    v_mfma_f32_16x16x32_bf16 v[156:159], v[60:63], v[20:23], v[156:159]
    ds_read_b128 v[20:23], v3 offset:34816
    ds_read_b64_tr_b16 v[68:69], v5 offset:40960
    ds_read_b64_tr_b16 v[70:71], v5 offset:41984
    v_mfma_f32_16x16x32_bf16 v[160:163], v[48:51], v[24:27], v[160:163]
    v_mfma_f32_16x16x32_bf16 v[164:167], v[52:55], v[24:27], v[164:167]
    v_mfma_f32_16x16x32_bf16 v[168:171], v[56:59], v[24:27], v[168:171]
    v_mfma_f32_16x16x32_bf16 v[172:175], v[60:63], v[24:27], v[172:175]
    ds_read_b128 v[24:27], v3 offset:36864
    ds_read_b64_tr_b16 v[72:73], v6 offset:40960
    ds_read_b64_tr_b16 v[74:75], v6 offset:41984
    v_mfma_f32_16x16x32_bf16 v[176:179], v[48:51], v[28:31], v[176:179]
    v_mfma_f32_16x16x32_bf16 v[180:183], v[52:55], v[28:31], v[180:183]
    v_mfma_f32_16x16x32_bf16 v[184:187], v[56:59], v[28:31], v[184:187]
    v_mfma_f32_16x16x32_bf16 v[188:191], v[60:63], v[28:31], v[188:191]
    ds_read_b128 v[28:31], v3 offset:38912
    ds_read_b64_tr_b16 v[76:77], v7 offset:40960
    ds_read_b64_tr_b16 v[78:79], v7 offset:41984
    s_waitcnt lgkmcnt(12)
    v_mfma_f32_16x16x32_bf16 v[192:195], v[48:51], v[32:35], v[192:195]
    v_mfma_f32_16x16x32_bf16 v[196:199], v[52:55], v[32:35], v[196:199]
    v_mfma_f32_16x16x32_bf16 v[200:203], v[56:59], v[32:35], v[200:203]
    v_mfma_f32_16x16x32_bf16 v[204:207], v[60:63], v[32:35], v[204:207]
    ds_read_b128 v[32:35], v3 offset:40960
    v_mfma_f32_16x16x32_bf16 v[208:211], v[48:51], v[36:39], v[208:211]
    v_mfma_f32_16x16x32_bf16 v[212:215], v[52:55], v[36:39], v[212:215]
    v_mfma_f32_16x16x32_bf16 v[216:219], v[56:59], v[36:39], v[216:219]
    v_mfma_f32_16x16x32_bf16 v[220:223], v[60:63], v[36:39], v[220:223]
    ds_read_b128 v[36:39], v3 offset:43008
    v_mfma_f32_16x16x32_bf16 v[224:227], v[48:51], v[40:43], v[224:227]
    v_mfma_f32_16x16x32_bf16 v[228:231], v[52:55], v[40:43], v[228:231]
    v_mfma_f32_16x16x32_bf16 v[232:235], v[56:59], v[40:43], v[232:235]
    v_mfma_f32_16x16x32_bf16 v[236:239], v[60:63], v[40:43], v[236:239]
    ds_read_b128 v[40:43], v3 offset:45056
    v_mfma_f32_16x16x32_bf16 v[240:243], v[48:51], v[44:47], v[240:243]
    v_mfma_f32_16x16x32_bf16 v[244:247], v[52:55], v[44:47], v[244:247]
    v_mfma_f32_16x16x32_bf16 v[248:251], v[56:59], v[44:47], v[248:251]
    v_mfma_f32_16x16x32_bf16 v[252:255], v[60:63], v[44:47], v[252:255]
    ds_read_b128 v[44:47], v3 offset:47104
    s_waitcnt lgkmcnt(4)
    v_mfma_f32_16x16x32_bf16 v[128:131], v[64:67], v[16:19], v[128:131]
    v_mfma_f32_16x16x32_bf16 v[132:135], v[68:71], v[16:19], v[132:135]
    v_mfma_f32_16x16x32_bf16 v[136:139], v[72:75], v[16:19], v[136:139]
    v_mfma_f32_16x16x32_bf16 v[140:143], v[76:79], v[16:19], v[140:143]
    v_mfma_f32_16x16x32_bf16 v[144:147], v[64:67], v[20:23], v[144:147]
    v_mfma_f32_16x16x32_bf16 v[148:151], v[68:71], v[20:23], v[148:151]
    v_mfma_f32_16x16x32_bf16 v[152:155], v[72:75], v[20:23], v[152:155]
    v_mfma_f32_16x16x32_bf16 v[156:159], v[76:79], v[20:23], v[156:159]
    s_waitcnt lgkmcnt(0)
    s_cbranch_vccnz Lfw_273
    s_waitcnt vmcnt(1)
Lfw_273:
Lfw_274:
    s_barrier
    ds_read_b128 v[16:19], v2 offset:0
    ds_read_b128 v[20:23], v2 offset:2048
    ds_read_b64_tr_b16 v[48:49], v4 offset:0
    ds_read_b64_tr_b16 v[50:51], v4 offset:1024
    ds_read_b64_tr_b16 v[52:53], v5 offset:0
    ds_read_b64_tr_b16 v[54:55], v5 offset:1024
    v_mfma_f32_16x16x32_bf16 v[160:163], v[64:67], v[24:27], v[160:163]
    v_mfma_f32_16x16x32_bf16 v[164:167], v[68:71], v[24:27], v[164:167]
    v_mfma_f32_16x16x32_bf16 v[168:171], v[72:75], v[24:27], v[168:171]
    v_mfma_f32_16x16x32_bf16 v[172:175], v[76:79], v[24:27], v[172:175]
    ds_read_b128 v[24:27], v2 offset:4096
    ds_read_b64_tr_b16 v[56:57], v6 offset:0
    ds_read_b64_tr_b16 v[58:59], v6 offset:1024
    s_cbranch_vccnz Lnd_275
    s_add_u32 m0, s81, 32768
    s_nop 0
    buffer_load_dwordx4 v8, s[44:47], s64 offen lds
    s_add_u32 m0, s81, 33792
    s_nop 0
    buffer_load_dwordx4 v9, s[44:47], s64 offen lds
Lnd_275:
    v_mfma_f32_16x16x32_bf16 v[176:179], v[64:67], v[28:31], v[176:179]
    v_mfma_f32_16x16x32_bf16 v[180:183], v[68:71], v[28:31], v[180:183]
    v_mfma_f32_16x16x32_bf16 v[184:187], v[72:75], v[28:31], v[184:187]
    v_mfma_f32_16x16x32_bf16 v[188:191], v[76:79], v[28:31], v[188:191]
    ds_read_b128 v[28:31], v2 offset:6144
    ds_read_b64_tr_b16 v[60:61], v7 offset:0
    ds_read_b64_tr_b16 v[62:63], v7 offset:1024
    s_cbranch_vccnz Lnd_276
    s_add_u32 s68, s64, s4
    s_add_u32 m0, s81, 34816
    s_nop 0
    buffer_load_dwordx4 v8, s[44:47], s68 offen lds
    s_add_u32 s68, s64, s4
    s_add_u32 m0, s81, 35840
    s_nop 0
    buffer_load_dwordx4 v9, s[44:47], s68 offen lds
Lnd_276:
    v_mfma_f32_16x16x32_bf16 v[192:195], v[64:67], v[32:35], v[192:195]
    v_mfma_f32_16x16x32_bf16 v[196:199], v[68:71], v[32:35], v[196:199]
    v_mfma_f32_16x16x32_bf16 v[200:203], v[72:75], v[32:35], v[200:203]
    v_mfma_f32_16x16x32_bf16 v[204:207], v[76:79], v[32:35], v[204:207]
    ds_read_b128 v[32:35], v2 offset:8192
    s_cbranch_vccnz Lnd_277
    s_add_u32 m0, s81, 49152
    s_nop 0
    buffer_load_dwordx4 v8, s[44:47], s65 offen lds
    s_add_u32 m0, s81, 50176
    s_nop 0
    buffer_load_dwordx4 v9, s[44:47], s65 offen lds
    s_add_u32 s68, s65, s4
    s_add_u32 m0, s81, 51200
    s_nop 0
    buffer_load_dwordx4 v8, s[44:47], s68 offen lds
Lnd_277:
    v_mfma_f32_16x16x32_bf16 v[208:211], v[64:67], v[36:39], v[208:211]
    v_mfma_f32_16x16x32_bf16 v[212:215], v[68:71], v[36:39], v[212:215]
    v_mfma_f32_16x16x32_bf16 v[216:219], v[72:75], v[36:39], v[216:219]
    v_mfma_f32_16x16x32_bf16 v[220:223], v[76:79], v[36:39], v[220:223]
    ds_read_b128 v[36:39], v2 offset:10240
    s_cbranch_vccnz Lnd_278
    s_add_u32 s68, s65, s4
    s_add_u32 m0, s81, 52224
    s_nop 0
    buffer_load_dwordx4 v9, s[44:47], s68 offen lds
    s_add_u32 m0, s81, 98304
    s_nop 0
    buffer_load_dwordx4 v10, s[48:51], s66 offen lds
    s_add_u32 s68, s66, s5
    s_add_u32 m0, s81, 99328
    s_nop 0
    buffer_load_dwordx4 v10, s[48:51], s68 offen lds
Lnd_278:
    v_mfma_f32_16x16x32_bf16 v[224:227], v[64:67], v[40:43], v[224:227]
    v_mfma_f32_16x16x32_bf16 v[228:231], v[68:71], v[40:43], v[228:231]
    v_mfma_f32_16x16x32_bf16 v[232:235], v[72:75], v[40:43], v[232:235]
    v_mfma_f32_16x16x32_bf16 v[236:239], v[76:79], v[40:43], v[236:239]
    ds_read_b128 v[40:43], v2 offset:12288
    s_cbranch_vccnz Lnd_279
    s_add_u32 m0, s81, 100352
    s_nop 0
    buffer_load_dwordx4 v11, s[48:51], s66 offen lds
    s_add_u32 s68, s66, s5
    s_add_u32 m0, s81, 101376
    s_nop 0
    buffer_load_dwordx4 v11, s[48:51], s68 offen lds
    s_add_u32 m0, s81, 114688
    s_nop 0
    buffer_load_dwordx4 v12, s[96:99], s67 offen lds
Lnd_279:
    v_mfma_f32_16x16x32_bf16 v[240:243], v[64:67], v[44:47], v[240:243]
    v_mfma_f32_16x16x32_bf16 v[244:247], v[68:71], v[44:47], v[244:247]
    v_mfma_f32_16x16x32_bf16 v[248:251], v[72:75], v[44:47], v[248:251]
    v_mfma_f32_16x16x32_bf16 v[252:255], v[76:79], v[44:47], v[252:255]
    ds_read_b128 v[44:47], v2 offset:14336
    s_cbranch_vccnz Lnd_280
    s_add_u32 s68, s67, s6
    s_add_u32 m0, s81, 115712
    s_nop 0
    buffer_load_dwordx4 v12, s[96:99], s68 offen lds
    s_add_u32 m0, s81, 116736
    s_nop 0
    buffer_load_dwordx4 v13, s[96:99], s67 offen lds
    s_add_u32 s68, s67, s6
    s_add_u32 m0, s81, 117760
    s_nop 0
    buffer_load_dwordx4 v13, s[96:99], s68 offen lds
Lnd_280:
    s_add_u32 s64, s64, 128
    s_add_u32 s65, s65, 128
    s_add_u32 s66, s66, s7
    s_add_u32 s67, s67, s8
    buffer_store_dwordx4 v[92:95], v14, s[52:55], s83 offen sc0 sc1
    s_waitcnt lgkmcnt(4)
    v_mfma_f32_16x16x32_bf16 v[128:131], v[48:51], v[16:19], v[128:131]
    v_mfma_f32_16x16x32_bf16 v[132:135], v[52:55], v[16:19], v[132:135]
    v_mfma_f32_16x16x32_bf16 v[136:139], v[56:59], v[16:19], v[136:139]
    v_mfma_f32_16x16x32_bf16 v[140:143], v[60:63], v[16:19], v[140:143]
    ds_read_b128 v[16:19], v3 offset:0
    ds_read_b64_tr_b16 v[64:65], v4 offset:8192
    ds_read_b64_tr_b16 v[66:67], v4 offset:9216
    v_mfma_f32_16x16x32_bf16 v[144:147], v[48:51], v[20:23], v[144:147]
    v_mfma_f32_16x16x32_bf16 v[148:151], v[52:55], v[20:23], v[148:151]
    v_mfma_f32_16x16x32_bf16 v[152:155], v[56:59], v[20:23], v[152:155]
    v_mfma_f32_16x16x32_bf16 v[156:159], v[60:63], v[20:23], v[156:159]
    ds_read_b128 v[20:23], v3 offset:2048
    ds_read_b64_tr_b16 v[68:69], v5 offset:8192
    ds_read_b64_tr_b16 v[70:71], v5 offset:9216
    v_mfma_f32_16x16x32_bf16 v[160:163], v[48:51], v[24:27], v[160:163]
    v_mfma_f32_16x16x32_bf16 v[164:167], v[52:55], v[24:27], v[164:167]
    v_mfma_f32_16x16x32_bf16 v[168:171], v[56:59], v[24:27], v[168:171]
    v_mfma_f32_16x16x32_bf16 v[172:175], v[60:63], v[24:27], v[172:175]
    ds_read_b128 v[24:27], v3 offset:4096
    ds_read_b64_tr_b16 v[72:73], v6 offset:8192
    ds_read_b64_tr_b16 v[74:75], v6 offset:9216
    v_mfma_f32_16x16x32_bf16 v[176:179], v[48:51], v[28:31], v[176:179]
    v_mfma_f32_16x16x32_bf16 v[180:183], v[52:55], v[28:31], v[180:183]
    v_mfma_f32_16x16x32_bf16 v[184:187], v[56:59], v[28:31], v[184:187]
    v_mfma_f32_16x16x32_bf16 v[188:191], v[60:63], v[28:31], v[188:191]
    ds_read_b128 v[28:31], v3 offset:6144
    ds_read_b64_tr_b16 v[76:77], v7 offset:8192
    ds_read_b64_tr_b16 v[78:79], v7 offset:9216
    s_waitcnt lgkmcnt(12)
    v_mfma_f32_16x16x32_bf16 v[192:195], v[48:51], v[32:35], v[192:195]
    v_mfma_f32_16x16x32_bf16 v[196:199], v[52:55], v[32:35], v[196:199]
    v_mfma_f32_16x16x32_bf16 v[200:203], v[56:59], v[32:35], v[200:203]
    v_mfma_f32_16x16x32_bf16 v[204:207], v[60:63], v[32:35], v[204:207]
    ds_read_b128 v[32:35], v3 offset:8192
    v_mfma_f32_16x16x32_bf16 v[208:211], v[48:51], v[36:39], v[208:211]
    v_mfma_f32_16x16x32_bf16 v[212:215], v[52:55], v[36:39], v[212:215]
    v_mfma_f32_16x16x32_bf16 v[216:219], v[56:59], v[36:39], v[216:219]
    v_mfma_f32_16x16x32_bf16 v[220:223], v[60:63], v[36:39], v[220:223]
    ds_read_b128 v[36:39], v3 offset:10240
    v_mfma_f32_16x16x32_bf16 v[224:227], v[48:51], v[40:43], v[224:227]
    v_mfma_f32_16x16x32_bf16 v[228:231], v[52:55], v[40:43], v[228:231]
    v_mfma_f32_16x16x32_bf16 v[232:235], v[56:59], v[40:43], v[232:235]
    v_mfma_f32_16x16x32_bf16 v[236:239], v[60:63], v[40:43], v[236:239]
    ds_read_b128 v[40:43], v3 offset:12288
    v_mfma_f32_16x16x32_bf16 v[240:243], v[48:51], v[44:47], v[240:243]
    v_mfma_f32_16x16x32_bf16 v[244:247], v[52:55], v[44:47], v[244:247]
    v_mfma_f32_16x16x32_bf16 v[248:251], v[56:59], v[44:47], v[248:251]
    v_mfma_f32_16x16x32_bf16 v[252:255], v[60:63], v[44:47], v[252:255]
    ds_read_b128 v[44:47], v3 offset:14336
    s_waitcnt lgkmcnt(4)
    v_mfma_f32_16x16x32_bf16 v[128:131], v[64:67], v[16:19], v[128:131]
    v_mfma_f32_16x16x32_bf16 v[132:135], v[68:71], v[16:19], v[132:135]
    v_mfma_f32_16x16x32_bf16 v[136:139], v[72:75], v[16:19], v[136:139]
    v_mfma_f32_16x16x32_bf16 v[140:143], v[76:79], v[16:19], v[140:143]
    v_mfma_f32_16x16x32_bf16 v[144:147], v[64:67], v[20:23], v[144:147]
    v_mfma_f32_16x16x32_bf16 v[148:151], v[68:71], v[20:23], v[148:151]
    v_mfma_f32_16x16x32_bf16 v[152:155], v[72:75], v[20:23], v[152:155]
    v_mfma_f32_16x16x32_bf16 v[156:159], v[76:79], v[20:23], v[156:159]
    s_waitcnt lgkmcnt(0)
    s_cbranch_vccnz Lfw_281
    s_waitcnt vmcnt(0)
    s_branch Lfw_282
Lfw_281:
    s_waitcnt vmcnt(0)
Lfw_282:
    s_barrier
    ds_read_b128 v[16:19], v2 offset:32768
    ds_read_b128 v[20:23], v2 offset:34816
    ds_read_b64_tr_b16 v[48:49], v4 offset:32768
    ds_read_b64_tr_b16 v[50:51], v4 offset:33792
    ds_read_b64_tr_b16 v[52:53], v5 offset:32768
    ds_read_b64_tr_b16 v[54:55], v5 offset:33792
    v_mfma_f32_16x16x32_bf16 v[160:163], v[64:67], v[24:27], v[160:163]
    v_mfma_f32_16x16x32_bf16 v[164:167], v[68:71], v[24:27], v[164:167]
    v_mfma_f32_16x16x32_bf16 v[168:171], v[72:75], v[24:27], v[168:171]
    v_mfma_f32_16x16x32_bf16 v[172:175], v[76:79], v[24:27], v[172:175]
    ds_read_b128 v[24:27], v2 offset:36864
    ds_read_b64_tr_b16 v[56:57], v6 offset:32768
    ds_read_b64_tr_b16 v[58:59], v6 offset:33792
    s_cbranch_vccnz Lnd_283
    s_add_u32 m0, s81, 0
    s_nop 0
    buffer_load_dwordx4 v8, s[44:47], s64 offen lds
    s_add_u32 m0, s81, 1024
    s_nop 0
    buffer_load_dwordx4 v9, s[44:47], s64 offen lds
Lnd_283:
    v_mfma_f32_16x16x32_bf16 v[176:179], v[64:67], v[28:31], v[176:179]
    v_mfma_f32_16x16x32_bf16 v[180:183], v[68:71], v[28:31], v[180:183]
    v_mfma_f32_16x16x32_bf16 v[184:187], v[72:75], v[28:31], v[184:187]
    v_mfma_f32_16x16x32_bf16 v[188:191], v[76:79], v[28:31], v[188:191]
    ds_read_b128 v[28:31], v2 offset:38912
    ds_read_b64_tr_b16 v[60:61], v7 offset:32768
    ds_read_b64_tr_b16 v[62:63], v7 offset:33792
    s_cbranch_vccnz Lnd_284
    s_add_u32 s68, s64, s4
    s_add_u32 m0, s81, 2048
    s_nop 0
    buffer_load_dwordx4 v8, s[44:47], s68 offen lds
    s_add_u32 s68, s64, s4
    s_add_u32 m0, s81, 3072
    s_nop 0
    buffer_load_dwordx4 v9, s[44:47], s68 offen lds
Lnd_284:
    v_mfma_f32_16x16x32_bf16 v[192:195], v[64:67], v[32:35], v[192:195]
    v_mfma_f32_16x16x32_bf16 v[196:199], v[68:71], v[32:35], v[196:199]
    v_mfma_f32_16x16x32_bf16 v[200:203], v[72:75], v[32:35], v[200:203]
    v_mfma_f32_16x16x32_bf16 v[204:207], v[76:79], v[32:35], v[204:207]
    ds_read_b128 v[32:35], v2 offset:40960
    s_cbranch_vccnz Lnd_285
    s_add_u32 m0, s81, 16384
    s_nop 0
    buffer_load_dwordx4 v8, s[44:47], s65 offen lds
    s_add_u32 m0, s81, 17408
    s_nop 0
    buffer_load_dwordx4 v9, s[44:47], s65 offen lds
    s_add_u32 s68, s65, s4
    s_add_u32 m0, s81, 18432
    s_nop 0
    buffer_load_dwordx4 v8, s[44:47], s68 offen lds
Lnd_285:
    v_mfma_f32_16x16x32_bf16 v[208:211], v[64:67], v[36:39], v[208:211]
    v_mfma_f32_16x16x32_bf16 v[212:215], v[68:71], v[36:39], v[212:215]
    v_mfma_f32_16x16x32_bf16 v[216:219], v[72:75], v[36:39], v[216:219]
    v_mfma_f32_16x16x32_bf16 v[220:223], v[76:79], v[36:39], v[220:223]
    ds_read_b128 v[36:39], v2 offset:43008
    s_cbranch_vccnz Lnd_286
    s_add_u32 s68, s65, s4
    s_add_u32 m0, s81, 19456
    s_nop 0
    buffer_load_dwordx4 v9, s[44:47], s68 offen lds
    s_add_u32 m0, s81, 65536
    s_nop 0
    buffer_load_dwordx4 v10, s[48:51], s66 offen lds
    s_add_u32 s68, s66, s5
    s_add_u32 m0, s81, 66560
    s_nop 0
    buffer_load_dwordx4 v10, s[48:51], s68 offen lds
Lnd_286:
    v_mfma_f32_16x16x32_bf16 v[224:227], v[64:67], v[40:43], v[224:227]
    v_mfma_f32_16x16x32_bf16 v[228:231], v[68:71], v[40:43], v[228:231]
    v_mfma_f32_16x16x32_bf16 v[232:235], v[72:75], v[40:43], v[232:235]
    v_mfma_f32_16x16x32_bf16 v[236:239], v[76:79], v[40:43], v[236:239]
    ds_read_b128 v[40:43], v2 offset:45056
    s_cbranch_vccnz Lnd_287
    s_add_u32 m0, s81, 67584
    s_nop 0
    buffer_load_dwordx4 v11, s[48:51], s66 offen lds
    s_add_u32 s68, s66, s5
    s_add_u32 m0, s81, 68608
    s_nop 0
    buffer_load_dwordx4 v11, s[48:51], s68 offen lds
    s_add_u32 m0, s81, 81920
    s_nop 0
    buffer_load_dwordx4 v12, s[96:99], s67 offen lds
Lnd_287:
    v_mfma_f32_16x16x32_bf16 v[240:243], v[64:67], v[44:47], v[240:243]
    v_mfma_f32_16x16x32_bf16 v[244:247], v[68:71], v[44:47], v[244:247]
    v_mfma_f32_16x16x32_bf16 v[248:251], v[72:75], v[44:47], v[248:251]
    v_mfma_f32_16x16x32_bf16 v[252:255], v[76:79], v[44:47], v[252:255]
    ds_read_b128 v[44:47], v2 offset:47104
    s_cbranch_vccnz Lnd_288
    s_add_u32 s68, s67, s6
    s_add_u32 m0, s81, 82944
    s_nop 0
    buffer_load_dwordx4 v12, s[96:99], s68 offen lds
    s_add_u32 m0, s81, 83968
    s_nop 0
    buffer_load_dwordx4 v13, s[96:99], s67 offen lds
    s_add_u32 s68, s67, s6
    s_add_u32 m0, s81, 84992
    s_nop 0
    buffer_load_dwordx4 v13, s[96:99], s68 offen lds
Lnd_288:
    s_add_u32 s64, s64, 128
    s_add_u32 s65, s65, 128
    s_add_u32 s66, s66, s7
    s_add_u32 s67, s67, s8
    s_cmp_lg_u32 s60, 0
    s_cbranch_scc1 Lnw0_289
    s_add_u32 s56, s42, 209715200
    s_addc_u32 s57, s43, 0
    s_mov_b32 s58, 262144
    s_and_b32 s57, s57, 0xffff
    s_mov_b32 s59, 0x00020000
    s_lshl_b32 s68, s73, 3
    s_add_u32 s68, s68, s72
    s_lshl_b32 s68, s68, 7
    s_add_u32 s68, s68, 32768
    v_mov_b32 v80, s12
    v_mov_b32 v81, s13
    v_mov_b32 v82, 0
    s_mov_b64 exec, 1
    buffer_store_dwordx2 v[80:81], v82, s[56:59], s68 offen sc0 sc1
    s_mov_b64 exec, -1
Lnw0_289:
    s_waitcnt lgkmcnt(4)
    v_mfma_f32_16x16x32_bf16 v[128:131], v[48:51], v[16:19], v[128:131]
    v_mfma_f32_16x16x32_bf16 v[132:135], v[52:55], v[16:19], v[132:135]
    v_mfma_f32_16x16x32_bf16 v[136:139], v[56:59], v[16:19], v[136:139]
    v_mfma_f32_16x16x32_bf16 v[140:143], v[60:63], v[16:19], v[140:143]
    ds_read_b128 v[16:19], v3 offset:32768
    ds_read_b64_tr_b16 v[64:65], v4 offset:40960
    ds_read_b64_tr_b16 v[66:67], v4 offset:41984
    v_mfma_f32_16x16x32_bf16 v[144:147], v[48:51], v[20:23], v[144:147]
    v_mfma_f32_16x16x32_bf16 v[148:151], v[52:55], v[20:23], v[148:151]
    v_mfma_f32_16x16x32_bf16 v[152:155], v[56:59], v[20:23], v[152:155]
    v_mfma_f32_16x16x32_bf16 v[156:159], v[60:63], v[20:23], v[156:159]
    ds_read_b128 v[20:23], v3 offset:34816
    ds_read_b64_tr_b16 v[68:69], v5 offset:40960
    ds_read_b64_tr_b16 v[70:71], v5 offset:41984
    v_mfma_f32_16x16x32_bf16 v[160:163], v[48:51], v[24:27], v[160:163]
    v_mfma_f32_16x16x32_bf16 v[164:167], v[52:55], v[24:27], v[164:167]
    v_mfma_f32_16x16x32_bf16 v[168:171], v[56:59], v[24:27], v[168:171]
    v_mfma_f32_16x16x32_bf16 v[172:175], v[60:63], v[24:27], v[172:175]
    ds_read_b128 v[24:27], v3 offset:36864
    ds_read_b64_tr_b16 v[72:73], v6 offset:40960
    ds_read_b64_tr_b16 v[74:75], v6 offset:41984
    v_mfma_f32_16x16x32_bf16 v[176:179], v[48:51], v[28:31], v[176:179]
    v_mfma_f32_16x16x32_bf16 v[180:183], v[52:55], v[28:31], v[180:183]
    v_mfma_f32_16x16x32_bf16 v[184:187], v[56:59], v[28:31], v[184:187]
    v_mfma_f32_16x16x32_bf16 v[188:191], v[60:63], v[28:31], v[188:191]
    ds_read_b128 v[28:31], v3 offset:38912
    ds_read_b64_tr_b16 v[76:77], v7 offset:40960
    ds_read_b64_tr_b16 v[78:79], v7 offset:41984
    s_waitcnt lgkmcnt(12)
    v_mfma_f32_16x16x32_bf16 v[192:195], v[48:51], v[32:35], v[192:195]
    v_mfma_f32_16x16x32_bf16 v[196:199], v[52:55], v[32:35], v[196:199]
    v_mfma_f32_16x16x32_bf16 v[200:203], v[56:59], v[32:35], v[200:203]
    v_mfma_f32_16x16x32_bf16 v[204:207], v[60:63], v[32:35], v[204:207]
    ds_read_b128 v[32:35], v3 offset:40960
    v_mfma_f32_16x16x32_bf16 v[208:211], v[48:51], v[36:39], v[208:211]
    v_mfma_f32_16x16x32_bf16 v[212:215], v[52:55], v[36:39], v[212:215]
    v_mfma_f32_16x16x32_bf16 v[216:219], v[56:59], v[36:39], v[216:219]
    v_mfma_f32_16x16x32_bf16 v[220:223], v[60:63], v[36:39], v[220:223]
    ds_read_b128 v[36:39], v3 offset:43008
    v_mfma_f32_16x16x32_bf16 v[224:227], v[48:51], v[40:43], v[224:227]
    v_mfma_f32_16x16x32_bf16 v[228:231], v[52:55], v[40:43], v[228:231]
    v_mfma_f32_16x16x32_bf16 v[232:235], v[56:59], v[40:43], v[232:235]
    v_mfma_f32_16x16x32_bf16 v[236:239], v[60:63], v[40:43], v[236:239]
    ds_read_b128 v[40:43], v3 offset:45056
    v_mfma_f32_16x16x32_bf16 v[240:243], v[48:51], v[44:47], v[240:243]
    v_mfma_f32_16x16x32_bf16 v[244:247], v[52:55], v[44:47], v[244:247]
    v_mfma_f32_16x16x32_bf16 v[248:251], v[56:59], v[44:47], v[248:251]
    v_mfma_f32_16x16x32_bf16 v[252:255], v[60:63], v[44:47], v[252:255]
    ds_read_b128 v[44:47], v3 offset:47104
    s_waitcnt lgkmcnt(4)
    v_mfma_f32_16x16x32_bf16 v[128:131], v[64:67], v[16:19], v[128:131]
    v_mfma_f32_16x16x32_bf16 v[132:135], v[68:71], v[16:19], v[132:135]
    v_mfma_f32_16x16x32_bf16 v[136:139], v[72:75], v[16:19], v[136:139]
    v_mfma_f32_16x16x32_bf16 v[140:143], v[76:79], v[16:19], v[140:143]
    v_mfma_f32_16x16x32_bf16 v[144:147], v[64:67], v[20:23], v[144:147]
    v_mfma_f32_16x16x32_bf16 v[148:151], v[68:71], v[20:23], v[148:151]
    v_mfma_f32_16x16x32_bf16 v[152:155], v[72:75], v[20:23], v[152:155]
    v_mfma_f32_16x16x32_bf16 v[156:159], v[76:79], v[20:23], v[156:159]
    s_waitcnt lgkmcnt(0)
    s_cbranch_vccnz Lfw_290
    s_waitcnt vmcnt(1)
    s_cmp_eq_u32 s60, 0
    s_cbranch_scc1 Lfw_291
    s_waitcnt vmcnt(0)
Lfw_290:
Lfw_291:
    s_barrier
    ds_read_b128 v[16:19], v2 offset:0
    ds_read_b128 v[20:23], v2 offset:2048
    ds_read_b64_tr_b16 v[48:49], v4 offset:0
    ds_read_b64_tr_b16 v[50:51], v4 offset:1024
    ds_read_b64_tr_b16 v[52:53], v5 offset:0
    ds_read_b64_tr_b16 v[54:55], v5 offset:1024
    v_mfma_f32_16x16x32_bf16 v[160:163], v[64:67], v[24:27], v[160:163]
    v_mfma_f32_16x16x32_bf16 v[164:167], v[68:71], v[24:27], v[164:167]
    v_mfma_f32_16x16x32_bf16 v[168:171], v[72:75], v[24:27], v[168:171]
    v_mfma_f32_16x16x32_bf16 v[172:175], v[76:79], v[24:27], v[172:175]
    ds_read_b128 v[24:27], v2 offset:4096
    ds_read_b64_tr_b16 v[56:57], v6 offset:0
    ds_read_b64_tr_b16 v[58:59], v6 offset:1024
    s_cbranch_vccnz Lnd_292
    s_add_u32 m0, s81, 32768
    s_nop 0
    buffer_load_dwordx4 v8, s[44:47], s64 offen lds
    s_add_u32 m0, s81, 33792
    s_nop 0
    buffer_load_dwordx4 v9, s[44:47], s64 offen lds
Lnd_292:
    v_mfma_f32_16x16x32_bf16 v[176:179], v[64:67], v[28:31], v[176:179]
    v_mfma_f32_16x16x32_bf16 v[180:183], v[68:71], v[28:31], v[180:183]
    v_mfma_f32_16x16x32_bf16 v[184:187], v[72:75], v[28:31], v[184:187]
    v_mfma_f32_16x16x32_bf16 v[188:191], v[76:79], v[28:31], v[188:191]
    ds_read_b128 v[28:31], v2 offset:6144
    ds_read_b64_tr_b16 v[60:61], v7 offset:0
    ds_read_b64_tr_b16 v[62:63], v7 offset:1024
    s_cbranch_vccnz Lnd_293
    s_add_u32 s68, s64, s4
    s_add_u32 m0, s81, 34816
    s_nop 0
    buffer_load_dwordx4 v8, s[44:47], s68 offen lds
    s_add_u32 s68, s64, s4
    s_add_u32 m0, s81, 35840
    s_nop 0
    buffer_load_dwordx4 v9, s[44:47], s68 offen lds
Lnd_293:
    v_mfma_f32_16x16x32_bf16 v[192:195], v[64:67], v[32:35], v[192:195]
    v_mfma_f32_16x16x32_bf16 v[196:199], v[68:71], v[32:35], v[196:199]
    v_mfma_f32_16x16x32_bf16 v[200:203], v[72:75], v[32:35], v[200:203]
    v_mfma_f32_16x16x32_bf16 v[204:207], v[76:79], v[32:35], v[204:207]
    ds_read_b128 v[32:35], v2 offset:8192
    s_cbranch_vccnz Lnd_294
    s_add_u32 m0, s81, 49152
    s_nop 0
    buffer_load_dwordx4 v8, s[44:47], s65 offen lds
    s_add_u32 m0, s81, 50176
    s_nop 0
    buffer_load_dwordx4 v9, s[44:47], s65 offen lds
    s_add_u32 s68, s65, s4
    s_add_u32 m0, s81, 51200
    s_nop 0
    buffer_load_dwordx4 v8, s[44:47], s68 offen lds
Lnd_294:
    v_mfma_f32_16x16x32_bf16 v[208:211], v[64:67], v[36:39], v[208:211]
    v_mfma_f32_16x16x32_bf16 v[212:215], v[68:71], v[36:39], v[212:215]
    v_mfma_f32_16x16x32_bf16 v[216:219], v[72:75], v[36:39], v[216:219]
    v_mfma_f32_16x16x32_bf16 v[220:223], v[76:79], v[36:39], v[220:223]
    ds_read_b128 v[36:39], v2 offset:10240
    s_cbranch_vccnz Lnd_295
    s_add_u32 s68, s65, s4
    s_add_u32 m0, s81, 52224
    s_nop 0
    buffer_load_dwordx4 v9, s[44:47], s68 offen lds
    s_add_u32 m0, s81, 98304
    s_nop 0
    buffer_load_dwordx4 v10, s[48:51], s66 offen lds
    s_add_u32 s68, s66, s5
    s_add_u32 m0, s81, 99328
    s_nop 0
    buffer_load_dwordx4 v10, s[48:51], s68 offen lds
Lnd_295:
    v_mfma_f32_16x16x32_bf16 v[224:227], v[64:67], v[40:43], v[224:227]
    v_mfma_f32_16x16x32_bf16 v[228:231], v[68:71], v[40:43], v[228:231]
    v_mfma_f32_16x16x32_bf16 v[232:235], v[72:75], v[40:43], v[232:235]
    v_mfma_f32_16x16x32_bf16 v[236:239], v[76:79], v[40:43], v[236:239]
    ds_read_b128 v[40:43], v2 offset:12288
    s_cbranch_vccnz Lnd_296
    s_add_u32 m0, s81, 100352
    s_nop 0
    buffer_load_dwordx4 v11, s[48:51], s66 offen lds
    s_add_u32 s68, s66, s5
    s_add_u32 m0, s81, 101376
    s_nop 0
    buffer_load_dwordx4 v11, s[48:51], s68 offen lds
    s_add_u32 m0, s81, 114688
    s_nop 0
    buffer_load_dwordx4 v12, s[96:99], s67 offen lds
Lnd_296:
    v_mfma_f32_16x16x32_bf16 v[240:243], v[64:67], v[44:47], v[240:243]
    v_mfma_f32_16x16x32_bf16 v[244:247], v[68:71], v[44:47], v[244:247]
    v_mfma_f32_16x16x32_bf16 v[248:251], v[72:75], v[44:47], v[248:251]
    v_mfma_f32_16x16x32_bf16 v[252:255], v[76:79], v[44:47], v[252:255]
    ds_read_b128 v[44:47], v2 offset:14336
    s_cbranch_vccnz Lnd_297
    s_add_u32 s68, s67, s6
    s_add_u32 m0, s81, 115712
    s_nop 0
    buffer_load_dwordx4 v12, s[96:99], s68 offen lds
    s_add_u32 m0, s81, 116736
    s_nop 0
    buffer_load_dwordx4 v13, s[96:99], s67 offen lds
    s_add_u32 s68, s67, s6
    s_add_u32 m0, s81, 117760
    s_nop 0
    buffer_load_dwordx4 v13, s[96:99], s68 offen lds
Lnd_297:
    s_add_u32 s64, s64, 128
    s_add_u32 s65, s65, 128
    s_add_u32 s66, s66, s7
    s_add_u32 s67, s67, s8
    s_cbranch_vccz Lnb_298
    s_add_u32 s56, s36, 0
    s_addc_u32 s57, s37, 0
    s_mov_b32 s58, 2048
    s_and_b32 s57, s57, 0xffff
    s_mov_b32 s59, 0x00020000
    v_lshlrev_b32 v121, 4, v1
    s_lshl_b32 s68, s62, 10
    buffer_load_dwordx4 v[124:127], v121, s[56:59], s68 offen
    s_add_u32 s56, s32, 0
    s_addc_u32 s57, s33, 0
    s_mov_b32 s58, 7168
    s_and_b32 s57, s57, 0xffff
    s_mov_b32 s59, 0x00020000
    v_lshrrev_b32 v120, 4, v1
    v_lshlrev_b32 v120, 3, v120
    s_lshl_b32 s68, s82, 8
    s_lshl_b32 s69, s62, 7
    s_add_u32 s69, s69, s68
    buffer_load_dwordx2 v[112:113], v120, s[56:59], s69 offen offset:0
    buffer_load_dwordx2 v[114:115], v120, s[56:59], s69 offen offset:32
    buffer_load_dwordx2 v[116:117], v120, s[56:59], s69 offen offset:64
    buffer_load_dwordx2 v[118:119], v120, s[56:59], s69 offen offset:96
Lnb_298:
    s_waitcnt lgkmcnt(4)
    v_mfma_f32_16x16x32_bf16 v[128:131], v[48:51], v[16:19], v[128:131]
    v_mfma_f32_16x16x32_bf16 v[132:135], v[52:55], v[16:19], v[132:135]
    v_mfma_f32_16x16x32_bf16 v[136:139], v[56:59], v[16:19], v[136:139]
    v_mfma_f32_16x16x32_bf16 v[140:143], v[60:63], v[16:19], v[140:143]
    ds_read_b128 v[16:19], v3 offset:0
    ds_read_b64_tr_b16 v[64:65], v4 offset:8192
    ds_read_b64_tr_b16 v[66:67], v4 offset:9216
    v_mfma_f32_16x16x32_bf16 v[144:147], v[48:51], v[20:23], v[144:147]
    v_mfma_f32_16x16x32_bf16 v[148:151], v[52:55], v[20:23], v[148:151]
    v_mfma_f32_16x16x32_bf16 v[152:155], v[56:59], v[20:23], v[152:155]
    v_mfma_f32_16x16x32_bf16 v[156:159], v[60:63], v[20:23], v[156:159]
    ds_read_b128 v[20:23], v3 offset:2048
    ds_read_b64_tr_b16 v[68:69], v5 offset:8192
    ds_read_b64_tr_b16 v[70:71], v5 offset:9216
    v_mfma_f32_16x16x32_bf16 v[160:163], v[48:51], v[24:27], v[160:163]
    v_mfma_f32_16x16x32_bf16 v[164:167], v[52:55], v[24:27], v[164:167]
    v_mfma_f32_16x16x32_bf16 v[168:171], v[56:59], v[24:27], v[168:171]
    v_mfma_f32_16x16x32_bf16 v[172:175], v[60:63], v[24:27], v[172:175]
    ds_read_b128 v[24:27], v3 offset:4096
    ds_read_b64_tr_b16 v[72:73], v6 offset:8192
    ds_read_b64_tr_b16 v[74:75], v6 offset:9216
    v_mfma_f32_16x16x32_bf16 v[176:179], v[48:51], v[28:31], v[176:179]
    v_mfma_f32_16x16x32_bf16 v[180:183], v[52:55], v[28:31], v[180:183]
    v_mfma_f32_16x16x32_bf16 v[184:187], v[56:59], v[28:31], v[184:187]
    v_mfma_f32_16x16x32_bf16 v[188:191], v[60:63], v[28:31], v[188:191]
    ds_read_b128 v[28:31], v3 offset:6144
    ds_read_b64_tr_b16 v[76:77], v7 offset:8192
    ds_read_b64_tr_b16 v[78:79], v7 offset:9216
    s_waitcnt lgkmcnt(12)
    v_mfma_f32_16x16x32_bf16 v[192:195], v[48:51], v[32:35], v[192:195]
    v_mfma_f32_16x16x32_bf16 v[196:199], v[52:55], v[32:35], v[196:199]
    v_mfma_f32_16x16x32_bf16 v[200:203], v[56:59], v[32:35], v[200:203]
    v_mfma_f32_16x16x32_bf16 v[204:207], v[60:63], v[32:35], v[204:207]
    ds_read_b128 v[32:35], v3 offset:8192
    v_mfma_f32_16x16x32_bf16 v[208:211], v[48:51], v[36:39], v[208:211]
    v_mfma_f32_16x16x32_bf16 v[212:215], v[52:55], v[36:39], v[212:215]
    v_mfma_f32_16x16x32_bf16 v[216:219], v[56:59], v[36:39], v[216:219]
    v_mfma_f32_16x16x32_bf16 v[220:223], v[60:63], v[36:39], v[220:223]
    ds_read_b128 v[36:39], v3 offset:10240
    v_mfma_f32_16x16x32_bf16 v[224:227], v[48:51], v[40:43], v[224:227]
    v_mfma_f32_16x16x32_bf16 v[228:231], v[52:55], v[40:43], v[228:231]
    v_mfma_f32_16x16x32_bf16 v[232:235], v[56:59], v[40:43], v[232:235]
    v_mfma_f32_16x16x32_bf16 v[236:239], v[60:63], v[40:43], v[236:239]
    ds_read_b128 v[40:43], v3 offset:12288
    v_mfma_f32_16x16x32_bf16 v[240:243], v[48:51], v[44:47], v[240:243]
    v_mfma_f32_16x16x32_bf16 v[244:247], v[52:55], v[44:47], v[244:247]
    v_mfma_f32_16x16x32_bf16 v[248:251], v[56:59], v[44:47], v[248:251]
    v_mfma_f32_16x16x32_bf16 v[252:255], v[60:63], v[44:47], v[252:255]
    ds_read_b128 v[44:47], v3 offset:14336
    s_waitcnt lgkmcnt(4)
    v_mfma_f32_16x16x32_bf16 v[128:131], v[64:67], v[16:19], v[128:131]
    v_mfma_f32_16x16x32_bf16 v[132:135], v[68:71], v[16:19], v[132:135]
    v_mfma_f32_16x16x32_bf16 v[136:139], v[72:75], v[16:19], v[136:139]
    v_mfma_f32_16x16x32_bf16 v[140:143], v[76:79], v[16:19], v[140:143]
    v_mfma_f32_16x16x32_bf16 v[144:147], v[64:67], v[20:23], v[144:147]
    v_mfma_f32_16x16x32_bf16 v[148:151], v[68:71], v[20:23], v[148:151]
    v_mfma_f32_16x16x32_bf16 v[152:155], v[72:75], v[20:23], v[152:155]
    v_mfma_f32_16x16x32_bf16 v[156:159], v[76:79], v[20:23], v[156:159]
    s_waitcnt lgkmcnt(0)
    s_cbranch_vccnz Lfw_299
    s_waitcnt vmcnt(0)
Lfw_299:
Lfw_300:
    s_barrier
    ds_read_b128 v[16:19], v2 offset:32768
    ds_read_b128 v[20:23], v2 offset:34816
    ds_read_b64_tr_b16 v[48:49], v4 offset:32768
    ds_read_b64_tr_b16 v[50:51], v4 offset:33792
    ds_read_b64_tr_b16 v[52:53], v5 offset:32768
    ds_read_b64_tr_b16 v[54:55], v5 offset:33792
    v_mfma_f32_16x16x32_bf16 v[160:163], v[64:67], v[24:27], v[160:163]
    v_mfma_f32_16x16x32_bf16 v[164:167], v[68:71], v[24:27], v[164:167]
    v_mfma_f32_16x16x32_bf16 v[168:171], v[72:75], v[24:27], v[168:171]
    v_mfma_f32_16x16x32_bf16 v[172:175], v[76:79], v[24:27], v[172:175]
    ds_read_b128 v[24:27], v2 offset:36864
    ds_read_b64_tr_b16 v[56:57], v6 offset:32768
    ds_read_b64_tr_b16 v[58:59], v6 offset:33792
    v_mfma_f32_16x16x32_bf16 v[176:179], v[64:67], v[28:31], v[176:179]
    v_mfma_f32_16x16x32_bf16 v[180:183], v[68:71], v[28:31], v[180:183]
    v_mfma_f32_16x16x32_bf16 v[184:187], v[72:75], v[28:31], v[184:187]
    v_mfma_f32_16x16x32_bf16 v[188:191], v[76:79], v[28:31], v[188:191]
    ds_read_b128 v[28:31], v2 offset:38912
    ds_read_b64_tr_b16 v[60:61], v7 offset:32768
    ds_read_b64_tr_b16 v[62:63], v7 offset:33792
    v_mfma_f32_16x16x32_bf16 v[192:195], v[64:67], v[32:35], v[192:195]
    v_mfma_f32_16x16x32_bf16 v[196:199], v[68:71], v[32:35], v[196:199]
    v_mfma_f32_16x16x32_bf16 v[200:203], v[72:75], v[32:35], v[200:203]
    v_mfma_f32_16x16x32_bf16 v[204:207], v[76:79], v[32:35], v[204:207]
    ds_read_b128 v[32:35], v2 offset:40960
    v_mfma_f32_16x16x32_bf16 v[208:211], v[64:67], v[36:39], v[208:211]
    v_mfma_f32_16x16x32_bf16 v[212:215], v[68:71], v[36:39], v[212:215]
    v_mfma_f32_16x16x32_bf16 v[216:219], v[72:75], v[36:39], v[216:219]
    v_mfma_f32_16x16x32_bf16 v[220:223], v[76:79], v[36:39], v[220:223]
    ds_read_b128 v[36:39], v2 offset:43008
    v_mfma_f32_16x16x32_bf16 v[224:227], v[64:67], v[40:43], v[224:227]
    v_mfma_f32_16x16x32_bf16 v[228:231], v[68:71], v[40:43], v[228:231]
    v_mfma_f32_16x16x32_bf16 v[232:235], v[72:75], v[40:43], v[232:235]
    v_mfma_f32_16x16x32_bf16 v[236:239], v[76:79], v[40:43], v[236:239]
    ds_read_b128 v[40:43], v2 offset:45056
    v_mfma_f32_16x16x32_bf16 v[240:243], v[64:67], v[44:47], v[240:243]
    v_mfma_f32_16x16x32_bf16 v[244:247], v[68:71], v[44:47], v[244:247]
    v_mfma_f32_16x16x32_bf16 v[248:251], v[72:75], v[44:47], v[248:251]
    v_mfma_f32_16x16x32_bf16 v[252:255], v[76:79], v[44:47], v[252:255]
    ds_read_b128 v[44:47], v2 offset:47104
    v_and_b32 v124, 7, v1
    v_and_b32 v125, 8, v1
    v_lshlrev_b32 v125, 4, v125
    v_add_u32 v124, v124, v125
    s_lshr_b32 s68, s73, 1
    s_lshl_b32 s68, s68, 3
    v_add_u32 v124, s68, v124
    v_lshlrev_b32 v124, 7, v124
    v_add_u32 v124, 32768, v124
    s_cmp_lg_u32 s60, 0
    s_cbranch_scc1 Lnw0_301
    s_add_u32 s56, s42, 209715200
    s_addc_u32 s57, s43, 0
    s_mov_b32 s58, 262144
    s_and_b32 s57, s57, 0xffff
    s_mov_b32 s59, 0x00020000
    buffer_load_dwordx2 v[126:127], v124, s[56:59], 0 offen sc0 sc1
Lnw0_301:
    s_waitcnt lgkmcnt(4)
    v_mfma_f32_16x16x32_bf16 v[128:131], v[48:51], v[16:19], v[128:131]
    v_mfma_f32_16x16x32_bf16 v[132:135], v[52:55], v[16:19], v[132:135]
    v_mfma_f32_16x16x32_bf16 v[136:139], v[56:59], v[16:19], v[136:139]
    v_mfma_f32_16x16x32_bf16 v[140:143], v[60:63], v[16:19], v[140:143]
    ds_read_b128 v[16:19], v3 offset:32768
    ds_read_b64_tr_b16 v[64:65], v4 offset:40960
    ds_read_b64_tr_b16 v[66:67], v4 offset:41984
    v_mfma_f32_16x16x32_bf16 v[144:147], v[48:51], v[20:23], v[144:147]
    v_mfma_f32_16x16x32_bf16 v[148:151], v[52:55], v[20:23], v[148:151]
    v_mfma_f32_16x16x32_bf16 v[152:155], v[56:59], v[20:23], v[152:155]
    v_mfma_f32_16x16x32_bf16 v[156:159], v[60:63], v[20:23], v[156:159]
    ds_read_b128 v[20:23], v3 offset:34816
    ds_read_b64_tr_b16 v[68:69], v5 offset:40960
    ds_read_b64_tr_b16 v[70:71], v5 offset:41984
    v_mfma_f32_16x16x32_bf16 v[160:163], v[48:51], v[24:27], v[160:163]
    v_mfma_f32_16x16x32_bf16 v[164:167], v[52:55], v[24:27], v[164:167]
    v_mfma_f32_16x16x32_bf16 v[168:171], v[56:59], v[24:27], v[168:171]
    v_mfma_f32_16x16x32_bf16 v[172:175], v[60:63], v[24:27], v[172:175]
    ds_read_b128 v[24:27], v3 offset:36864
    ds_read_b64_tr_b16 v[72:73], v6 offset:40960
    ds_read_b64_tr_b16 v[74:75], v6 offset:41984
    v_mfma_f32_16x16x32_bf16 v[176:179], v[48:51], v[28:31], v[176:179]
    v_mfma_f32_16x16x32_bf16 v[180:183], v[52:55], v[28:31], v[180:183]
    v_mfma_f32_16x16x32_bf16 v[184:187], v[56:59], v[28:31], v[184:187]
    v_mfma_f32_16x16x32_bf16 v[188:191], v[60:63], v[28:31], v[188:191]
    ds_read_b128 v[28:31], v3 offset:38912
    ds_read_b64_tr_b16 v[76:77], v7 offset:40960
    ds_read_b64_tr_b16 v[78:79], v7 offset:41984
    s_waitcnt lgkmcnt(12)
    v_mfma_f32_16x16x32_bf16 v[192:195], v[48:51], v[32:35], v[192:195]
    v_mfma_f32_16x16x32_bf16 v[196:199], v[52:55], v[32:35], v[196:199]
    v_mfma_f32_16x16x32_bf16 v[200:203], v[56:59], v[32:35], v[200:203]
    v_mfma_f32_16x16x32_bf16 v[204:207], v[60:63], v[32:35], v[204:207]
    ds_read_b128 v[32:35], v3 offset:40960
    v_mfma_f32_16x16x32_bf16 v[208:211], v[48:51], v[36:39], v[208:211]
    v_mfma_f32_16x16x32_bf16 v[212:215], v[52:55], v[36:39], v[212:215]
    v_mfma_f32_16x16x32_bf16 v[216:219], v[56:59], v[36:39], v[216:219]
    v_mfma_f32_16x16x32_bf16 v[220:223], v[60:63], v[36:39], v[220:223]
    ds_read_b128 v[36:39], v3 offset:43008
    v_mfma_f32_16x16x32_bf16 v[224:227], v[48:51], v[40:43], v[224:227]
    v_mfma_f32_16x16x32_bf16 v[228:231], v[52:55], v[40:43], v[228:231]
    v_mfma_f32_16x16x32_bf16 v[232:235], v[56:59], v[40:43], v[232:235]
    v_mfma_f32_16x16x32_bf16 v[236:239], v[60:63], v[40:43], v[236:239]
    ds_read_b128 v[40:43], v3 offset:45056
    v_mfma_f32_16x16x32_bf16 v[240:243], v[48:51], v[44:47], v[240:243]
    v_mfma_f32_16x16x32_bf16 v[244:247], v[52:55], v[44:47], v[244:247]
    v_mfma_f32_16x16x32_bf16 v[248:251], v[56:59], v[44:47], v[248:251]
    v_mfma_f32_16x16x32_bf16 v[252:255], v[60:63], v[44:47], v[252:255]
    ds_read_b128 v[44:47], v3 offset:47104
    s_waitcnt lgkmcnt(4)
    v_mfma_f32_16x16x32_bf16 v[128:131], v[64:67], v[16:19], v[128:131]
    v_mfma_f32_16x16x32_bf16 v[132:135], v[68:71], v[16:19], v[132:135]
    v_mfma_f32_16x16x32_bf16 v[136:139], v[72:75], v[16:19], v[136:139]
    v_mfma_f32_16x16x32_bf16 v[140:143], v[76:79], v[16:19], v[140:143]
    v_mfma_f32_16x16x32_bf16 v[144:147], v[64:67], v[20:23], v[144:147]
    v_mfma_f32_16x16x32_bf16 v[148:151], v[68:71], v[20:23], v[148:151]
    v_mfma_f32_16x16x32_bf16 v[152:155], v[72:75], v[20:23], v[152:155]
    v_mfma_f32_16x16x32_bf16 v[156:159], v[76:79], v[20:23], v[156:159]
    s_waitcnt lgkmcnt(0)
    v_mfma_f32_16x16x32_bf16 v[160:163], v[64:67], v[24:27], v[160:163]
    v_mfma_f32_16x16x32_bf16 v[164:167], v[68:71], v[24:27], v[164:167]
    v_mfma_f32_16x16x32_bf16 v[168:171], v[72:75], v[24:27], v[168:171]
    v_mfma_f32_16x16x32_bf16 v[172:175], v[76:79], v[24:27], v[172:175]
    v_mfma_f32_16x16x32_bf16 v[176:179], v[64:67], v[28:31], v[176:179]
    v_mfma_f32_16x16x32_bf16 v[180:183], v[68:71], v[28:31], v[180:183]
    v_mfma_f32_16x16x32_bf16 v[184:187], v[72:75], v[28:31], v[184:187]
    v_mfma_f32_16x16x32_bf16 v[188:191], v[76:79], v[28:31], v[188:191]
    v_mfma_f32_16x16x32_bf16 v[192:195], v[64:67], v[32:35], v[192:195]
    v_mfma_f32_16x16x32_bf16 v[196:199], v[68:71], v[32:35], v[196:199]
    v_mfma_f32_16x16x32_bf16 v[200:203], v[72:75], v[32:35], v[200:203]
    v_mfma_f32_16x16x32_bf16 v[204:207], v[76:79], v[32:35], v[204:207]
    v_mfma_f32_16x16x32_bf16 v[208:211], v[64:67], v[36:39], v[208:211]
    v_mfma_f32_16x16x32_bf16 v[212:215], v[68:71], v[36:39], v[212:215]
    v_mfma_f32_16x16x32_bf16 v[216:219], v[72:75], v[36:39], v[216:219]
    v_mfma_f32_16x16x32_bf16 v[220:223], v[76:79], v[36:39], v[220:223]
    v_mfma_f32_16x16x32_bf16 v[224:227], v[64:67], v[40:43], v[224:227]
    v_mfma_f32_16x16x32_bf16 v[228:231], v[68:71], v[40:43], v[228:231]
    v_mfma_f32_16x16x32_bf16 v[232:235], v[72:75], v[40:43], v[232:235]
    v_mfma_f32_16x16x32_bf16 v[236:239], v[76:79], v[40:43], v[236:239]
    v_mfma_f32_16x16x32_bf16 v[240:243], v[64:67], v[44:47], v[240:243]
    v_mfma_f32_16x16x32_bf16 v[244:247], v[68:71], v[44:47], v[244:247]
    v_mfma_f32_16x16x32_bf16 v[248:251], v[72:75], v[44:47], v[248:251]
    v_mfma_f32_16x16x32_bf16 v[252:255], v[76:79], v[44:47], v[252:255]
    s_cmp_lg_u32 s60, 0
    s_cbranch_scc1 Lnw0_302
    s_waitcnt vmcnt(0)
    s_add_u32 s56, s42, 209715200
    s_addc_u32 s57, s43, 0
    s_mov_b32 s58, 262144
    s_and_b32 s57, s57, 0xffff
    s_mov_b32 s59, 0x00020000
    s_mov_b32 s14, 0x400000
    s_branch Lpoll_303
Lld_305:
    buffer_load_dwordx2 v[126:127], v124, s[56:59], 0 offen sc0 sc1
    s_waitcnt vmcnt(0)
Lpoll_303:
    v_cmp_ne_u32 vcc, s12, v126
    v_cmp_ne_u32 s[68:69], s13, v127
    s_nop 3
    s_or_b64 vcc, vcc, s[68:69]
    s_cbranch_scc0 Lok_304
    s_sleep 1
    s_sub_u32 s14, s14, 1
    s_cmp_lg_u32 s14, 0
    s_cbranch_scc1 Lld_305
    s_mov_b64 vcc, 0
Lok_304:
Lnw0_302:
    s_branch proj_loop_done
proj_noh:
    s_waitcnt lgkmcnt(0)
    buffer_store_dwordx4 v[96:99], v0, s[52:55], s83 offen sc0 sc1
    buffer_store_dwordx4 v[100:103], v14, s[52:55], s83 offen sc0 sc1
    s_add_u32 s83, s83, s84
    buffer_store_dwordx4 v[104:107], v0, s[52:55], s83 offen sc0 sc1
    buffer_store_dwordx4 v[108:111], v14, s[52:55], s83 offen sc0 sc1
    s_add_u32 s83, s83, s85
    buffer_store_dwordx4 v[112:115], v0, s[52:55], s83 offen sc0 sc1
    buffer_store_dwordx4 v[116:119], v14, s[52:55], s83 offen sc0 sc1
    s_add_u32 s83, s83, s84
    buffer_store_dwordx4 v[120:123], v0, s[52:55], s83 offen sc0 sc1
    buffer_store_dwordx4 v[124:127], v14, s[52:55], s83 offen sc0 sc1
    s_add_u32 s83, s83, s84
    buffer_store_dwordx4 v[80:83], v0, s[52:55], s83 offen sc0 sc1
    buffer_store_dwordx4 v[84:87], v14, s[52:55], s83 offen sc0 sc1
    s_add_u32 s83, s83, s84
    buffer_store_dwordx4 v[88:91], v0, s[52:55], s83 offen sc0 sc1
    buffer_store_dwordx4 v[92:95], v14, s[52:55], s83 offen sc0 sc1
    s_waitcnt vmcnt(0)
    s_barrier
    s_barrier
    s_barrier
    s_barrier
    s_barrier
    s_barrier
    s_barrier
    s_barrier
    s_barrier
    s_barrier
    s_barrier
    s_barrier
    s_barrier
    s_barrier
    s_barrier
proj_loop_done:
    s_barrier
    s_mov_b32 s84, s61
    s_mov_b32 s85, s62
    s_mov_b32 s61, s63
    s_and_b32 s62, s60, 3
    s_and_b32 s68, s2, 7
    s_lshr_b32 s69, s2, 3
    s_and_b32 s75, s69, 7
    s_lshr_b32 s69, s69, 3
    s_lshl_b32 s72, s68, 2
    s_add_u32 s72, s72, s69
    s_sub_u32 s74, 15, s75
    s_lshl_b32 s68, s74, 1
    s_sub_u32 s68, s68, 15
    s_lshl_b32 s68, s68, 14
    s_lshl_b32 s69, s75, 1
    s_add_u32 s11, s69, 2
    s_cmp_eq_u32 s61, 0
    s_cselect_b32 s64, s68, 0
    s_cselect_b32 s6, 99, s11
    s_mov_b32 s65, s64
    s_mov_b32 s63, s6
    s_lshl_b32 s70, s72, 19
    s_add_u32 s71, s70, 20971520
    s_add_u32 s44, s42, s71
    s_addc_u32 s45, s43, 0
    s_and_b32 s45, s45, 0xffff
    s_mov_b32 s46, 524288
    s_mov_b32 s47, 0x00020000
    s_add_u32 s71, s70, 37748736
    s_add_u32 s48, s42, s71
    s_addc_u32 s49, s43, 0
    s_and_b32 s49, s49, 0xffff
    s_mov_b32 s50, 524288
    s_mov_b32 s51, 0x00020000
    s_lshl_b32 s68, s62, 12
    v_lshrrev_b32 v12, 4, v1
    v_and_b32 v13, 15, v1
    v_xor_b32 v13, v13, v12
    v_lshlrev_b32 v13, 4, v13
    v_lshlrev_b32 v12, 8, v12
    v_add3_u32 v2, v12, v13, s68
    v_lshrrev_b32 v12, 3, v1
    v_lshrrev_b32 v14, 4, v1
    v_and_b32 v13, 7, v1
    v_xor_b32 v13, v13, v14
    v_lshlrev_b32 v13, 4, v13
    v_lshlrev_b32 v12, 7, v12
    v_add3_u32 v3, v12, v13, s68
    s_mul_i32 s67, s61, 69632
    s_mul_i32 s68, s62, 4352
    s_add_u32 s67, s67, s68
    s_add_u32 s68, s67, 17408
    s_xor_b32 s7, s68, s67
    s_add_u32 s5, s67, 34816
    s_add_u32 s69, s67, 52224
    s_xor_b32 s8, s5, s69
    s_mov_b32 s4, s67
    s_cmp_lg_u32 s61, 0
    s_cbranch_scc1 Lnk_306
    s_add_u32 m0, s4, 0
    s_nop 0
    buffer_load_dwordx4 v2, s[44:47], s64 offen offset:0 lds
    s_add_u32 m0, s4, 64
    s_nop 0
    buffer_load_dwordx4 v2, s[44:47], s64 offen offset:1024 lds
    s_add_u32 m0, s4, 128
    s_nop 0
    buffer_load_dwordx4 v2, s[44:47], s64 offen offset:2048 lds
    s_add_u32 m0, s4, 192
    s_nop 0
    buffer_load_dwordx4 v2, s[44:47], s64 offen offset:3072 lds
    s_mov_b32 s68, 0
    s_add_u32 m0, s4, 69632
    s_nop 0
    buffer_load_dwordx4 v2, s[44:47], s68 offen offset:0 lds
    s_add_u32 m0, s4, 69696
    s_nop 0
    buffer_load_dwordx4 v2, s[44:47], s68 offen offset:1024 lds
    s_add_u32 m0, s4, 69760
    s_nop 0
    buffer_load_dwordx4 v2, s[44:47], s68 offen offset:2048 lds
    s_add_u32 m0, s4, 69824
    s_nop 0
    buffer_load_dwordx4 v2, s[44:47], s68 offen offset:3072 lds
Lnk_306:
    s_add_u32 s64, s64, 16384
    s_xor_b32 s4, s4, s7
    s_sub_u32 s6, s6, 1
    s_cmp_eq_u32 s6, 0
    s_cselect_b32 s64, 0, s64
    s_cmp_lg_u32 s61, 0
    s_cbranch_scc1 Lnk_307
    s_add_u32 m0, s4, 0
    s_nop 0
    buffer_load_dwordx4 v2, s[44:47], s64 offen offset:0 lds
    s_add_u32 m0, s4, 64
    s_nop 0
    buffer_load_dwordx4 v2, s[44:47], s64 offen offset:1024 lds
    s_add_u32 m0, s4, 128
    s_nop 0
    buffer_load_dwordx4 v2, s[44:47], s64 offen offset:2048 lds
    s_add_u32 m0, s4, 192
    s_nop 0
    buffer_load_dwordx4 v2, s[44:47], s64 offen offset:3072 lds
    s_mov_b32 s68, 16384
    s_add_u32 m0, s4, 69632
    s_nop 0
    buffer_load_dwordx4 v2, s[44:47], s68 offen offset:0 lds
    s_add_u32 m0, s4, 69696
    s_nop 0
    buffer_load_dwordx4 v2, s[44:47], s68 offen offset:1024 lds
    s_add_u32 m0, s4, 69760
    s_nop 0
    buffer_load_dwordx4 v2, s[44:47], s68 offen offset:2048 lds
    s_add_u32 m0, s4, 69824
    s_nop 0
    buffer_load_dwordx4 v2, s[44:47], s68 offen offset:3072 lds
Lnk_307:
    s_add_u32 s64, s64, 16384
    s_xor_b32 s4, s4, s7
    s_sub_u32 s6, s6, 1
    s_cmp_eq_u32 s6, 0
    s_cselect_b32 s64, 0, s64
    s_cbranch_vccnz proj_hepi
    s_mov_b32 s76, 0x3e0293ee
    s_mov_b32 s77, 0x3e0293ee
    v_and_b32 v80, 15, v1
    v_lshlrev_b32 v80, 4, v80
    v_lshrrev_b32 v81, 4, v1
    v_and_b32 v82, 1, v81
    v_lshlrev_b32 v82, 9, v82
    v_lshrrev_b32 v81, 1, v81
    v_lshlrev_b32 v81, 8, v81
    v_add3_u32 v88, v80, v81, v82
    s_mul_i32 s68, s84, 69632
    s_lshl_b32 s69, s85, 11
    s_add_u32 s68, s68, s69
    s_add_u32 s68, s68, 34816
    v_add_u32 v88, s68, v88
    v_pk_mul_f32 v[128:129], v[128:129], s[76:77]
    v_pk_mul_f32 v[130:131], v[130:131], s[76:77]
    v_pk_mul_f32 v[132:133], v[132:133], s[76:77]
    v_pk_mul_f32 v[134:135], v[134:135], s[76:77]
    v_cvt_pk_bf16_f32 v96, v128, v129
    v_cvt_pk_bf16_f32 v97, v130, v131
    v_cvt_pk_bf16_f32 v98, v132, v133
    v_cvt_pk_bf16_f32 v99, v134, v135
    s_nop 1
    v_permlane16_swap_b32 v96, v98
    v_permlane16_swap_b32 v97, v99
    s_nop 0
    ds_write_b128 v88, v[96:99] offset:0
    v_pk_mul_f32 v[136:137], v[136:137], s[76:77]
    v_pk_mul_f32 v[138:139], v[138:139], s[76:77]
    v_pk_mul_f32 v[140:141], v[140:141], s[76:77]
    v_pk_mul_f32 v[142:143], v[142:143], s[76:77]
    v_cvt_pk_bf16_f32 v100, v136, v137
    v_cvt_pk_bf16_f32 v101, v138, v139
    v_cvt_pk_bf16_f32 v102, v140, v141
    v_cvt_pk_bf16_f32 v103, v142, v143
    s_nop 1
    v_permlane16_swap_b32 v100, v102
    v_permlane16_swap_b32 v101, v103
    s_nop 0
    ds_write_b128 v88, v[100:103] offset:1024
    v_pk_mul_f32 v[144:145], v[144:145], s[76:77]
    v_pk_mul_f32 v[146:147], v[146:147], s[76:77]
    v_pk_mul_f32 v[148:149], v[148:149], s[76:77]
    v_pk_mul_f32 v[150:151], v[150:151], s[76:77]
    v_cvt_pk_bf16_f32 v104, v144, v145
    v_cvt_pk_bf16_f32 v105, v146, v147
    v_cvt_pk_bf16_f32 v106, v148, v149
    v_cvt_pk_bf16_f32 v107, v150, v151
    s_nop 1
    v_permlane16_swap_b32 v104, v106
    v_permlane16_swap_b32 v105, v107
    s_nop 0
    ds_write_b128 v88, v[104:107] offset:4096
    v_pk_mul_f32 v[152:153], v[152:153], s[76:77]
    v_pk_mul_f32 v[154:155], v[154:155], s[76:77]
    v_pk_mul_f32 v[156:157], v[156:157], s[76:77]
    v_pk_mul_f32 v[158:159], v[158:159], s[76:77]
    v_cvt_pk_bf16_f32 v108, v152, v153
    v_cvt_pk_bf16_f32 v109, v154, v155
    v_cvt_pk_bf16_f32 v110, v156, v157
    v_cvt_pk_bf16_f32 v111, v158, v159
    s_nop 1
    v_permlane16_swap_b32 v108, v110
    v_permlane16_swap_b32 v109, v111
    s_nop 0
    ds_write_b128 v88, v[108:111] offset:5120
    v_pk_mul_f32 v[160:161], v[160:161], s[76:77]
    v_pk_mul_f32 v[162:163], v[162:163], s[76:77]
    v_pk_mul_f32 v[164:165], v[164:165], s[76:77]
    v_pk_mul_f32 v[166:167], v[166:167], s[76:77]
    v_cvt_pk_bf16_f32 v112, v160, v161
    v_cvt_pk_bf16_f32 v113, v162, v163
    v_cvt_pk_bf16_f32 v114, v164, v165
    v_cvt_pk_bf16_f32 v115, v166, v167
    s_nop 1
    v_permlane16_swap_b32 v112, v114
    v_permlane16_swap_b32 v113, v115
    s_nop 0
    ds_write_b128 v88, v[112:115] offset:8192
    v_pk_mul_f32 v[168:169], v[168:169], s[76:77]
    v_pk_mul_f32 v[170:171], v[170:171], s[76:77]
    v_pk_mul_f32 v[172:173], v[172:173], s[76:77]
    v_pk_mul_f32 v[174:175], v[174:175], s[76:77]
    v_cvt_pk_bf16_f32 v116, v168, v169
    v_cvt_pk_bf16_f32 v117, v170, v171
    v_cvt_pk_bf16_f32 v118, v172, v173
    v_cvt_pk_bf16_f32 v119, v174, v175
    s_nop 1
    v_permlane16_swap_b32 v116, v118
    v_permlane16_swap_b32 v117, v119
    s_nop 0
    ds_write_b128 v88, v[116:119] offset:9216
    v_pk_mul_f32 v[176:177], v[176:177], s[76:77]
    v_pk_mul_f32 v[178:179], v[178:179], s[76:77]
    v_pk_mul_f32 v[180:181], v[180:181], s[76:77]
    v_pk_mul_f32 v[182:183], v[182:183], s[76:77]
    v_cvt_pk_bf16_f32 v120, v176, v177
    v_cvt_pk_bf16_f32 v121, v178, v179
    v_cvt_pk_bf16_f32 v122, v180, v181
    v_cvt_pk_bf16_f32 v123, v182, v183
    s_nop 1
    v_permlane16_swap_b32 v120, v122
    v_permlane16_swap_b32 v121, v123
    s_nop 0
    ds_write_b128 v88, v[120:123] offset:12288
    v_pk_mul_f32 v[184:185], v[184:185], s[76:77]
    v_pk_mul_f32 v[186:187], v[186:187], s[76:77]
    v_pk_mul_f32 v[188:189], v[188:189], s[76:77]
    v_pk_mul_f32 v[190:191], v[190:191], s[76:77]
    v_cvt_pk_bf16_f32 v124, v184, v185
    v_cvt_pk_bf16_f32 v125, v186, v187
    v_cvt_pk_bf16_f32 v126, v188, v189
    v_cvt_pk_bf16_f32 v127, v190, v191
    s_nop 1
    v_permlane16_swap_b32 v124, v126
    v_permlane16_swap_b32 v125, v127
    s_nop 0
    ds_write_b128 v88, v[124:127] offset:13312
    v_pk_mul_f32 v[192:193], v[192:193], s[76:77]
    v_pk_mul_f32 v[194:195], v[194:195], s[76:77]
    v_pk_mul_f32 v[196:197], v[196:197], s[76:77]
    v_pk_mul_f32 v[198:199], v[198:199], s[76:77]
    v_cvt_pk_bf16_f32 v96, v192, v193
    v_cvt_pk_bf16_f32 v97, v194, v195
    v_cvt_pk_bf16_f32 v98, v196, v197
    v_cvt_pk_bf16_f32 v99, v198, v199
    s_nop 1
    v_permlane16_swap_b32 v96, v98
    v_permlane16_swap_b32 v97, v99
    s_nop 0
    ds_write_b128 v88, v[96:99] offset:16384
    v_pk_mul_f32 v[200:201], v[200:201], s[76:77]
    v_pk_mul_f32 v[202:203], v[202:203], s[76:77]
    v_pk_mul_f32 v[204:205], v[204:205], s[76:77]
    v_pk_mul_f32 v[206:207], v[206:207], s[76:77]
    v_cvt_pk_bf16_f32 v100, v200, v201
    v_cvt_pk_bf16_f32 v101, v202, v203
    v_cvt_pk_bf16_f32 v102, v204, v205
    v_cvt_pk_bf16_f32 v103, v206, v207
    s_nop 1
    v_permlane16_swap_b32 v100, v102
    v_permlane16_swap_b32 v101, v103
    s_nop 0
    ds_write_b128 v88, v[100:103] offset:17408
    v_pk_mul_f32 v[208:209], v[208:209], s[76:77]
    v_pk_mul_f32 v[210:211], v[210:211], s[76:77]
    v_pk_mul_f32 v[212:213], v[212:213], s[76:77]
    v_pk_mul_f32 v[214:215], v[214:215], s[76:77]
    v_cvt_pk_bf16_f32 v104, v208, v209
    v_cvt_pk_bf16_f32 v105, v210, v211
    v_cvt_pk_bf16_f32 v106, v212, v213
    v_cvt_pk_bf16_f32 v107, v214, v215
    s_nop 1
    v_permlane16_swap_b32 v104, v106
    v_permlane16_swap_b32 v105, v107
    s_nop 0
    ds_write_b128 v88, v[104:107] offset:20480
    v_pk_mul_f32 v[216:217], v[216:217], s[76:77]
    v_pk_mul_f32 v[218:219], v[218:219], s[76:77]
    v_pk_mul_f32 v[220:221], v[220:221], s[76:77]
    v_pk_mul_f32 v[222:223], v[222:223], s[76:77]
    v_cvt_pk_bf16_f32 v108, v216, v217
    v_cvt_pk_bf16_f32 v109, v218, v219
    v_cvt_pk_bf16_f32 v110, v220, v221
    v_cvt_pk_bf16_f32 v111, v222, v223
    s_nop 1
    v_permlane16_swap_b32 v108, v110
    v_permlane16_swap_b32 v109, v111
    s_nop 0
    ds_write_b128 v88, v[108:111] offset:21504
    v_pk_mul_f32 v[224:225], v[224:225], s[76:77]
    v_pk_mul_f32 v[226:227], v[226:227], s[76:77]
    v_pk_mul_f32 v[228:229], v[228:229], s[76:77]
    v_pk_mul_f32 v[230:231], v[230:231], s[76:77]
    v_cvt_pk_bf16_f32 v112, v224, v225
    v_cvt_pk_bf16_f32 v113, v226, v227
    v_cvt_pk_bf16_f32 v114, v228, v229
    v_cvt_pk_bf16_f32 v115, v230, v231
    s_nop 1
    v_permlane16_swap_b32 v112, v114
    v_permlane16_swap_b32 v113, v115
    s_nop 0
    ds_write_b128 v88, v[112:115] offset:24576
    v_pk_mul_f32 v[232:233], v[232:233], s[76:77]
    v_pk_mul_f32 v[234:235], v[234:235], s[76:77]
    v_pk_mul_f32 v[236:237], v[236:237], s[76:77]
    v_pk_mul_f32 v[238:239], v[238:239], s[76:77]
    v_cvt_pk_bf16_f32 v116, v232, v233
    v_cvt_pk_bf16_f32 v117, v234, v235
    v_cvt_pk_bf16_f32 v118, v236, v237
    v_cvt_pk_bf16_f32 v119, v238, v239
    s_nop 1
    v_permlane16_swap_b32 v116, v118
    v_permlane16_swap_b32 v117, v119
    s_nop 0
    ds_write_b128 v88, v[116:119] offset:25600
    v_pk_mul_f32 v[240:241], v[240:241], s[76:77]
    v_pk_mul_f32 v[242:243], v[242:243], s[76:77]
    v_pk_mul_f32 v[244:245], v[244:245], s[76:77]
    v_pk_mul_f32 v[246:247], v[246:247], s[76:77]
    v_cvt_pk_bf16_f32 v120, v240, v241
    v_cvt_pk_bf16_f32 v121, v242, v243
    v_cvt_pk_bf16_f32 v122, v244, v245
    v_cvt_pk_bf16_f32 v123, v246, v247
    s_nop 1
    v_permlane16_swap_b32 v120, v122
    v_permlane16_swap_b32 v121, v123
    s_nop 0
    ds_write_b128 v88, v[120:123] offset:28672
    v_pk_mul_f32 v[248:249], v[248:249], s[76:77]
    v_pk_mul_f32 v[250:251], v[250:251], s[76:77]
    v_pk_mul_f32 v[252:253], v[252:253], s[76:77]
    v_pk_mul_f32 v[254:255], v[254:255], s[76:77]
    v_cvt_pk_bf16_f32 v124, v248, v249
    v_cvt_pk_bf16_f32 v125, v250, v251
    v_cvt_pk_bf16_f32 v126, v252, v253
    v_cvt_pk_bf16_f32 v127, v254, v255
    s_nop 1
    v_permlane16_swap_b32 v124, v126
    v_permlane16_swap_b32 v125, v127
    s_nop 0
    ds_write_b128 v88, v[124:127] offset:29696
proj_w0:
    s_waitcnt vmcnt(0) lgkmcnt(0)
    s_branch proj_done
proj_hepi:
    s_cmp_eq_u32 s82, 99
    s_cbranch_scc1 proj_w0
    s_add_u32 s52, s42, 54525952
    s_addc_u32 s53, s43, 0
    s_mov_b32 s54, 31719424
    s_and_b32 s53, s53, 0xffff
    s_mov_b32 s55, 0x00020000
    v_and_b32 v80, 15, v1
    s_mov_b32 s68, 15488
    v_mul_lo_u32 v80, v80, s68
    v_lshrrev_b32 v81, 4, v1
    v_and_b32 v82, 1, v81
    v_lshlrev_b32 v82, 5, v82
    v_lshrrev_b32 v81, 1, v81
    v_lshlrev_b32 v81, 4, v81
    v_add3_u32 v48, v80, v81, v82
    v_and_b32 v84, 8, v1
    s_mov_b32 s68, 15480
    v_mul_lo_u32 v84, v84, s68
    v_sub_u32 v48, v48, v84
    v_add_u32 v49, 123904, v48
    s_waitcnt vmcnt(0)
    v_lshlrev_b32 v80, 16, v112
    v_and_b32 v81, 0xffff0000, v112
    v_lshlrev_b32 v82, 16, v113
    v_and_b32 v83, 0xffff0000, v113
    v_lshlrev_b32 v84, 16, v114
    v_and_b32 v85, 0xffff0000, v114
    v_lshlrev_b32 v86, 16, v115
    v_and_b32 v87, 0xffff0000, v115
    v_lshlrev_b32 v88, 16, v116
    v_and_b32 v89, 0xffff0000, v116
    v_lshlrev_b32 v90, 16, v117
    v_and_b32 v91, 0xffff0000, v117
    v_lshlrev_b32 v92, 16, v118
    v_and_b32 v93, 0xffff0000, v118
    v_lshlrev_b32 v94, 16, v119
    v_and_b32 v95, 0xffff0000, v119
    s_mov_b32 s76, 0xbdd2d3e8
    s_mov_b32 s77, 0xbdd2d3e8
    v_mov_b32 v60, 0xc0135761
    v_mov_b32 v61, 0xc0135761
    v_mov_b32 v62, 1.0
    v_mov_b32 v63, 1.0
    s_cmp_eq_u32 s84, 0
    s_cselect_b32 s68, s74, s75
    s_mul_i32 s79, s68, 1982464
    s_lshl_b32 s68, s82, 8
    s_add_u32 s79, s79, s68
    s_lshl_b32 s68, s85, 7
    s_add_u32 s79, s79, s68
    s_add_u32 s79, s79, 8192
    v_pk_add_f32 v[128:129], v[128:129], v[80:81]
    v_pk_mul_f32 v[52:53], v[128:129], v[128:129]
    v_pk_fma_f32 v[52:53], v[52:53], s[76:77], v[60:61]
    v_pk_mul_f32 v[52:53], v[52:53], v[128:129]
    v_exp_f32 v52, v52
    v_exp_f32 v53, v53
    v_pk_add_f32 v[130:131], v[130:131], v[82:83]
    v_pk_mul_f32 v[54:55], v[130:131], v[130:131]
    v_pk_fma_f32 v[54:55], v[54:55], s[76:77], v[60:61]
    v_pk_mul_f32 v[54:55], v[54:55], v[130:131]
    v_exp_f32 v54, v54
    v_exp_f32 v55, v55
    v_pk_add_f32 v[52:53], v[52:53], v[62:63]
    v_rcp_f32 v52, v52
    v_rcp_f32 v53, v53
    v_pk_add_f32 v[54:55], v[54:55], v[62:63]
    v_rcp_f32 v54, v54
    v_rcp_f32 v55, v55
    v_pk_mul_f32 v[128:129], v[128:129], v[52:53]
    v_pk_mul_f32 v[130:131], v[130:131], v[54:55]
    v_pk_add_f32 v[132:133], v[132:133], v[84:85]
    v_pk_mul_f32 v[56:57], v[132:133], v[132:133]
    v_pk_fma_f32 v[56:57], v[56:57], s[76:77], v[60:61]
    v_pk_mul_f32 v[56:57], v[56:57], v[132:133]
    v_exp_f32 v56, v56
    v_exp_f32 v57, v57
    v_pk_add_f32 v[134:135], v[134:135], v[86:87]
    v_pk_mul_f32 v[58:59], v[134:135], v[134:135]
    v_pk_fma_f32 v[58:59], v[58:59], s[76:77], v[60:61]
    v_pk_mul_f32 v[58:59], v[58:59], v[134:135]
    v_exp_f32 v58, v58
    v_exp_f32 v59, v59
    v_pk_add_f32 v[56:57], v[56:57], v[62:63]
    v_rcp_f32 v56, v56
    v_rcp_f32 v57, v57
    v_pk_add_f32 v[58:59], v[58:59], v[62:63]
    v_rcp_f32 v58, v58
    v_rcp_f32 v59, v59
    v_pk_mul_f32 v[132:133], v[132:133], v[56:57]
    v_pk_mul_f32 v[134:135], v[134:135], v[58:59]
    v_cvt_pk_bf16_f32 v96, v128, v129
    v_cvt_pk_bf16_f32 v97, v130, v131
    v_cvt_pk_bf16_f32 v98, v132, v133
    v_cvt_pk_bf16_f32 v99, v134, v135
    s_nop 1
    v_permlane16_swap_b32 v96, v98
    v_permlane16_swap_b32 v97, v99
    v_pk_add_f32 v[136:137], v[136:137], v[88:89]
    v_pk_mul_f32 v[52:53], v[136:137], v[136:137]
    v_pk_fma_f32 v[52:53], v[52:53], s[76:77], v[60:61]
    v_pk_mul_f32 v[52:53], v[52:53], v[136:137]
    v_exp_f32 v52, v52
    v_exp_f32 v53, v53
    v_pk_add_f32 v[138:139], v[138:139], v[90:91]
    v_pk_mul_f32 v[54:55], v[138:139], v[138:139]
    v_pk_fma_f32 v[54:55], v[54:55], s[76:77], v[60:61]
    v_pk_mul_f32 v[54:55], v[54:55], v[138:139]
    v_exp_f32 v54, v54
    v_exp_f32 v55, v55
    v_pk_add_f32 v[52:53], v[52:53], v[62:63]
    v_rcp_f32 v52, v52
    v_rcp_f32 v53, v53
    v_pk_add_f32 v[54:55], v[54:55], v[62:63]
    v_rcp_f32 v54, v54
    v_rcp_f32 v55, v55
    v_pk_mul_f32 v[136:137], v[136:137], v[52:53]
    v_pk_mul_f32 v[138:139], v[138:139], v[54:55]
    v_pk_add_f32 v[140:141], v[140:141], v[92:93]
    v_pk_mul_f32 v[56:57], v[140:141], v[140:141]
    v_pk_fma_f32 v[56:57], v[56:57], s[76:77], v[60:61]
    v_pk_mul_f32 v[56:57], v[56:57], v[140:141]
    v_exp_f32 v56, v56
    v_exp_f32 v57, v57
    v_pk_add_f32 v[142:143], v[142:143], v[94:95]
    v_pk_mul_f32 v[58:59], v[142:143], v[142:143]
    v_pk_fma_f32 v[58:59], v[58:59], s[76:77], v[60:61]
    v_pk_mul_f32 v[58:59], v[58:59], v[142:143]
    v_exp_f32 v58, v58
    v_exp_f32 v59, v59
    v_pk_add_f32 v[56:57], v[56:57], v[62:63]
    v_rcp_f32 v56, v56
    v_rcp_f32 v57, v57
    v_pk_add_f32 v[58:59], v[58:59], v[62:63]
    v_rcp_f32 v58, v58
    v_rcp_f32 v59, v59
    v_pk_mul_f32 v[140:141], v[140:141], v[56:57]
    v_pk_mul_f32 v[142:143], v[142:143], v[58:59]
    v_cvt_pk_bf16_f32 v100, v136, v137
    v_cvt_pk_bf16_f32 v101, v138, v139
    v_cvt_pk_bf16_f32 v102, v140, v141
    v_cvt_pk_bf16_f32 v103, v142, v143
    s_nop 1
    v_permlane16_swap_b32 v100, v102
    v_permlane16_swap_b32 v101, v103
    s_nop 0
    v_mov_b32 v128, v100
    v_mov_b32 v129, v101
    v_mov_b32 v130, v102
    v_mov_b32 v131, v103
    v_mov_b32_dpp v100, v96 row_ror:8 row_mask:0xf bank_mask:0x3
    v_mov_b32_dpp v101, v97 row_ror:8 row_mask:0xf bank_mask:0x3
    v_mov_b32_dpp v102, v98 row_ror:8 row_mask:0xf bank_mask:0x3
    v_mov_b32_dpp v103, v99 row_ror:8 row_mask:0xf bank_mask:0x3
    v_mov_b32_dpp v96, v128 row_ror:8 row_mask:0xf bank_mask:0xc
    v_mov_b32_dpp v97, v129 row_ror:8 row_mask:0xf bank_mask:0xc
    v_mov_b32_dpp v98, v130 row_ror:8 row_mask:0xf bank_mask:0xc
    v_mov_b32_dpp v99, v131 row_ror:8 row_mask:0xf bank_mask:0xc
    s_add_u32 s78, s79, 0
    buffer_store_dwordx4 v[96:99], v48, s[52:55], s78 offen sc0 sc1
    buffer_store_dwordx4 v[100:103], v49, s[52:55], s78 offen sc0 sc1
    v_pk_add_f32 v[144:145], v[144:145], v[80:81]
    v_pk_mul_f32 v[52:53], v[144:145], v[144:145]
    v_pk_fma_f32 v[52:53], v[52:53], s[76:77], v[60:61]
    v_pk_mul_f32 v[52:53], v[52:53], v[144:145]
    v_exp_f32 v52, v52
    v_exp_f32 v53, v53
    v_pk_add_f32 v[146:147], v[146:147], v[82:83]
    v_pk_mul_f32 v[54:55], v[146:147], v[146:147]
    v_pk_fma_f32 v[54:55], v[54:55], s[76:77], v[60:61]
    v_pk_mul_f32 v[54:55], v[54:55], v[146:147]
    v_exp_f32 v54, v54
    v_exp_f32 v55, v55
    v_pk_add_f32 v[52:53], v[52:53], v[62:63]
    v_rcp_f32 v52, v52
    v_rcp_f32 v53, v53
    v_pk_add_f32 v[54:55], v[54:55], v[62:63]
    v_rcp_f32 v54, v54
    v_rcp_f32 v55, v55
    v_pk_mul_f32 v[144:145], v[144:145], v[52:53]
    v_pk_mul_f32 v[146:147], v[146:147], v[54:55]
    v_pk_add_f32 v[148:149], v[148:149], v[84:85]
    v_pk_mul_f32 v[56:57], v[148:149], v[148:149]
    v_pk_fma_f32 v[56:57], v[56:57], s[76:77], v[60:61]
    v_pk_mul_f32 v[56:57], v[56:57], v[148:149]
    v_exp_f32 v56, v56
    v_exp_f32 v57, v57
    v_pk_add_f32 v[150:151], v[150:151], v[86:87]
    v_pk_mul_f32 v[58:59], v[150:151], v[150:151]
    v_pk_fma_f32 v[58:59], v[58:59], s[76:77], v[60:61]
    v_pk_mul_f32 v[58:59], v[58:59], v[150:151]
    v_exp_f32 v58, v58
    v_exp_f32 v59, v59
    v_pk_add_f32 v[56:57], v[56:57], v[62:63]
    v_rcp_f32 v56, v56
    v_rcp_f32 v57, v57
    v_pk_add_f32 v[58:59], v[58:59], v[62:63]
    v_rcp_f32 v58, v58
    v_rcp_f32 v59, v59
    v_pk_mul_f32 v[148:149], v[148:149], v[56:57]
    v_pk_mul_f32 v[150:151], v[150:151], v[58:59]
    v_cvt_pk_bf16_f32 v104, v144, v145
    v_cvt_pk_bf16_f32 v105, v146, v147
    v_cvt_pk_bf16_f32 v106, v148, v149
    v_cvt_pk_bf16_f32 v107, v150, v151
    s_nop 1
    v_permlane16_swap_b32 v104, v106
    v_permlane16_swap_b32 v105, v107
    v_pk_add_f32 v[152:153], v[152:153], v[88:89]
    v_pk_mul_f32 v[52:53], v[152:153], v[152:153]
    v_pk_fma_f32 v[52:53], v[52:53], s[76:77], v[60:61]
    v_pk_mul_f32 v[52:53], v[52:53], v[152:153]
    v_exp_f32 v52, v52
    v_exp_f32 v53, v53
    v_pk_add_f32 v[154:155], v[154:155], v[90:91]
    v_pk_mul_f32 v[54:55], v[154:155], v[154:155]
    v_pk_fma_f32 v[54:55], v[54:55], s[76:77], v[60:61]
    v_pk_mul_f32 v[54:55], v[54:55], v[154:155]
    v_exp_f32 v54, v54
    v_exp_f32 v55, v55
    v_pk_add_f32 v[52:53], v[52:53], v[62:63]
    v_rcp_f32 v52, v52
    v_rcp_f32 v53, v53
    v_pk_add_f32 v[54:55], v[54:55], v[62:63]
    v_rcp_f32 v54, v54
    v_rcp_f32 v55, v55
    v_pk_mul_f32 v[152:153], v[152:153], v[52:53]
    v_pk_mul_f32 v[154:155], v[154:155], v[54:55]
    v_pk_add_f32 v[156:157], v[156:157], v[92:93]
    v_pk_mul_f32 v[56:57], v[156:157], v[156:157]
    v_pk_fma_f32 v[56:57], v[56:57], s[76:77], v[60:61]
    v_pk_mul_f32 v[56:57], v[56:57], v[156:157]
    v_exp_f32 v56, v56
    v_exp_f32 v57, v57
    v_pk_add_f32 v[158:159], v[158:159], v[94:95]
    v_pk_mul_f32 v[58:59], v[158:159], v[158:159]
    v_pk_fma_f32 v[58:59], v[58:59], s[76:77], v[60:61]
    v_pk_mul_f32 v[58:59], v[58:59], v[158:159]
    v_exp_f32 v58, v58
    v_exp_f32 v59, v59
    v_pk_add_f32 v[56:57], v[56:57], v[62:63]
    v_rcp_f32 v56, v56
    v_rcp_f32 v57, v57
    v_pk_add_f32 v[58:59], v[58:59], v[62:63]
    v_rcp_f32 v58, v58
    v_rcp_f32 v59, v59
    v_pk_mul_f32 v[156:157], v[156:157], v[56:57]
    v_pk_mul_f32 v[158:159], v[158:159], v[58:59]
    v_cvt_pk_bf16_f32 v108, v152, v153
    v_cvt_pk_bf16_f32 v109, v154, v155
    v_cvt_pk_bf16_f32 v110, v156, v157
    v_cvt_pk_bf16_f32 v111, v158, v159
    s_nop 1
    v_permlane16_swap_b32 v108, v110
    v_permlane16_swap_b32 v109, v111
    s_nop 0
    v_mov_b32 v144, v108
    v_mov_b32 v145, v109
    v_mov_b32 v146, v110
    v_mov_b32 v147, v111
    v_mov_b32_dpp v108, v104 row_ror:8 row_mask:0xf bank_mask:0x3
    v_mov_b32_dpp v109, v105 row_ror:8 row_mask:0xf bank_mask:0x3
    v_mov_b32_dpp v110, v106 row_ror:8 row_mask:0xf bank_mask:0x3
    v_mov_b32_dpp v111, v107 row_ror:8 row_mask:0xf bank_mask:0x3
    v_mov_b32_dpp v104, v144 row_ror:8 row_mask:0xf bank_mask:0xc
    v_mov_b32_dpp v105, v145 row_ror:8 row_mask:0xf bank_mask:0xc
    v_mov_b32_dpp v106, v146 row_ror:8 row_mask:0xf bank_mask:0xc
    v_mov_b32_dpp v107, v147 row_ror:8 row_mask:0xf bank_mask:0xc
    s_add_u32 s78, s79, 247808
    buffer_store_dwordx4 v[104:107], v48, s[52:55], s78 offen sc0 sc1
    buffer_store_dwordx4 v[108:111], v49, s[52:55], s78 offen sc0 sc1
    v_pk_add_f32 v[160:161], v[160:161], v[80:81]
    v_pk_mul_f32 v[52:53], v[160:161], v[160:161]
    v_pk_fma_f32 v[52:53], v[52:53], s[76:77], v[60:61]
    v_pk_mul_f32 v[52:53], v[52:53], v[160:161]
    v_exp_f32 v52, v52
    v_exp_f32 v53, v53
    v_pk_add_f32 v[162:163], v[162:163], v[82:83]
    v_pk_mul_f32 v[54:55], v[162:163], v[162:163]
    v_pk_fma_f32 v[54:55], v[54:55], s[76:77], v[60:61]
    v_pk_mul_f32 v[54:55], v[54:55], v[162:163]
    v_exp_f32 v54, v54
    v_exp_f32 v55, v55
    v_pk_add_f32 v[52:53], v[52:53], v[62:63]
    v_rcp_f32 v52, v52
    v_rcp_f32 v53, v53
    v_pk_add_f32 v[54:55], v[54:55], v[62:63]
    v_rcp_f32 v54, v54
    v_rcp_f32 v55, v55
    v_pk_mul_f32 v[160:161], v[160:161], v[52:53]
    v_pk_mul_f32 v[162:163], v[162:163], v[54:55]
    v_pk_add_f32 v[164:165], v[164:165], v[84:85]
    v_pk_mul_f32 v[56:57], v[164:165], v[164:165]
    v_pk_fma_f32 v[56:57], v[56:57], s[76:77], v[60:61]
    v_pk_mul_f32 v[56:57], v[56:57], v[164:165]
    v_exp_f32 v56, v56
    v_exp_f32 v57, v57
    v_pk_add_f32 v[166:167], v[166:167], v[86:87]
    v_pk_mul_f32 v[58:59], v[166:167], v[166:167]
    v_pk_fma_f32 v[58:59], v[58:59], s[76:77], v[60:61]
    v_pk_mul_f32 v[58:59], v[58:59], v[166:167]
    v_exp_f32 v58, v58
    v_exp_f32 v59, v59
    v_pk_add_f32 v[56:57], v[56:57], v[62:63]
    v_rcp_f32 v56, v56
    v_rcp_f32 v57, v57
    v_pk_add_f32 v[58:59], v[58:59], v[62:63]
    v_rcp_f32 v58, v58
    v_rcp_f32 v59, v59
    v_pk_mul_f32 v[164:165], v[164:165], v[56:57]
    v_pk_mul_f32 v[166:167], v[166:167], v[58:59]
    v_cvt_pk_bf16_f32 v112, v160, v161
    v_cvt_pk_bf16_f32 v113, v162, v163
    v_cvt_pk_bf16_f32 v114, v164, v165
    v_cvt_pk_bf16_f32 v115, v166, v167
    s_nop 1
    v_permlane16_swap_b32 v112, v114
    v_permlane16_swap_b32 v113, v115
    v_pk_add_f32 v[168:169], v[168:169], v[88:89]
    v_pk_mul_f32 v[52:53], v[168:169], v[168:169]
    v_pk_fma_f32 v[52:53], v[52:53], s[76:77], v[60:61]
    v_pk_mul_f32 v[52:53], v[52:53], v[168:169]
    v_exp_f32 v52, v52
    v_exp_f32 v53, v53
    v_pk_add_f32 v[170:171], v[170:171], v[90:91]
    v_pk_mul_f32 v[54:55], v[170:171], v[170:171]
    v_pk_fma_f32 v[54:55], v[54:55], s[76:77], v[60:61]
    v_pk_mul_f32 v[54:55], v[54:55], v[170:171]
    v_exp_f32 v54, v54
    v_exp_f32 v55, v55
    v_pk_add_f32 v[52:53], v[52:53], v[62:63]
    v_rcp_f32 v52, v52
    v_rcp_f32 v53, v53
    v_pk_add_f32 v[54:55], v[54:55], v[62:63]
    v_rcp_f32 v54, v54
    v_rcp_f32 v55, v55
    v_pk_mul_f32 v[168:169], v[168:169], v[52:53]
    v_pk_mul_f32 v[170:171], v[170:171], v[54:55]
    v_pk_add_f32 v[172:173], v[172:173], v[92:93]
    v_pk_mul_f32 v[56:57], v[172:173], v[172:173]
    v_pk_fma_f32 v[56:57], v[56:57], s[76:77], v[60:61]
    v_pk_mul_f32 v[56:57], v[56:57], v[172:173]
    v_exp_f32 v56, v56
    v_exp_f32 v57, v57
    v_pk_add_f32 v[174:175], v[174:175], v[94:95]
    v_pk_mul_f32 v[58:59], v[174:175], v[174:175]
    v_pk_fma_f32 v[58:59], v[58:59], s[76:77], v[60:61]
    v_pk_mul_f32 v[58:59], v[58:59], v[174:175]
    v_exp_f32 v58, v58
    v_exp_f32 v59, v59
    v_pk_add_f32 v[56:57], v[56:57], v[62:63]
    v_rcp_f32 v56, v56
    v_rcp_f32 v57, v57
    v_pk_add_f32 v[58:59], v[58:59], v[62:63]
    v_rcp_f32 v58, v58
    v_rcp_f32 v59, v59
    v_pk_mul_f32 v[172:173], v[172:173], v[56:57]
    v_pk_mul_f32 v[174:175], v[174:175], v[58:59]
    v_cvt_pk_bf16_f32 v116, v168, v169
    v_cvt_pk_bf16_f32 v117, v170, v171
    v_cvt_pk_bf16_f32 v118, v172, v173
    v_cvt_pk_bf16_f32 v119, v174, v175
    s_nop 1
    v_permlane16_swap_b32 v116, v118
    v_permlane16_swap_b32 v117, v119
    s_nop 0
    v_mov_b32 v160, v116
    v_mov_b32 v161, v117
    v_mov_b32 v162, v118
    v_mov_b32 v163, v119
    v_mov_b32_dpp v116, v112 row_ror:8 row_mask:0xf bank_mask:0x3
    v_mov_b32_dpp v117, v113 row_ror:8 row_mask:0xf bank_mask:0x3
    v_mov_b32_dpp v118, v114 row_ror:8 row_mask:0xf bank_mask:0x3
    v_mov_b32_dpp v119, v115 row_ror:8 row_mask:0xf bank_mask:0x3
    v_mov_b32_dpp v112, v160 row_ror:8 row_mask:0xf bank_mask:0xc
    v_mov_b32_dpp v113, v161 row_ror:8 row_mask:0xf bank_mask:0xc
    v_mov_b32_dpp v114, v162 row_ror:8 row_mask:0xf bank_mask:0xc
    v_mov_b32_dpp v115, v163 row_ror:8 row_mask:0xf bank_mask:0xc
    s_add_u32 s78, s79, 495616
    buffer_store_dwordx4 v[112:115], v48, s[52:55], s78 offen sc0 sc1
    buffer_store_dwordx4 v[116:119], v49, s[52:55], s78 offen sc0 sc1
    v_pk_add_f32 v[176:177], v[176:177], v[80:81]
    v_pk_mul_f32 v[52:53], v[176:177], v[176:177]
    v_pk_fma_f32 v[52:53], v[52:53], s[76:77], v[60:61]
    v_pk_mul_f32 v[52:53], v[52:53], v[176:177]
    v_exp_f32 v52, v52
    v_exp_f32 v53, v53
    v_pk_add_f32 v[178:179], v[178:179], v[82:83]
    v_pk_mul_f32 v[54:55], v[178:179], v[178:179]
    v_pk_fma_f32 v[54:55], v[54:55], s[76:77], v[60:61]
    v_pk_mul_f32 v[54:55], v[54:55], v[178:179]
    v_exp_f32 v54, v54
    v_exp_f32 v55, v55
    v_pk_add_f32 v[52:53], v[52:53], v[62:63]
    v_rcp_f32 v52, v52
    v_rcp_f32 v53, v53
    v_pk_add_f32 v[54:55], v[54:55], v[62:63]
    v_rcp_f32 v54, v54
    v_rcp_f32 v55, v55
    v_pk_mul_f32 v[176:177], v[176:177], v[52:53]
    v_pk_mul_f32 v[178:179], v[178:179], v[54:55]
    v_pk_add_f32 v[180:181], v[180:181], v[84:85]
    v_pk_mul_f32 v[56:57], v[180:181], v[180:181]
    v_pk_fma_f32 v[56:57], v[56:57], s[76:77], v[60:61]
    v_pk_mul_f32 v[56:57], v[56:57], v[180:181]
    v_exp_f32 v56, v56
    v_exp_f32 v57, v57
    v_pk_add_f32 v[182:183], v[182:183], v[86:87]
    v_pk_mul_f32 v[58:59], v[182:183], v[182:183]
    v_pk_fma_f32 v[58:59], v[58:59], s[76:77], v[60:61]
    v_pk_mul_f32 v[58:59], v[58:59], v[182:183]
    v_exp_f32 v58, v58
    v_exp_f32 v59, v59
    v_pk_add_f32 v[56:57], v[56:57], v[62:63]
    v_rcp_f32 v56, v56
    v_rcp_f32 v57, v57
    v_pk_add_f32 v[58:59], v[58:59], v[62:63]
    v_rcp_f32 v58, v58
    v_rcp_f32 v59, v59
    v_pk_mul_f32 v[180:181], v[180:181], v[56:57]
    v_pk_mul_f32 v[182:183], v[182:183], v[58:59]
    v_cvt_pk_bf16_f32 v120, v176, v177
    v_cvt_pk_bf16_f32 v121, v178, v179
    v_cvt_pk_bf16_f32 v122, v180, v181
    v_cvt_pk_bf16_f32 v123, v182, v183
    s_nop 1
    v_permlane16_swap_b32 v120, v122
    v_permlane16_swap_b32 v121, v123
    v_pk_add_f32 v[184:185], v[184:185], v[88:89]
    v_pk_mul_f32 v[52:53], v[184:185], v[184:185]
    v_pk_fma_f32 v[52:53], v[52:53], s[76:77], v[60:61]
    v_pk_mul_f32 v[52:53], v[52:53], v[184:185]
    v_exp_f32 v52, v52
    v_exp_f32 v53, v53
    v_pk_add_f32 v[186:187], v[186:187], v[90:91]
    v_pk_mul_f32 v[54:55], v[186:187], v[186:187]
    v_pk_fma_f32 v[54:55], v[54:55], s[76:77], v[60:61]
    v_pk_mul_f32 v[54:55], v[54:55], v[186:187]
    v_exp_f32 v54, v54
    v_exp_f32 v55, v55
    v_pk_add_f32 v[52:53], v[52:53], v[62:63]
    v_rcp_f32 v52, v52
    v_rcp_f32 v53, v53
    v_pk_add_f32 v[54:55], v[54:55], v[62:63]
    v_rcp_f32 v54, v54
    v_rcp_f32 v55, v55
    v_pk_mul_f32 v[184:185], v[184:185], v[52:53]
    v_pk_mul_f32 v[186:187], v[186:187], v[54:55]
    v_pk_add_f32 v[188:189], v[188:189], v[92:93]
    v_pk_mul_f32 v[56:57], v[188:189], v[188:189]
    v_pk_fma_f32 v[56:57], v[56:57], s[76:77], v[60:61]
    v_pk_mul_f32 v[56:57], v[56:57], v[188:189]
    v_exp_f32 v56, v56
    v_exp_f32 v57, v57
    v_pk_add_f32 v[190:191], v[190:191], v[94:95]
    v_pk_mul_f32 v[58:59], v[190:191], v[190:191]
    v_pk_fma_f32 v[58:59], v[58:59], s[76:77], v[60:61]
    v_pk_mul_f32 v[58:59], v[58:59], v[190:191]
    v_exp_f32 v58, v58
    v_exp_f32 v59, v59
    v_pk_add_f32 v[56:57], v[56:57], v[62:63]
    v_rcp_f32 v56, v56
    v_rcp_f32 v57, v57
    v_pk_add_f32 v[58:59], v[58:59], v[62:63]
    v_rcp_f32 v58, v58
    v_rcp_f32 v59, v59
    v_pk_mul_f32 v[188:189], v[188:189], v[56:57]
    v_pk_mul_f32 v[190:191], v[190:191], v[58:59]
    v_cvt_pk_bf16_f32 v124, v184, v185
    v_cvt_pk_bf16_f32 v125, v186, v187
    v_cvt_pk_bf16_f32 v126, v188, v189
    v_cvt_pk_bf16_f32 v127, v190, v191
    s_nop 1
    v_permlane16_swap_b32 v124, v126
    v_permlane16_swap_b32 v125, v127
    s_nop 0
    v_mov_b32 v176, v124
    v_mov_b32 v177, v125
    v_mov_b32 v178, v126
    v_mov_b32 v179, v127
    v_mov_b32_dpp v124, v120 row_ror:8 row_mask:0xf bank_mask:0x3
    v_mov_b32_dpp v125, v121 row_ror:8 row_mask:0xf bank_mask:0x3
    v_mov_b32_dpp v126, v122 row_ror:8 row_mask:0xf bank_mask:0x3
    v_mov_b32_dpp v127, v123 row_ror:8 row_mask:0xf bank_mask:0x3
    v_mov_b32_dpp v120, v176 row_ror:8 row_mask:0xf bank_mask:0xc
    v_mov_b32_dpp v121, v177 row_ror:8 row_mask:0xf bank_mask:0xc
    v_mov_b32_dpp v122, v178 row_ror:8 row_mask:0xf bank_mask:0xc
    v_mov_b32_dpp v123, v179 row_ror:8 row_mask:0xf bank_mask:0xc
    s_add_u32 s78, s79, 743424
    buffer_store_dwordx4 v[120:123], v48, s[52:55], s78 offen sc0 sc1
    buffer_store_dwordx4 v[124:127], v49, s[52:55], s78 offen sc0 sc1
    v_pk_add_f32 v[192:193], v[192:193], v[80:81]
    v_pk_mul_f32 v[52:53], v[192:193], v[192:193]
    v_pk_fma_f32 v[52:53], v[52:53], s[76:77], v[60:61]
    v_pk_mul_f32 v[52:53], v[52:53], v[192:193]
    v_exp_f32 v52, v52
    v_exp_f32 v53, v53
    v_pk_add_f32 v[194:195], v[194:195], v[82:83]
    v_pk_mul_f32 v[54:55], v[194:195], v[194:195]
    v_pk_fma_f32 v[54:55], v[54:55], s[76:77], v[60:61]
    v_pk_mul_f32 v[54:55], v[54:55], v[194:195]
    v_exp_f32 v54, v54
    v_exp_f32 v55, v55
    v_pk_add_f32 v[52:53], v[52:53], v[62:63]
    v_rcp_f32 v52, v52
    v_rcp_f32 v53, v53
    v_pk_add_f32 v[54:55], v[54:55], v[62:63]
    v_rcp_f32 v54, v54
    v_rcp_f32 v55, v55
    v_pk_mul_f32 v[192:193], v[192:193], v[52:53]
    v_pk_mul_f32 v[194:195], v[194:195], v[54:55]
    v_pk_add_f32 v[196:197], v[196:197], v[84:85]
    v_pk_mul_f32 v[56:57], v[196:197], v[196:197]
    v_pk_fma_f32 v[56:57], v[56:57], s[76:77], v[60:61]
    v_pk_mul_f32 v[56:57], v[56:57], v[196:197]
    v_exp_f32 v56, v56
    v_exp_f32 v57, v57
    v_pk_add_f32 v[198:199], v[198:199], v[86:87]
    v_pk_mul_f32 v[58:59], v[198:199], v[198:199]
    v_pk_fma_f32 v[58:59], v[58:59], s[76:77], v[60:61]
    v_pk_mul_f32 v[58:59], v[58:59], v[198:199]
    v_exp_f32 v58, v58
    v_exp_f32 v59, v59
    v_pk_add_f32 v[56:57], v[56:57], v[62:63]
    v_rcp_f32 v56, v56
    v_rcp_f32 v57, v57
    v_pk_add_f32 v[58:59], v[58:59], v[62:63]
    v_rcp_f32 v58, v58
    v_rcp_f32 v59, v59
    v_pk_mul_f32 v[196:197], v[196:197], v[56:57]
    v_pk_mul_f32 v[198:199], v[198:199], v[58:59]
    v_cvt_pk_bf16_f32 v96, v192, v193
    v_cvt_pk_bf16_f32 v97, v194, v195
    v_cvt_pk_bf16_f32 v98, v196, v197
    v_cvt_pk_bf16_f32 v99, v198, v199
    s_nop 1
    v_permlane16_swap_b32 v96, v98
    v_permlane16_swap_b32 v97, v99
    v_pk_add_f32 v[200:201], v[200:201], v[88:89]
    v_pk_mul_f32 v[52:53], v[200:201], v[200:201]
    v_pk_fma_f32 v[52:53], v[52:53], s[76:77], v[60:61]
    v_pk_mul_f32 v[52:53], v[52:53], v[200:201]
    v_exp_f32 v52, v52
    v_exp_f32 v53, v53
    v_pk_add_f32 v[202:203], v[202:203], v[90:91]
    v_pk_mul_f32 v[54:55], v[202:203], v[202:203]
    v_pk_fma_f32 v[54:55], v[54:55], s[76:77], v[60:61]
    v_pk_mul_f32 v[54:55], v[54:55], v[202:203]
    v_exp_f32 v54, v54
    v_exp_f32 v55, v55
    v_pk_add_f32 v[52:53], v[52:53], v[62:63]
    v_rcp_f32 v52, v52
    v_rcp_f32 v53, v53
    v_pk_add_f32 v[54:55], v[54:55], v[62:63]
    v_rcp_f32 v54, v54
    v_rcp_f32 v55, v55
    v_pk_mul_f32 v[200:201], v[200:201], v[52:53]
    v_pk_mul_f32 v[202:203], v[202:203], v[54:55]
    v_pk_add_f32 v[204:205], v[204:205], v[92:93]
    v_pk_mul_f32 v[56:57], v[204:205], v[204:205]
    v_pk_fma_f32 v[56:57], v[56:57], s[76:77], v[60:61]
    v_pk_mul_f32 v[56:57], v[56:57], v[204:205]
    v_exp_f32 v56, v56
    v_exp_f32 v57, v57
    v_pk_add_f32 v[206:207], v[206:207], v[94:95]
    v_pk_mul_f32 v[58:59], v[206:207], v[206:207]
    v_pk_fma_f32 v[58:59], v[58:59], s[76:77], v[60:61]
    v_pk_mul_f32 v[58:59], v[58:59], v[206:207]
    v_exp_f32 v58, v58
    v_exp_f32 v59, v59
    v_pk_add_f32 v[56:57], v[56:57], v[62:63]
    v_rcp_f32 v56, v56
    v_rcp_f32 v57, v57
    v_pk_add_f32 v[58:59], v[58:59], v[62:63]
    v_rcp_f32 v58, v58
    v_rcp_f32 v59, v59
    v_pk_mul_f32 v[204:205], v[204:205], v[56:57]
    v_pk_mul_f32 v[206:207], v[206:207], v[58:59]
    v_cvt_pk_bf16_f32 v100, v200, v201
    v_cvt_pk_bf16_f32 v101, v202, v203
    v_cvt_pk_bf16_f32 v102, v204, v205
    v_cvt_pk_bf16_f32 v103, v206, v207
    s_nop 1
    v_permlane16_swap_b32 v100, v102
    v_permlane16_swap_b32 v101, v103
    s_nop 0
    v_mov_b32 v192, v100
    v_mov_b32 v193, v101
    v_mov_b32 v194, v102
    v_mov_b32 v195, v103
    v_mov_b32_dpp v100, v96 row_ror:8 row_mask:0xf bank_mask:0x3
    v_mov_b32_dpp v101, v97 row_ror:8 row_mask:0xf bank_mask:0x3
    v_mov_b32_dpp v102, v98 row_ror:8 row_mask:0xf bank_mask:0x3
    v_mov_b32_dpp v103, v99 row_ror:8 row_mask:0xf bank_mask:0x3
    v_mov_b32_dpp v96, v192 row_ror:8 row_mask:0xf bank_mask:0xc
    v_mov_b32_dpp v97, v193 row_ror:8 row_mask:0xf bank_mask:0xc
    v_mov_b32_dpp v98, v194 row_ror:8 row_mask:0xf bank_mask:0xc
    v_mov_b32_dpp v99, v195 row_ror:8 row_mask:0xf bank_mask:0xc
    s_add_u32 s78, s79, 991232
    buffer_store_dwordx4 v[96:99], v48, s[52:55], s78 offen sc0 sc1
    buffer_store_dwordx4 v[100:103], v49, s[52:55], s78 offen sc0 sc1
    v_pk_add_f32 v[208:209], v[208:209], v[80:81]
    v_pk_mul_f32 v[52:53], v[208:209], v[208:209]
    v_pk_fma_f32 v[52:53], v[52:53], s[76:77], v[60:61]
    v_pk_mul_f32 v[52:53], v[52:53], v[208:209]
    v_exp_f32 v52, v52
    v_exp_f32 v53, v53
    v_pk_add_f32 v[210:211], v[210:211], v[82:83]
    v_pk_mul_f32 v[54:55], v[210:211], v[210:211]
    v_pk_fma_f32 v[54:55], v[54:55], s[76:77], v[60:61]
    v_pk_mul_f32 v[54:55], v[54:55], v[210:211]
    v_exp_f32 v54, v54
    v_exp_f32 v55, v55
    v_pk_add_f32 v[52:53], v[52:53], v[62:63]
    v_rcp_f32 v52, v52
    v_rcp_f32 v53, v53
    v_pk_add_f32 v[54:55], v[54:55], v[62:63]
    v_rcp_f32 v54, v54
    v_rcp_f32 v55, v55
    v_pk_mul_f32 v[208:209], v[208:209], v[52:53]
    v_pk_mul_f32 v[210:211], v[210:211], v[54:55]
    v_pk_add_f32 v[212:213], v[212:213], v[84:85]
    v_pk_mul_f32 v[56:57], v[212:213], v[212:213]
    v_pk_fma_f32 v[56:57], v[56:57], s[76:77], v[60:61]
    v_pk_mul_f32 v[56:57], v[56:57], v[212:213]
    v_exp_f32 v56, v56
    v_exp_f32 v57, v57
    v_pk_add_f32 v[214:215], v[214:215], v[86:87]
    v_pk_mul_f32 v[58:59], v[214:215], v[214:215]
    v_pk_fma_f32 v[58:59], v[58:59], s[76:77], v[60:61]
    v_pk_mul_f32 v[58:59], v[58:59], v[214:215]
    v_exp_f32 v58, v58
    v_exp_f32 v59, v59
    v_pk_add_f32 v[56:57], v[56:57], v[62:63]
    v_rcp_f32 v56, v56
    v_rcp_f32 v57, v57
    v_pk_add_f32 v[58:59], v[58:59], v[62:63]
    v_rcp_f32 v58, v58
    v_rcp_f32 v59, v59
    v_pk_mul_f32 v[212:213], v[212:213], v[56:57]
    v_pk_mul_f32 v[214:215], v[214:215], v[58:59]
    v_cvt_pk_bf16_f32 v104, v208, v209
    v_cvt_pk_bf16_f32 v105, v210, v211
    v_cvt_pk_bf16_f32 v106, v212, v213
    v_cvt_pk_bf16_f32 v107, v214, v215
    s_nop 1
    v_permlane16_swap_b32 v104, v106
    v_permlane16_swap_b32 v105, v107
    v_pk_add_f32 v[216:217], v[216:217], v[88:89]
    v_pk_mul_f32 v[52:53], v[216:217], v[216:217]
    v_pk_fma_f32 v[52:53], v[52:53], s[76:77], v[60:61]
    v_pk_mul_f32 v[52:53], v[52:53], v[216:217]
    v_exp_f32 v52, v52
    v_exp_f32 v53, v53
    v_pk_add_f32 v[218:219], v[218:219], v[90:91]
    v_pk_mul_f32 v[54:55], v[218:219], v[218:219]
    v_pk_fma_f32 v[54:55], v[54:55], s[76:77], v[60:61]
    v_pk_mul_f32 v[54:55], v[54:55], v[218:219]
    v_exp_f32 v54, v54
    v_exp_f32 v55, v55
    v_pk_add_f32 v[52:53], v[52:53], v[62:63]
    v_rcp_f32 v52, v52
    v_rcp_f32 v53, v53
    v_pk_add_f32 v[54:55], v[54:55], v[62:63]
    v_rcp_f32 v54, v54
    v_rcp_f32 v55, v55
    v_pk_mul_f32 v[216:217], v[216:217], v[52:53]
    v_pk_mul_f32 v[218:219], v[218:219], v[54:55]
    v_pk_add_f32 v[220:221], v[220:221], v[92:93]
    v_pk_mul_f32 v[56:57], v[220:221], v[220:221]
    v_pk_fma_f32 v[56:57], v[56:57], s[76:77], v[60:61]
    v_pk_mul_f32 v[56:57], v[56:57], v[220:221]
    v_exp_f32 v56, v56
    v_exp_f32 v57, v57
    v_pk_add_f32 v[222:223], v[222:223], v[94:95]
    v_pk_mul_f32 v[58:59], v[222:223], v[222:223]
    v_pk_fma_f32 v[58:59], v[58:59], s[76:77], v[60:61]
    v_pk_mul_f32 v[58:59], v[58:59], v[222:223]
    v_exp_f32 v58, v58
    v_exp_f32 v59, v59
    v_pk_add_f32 v[56:57], v[56:57], v[62:63]
    v_rcp_f32 v56, v56
    v_rcp_f32 v57, v57
    v_pk_add_f32 v[58:59], v[58:59], v[62:63]
    v_rcp_f32 v58, v58
    v_rcp_f32 v59, v59
    v_pk_mul_f32 v[220:221], v[220:221], v[56:57]
    v_pk_mul_f32 v[222:223], v[222:223], v[58:59]
    v_cvt_pk_bf16_f32 v108, v216, v217
    v_cvt_pk_bf16_f32 v109, v218, v219
    v_cvt_pk_bf16_f32 v110, v220, v221
    v_cvt_pk_bf16_f32 v111, v222, v223
    s_nop 1
    v_permlane16_swap_b32 v108, v110
    v_permlane16_swap_b32 v109, v111
    s_nop 0
    v_mov_b32 v208, v108
    v_mov_b32 v209, v109
    v_mov_b32 v210, v110
    v_mov_b32 v211, v111
    v_mov_b32_dpp v108, v104 row_ror:8 row_mask:0xf bank_mask:0x3
    v_mov_b32_dpp v109, v105 row_ror:8 row_mask:0xf bank_mask:0x3
    v_mov_b32_dpp v110, v106 row_ror:8 row_mask:0xf bank_mask:0x3
    v_mov_b32_dpp v111, v107 row_ror:8 row_mask:0xf bank_mask:0x3
    v_mov_b32_dpp v104, v208 row_ror:8 row_mask:0xf bank_mask:0xc
    v_mov_b32_dpp v105, v209 row_ror:8 row_mask:0xf bank_mask:0xc
    v_mov_b32_dpp v106, v210 row_ror:8 row_mask:0xf bank_mask:0xc
    v_mov_b32_dpp v107, v211 row_ror:8 row_mask:0xf bank_mask:0xc
    s_add_u32 s78, s79, 1239040
    buffer_store_dwordx4 v[104:107], v48, s[52:55], s78 offen sc0 sc1
    buffer_store_dwordx4 v[108:111], v49, s[52:55], s78 offen sc0 sc1
    v_pk_add_f32 v[224:225], v[224:225], v[80:81]
    v_pk_mul_f32 v[52:53], v[224:225], v[224:225]
    v_pk_fma_f32 v[52:53], v[52:53], s[76:77], v[60:61]
    v_pk_mul_f32 v[52:53], v[52:53], v[224:225]
    v_exp_f32 v52, v52
    v_exp_f32 v53, v53
    v_pk_add_f32 v[226:227], v[226:227], v[82:83]
    v_pk_mul_f32 v[54:55], v[226:227], v[226:227]
    v_pk_fma_f32 v[54:55], v[54:55], s[76:77], v[60:61]
    v_pk_mul_f32 v[54:55], v[54:55], v[226:227]
    v_exp_f32 v54, v54
    v_exp_f32 v55, v55
    v_pk_add_f32 v[52:53], v[52:53], v[62:63]
    v_rcp_f32 v52, v52
    v_rcp_f32 v53, v53
    v_pk_add_f32 v[54:55], v[54:55], v[62:63]
    v_rcp_f32 v54, v54
    v_rcp_f32 v55, v55
    v_pk_mul_f32 v[224:225], v[224:225], v[52:53]
    v_pk_mul_f32 v[226:227], v[226:227], v[54:55]
    v_pk_add_f32 v[228:229], v[228:229], v[84:85]
    v_pk_mul_f32 v[56:57], v[228:229], v[228:229]
    v_pk_fma_f32 v[56:57], v[56:57], s[76:77], v[60:61]
    v_pk_mul_f32 v[56:57], v[56:57], v[228:229]
    v_exp_f32 v56, v56
    v_exp_f32 v57, v57
    v_pk_add_f32 v[230:231], v[230:231], v[86:87]
    v_pk_mul_f32 v[58:59], v[230:231], v[230:231]
    v_pk_fma_f32 v[58:59], v[58:59], s[76:77], v[60:61]
    v_pk_mul_f32 v[58:59], v[58:59], v[230:231]
    v_exp_f32 v58, v58
    v_exp_f32 v59, v59
    v_pk_add_f32 v[56:57], v[56:57], v[62:63]
    v_rcp_f32 v56, v56
    v_rcp_f32 v57, v57
    v_pk_add_f32 v[58:59], v[58:59], v[62:63]
    v_rcp_f32 v58, v58
    v_rcp_f32 v59, v59
    v_pk_mul_f32 v[228:229], v[228:229], v[56:57]
    v_pk_mul_f32 v[230:231], v[230:231], v[58:59]
    v_cvt_pk_bf16_f32 v112, v224, v225
    v_cvt_pk_bf16_f32 v113, v226, v227
    v_cvt_pk_bf16_f32 v114, v228, v229
    v_cvt_pk_bf16_f32 v115, v230, v231
    s_nop 1
    v_permlane16_swap_b32 v112, v114
    v_permlane16_swap_b32 v113, v115
    v_pk_add_f32 v[232:233], v[232:233], v[88:89]
    v_pk_mul_f32 v[52:53], v[232:233], v[232:233]
    v_pk_fma_f32 v[52:53], v[52:53], s[76:77], v[60:61]
    v_pk_mul_f32 v[52:53], v[52:53], v[232:233]
    v_exp_f32 v52, v52
    v_exp_f32 v53, v53
    v_pk_add_f32 v[234:235], v[234:235], v[90:91]
    v_pk_mul_f32 v[54:55], v[234:235], v[234:235]
    v_pk_fma_f32 v[54:55], v[54:55], s[76:77], v[60:61]
    v_pk_mul_f32 v[54:55], v[54:55], v[234:235]
    v_exp_f32 v54, v54
    v_exp_f32 v55, v55
    v_pk_add_f32 v[52:53], v[52:53], v[62:63]
    v_rcp_f32 v52, v52
    v_rcp_f32 v53, v53
    v_pk_add_f32 v[54:55], v[54:55], v[62:63]
    v_rcp_f32 v54, v54
    v_rcp_f32 v55, v55
    v_pk_mul_f32 v[232:233], v[232:233], v[52:53]
    v_pk_mul_f32 v[234:235], v[234:235], v[54:55]
    v_pk_add_f32 v[236:237], v[236:237], v[92:93]
    v_pk_mul_f32 v[56:57], v[236:237], v[236:237]
    v_pk_fma_f32 v[56:57], v[56:57], s[76:77], v[60:61]
    v_pk_mul_f32 v[56:57], v[56:57], v[236:237]
    v_exp_f32 v56, v56
    v_exp_f32 v57, v57
    v_pk_add_f32 v[238:239], v[238:239], v[94:95]
    v_pk_mul_f32 v[58:59], v[238:239], v[238:239]
    v_pk_fma_f32 v[58:59], v[58:59], s[76:77], v[60:61]
    v_pk_mul_f32 v[58:59], v[58:59], v[238:239]
    v_exp_f32 v58, v58
    v_exp_f32 v59, v59
    v_pk_add_f32 v[56:57], v[56:57], v[62:63]
    v_rcp_f32 v56, v56
    v_rcp_f32 v57, v57
    v_pk_add_f32 v[58:59], v[58:59], v[62:63]
    v_rcp_f32 v58, v58
    v_rcp_f32 v59, v59
    v_pk_mul_f32 v[236:237], v[236:237], v[56:57]
    v_pk_mul_f32 v[238:239], v[238:239], v[58:59]
    v_cvt_pk_bf16_f32 v116, v232, v233
    v_cvt_pk_bf16_f32 v117, v234, v235
    v_cvt_pk_bf16_f32 v118, v236, v237
    v_cvt_pk_bf16_f32 v119, v238, v239
    s_nop 1
    v_permlane16_swap_b32 v116, v118
    v_permlane16_swap_b32 v117, v119
    s_nop 0
    v_mov_b32 v224, v116
    v_mov_b32 v225, v117
    v_mov_b32 v226, v118
    v_mov_b32 v227, v119
    v_mov_b32_dpp v116, v112 row_ror:8 row_mask:0xf bank_mask:0x3
    v_mov_b32_dpp v117, v113 row_ror:8 row_mask:0xf bank_mask:0x3
    v_mov_b32_dpp v118, v114 row_ror:8 row_mask:0xf bank_mask:0x3
    v_mov_b32_dpp v119, v115 row_ror:8 row_mask:0xf bank_mask:0x3
    v_mov_b32_dpp v112, v224 row_ror:8 row_mask:0xf bank_mask:0xc
    v_mov_b32_dpp v113, v225 row_ror:8 row_mask:0xf bank_mask:0xc
    v_mov_b32_dpp v114, v226 row_ror:8 row_mask:0xf bank_mask:0xc
    v_mov_b32_dpp v115, v227 row_ror:8 row_mask:0xf bank_mask:0xc
    s_add_u32 s78, s79, 1486848
    buffer_store_dwordx4 v[112:115], v48, s[52:55], s78 offen sc0 sc1
    buffer_store_dwordx4 v[116:119], v49, s[52:55], s78 offen sc0 sc1
    v_pk_add_f32 v[240:241], v[240:241], v[80:81]
    v_pk_mul_f32 v[52:53], v[240:241], v[240:241]
    v_pk_fma_f32 v[52:53], v[52:53], s[76:77], v[60:61]
    v_pk_mul_f32 v[52:53], v[52:53], v[240:241]
    v_exp_f32 v52, v52
    v_exp_f32 v53, v53
    v_pk_add_f32 v[242:243], v[242:243], v[82:83]
    v_pk_mul_f32 v[54:55], v[242:243], v[242:243]
    v_pk_fma_f32 v[54:55], v[54:55], s[76:77], v[60:61]
    v_pk_mul_f32 v[54:55], v[54:55], v[242:243]
    v_exp_f32 v54, v54
    v_exp_f32 v55, v55
    v_pk_add_f32 v[52:53], v[52:53], v[62:63]
    v_rcp_f32 v52, v52
    v_rcp_f32 v53, v53
    v_pk_add_f32 v[54:55], v[54:55], v[62:63]
    v_rcp_f32 v54, v54
    v_rcp_f32 v55, v55
    v_pk_mul_f32 v[240:241], v[240:241], v[52:53]
    v_pk_mul_f32 v[242:243], v[242:243], v[54:55]
    v_pk_add_f32 v[244:245], v[244:245], v[84:85]
    v_pk_mul_f32 v[56:57], v[244:245], v[244:245]
    v_pk_fma_f32 v[56:57], v[56:57], s[76:77], v[60:61]
    v_pk_mul_f32 v[56:57], v[56:57], v[244:245]
    v_exp_f32 v56, v56
    v_exp_f32 v57, v57
    v_pk_add_f32 v[246:247], v[246:247], v[86:87]
    v_pk_mul_f32 v[58:59], v[246:247], v[246:247]
    v_pk_fma_f32 v[58:59], v[58:59], s[76:77], v[60:61]
    v_pk_mul_f32 v[58:59], v[58:59], v[246:247]
    v_exp_f32 v58, v58
    v_exp_f32 v59, v59
    v_pk_add_f32 v[56:57], v[56:57], v[62:63]
    v_rcp_f32 v56, v56
    v_rcp_f32 v57, v57
    v_pk_add_f32 v[58:59], v[58:59], v[62:63]
    v_rcp_f32 v58, v58
    v_rcp_f32 v59, v59
    v_pk_mul_f32 v[244:245], v[244:245], v[56:57]
    v_pk_mul_f32 v[246:247], v[246:247], v[58:59]
    v_cvt_pk_bf16_f32 v120, v240, v241
    v_cvt_pk_bf16_f32 v121, v242, v243
    v_cvt_pk_bf16_f32 v122, v244, v245
    v_cvt_pk_bf16_f32 v123, v246, v247
    s_nop 1
    v_permlane16_swap_b32 v120, v122
    v_permlane16_swap_b32 v121, v123
    v_pk_add_f32 v[248:249], v[248:249], v[88:89]
    v_pk_mul_f32 v[52:53], v[248:249], v[248:249]
    v_pk_fma_f32 v[52:53], v[52:53], s[76:77], v[60:61]
    v_pk_mul_f32 v[52:53], v[52:53], v[248:249]
    v_exp_f32 v52, v52
    v_exp_f32 v53, v53
    v_pk_add_f32 v[250:251], v[250:251], v[90:91]
    v_pk_mul_f32 v[54:55], v[250:251], v[250:251]
    v_pk_fma_f32 v[54:55], v[54:55], s[76:77], v[60:61]
    v_pk_mul_f32 v[54:55], v[54:55], v[250:251]
    v_exp_f32 v54, v54
    v_exp_f32 v55, v55
    v_pk_add_f32 v[52:53], v[52:53], v[62:63]
    v_rcp_f32 v52, v52
    v_rcp_f32 v53, v53
    v_pk_add_f32 v[54:55], v[54:55], v[62:63]
    v_rcp_f32 v54, v54
    v_rcp_f32 v55, v55
    v_pk_mul_f32 v[248:249], v[248:249], v[52:53]
    v_pk_mul_f32 v[250:251], v[250:251], v[54:55]
    v_pk_add_f32 v[252:253], v[252:253], v[92:93]
    v_pk_mul_f32 v[56:57], v[252:253], v[252:253]
    v_pk_fma_f32 v[56:57], v[56:57], s[76:77], v[60:61]
    v_pk_mul_f32 v[56:57], v[56:57], v[252:253]
    v_exp_f32 v56, v56
    v_exp_f32 v57, v57
    v_pk_add_f32 v[254:255], v[254:255], v[94:95]
    v_pk_mul_f32 v[58:59], v[254:255], v[254:255]
    v_pk_fma_f32 v[58:59], v[58:59], s[76:77], v[60:61]
    v_pk_mul_f32 v[58:59], v[58:59], v[254:255]
    v_exp_f32 v58, v58
    v_exp_f32 v59, v59
    v_pk_add_f32 v[56:57], v[56:57], v[62:63]
    v_rcp_f32 v56, v56
    v_rcp_f32 v57, v57
    v_pk_add_f32 v[58:59], v[58:59], v[62:63]
    v_rcp_f32 v58, v58
    v_rcp_f32 v59, v59
    v_pk_mul_f32 v[252:253], v[252:253], v[56:57]
    v_pk_mul_f32 v[254:255], v[254:255], v[58:59]
    v_cvt_pk_bf16_f32 v124, v248, v249
    v_cvt_pk_bf16_f32 v125, v250, v251
    v_cvt_pk_bf16_f32 v126, v252, v253
    v_cvt_pk_bf16_f32 v127, v254, v255
    s_nop 1
    v_permlane16_swap_b32 v124, v126
    v_permlane16_swap_b32 v125, v127
    s_nop 0
    v_mov_b32 v240, v124
    v_mov_b32 v241, v125
    v_mov_b32 v242, v126
    v_mov_b32 v243, v127
    v_mov_b32_dpp v124, v120 row_ror:8 row_mask:0xf bank_mask:0x3
    v_mov_b32_dpp v125, v121 row_ror:8 row_mask:0xf bank_mask:0x3
    v_mov_b32_dpp v126, v122 row_ror:8 row_mask:0xf bank_mask:0x3
    v_mov_b32_dpp v127, v123 row_ror:8 row_mask:0xf bank_mask:0x3
    v_mov_b32_dpp v120, v240 row_ror:8 row_mask:0xf bank_mask:0xc
    v_mov_b32_dpp v121, v241 row_ror:8 row_mask:0xf bank_mask:0xc
    v_mov_b32_dpp v122, v242 row_ror:8 row_mask:0xf bank_mask:0xc
    v_mov_b32_dpp v123, v243 row_ror:8 row_mask:0xf bank_mask:0xc
    s_add_u32 s78, s79, 1734656
    buffer_store_dwordx4 v[120:123], v48, s[52:55], s78 offen sc0 sc1
    buffer_store_dwordx4 v[124:127], v49, s[52:55], s78 offen sc0 sc1
proj_done:
    s_setprio 0
    s_lshl_b32 s69, s75, 1
    s_cmp_eq_u32 s61, 0
    s_cselect_b32 s96, 15, s69
    s_cselect_b32 s97, 99, s11
    s_mov_b32 s66, 0
    s_barrier
    v_lshlrev_b32 v12, 4, v1
    s_lshl_b32 s68, s62, 13
    s_add_u32 s68, s68, 34816
    v_add_u32 v13, s68, v12
    s_mul_i32 s69, s61, 69632
    v_add_u32 v12, s69, v13
    ds_read_b128 v[16:19], v12 offset:0
    ds_read_b128 v[20:23], v12 offset:1024
    ds_read_b128 v[24:27], v12 offset:2048
    ds_read_b128 v[28:31], v12 offset:3072
    ds_read_b128 v[32:35], v12 offset:4096
    ds_read_b128 v[36:39], v12 offset:5120
    ds_read_b128 v[40:43], v12 offset:6144
    ds_read_b128 v[44:47], v12 offset:7168
    ds_read_b128 v[192:195], v13 offset:0
    ds_read_b128 v[196:199], v13 offset:1024
    ds_read_b128 v[200:203], v13 offset:2048
    ds_read_b128 v[204:207], v13 offset:3072
    ds_read_b128 v[208:211], v13 offset:4096
    ds_read_b128 v[212:215], v13 offset:5120
    ds_read_b128 v[216:219], v13 offset:6144
    ds_read_b128 v[220:223], v13 offset:7168
    s_waitcnt lgkmcnt(0)
    s_barrier
    s_add_u32 m0, s5, 0
    s_nop 0
    buffer_load_dwordx4 v3, s[48:51], s65 offen offset:0 lds
    s_add_u32 m0, s5, 64
    s_nop 0
    buffer_load_dwordx4 v3, s[48:51], s65 offen offset:1024 lds
    s_add_u32 m0, s5, 128
    s_nop 0
    buffer_load_dwordx4 v3, s[48:51], s65 offen offset:2048 lds
    s_add_u32 m0, s5, 192
    s_nop 0
    buffer_load_dwordx4 v3, s[48:51], s65 offen offset:3072 lds
    s_add_u32 s65, s65, 16384
    s_xor_b32 s5, s5, s8
    s_sub_u32 s63, s63, 1
    s_cmp_eq_u32 s63, 0
    s_cselect_b32 s65, 0, s65
    s_add_u32 s52, s42, 54525952
    s_addc_u32 s53, s43, 0
    s_mov_b32 s54, 31719424
    s_and_b32 s53, s53, 0xffff
    s_mov_b32 s55, 0x00020000
    v_and_b32 v12, 15, v1
    v_lshrrev_b32 v13, 2, v12
    v_mul_u32_u24 v13, 1088, v13
    v_and_b32 v12, 3, v12
    v_lshlrev_b32 v14, 8, v12
    v_add_u32 v13, v13, v14
    v_lshrrev_b32 v14, 4, v1
    v_xor_b32 v14, v14, v12
    v_lshlrev_b32 v14, 4, v14
    s_mul_i32 s68, s61, 69632
    v_add3_u32 v4, v13, v14, s68
    v_and_b32 v12, 15, v1
    v_lshrrev_b32 v13, 3, v12
    v_mul_u32_u24 v13, 1088, v13
    v_and_b32 v12, 7, v12
    v_lshlrev_b32 v14, 7, v12
    v_add_u32 v13, v13, v14
    v_lshrrev_b32 v12, 1, v12
    v_lshrrev_b32 v14, 4, v1
    v_xor_b32 v14, v14, v12
    v_lshlrev_b32 v14, 4, v14
    v_add_u32 v15, v13, v14
    s_mul_i32 s68, s61, 78336
    s_add_u32 s68, s68, 34816
    s_mul_i32 s69, s61, 60928
    s_add_u32 s69, s69, 43520
    v_add_u32 v6, s68, v15
    v_add_u32 v7, s69, v15
    v_and_b32 v12, 15, v1
    v_lshrrev_b32 v13, 4, v1
    v_lshlrev_b32 v14, 2, v13
    v_sub_u32 v14, v12, v14
    s_lshl_b32 s68, s62, 5
    v_add_u32 v232, s68, v14
    s_mov_b32 s69, 15488
    v_lshrrev_b32 v12, 3, v1
    v_mul_lo_u32 v12, v12, s69
    v_and_b32 v13, 7, v1
    v_lshlrev_b32 v13, 4, v13
    v_add_u32 v233, v12, v13
    s_mul_i32 s99, s68, 15488
    s_lshl_b32 s69, s72, 8
    s_add_u32 s99, s99, s69
    s_mov_b32 s9, 17408
    s_mov_b32 s10, 17408
    v_mov_b64 v[8:9], 0
    v_mov_b64 v[244:245], 0
    v_mov_b64 v[224:225], 0
    v_mov_b64 v[246:247], 0
    v_mov_b64 v[226:227], 0
    v_mov_b64 v[248:249], 0
    v_mov_b64 v[228:229], 0
    v_mov_b64 v[250:251], 0
    v_mov_b64 v[230:231], 0
    v_mov_b32 v240, 0x3f803f80
    v_mov_b32 v241, 0x3f803f80
    v_mov_b32 v242, 0x3f803f80
    v_mov_b32 v243, 0x3f803f80
    v_mov_b64 v[128:129], 0
    v_mov_b64 v[130:131], 0
    v_mov_b64 v[132:133], 0
    v_mov_b64 v[134:135], 0
    v_mov_b64 v[136:137], 0
    v_mov_b64 v[138:139], 0
    v_mov_b64 v[140:141], 0
    v_mov_b64 v[142:143], 0
    v_mov_b64 v[144:145], 0
    v_mov_b64 v[146:147], 0
    v_mov_b64 v[148:149], 0
    v_mov_b64 v[150:151], 0
    v_mov_b64 v[152:153], 0
    v_mov_b64 v[154:155], 0
    v_mov_b64 v[156:157], 0
    v_mov_b64 v[158:159], 0
    v_mov_b64 v[160:161], 0
    v_mov_b64 v[162:163], 0
    v_mov_b64 v[164:165], 0
    v_mov_b64 v[166:167], 0
    v_mov_b64 v[168:169], 0
    v_mov_b64 v[170:171], 0
    v_mov_b64 v[172:173], 0
    v_mov_b64 v[174:175], 0
    v_mov_b64 v[176:177], 0
    v_mov_b64 v[178:179], 0
    v_mov_b64 v[180:181], 0
    v_mov_b64 v[182:183], 0
    v_mov_b64 v[184:185], 0
    v_mov_b64 v[186:187], 0
    v_mov_b64 v[188:189], 0
    v_mov_b64 v[190:191], 0
    v_lshlrev_b32 v238, 4, v1
    s_lshl_b32 s81, s2, 3
    s_add_u32 s81, s81, s60
    s_lshl_b32 s81, s81, 10
    s_add_u32 s56, s26, 0
    s_addc_u32 s57, s27, 0
    s_mov_b32 s58, 0
    s_and_b32 s57, s57, 0xffff
    s_mov_b32 s59, 0x00020000
    s_mov_b32 m0, 139264
    s_nop 0
    buffer_load_dwordx4 v238, s[56:59], 0 offen lds
    s_cmp_eq_u32 s61, 0
    s_cbranch_scc1 attn_nostag
    s_barrier
attn_nostag:
    ds_read_b128 v[96:99], v4 offset:0
    ds_read_b128 v[100:103], v4 offset:64
    ds_read_b128 v[104:107], v4 offset:128
    ds_read_b128 v[108:111], v4 offset:192
    ds_read_b128 v[112:115], v4 offset:4352
    ds_read_b128 v[116:119], v4 offset:4416
    ds_read_b128 v[120:123], v4 offset:4480
    ds_read_b128 v[124:127], v4 offset:4544
    s_waitcnt lgkmcnt(7)
    v_mfma_f32_16x16x32_bf16 v[48:51], v[96:99], v[16:19], v[244:247]
    v_mfma_f32_16x16x32_bf16 v[52:55], v[96:99], v[32:35], v[248:251]
    ds_read_b128 v[96:99], v4 offset:8704
    s_waitcnt lgkmcnt(7)
    v_mfma_f32_16x16x32_bf16 v[48:51], v[100:103], v[20:23], v[48:51]
    v_mfma_f32_16x16x32_bf16 v[52:55], v[100:103], v[36:39], v[52:55]
    ds_read_b128 v[100:103], v4 offset:8768
    s_waitcnt lgkmcnt(7)
    v_mfma_f32_16x16x32_bf16 v[48:51], v[104:107], v[24:27], v[48:51]
    v_mfma_f32_16x16x32_bf16 v[52:55], v[104:107], v[40:43], v[52:55]
    ds_read_b128 v[104:107], v4 offset:8832
    s_waitcnt lgkmcnt(7)
    v_mfma_f32_16x16x32_bf16 v[48:51], v[108:111], v[28:31], v[48:51]
    v_mfma_f32_16x16x32_bf16 v[52:55], v[108:111], v[44:47], v[52:55]
    ds_read_b128 v[108:111], v4 offset:8896
    s_waitcnt lgkmcnt(7)
    v_mfma_f32_16x16x32_bf16 v[56:59], v[112:115], v[16:19], v[244:247]
    v_mfma_f32_16x16x32_bf16 v[60:63], v[112:115], v[32:35], v[248:251]
    ds_read_b128 v[112:115], v4 offset:13056
    s_waitcnt lgkmcnt(7)
    v_mfma_f32_16x16x32_bf16 v[56:59], v[116:119], v[20:23], v[56:59]
    v_mfma_f32_16x16x32_bf16 v[60:63], v[116:119], v[36:39], v[60:63]
    ds_read_b128 v[116:119], v4 offset:13120
    s_waitcnt lgkmcnt(7)
    v_mfma_f32_16x16x32_bf16 v[56:59], v[120:123], v[24:27], v[56:59]
    v_mfma_f32_16x16x32_bf16 v[60:63], v[120:123], v[40:43], v[60:63]
    ds_read_b128 v[120:123], v4 offset:13184
    s_waitcnt lgkmcnt(7)
    v_mfma_f32_16x16x32_bf16 v[56:59], v[124:127], v[28:31], v[56:59]
    v_mfma_f32_16x16x32_bf16 v[60:63], v[124:127], v[44:47], v[60:63]
    ds_read_b128 v[124:127], v4 offset:13248
    s_waitcnt lgkmcnt(7)
    v_mfma_f32_16x16x32_bf16 v[64:67], v[96:99], v[16:19], v[244:247]
    v_mfma_f32_16x16x32_bf16 v[68:71], v[96:99], v[32:35], v[248:251]
    s_waitcnt lgkmcnt(6)
    v_mfma_f32_16x16x32_bf16 v[64:67], v[100:103], v[20:23], v[64:67]
    v_mfma_f32_16x16x32_bf16 v[68:71], v[100:103], v[36:39], v[68:71]
    s_waitcnt lgkmcnt(5)
    v_mfma_f32_16x16x32_bf16 v[64:67], v[104:107], v[24:27], v[64:67]
    v_mfma_f32_16x16x32_bf16 v[68:71], v[104:107], v[40:43], v[68:71]
    s_waitcnt lgkmcnt(4)
    v_mfma_f32_16x16x32_bf16 v[64:67], v[108:111], v[28:31], v[64:67]
    v_mfma_f32_16x16x32_bf16 v[68:71], v[108:111], v[44:47], v[68:71]
    s_waitcnt lgkmcnt(3)
    v_mfma_f32_16x16x32_bf16 v[72:75], v[112:115], v[16:19], v[244:247]
    v_mfma_f32_16x16x32_bf16 v[76:79], v[112:115], v[32:35], v[248:251]
    s_waitcnt lgkmcnt(2)
    v_mfma_f32_16x16x32_bf16 v[72:75], v[116:119], v[20:23], v[72:75]
    v_mfma_f32_16x16x32_bf16 v[76:79], v[116:119], v[36:39], v[76:79]
    s_waitcnt lgkmcnt(1)
    v_mfma_f32_16x16x32_bf16 v[72:75], v[120:123], v[24:27], v[72:75]
    v_mfma_f32_16x16x32_bf16 v[76:79], v[120:123], v[40:43], v[76:79]
    s_waitcnt lgkmcnt(0)
    v_mfma_f32_16x16x32_bf16 v[72:75], v[124:127], v[28:31], v[72:75]
    v_mfma_f32_16x16x32_bf16 v[76:79], v[124:127], v[44:47], v[76:79]
    s_barrier
attn_loop:
    s_cmp_eq_u32 s66, 0
    s_cselect_b32 s100, 1, 0
    s_cmp_lg_u32 s66, s97
    s_cbranch_scc1 Lnosw_308
    s_nop 7
    v_rcp_f32 v10, v224
    v_rcp_f32 v11, v228
    s_nop 0
    s_lshl_b32 s68, s75, 7
    s_mul_i32 s68, s68, 15488
    s_add_u32 s68, s68, s99
    s_lshl_b32 s69, s61, 7
    s_add_u32 s70, s68, s69
    s_sub_u32 s71, 128, s69
    s_add_u32 s71, s71, s68
    s_lshl_b32 s68, s62, 12
    s_add_u32 s68, s68, 147456
    v_and_b32 v12, 15, v1
    v_lshrrev_b32 v14, 4, v1
    v_and_b32 v13, 1, v14
    v_lshlrev_b32 v13, 1, v13
    v_lshrrev_b32 v14, 1, v14
    v_add_u32 v13, v13, v14
    v_and_b32 v14, 7, v1
    v_xor_b32 v13, v13, v14
    v_lshlrev_b32 v13, 4, v13
    v_lshlrev_b32 v12, 7, v12
    v_add3_u32 v12, v12, v13, s68
    v_xor_b32 v13, 64, v12
    v_lshrrev_b32 v14, 3, v1
    v_and_b32 v15, 7, v1
    v_xor_b32 v15, v15, v14
    v_lshlrev_b32 v15, 4, v15
    v_lshl_add_u32 v15, v14, 7, v15
    v_add_u32 v15, s68, v15
    v_mul_f32 v128, v128, v10
    v_mul_f32 v129, v129, v10
    v_mul_f32 v130, v130, v10
    v_mul_f32 v131, v131, v10
    v_mul_f32 v136, v136, v10
    v_mul_f32 v137, v137, v10
    v_mul_f32 v138, v138, v10
    v_mul_f32 v139, v139, v10
    v_cvt_pk_bf16_f32 v96, v128, v129
    v_cvt_pk_bf16_f32 v97, v130, v131
    v_cvt_pk_bf16_f32 v98, v136, v137
    v_cvt_pk_bf16_f32 v99, v138, v139
    s_nop 1
    v_permlane16_swap_b32 v96, v98
    v_permlane16_swap_b32 v97, v99
    s_nop 0
    ds_write_b128 v12, v[96:99] offset:0
    v_mul_f32 v132, v132, v11
    v_mul_f32 v133, v133, v11
    v_mul_f32 v134, v134, v11
    v_mul_f32 v135, v135, v11
    v_mul_f32 v140, v140, v11
    v_mul_f32 v141, v141, v11
    v_mul_f32 v142, v142, v11
    v_mul_f32 v143, v143, v11
    v_cvt_pk_bf16_f32 v100, v132, v133
    v_cvt_pk_bf16_f32 v101, v134, v135
    v_cvt_pk_bf16_f32 v102, v140, v141
    v_cvt_pk_bf16_f32 v103, v142, v143
    s_nop 1
    v_permlane16_swap_b32 v100, v102
    v_permlane16_swap_b32 v101, v103
    s_nop 0
    ds_write_b128 v12, v[100:103] offset:2048
    v_mul_f32 v144, v144, v10
    v_mul_f32 v145, v145, v10
    v_mul_f32 v146, v146, v10
    v_mul_f32 v147, v147, v10
    v_mul_f32 v152, v152, v10
    v_mul_f32 v153, v153, v10
    v_mul_f32 v154, v154, v10
    v_mul_f32 v155, v155, v10
    v_cvt_pk_bf16_f32 v96, v144, v145
    v_cvt_pk_bf16_f32 v97, v146, v147
    v_cvt_pk_bf16_f32 v98, v152, v153
    v_cvt_pk_bf16_f32 v99, v154, v155
    s_nop 1
    v_permlane16_swap_b32 v96, v98
    v_permlane16_swap_b32 v97, v99
    s_nop 0
    ds_write_b128 v13, v[96:99] offset:0
    v_mul_f32 v148, v148, v11
    v_mul_f32 v149, v149, v11
    v_mul_f32 v150, v150, v11
    v_mul_f32 v151, v151, v11
    v_mul_f32 v156, v156, v11
    v_mul_f32 v157, v157, v11
    v_mul_f32 v158, v158, v11
    v_mul_f32 v159, v159, v11
    v_cvt_pk_bf16_f32 v100, v148, v149
    v_cvt_pk_bf16_f32 v101, v150, v151
    v_cvt_pk_bf16_f32 v102, v156, v157
    v_cvt_pk_bf16_f32 v103, v158, v159
    s_nop 1
    v_permlane16_swap_b32 v100, v102
    v_permlane16_swap_b32 v101, v103
    s_nop 0
    ds_write_b128 v13, v[100:103] offset:2048
    s_waitcnt lgkmcnt(0)
    ds_read_b128 v[128:131], v15 offset:0
    ds_read_b128 v[132:135], v15 offset:1024
    ds_read_b128 v[136:139], v15 offset:2048
    ds_read_b128 v[140:143], v15 offset:3072
    s_waitcnt lgkmcnt(3)
    buffer_store_dwordx4 v[128:131], v233, s[52:55], s70 offen sc0 sc1
    s_add_u32 s70, s70, 123904
    s_waitcnt lgkmcnt(2)
    buffer_store_dwordx4 v[132:135], v233, s[52:55], s70 offen sc0 sc1
    s_add_u32 s70, s70, 123904
    s_waitcnt lgkmcnt(1)
    buffer_store_dwordx4 v[136:139], v233, s[52:55], s70 offen sc0 sc1
    s_add_u32 s70, s70, 123904
    s_waitcnt lgkmcnt(0)
    buffer_store_dwordx4 v[140:143], v233, s[52:55], s70 offen sc0 sc1
    v_mul_f32 v160, v160, v10
    v_mul_f32 v161, v161, v10
    v_mul_f32 v162, v162, v10
    v_mul_f32 v163, v163, v10
    v_mul_f32 v168, v168, v10
    v_mul_f32 v169, v169, v10
    v_mul_f32 v170, v170, v10
    v_mul_f32 v171, v171, v10
    v_cvt_pk_bf16_f32 v96, v160, v161
    v_cvt_pk_bf16_f32 v97, v162, v163
    v_cvt_pk_bf16_f32 v98, v168, v169
    v_cvt_pk_bf16_f32 v99, v170, v171
    s_nop 1
    v_permlane16_swap_b32 v96, v98
    v_permlane16_swap_b32 v97, v99
    s_nop 0
    ds_write_b128 v12, v[96:99] offset:0
    v_mul_f32 v164, v164, v11
    v_mul_f32 v165, v165, v11
    v_mul_f32 v166, v166, v11
    v_mul_f32 v167, v167, v11
    v_mul_f32 v172, v172, v11
    v_mul_f32 v173, v173, v11
    v_mul_f32 v174, v174, v11
    v_mul_f32 v175, v175, v11
    v_cvt_pk_bf16_f32 v100, v164, v165
    v_cvt_pk_bf16_f32 v101, v166, v167
    v_cvt_pk_bf16_f32 v102, v172, v173
    v_cvt_pk_bf16_f32 v103, v174, v175
    s_nop 1
    v_permlane16_swap_b32 v100, v102
    v_permlane16_swap_b32 v101, v103
    s_nop 0
    ds_write_b128 v12, v[100:103] offset:2048
    v_mul_f32 v176, v176, v10
    v_mul_f32 v177, v177, v10
    v_mul_f32 v178, v178, v10
    v_mul_f32 v179, v179, v10
    v_mul_f32 v184, v184, v10
    v_mul_f32 v185, v185, v10
    v_mul_f32 v186, v186, v10
    v_mul_f32 v187, v187, v10
    v_cvt_pk_bf16_f32 v96, v176, v177
    v_cvt_pk_bf16_f32 v97, v178, v179
    v_cvt_pk_bf16_f32 v98, v184, v185
    v_cvt_pk_bf16_f32 v99, v186, v187
    s_nop 1
    v_permlane16_swap_b32 v96, v98
    v_permlane16_swap_b32 v97, v99
    s_nop 0
    ds_write_b128 v13, v[96:99] offset:0
    v_mul_f32 v180, v180, v11
    v_mul_f32 v181, v181, v11
    v_mul_f32 v182, v182, v11
    v_mul_f32 v183, v183, v11
    v_mul_f32 v188, v188, v11
    v_mul_f32 v189, v189, v11
    v_mul_f32 v190, v190, v11
    v_mul_f32 v191, v191, v11
    v_cvt_pk_bf16_f32 v100, v180, v181
    v_cvt_pk_bf16_f32 v101, v182, v183
    v_cvt_pk_bf16_f32 v102, v188, v189
    v_cvt_pk_bf16_f32 v103, v190, v191
    s_nop 1
    v_permlane16_swap_b32 v100, v102
    v_permlane16_swap_b32 v101, v103
    s_nop 0
    ds_write_b128 v13, v[100:103] offset:2048
    s_waitcnt lgkmcnt(0)
    ds_read_b128 v[160:163], v15 offset:0
    ds_read_b128 v[164:167], v15 offset:1024
    ds_read_b128 v[168:171], v15 offset:2048
    ds_read_b128 v[172:175], v15 offset:3072
    s_waitcnt lgkmcnt(3)
    buffer_store_dwordx4 v[160:163], v233, s[52:55], s71 offen sc0 sc1
    s_add_u32 s71, s71, 123904
    s_waitcnt lgkmcnt(2)
    buffer_store_dwordx4 v[164:167], v233, s[52:55], s71 offen sc0 sc1
    s_add_u32 s71, s71, 123904
    s_waitcnt lgkmcnt(1)
    buffer_store_dwordx4 v[168:171], v233, s[52:55], s71 offen sc0 sc1
    s_add_u32 s71, s71, 123904
    s_waitcnt lgkmcnt(0)
    buffer_store_dwordx4 v[172:175], v233, s[52:55], s71 offen sc0 sc1
    s_nop 1
    v_mov_b64 v[128:129], 0
    v_mov_b64 v[130:131], 0
    v_mov_b64 v[132:133], 0
    v_mov_b64 v[134:135], 0
    v_mov_b64 v[136:137], 0
    v_mov_b64 v[138:139], 0
    v_mov_b64 v[140:141], 0
    v_mov_b64 v[142:143], 0
    v_mov_b64 v[144:145], 0
    v_mov_b64 v[146:147], 0
    v_mov_b64 v[148:149], 0
    v_mov_b64 v[150:151], 0
    v_mov_b64 v[152:153], 0
    v_mov_b64 v[154:155], 0
    v_mov_b64 v[156:157], 0
    v_mov_b64 v[158:159], 0
    v_mov_b64 v[160:161], 0
    v_mov_b64 v[162:163], 0
    v_mov_b64 v[164:165], 0
    v_mov_b64 v[166:167], 0
    v_mov_b64 v[168:169], 0
    v_mov_b64 v[170:171], 0
    v_mov_b64 v[172:173], 0
    v_mov_b64 v[174:175], 0
    v_mov_b64 v[176:177], 0
    v_mov_b64 v[178:179], 0
    v_mov_b64 v[180:181], 0
    v_mov_b64 v[182:183], 0
    v_mov_b64 v[184:185], 0
    v_mov_b64 v[186:187], 0
    v_mov_b64 v[188:189], 0
    v_mov_b64 v[190:191], 0
    v_mov_b64 v[8:9], 0
    v_mov_b64 v[224:225], 0
    v_mov_b64 v[226:227], 0
    v_mov_b64 v[228:229], 0
    v_mov_b64 v[230:231], 0
    s_mov_b32 s100, 1
Lnosw_308:
    s_add_u32 m0, s4, 0
    s_nop 0
    buffer_load_dwordx4 v2, s[44:47], s64 offen offset:0 lds
    s_nop 4
    s_sub_u32 s68, s66, s96
    s_cmp_gt_u32 s68, 1
    s_cbranch_scc1 Lnomask_309
    s_lshl_b32 s68, s68, 6
    v_subrev_u32 v14, s68, v232
    v_mov_b32 v15, 0xff800000
    v_cmp_le_i32 s[68:69], 0, v14
    v_cmp_le_i32 s[70:71], 1, v14
    v_cmp_le_i32 s[76:77], 2, v14
    v_cmp_le_i32 vcc, 3, v14
    v_cndmask_b32 v48, v15, v48, s[68:69]
    v_cndmask_b32 v49, v15, v49, s[70:71]
    v_cndmask_b32 v50, v15, v50, s[76:77]
    v_cndmask_b32 v51, v15, v51, vcc
    v_cmp_le_i32 s[68:69], -16, v14
    v_cmp_le_i32 s[70:71], -15, v14
    v_cmp_le_i32 s[76:77], -14, v14
    v_cmp_le_i32 vcc, -13, v14
    v_cndmask_b32 v52, v15, v52, s[68:69]
    v_cndmask_b32 v53, v15, v53, s[70:71]
    v_cndmask_b32 v54, v15, v54, s[76:77]
    v_cndmask_b32 v55, v15, v55, vcc
    v_cmp_le_i32 s[68:69], 16, v14
    v_cmp_le_i32 s[70:71], 17, v14
    v_cmp_le_i32 s[76:77], 18, v14
    v_cmp_le_i32 vcc, 19, v14
    v_cndmask_b32 v56, v15, v56, s[68:69]
    v_cndmask_b32 v57, v15, v57, s[70:71]
    v_cndmask_b32 v58, v15, v58, s[76:77]
    v_cndmask_b32 v59, v15, v59, vcc
    v_cmp_le_i32 s[68:69], 0, v14
    v_cmp_le_i32 s[70:71], 1, v14
    v_cmp_le_i32 s[76:77], 2, v14
    v_cmp_le_i32 vcc, 3, v14
    v_cndmask_b32 v60, v15, v60, s[68:69]
    v_cndmask_b32 v61, v15, v61, s[70:71]
    v_cndmask_b32 v62, v15, v62, s[76:77]
    v_cndmask_b32 v63, v15, v63, vcc
    v_cmp_le_i32 s[68:69], 32, v14
    v_cmp_le_i32 s[70:71], 33, v14
    v_cmp_le_i32 s[76:77], 34, v14
    v_cmp_le_i32 vcc, 35, v14
    v_cndmask_b32 v64, v15, v64, s[68:69]
    v_cndmask_b32 v65, v15, v65, s[70:71]
    v_cndmask_b32 v66, v15, v66, s[76:77]
    v_cndmask_b32 v67, v15, v67, vcc
    v_cmp_le_i32 s[68:69], 16, v14
    v_cmp_le_i32 s[70:71], 17, v14
    v_cmp_le_i32 s[76:77], 18, v14
    v_cmp_le_i32 vcc, 19, v14
    v_cndmask_b32 v68, v15, v68, s[68:69]
    v_cndmask_b32 v69, v15, v69, s[70:71]
    v_cndmask_b32 v70, v15, v70, s[76:77]
    v_cndmask_b32 v71, v15, v71, vcc
    v_cmp_le_i32 s[68:69], 48, v14
    v_cmp_le_i32 s[70:71], 49, v14
    v_cmp_le_i32 s[76:77], 50, v14
    v_cmp_le_i32 vcc, 51, v14
    v_cndmask_b32 v72, v15, v72, s[68:69]
    v_cndmask_b32 v73, v15, v73, s[70:71]
    v_cndmask_b32 v74, v15, v74, s[76:77]
    v_cndmask_b32 v75, v15, v75, vcc
    v_cmp_le_i32 s[68:69], 32, v14
    v_cmp_le_i32 s[70:71], 33, v14
    v_cmp_le_i32 s[76:77], 34, v14
    v_cmp_le_i32 vcc, 35, v14
    v_cndmask_b32 v76, v15, v76, s[68:69]
    v_cndmask_b32 v77, v15, v77, s[70:71]
    v_cndmask_b32 v78, v15, v78, s[76:77]
    v_cndmask_b32 v79, v15, v79, vcc
Lnomask_309:
    v_max3_f32 v12, v48, v49, v50
    v_max3_f32 v252, v51, v56, v57
    v_max3_f32 v12, v12, v58, v59
    v_max3_f32 v252, v252, v64, v65
    v_max3_f32 v12, v12, v66, v67
    v_max3_f32 v252, v252, v72, v73
    v_max3_f32 v12, v12, v74, v75
    v_max_f32 v12, v12, v252
    s_add_u32 m0, s4, 64
    s_nop 0
    buffer_load_dwordx4 v2, s[44:47], s64 offen offset:1024 lds
    v_max3_f32 v13, v52, v53, v54
    v_max3_f32 v253, v55, v60, v61
    v_max3_f32 v13, v13, v62, v63
    v_max3_f32 v253, v253, v68, v69
    v_max3_f32 v13, v13, v70, v71
    v_max3_f32 v253, v253, v76, v77
    v_max3_f32 v13, v13, v78, v79
    v_max_f32 v13, v13, v253
    s_add_u32 m0, s4, 128
    s_nop 0
    buffer_load_dwordx4 v2, s[44:47], s64 offen offset:2048 lds
    v_max_f32 v252, v12, v13
    v_cmp_lt_f32 vcc, 0x42000000, v252
    s_cmp_lg_u32 s100, 0
    s_cbranch_scc1 Lresc_311
    s_cbranch_vccz Lnoresc_310
Lresc_311:
    s_cselect_b32 s68, 0xff800000, 0
    v_mov_b32 v252, v12
    s_nop 1
    v_permlane16_swap_b32 v12, v252
    s_nop 0
    v_max_f32 v12, v12, v252
    v_mov_b32 v252, v12
    s_nop 1
    v_permlane32_swap_b32 v12, v252
    s_nop 0
    v_max_f32 v12, v12, v252
    v_max_f32 v236, s68, v12
    v_exp_f32 v234, -v236
    v_add_f32 v8, v8, v236
    s_nop 0
    v_min_f32 v234, 1.0, v234
    v_sub_f32 v48, v48, v236
    v_sub_f32 v49, v49, v236
    v_sub_f32 v50, v50, v236
    v_sub_f32 v51, v51, v236
    v_sub_f32 v56, v56, v236
    v_sub_f32 v57, v57, v236
    v_sub_f32 v58, v58, v236
    v_sub_f32 v59, v59, v236
    v_sub_f32 v64, v64, v236
    v_sub_f32 v65, v65, v236
    v_sub_f32 v66, v66, v236
    v_sub_f32 v67, v67, v236
    v_sub_f32 v72, v72, v236
    v_sub_f32 v73, v73, v236
    v_sub_f32 v74, v74, v236
    v_sub_f32 v75, v75, v236
    v_sub_f32 v244, 0, v8
    v_sub_f32 v245, 0, v8
    v_sub_f32 v246, 0, v8
    v_sub_f32 v247, 0, v8
    v_mul_f32 v224, v224, v234
    v_mul_f32 v225, v225, v234
    v_mul_f32 v226, v226, v234
    v_mul_f32 v227, v227, v234
    v_mov_b32 v252, v13
    s_nop 1
    v_permlane16_swap_b32 v13, v252
    s_nop 0
    v_max_f32 v13, v13, v252
    v_mov_b32 v252, v13
    s_nop 1
    v_permlane32_swap_b32 v13, v252
    s_nop 0
    v_max_f32 v13, v13, v252
    v_max_f32 v237, s68, v13
    v_exp_f32 v235, -v237
    v_add_f32 v9, v9, v237
    s_nop 0
    v_min_f32 v235, 1.0, v235
    v_sub_f32 v52, v52, v237
    v_sub_f32 v53, v53, v237
    v_sub_f32 v54, v54, v237
    v_sub_f32 v55, v55, v237
    v_sub_f32 v60, v60, v237
    v_sub_f32 v61, v61, v237
    v_sub_f32 v62, v62, v237
    v_sub_f32 v63, v63, v237
    v_sub_f32 v68, v68, v237
    v_sub_f32 v69, v69, v237
    v_sub_f32 v70, v70, v237
    v_sub_f32 v71, v71, v237
    v_sub_f32 v76, v76, v237
    v_sub_f32 v77, v77, v237
    v_sub_f32 v78, v78, v237
    v_sub_f32 v79, v79, v237
    v_sub_f32 v248, 0, v9
    v_sub_f32 v249, 0, v9
    v_sub_f32 v250, 0, v9
    v_sub_f32 v251, 0, v9
    v_mul_f32 v228, v228, v235
    v_mul_f32 v229, v229, v235
    v_mul_f32 v230, v230, v235
    v_mul_f32 v231, v231, v235
    s_cbranch_scc1 Lnoresc_310
    v_mul_f32 v128, v128, v234
    v_mul_f32 v129, v129, v234
    v_mul_f32 v130, v130, v234
    v_mul_f32 v131, v131, v234
    v_mul_f32 v132, v132, v235
    v_mul_f32 v133, v133, v235
    v_mul_f32 v134, v134, v235
    v_mul_f32 v135, v135, v235
    v_mul_f32 v136, v136, v234
    v_mul_f32 v137, v137, v234
    v_mul_f32 v138, v138, v234
    v_mul_f32 v139, v139, v234
    v_mul_f32 v140, v140, v235
    v_mul_f32 v141, v141, v235
    v_mul_f32 v142, v142, v235
    v_mul_f32 v143, v143, v235
    v_mul_f32 v144, v144, v234
    v_mul_f32 v145, v145, v234
    v_mul_f32 v146, v146, v234
    v_mul_f32 v147, v147, v234
    v_mul_f32 v148, v148, v235
    v_mul_f32 v149, v149, v235
    v_mul_f32 v150, v150, v235
    v_mul_f32 v151, v151, v235
    v_mul_f32 v152, v152, v234
    v_mul_f32 v153, v153, v234
    v_mul_f32 v154, v154, v234
    v_mul_f32 v155, v155, v234
    v_mul_f32 v156, v156, v235
    v_mul_f32 v157, v157, v235
    v_mul_f32 v158, v158, v235
    v_mul_f32 v159, v159, v235
    v_mul_f32 v160, v160, v234
    v_mul_f32 v161, v161, v234
    v_mul_f32 v162, v162, v234
    v_mul_f32 v163, v163, v234
    v_mul_f32 v164, v164, v235
    v_mul_f32 v165, v165, v235
    v_mul_f32 v166, v166, v235
    v_mul_f32 v167, v167, v235
    v_mul_f32 v168, v168, v234
    v_mul_f32 v169, v169, v234
    v_mul_f32 v170, v170, v234
    v_mul_f32 v171, v171, v234
    v_mul_f32 v172, v172, v235
    v_mul_f32 v173, v173, v235
    v_mul_f32 v174, v174, v235
    v_mul_f32 v175, v175, v235
    v_mul_f32 v176, v176, v234
    v_mul_f32 v177, v177, v234
    v_mul_f32 v178, v178, v234
    v_mul_f32 v179, v179, v234
    v_mul_f32 v180, v180, v235
    v_mul_f32 v181, v181, v235
    v_mul_f32 v182, v182, v235
    v_mul_f32 v183, v183, v235
    v_mul_f32 v184, v184, v234
    v_mul_f32 v185, v185, v234
    v_mul_f32 v186, v186, v234
    v_mul_f32 v187, v187, v234
    v_mul_f32 v188, v188, v235
    v_mul_f32 v189, v189, v235
    v_mul_f32 v190, v190, v235
    v_mul_f32 v191, v191, v235
Lnoresc_310:
    v_exp_f32 v48, v48
    v_exp_f32 v49, v49
    v_exp_f32 v50, v50
    v_exp_f32 v51, v51
    v_exp_f32 v52, v52
    v_exp_f32 v53, v53
    v_exp_f32 v54, v54
    v_exp_f32 v55, v55
    s_add_u32 m0, s4, 192
    s_nop 0
    buffer_load_dwordx4 v2, s[44:47], s64 offen offset:3072 lds
    s_add_u32 s64, s64, 16384
    s_xor_b32 s4, s4, s7
    s_sub_u32 s6, s6, 1
    s_cmp_eq_u32 s6, 0
    s_cselect_b32 s64, 0, s64
    s_nop 0
    v_cvt_pk_bf16_f32 v80, v48, v49
    v_cvt_pk_bf16_f32 v81, v50, v51
    v_cvt_pk_bf16_f32 v84, v52, v53
    v_cvt_pk_bf16_f32 v85, v54, v55
    v_exp_f32 v56, v56
    v_exp_f32 v57, v57
    v_exp_f32 v58, v58
    v_exp_f32 v59, v59
    v_exp_f32 v60, v60
    v_exp_f32 v61, v61
    v_exp_f32 v62, v62
    v_exp_f32 v63, v63
    s_nop 0
    v_cvt_pk_bf16_f32 v82, v56, v57
    v_cvt_pk_bf16_f32 v83, v58, v59
    v_cvt_pk_bf16_f32 v86, v60, v61
    v_cvt_pk_bf16_f32 v87, v62, v63
    v_exp_f32 v64, v64
    v_exp_f32 v65, v65
    v_exp_f32 v66, v66
    v_exp_f32 v67, v67
    v_exp_f32 v68, v68
    v_exp_f32 v69, v69
    v_exp_f32 v70, v70
    v_exp_f32 v71, v71
    s_nop 0
    v_cvt_pk_bf16_f32 v88, v64, v65
    v_cvt_pk_bf16_f32 v89, v66, v67
    v_cvt_pk_bf16_f32 v92, v68, v69
    v_cvt_pk_bf16_f32 v93, v70, v71
    v_exp_f32 v72, v72
    v_exp_f32 v73, v73
    v_exp_f32 v74, v74
    v_exp_f32 v75, v75
    v_exp_f32 v76, v76
    v_exp_f32 v77, v77
    v_exp_f32 v78, v78
    v_exp_f32 v79, v79
    s_nop 0
    v_cvt_pk_bf16_f32 v90, v72, v73
    v_cvt_pk_bf16_f32 v91, v74, v75
    v_cvt_pk_bf16_f32 v94, v76, v77
    v_cvt_pk_bf16_f32 v95, v78, v79
    s_add_u32 s68, s66, 1
    s_cmp_lg_u32 s68, s97
    s_cbranch_scc1 Lnoq_312
    v_mov_b64 v[16:17], v[192:193]
    v_mov_b64 v[18:19], v[194:195]
    v_mov_b64 v[20:21], v[196:197]
    v_mov_b64 v[22:23], v[198:199]
    v_mov_b64 v[24:25], v[200:201]
    v_mov_b64 v[26:27], v[202:203]
    v_mov_b64 v[28:29], v[204:205]
    v_mov_b64 v[30:31], v[206:207]
    v_mov_b64 v[32:33], v[208:209]
    v_mov_b64 v[34:35], v[210:211]
    v_mov_b64 v[36:37], v[212:213]
    v_mov_b64 v[38:39], v[214:215]
    v_mov_b64 v[40:41], v[216:217]
    v_mov_b64 v[42:43], v[218:219]
    v_mov_b64 v[44:45], v[220:221]
    v_mov_b64 v[46:47], v[222:223]
    v_mov_b64 v[244:245], 0
    v_mov_b64 v[246:247], 0
    v_mov_b64 v[248:249], 0
    v_mov_b64 v[250:251], 0
Lnoq_312:
    v_add_u32 v4, s9, v4
    s_sub_u32 s9, 0, s9
    ds_read_b128 v[96:99], v4 offset:0
    ds_read_b128 v[100:103], v4 offset:64
    ds_read_b128 v[104:107], v4 offset:128
    ds_read_b128 v[108:111], v4 offset:192
    ds_read_b128 v[112:115], v4 offset:4352
    ds_read_b128 v[116:119], v4 offset:4416
    ds_read_b128 v[120:123], v4 offset:4480
    ds_read_b128 v[124:127], v4 offset:4544
    s_waitcnt vmcnt(5)
    s_barrier
    s_waitcnt lgkmcnt(7)
    v_mfma_f32_16x16x32_bf16 v[48:51], v[96:99], v[16:19], v[244:247]
    v_mfma_f32_16x16x32_bf16 v[52:55], v[96:99], v[32:35], v[248:251]
    ds_read_b128 v[96:99], v4 offset:8704
    s_waitcnt lgkmcnt(7)
    v_mfma_f32_16x16x32_bf16 v[48:51], v[100:103], v[20:23], v[48:51]
    v_mfma_f32_16x16x32_bf16 v[52:55], v[100:103], v[36:39], v[52:55]
    ds_read_b128 v[100:103], v4 offset:8768
    s_waitcnt lgkmcnt(7)
    v_mfma_f32_16x16x32_bf16 v[48:51], v[104:107], v[24:27], v[48:51]
    v_mfma_f32_16x16x32_bf16 v[52:55], v[104:107], v[40:43], v[52:55]
    ds_read_b128 v[104:107], v4 offset:8832
    s_waitcnt lgkmcnt(7)
    v_mfma_f32_16x16x32_bf16 v[48:51], v[108:111], v[28:31], v[48:51]
    v_mfma_f32_16x16x32_bf16 v[52:55], v[108:111], v[44:47], v[52:55]
    ds_read_b128 v[108:111], v4 offset:8896
    s_waitcnt lgkmcnt(7)
    v_mfma_f32_16x16x32_bf16 v[56:59], v[112:115], v[16:19], v[244:247]
    v_mfma_f32_16x16x32_bf16 v[60:63], v[112:115], v[32:35], v[248:251]
    ds_read_b128 v[112:115], v4 offset:13056
    s_waitcnt lgkmcnt(7)
    v_mfma_f32_16x16x32_bf16 v[56:59], v[116:119], v[20:23], v[56:59]
    v_mfma_f32_16x16x32_bf16 v[60:63], v[116:119], v[36:39], v[60:63]
    ds_read_b128 v[116:119], v4 offset:13120
    s_waitcnt lgkmcnt(7)
    v_mfma_f32_16x16x32_bf16 v[56:59], v[120:123], v[24:27], v[56:59]
    v_mfma_f32_16x16x32_bf16 v[60:63], v[120:123], v[40:43], v[60:63]
    ds_read_b128 v[120:123], v4 offset:13184
    s_waitcnt lgkmcnt(7)
    v_mfma_f32_16x16x32_bf16 v[56:59], v[124:127], v[28:31], v[56:59]
    v_mfma_f32_16x16x32_bf16 v[60:63], v[124:127], v[44:47], v[60:63]
    ds_read_b128 v[124:127], v4 offset:13248
    s_waitcnt lgkmcnt(7)
    v_mfma_f32_16x16x32_bf16 v[64:67], v[96:99], v[16:19], v[244:247]
    v_mfma_f32_16x16x32_bf16 v[68:71], v[96:99], v[32:35], v[248:251]
    ds_read_b128 v[96:99], v6 offset:0
    s_waitcnt lgkmcnt(7)
    v_mfma_f32_16x16x32_bf16 v[64:67], v[100:103], v[20:23], v[64:67]
    v_mfma_f32_16x16x32_bf16 v[68:71], v[100:103], v[36:39], v[68:71]
    ds_read_b128 v[100:103], v6 offset:2176
    s_waitcnt lgkmcnt(7)
    v_mfma_f32_16x16x32_bf16 v[64:67], v[104:107], v[24:27], v[64:67]
    v_mfma_f32_16x16x32_bf16 v[68:71], v[104:107], v[40:43], v[68:71]
    ds_read_b128 v[104:107], v6 offset:4352
    s_waitcnt lgkmcnt(7)
    v_mfma_f32_16x16x32_bf16 v[64:67], v[108:111], v[28:31], v[64:67]
    v_mfma_f32_16x16x32_bf16 v[68:71], v[108:111], v[44:47], v[68:71]
    ds_read_b128 v[108:111], v6 offset:6528
    s_waitcnt lgkmcnt(7)
    v_mfma_f32_16x16x32_bf16 v[72:75], v[112:115], v[16:19], v[244:247]
    v_mfma_f32_16x16x32_bf16 v[76:79], v[112:115], v[32:35], v[248:251]
    ds_read_b128 v[112:115], v7 offset:0
    s_waitcnt lgkmcnt(7)
    v_mfma_f32_16x16x32_bf16 v[72:75], v[116:119], v[20:23], v[72:75]
    v_mfma_f32_16x16x32_bf16 v[76:79], v[116:119], v[36:39], v[76:79]
    ds_read_b128 v[116:119], v7 offset:2176
    s_waitcnt lgkmcnt(7)
    v_mfma_f32_16x16x32_bf16 v[72:75], v[120:123], v[24:27], v[72:75]
    v_mfma_f32_16x16x32_bf16 v[76:79], v[120:123], v[40:43], v[76:79]
    ds_read_b128 v[120:123], v7 offset:4352
    s_waitcnt lgkmcnt(7)
    v_mfma_f32_16x16x32_bf16 v[72:75], v[124:127], v[28:31], v[72:75]
    v_mfma_f32_16x16x32_bf16 v[76:79], v[124:127], v[44:47], v[76:79]
    ds_read_b128 v[124:127], v7 offset:6528
    s_waitcnt lgkmcnt(7)
    v_mfma_f32_16x16x32_bf16 v[128:131], v[96:99], v[80:83], v[128:131]
    v_mfma_f32_16x16x32_bf16 v[132:135], v[96:99], v[84:87], v[132:135]
    v_mfma_f32_16x16x32_bf16 v[224:227], v[240:243], v[80:83], v[224:227]
    v_mfma_f32_16x16x32_bf16 v[228:231], v[240:243], v[84:87], v[228:231]
    ds_read_b128 v[96:99], v6 offset:64
    s_waitcnt lgkmcnt(7)
    v_mfma_f32_16x16x32_bf16 v[136:139], v[100:103], v[80:83], v[136:139]
    v_mfma_f32_16x16x32_bf16 v[140:143], v[100:103], v[84:87], v[140:143]
    ds_read_b128 v[100:103], v6 offset:2240
    s_waitcnt lgkmcnt(7)
    v_mfma_f32_16x16x32_bf16 v[144:147], v[104:107], v[80:83], v[144:147]
    v_mfma_f32_16x16x32_bf16 v[148:151], v[104:107], v[84:87], v[148:151]
    ds_read_b128 v[104:107], v6 offset:4416
    s_waitcnt lgkmcnt(7)
    v_mfma_f32_16x16x32_bf16 v[152:155], v[108:111], v[80:83], v[152:155]
    v_mfma_f32_16x16x32_bf16 v[156:159], v[108:111], v[84:87], v[156:159]
    ds_read_b128 v[108:111], v6 offset:6592
    s_waitcnt lgkmcnt(7)
    v_mfma_f32_16x16x32_bf16 v[160:163], v[112:115], v[80:83], v[160:163]
    v_mfma_f32_16x16x32_bf16 v[164:167], v[112:115], v[84:87], v[164:167]
    ds_read_b128 v[112:115], v7 offset:64
    s_waitcnt lgkmcnt(7)
    v_mfma_f32_16x16x32_bf16 v[168:171], v[116:119], v[80:83], v[168:171]
    v_mfma_f32_16x16x32_bf16 v[172:175], v[116:119], v[84:87], v[172:175]
    ds_read_b128 v[116:119], v7 offset:2240
    s_waitcnt lgkmcnt(7)
    v_mfma_f32_16x16x32_bf16 v[176:179], v[120:123], v[80:83], v[176:179]
    v_mfma_f32_16x16x32_bf16 v[180:183], v[120:123], v[84:87], v[180:183]
    ds_read_b128 v[120:123], v7 offset:4416
    s_waitcnt lgkmcnt(7)
    v_mfma_f32_16x16x32_bf16 v[184:187], v[124:127], v[80:83], v[184:187]
    v_mfma_f32_16x16x32_bf16 v[188:191], v[124:127], v[84:87], v[188:191]
    ds_read_b128 v[124:127], v7 offset:6592
    s_waitcnt lgkmcnt(7)
    v_mfma_f32_16x16x32_bf16 v[128:131], v[96:99], v[88:91], v[128:131]
    v_mfma_f32_16x16x32_bf16 v[132:135], v[96:99], v[92:95], v[132:135]
    v_mfma_f32_16x16x32_bf16 v[224:227], v[240:243], v[88:91], v[224:227]
    v_mfma_f32_16x16x32_bf16 v[228:231], v[240:243], v[92:95], v[228:231]
    s_waitcnt lgkmcnt(6)
    v_mfma_f32_16x16x32_bf16 v[136:139], v[100:103], v[88:91], v[136:139]
    v_mfma_f32_16x16x32_bf16 v[140:143], v[100:103], v[92:95], v[140:143]
    s_waitcnt lgkmcnt(5)
    v_mfma_f32_16x16x32_bf16 v[144:147], v[104:107], v[88:91], v[144:147]
    v_mfma_f32_16x16x32_bf16 v[148:151], v[104:107], v[92:95], v[148:151]
    s_waitcnt lgkmcnt(4)
    v_mfma_f32_16x16x32_bf16 v[152:155], v[108:111], v[88:91], v[152:155]
    v_mfma_f32_16x16x32_bf16 v[156:159], v[108:111], v[92:95], v[156:159]
    s_waitcnt lgkmcnt(3)
    v_mfma_f32_16x16x32_bf16 v[160:163], v[112:115], v[88:91], v[160:163]
    v_mfma_f32_16x16x32_bf16 v[164:167], v[112:115], v[92:95], v[164:167]
    s_waitcnt lgkmcnt(2)
    v_mfma_f32_16x16x32_bf16 v[168:171], v[116:119], v[88:91], v[168:171]
    v_mfma_f32_16x16x32_bf16 v[172:175], v[116:119], v[92:95], v[172:175]
    s_waitcnt lgkmcnt(1)
    v_mfma_f32_16x16x32_bf16 v[176:179], v[120:123], v[88:91], v[176:179]
    v_mfma_f32_16x16x32_bf16 v[180:183], v[120:123], v[92:95], v[180:183]
    s_waitcnt lgkmcnt(0)
    v_mfma_f32_16x16x32_bf16 v[184:187], v[124:127], v[88:91], v[184:187]
    v_mfma_f32_16x16x32_bf16 v[188:191], v[124:127], v[92:95], v[188:191]
    s_add_u32 m0, s5, 0
    s_nop 0
    buffer_load_dwordx4 v3, s[48:51], s65 offen offset:0 lds
    s_add_u32 m0, s5, 64
    s_nop 0
    buffer_load_dwordx4 v3, s[48:51], s65 offen offset:1024 lds
    s_add_u32 m0, s5, 128
    s_nop 0
    buffer_load_dwordx4 v3, s[48:51], s65 offen offset:2048 lds
    s_add_u32 m0, s5, 192
    s_nop 0
    buffer_load_dwordx4 v3, s[48:51], s65 offen offset:3072 lds
    s_add_u32 s65, s65, 16384
    s_xor_b32 s5, s5, s8
    s_sub_u32 s63, s63, 1
    s_cmp_eq_u32 s63, 0
    s_cselect_b32 s65, 0, s65
    s_cmp_lt_u32 s66, 4
    s_cselect_b32 s56, s26, s34
    s_cselect_b32 s57, s27, s35
    s_mov_b32 s58, 7340032
    s_cselect_b32 s58, 8388608, s58
    s_and_b32 s57, s57, 0xffff
    s_mov_b32 s59, 0x00020000
    s_cmp_lt_u32 s66, 8
    s_cselect_b32 s58, s58, 0
    s_and_b32 s68, s66, 3
    s_lshl_b32 s68, s68, 21
    s_add_u32 s68, s68, s81
    s_lshl_b32 s69, s60, 10
    s_add_u32 m0, s69, 139264
    s_nop 0
    buffer_load_dwordx4 v238, s[56:59], s68 offen lds
    v_add_u32 v6, s10, v6
    v_add_u32 v7, s10, v7
    s_sub_u32 s10, 0, s10
    s_add_u32 s66, s66, 1
    s_waitcnt vmcnt(5)
    s_barrier
    s_cmp_lg_u32 s60, 0
    s_cbranch_scc1 Lnw0_313
    s_cmp_lg_u32 s66, 1
    s_cbranch_scc1 attn_nohf
    s_cmp_lg_u32 s60, 0
    s_cbranch_scc1 Lnw0_314
    s_cmp_eq_u32 s82, 99
    s_cbranch_scc1 Lnw0_314
    s_add_u32 s56, s42, 209715200
    s_addc_u32 s57, s43, 0
    s_mov_b32 s58, 262144
    s_and_b32 s57, s57, 0xffff
    s_mov_b32 s59, 0x00020000
    s_lshl_b32 s68, s82, 3
    s_add_u32 s68, s68, s75
    s_lshl_b32 s68, s68, 7
    s_add_u32 s68, s68, 65536
    v_mov_b32 v96, s12
    v_mov_b32 v97, s13
    v_mov_b32 v98, 0
    s_mov_b64 exec, 1
    buffer_store_dwordx2 v[96:97], v98, s[56:59], s68 offen sc0 sc1
    s_mov_b64 exec, -1
Lnw0_314:
attn_nohf:
    s_sub_u32 s68, s66, s11
    s_cmp_lg_u32 s68, 2
    s_cbranch_scc1 Lnw0_313
    s_add_u32 s56, s42, 209715200
    s_addc_u32 s57, s43, 0
    s_mov_b32 s58, 262144
    s_and_b32 s57, s57, 0xffff
    s_mov_b32 s59, 0x00020000
    s_lshl_b32 s68, s75, 5
    s_add_u32 s68, s68, s72
    s_lshl_b32 s68, s68, 7
    s_add_u32 s68, s68, 98304
    v_mov_b32 v96, s12
    v_mov_b32 v97, s13
    v_mov_b32 v98, 0
    s_mov_b64 exec, 1
    buffer_store_dwordx2 v[96:97], v98, s[56:59], s68 offen sc0 sc1
    s_mov_b64 exec, -1
Lnw0_313:
    s_cmp_lt_u32 s66, 16
    s_cbranch_scc1 attn_loop
    s_cmp_eq_u32 s66, 0
    s_cselect_b32 s100, 1, 0
    s_cmp_lg_u32 s66, s97
    s_cbranch_scc1 Lnosw_315
    s_nop 7
    v_rcp_f32 v10, v224
    v_rcp_f32 v11, v228
    s_nop 0
    s_lshl_b32 s68, s75, 7
    s_mul_i32 s68, s68, 15488
    s_add_u32 s68, s68, s99
    s_lshl_b32 s69, s61, 7
    s_add_u32 s70, s68, s69
    s_sub_u32 s71, 128, s69
    s_add_u32 s71, s71, s68
    s_lshl_b32 s68, s62, 12
    s_add_u32 s68, s68, 147456
    v_and_b32 v12, 15, v1
    v_lshrrev_b32 v14, 4, v1
    v_and_b32 v13, 1, v14
    v_lshlrev_b32 v13, 1, v13
    v_lshrrev_b32 v14, 1, v14
    v_add_u32 v13, v13, v14
    v_and_b32 v14, 7, v1
    v_xor_b32 v13, v13, v14
    v_lshlrev_b32 v13, 4, v13
    v_lshlrev_b32 v12, 7, v12
    v_add3_u32 v12, v12, v13, s68
    v_xor_b32 v13, 64, v12
    v_lshrrev_b32 v14, 3, v1
    v_and_b32 v15, 7, v1
    v_xor_b32 v15, v15, v14
    v_lshlrev_b32 v15, 4, v15
    v_lshl_add_u32 v15, v14, 7, v15
    v_add_u32 v15, s68, v15
    v_mul_f32 v128, v128, v10
    v_mul_f32 v129, v129, v10
    v_mul_f32 v130, v130, v10
    v_mul_f32 v131, v131, v10
    v_mul_f32 v136, v136, v10
    v_mul_f32 v137, v137, v10
    v_mul_f32 v138, v138, v10
    v_mul_f32 v139, v139, v10
    v_cvt_pk_bf16_f32 v96, v128, v129
    v_cvt_pk_bf16_f32 v97, v130, v131
    v_cvt_pk_bf16_f32 v98, v136, v137
    v_cvt_pk_bf16_f32 v99, v138, v139
    s_nop 1
    v_permlane16_swap_b32 v96, v98
    v_permlane16_swap_b32 v97, v99
    s_nop 0
    ds_write_b128 v12, v[96:99] offset:0
    v_mul_f32 v132, v132, v11
    v_mul_f32 v133, v133, v11
    v_mul_f32 v134, v134, v11
    v_mul_f32 v135, v135, v11
    v_mul_f32 v140, v140, v11
    v_mul_f32 v141, v141, v11
    v_mul_f32 v142, v142, v11
    v_mul_f32 v143, v143, v11
    v_cvt_pk_bf16_f32 v100, v132, v133
    v_cvt_pk_bf16_f32 v101, v134, v135
    v_cvt_pk_bf16_f32 v102, v140, v141
    v_cvt_pk_bf16_f32 v103, v142, v143
    s_nop 1
    v_permlane16_swap_b32 v100, v102
    v_permlane16_swap_b32 v101, v103
    s_nop 0
    ds_write_b128 v12, v[100:103] offset:2048
    v_mul_f32 v144, v144, v10
    v_mul_f32 v145, v145, v10
    v_mul_f32 v146, v146, v10
    v_mul_f32 v147, v147, v10
    v_mul_f32 v152, v152, v10
    v_mul_f32 v153, v153, v10
    v_mul_f32 v154, v154, v10
    v_mul_f32 v155, v155, v10
    v_cvt_pk_bf16_f32 v96, v144, v145
    v_cvt_pk_bf16_f32 v97, v146, v147
    v_cvt_pk_bf16_f32 v98, v152, v153
    v_cvt_pk_bf16_f32 v99, v154, v155
    s_nop 1
    v_permlane16_swap_b32 v96, v98
    v_permlane16_swap_b32 v97, v99
    s_nop 0
    ds_write_b128 v13, v[96:99] offset:0
    v_mul_f32 v148, v148, v11
    v_mul_f32 v149, v149, v11
    v_mul_f32 v150, v150, v11
    v_mul_f32 v151, v151, v11
    v_mul_f32 v156, v156, v11
    v_mul_f32 v157, v157, v11
    v_mul_f32 v158, v158, v11
    v_mul_f32 v159, v159, v11
    v_cvt_pk_bf16_f32 v100, v148, v149
    v_cvt_pk_bf16_f32 v101, v150, v151
    v_cvt_pk_bf16_f32 v102, v156, v157
    v_cvt_pk_bf16_f32 v103, v158, v159
    s_nop 1
    v_permlane16_swap_b32 v100, v102
    v_permlane16_swap_b32 v101, v103
    s_nop 0
    ds_write_b128 v13, v[100:103] offset:2048
    s_waitcnt lgkmcnt(0)
    ds_read_b128 v[128:131], v15 offset:0
    ds_read_b128 v[132:135], v15 offset:1024
    ds_read_b128 v[136:139], v15 offset:2048
    ds_read_b128 v[140:143], v15 offset:3072
    s_waitcnt lgkmcnt(3)
    buffer_store_dwordx4 v[128:131], v233, s[52:55], s70 offen sc0 sc1
    s_add_u32 s70, s70, 123904
    s_waitcnt lgkmcnt(2)
    buffer_store_dwordx4 v[132:135], v233, s[52:55], s70 offen sc0 sc1
    s_add_u32 s70, s70, 123904
    s_waitcnt lgkmcnt(1)
    buffer_store_dwordx4 v[136:139], v233, s[52:55], s70 offen sc0 sc1
    s_add_u32 s70, s70, 123904
    s_waitcnt lgkmcnt(0)
    buffer_store_dwordx4 v[140:143], v233, s[52:55], s70 offen sc0 sc1
    v_mul_f32 v160, v160, v10
    v_mul_f32 v161, v161, v10
    v_mul_f32 v162, v162, v10
    v_mul_f32 v163, v163, v10
    v_mul_f32 v168, v168, v10
    v_mul_f32 v169, v169, v10
    v_mul_f32 v170, v170, v10
    v_mul_f32 v171, v171, v10
    v_cvt_pk_bf16_f32 v96, v160, v161
    v_cvt_pk_bf16_f32 v97, v162, v163
    v_cvt_pk_bf16_f32 v98, v168, v169
    v_cvt_pk_bf16_f32 v99, v170, v171
    s_nop 1
    v_permlane16_swap_b32 v96, v98
    v_permlane16_swap_b32 v97, v99
    s_nop 0
    ds_write_b128 v12, v[96:99] offset:0
    v_mul_f32 v164, v164, v11
    v_mul_f32 v165, v165, v11
    v_mul_f32 v166, v166, v11
    v_mul_f32 v167, v167, v11
    v_mul_f32 v172, v172, v11
    v_mul_f32 v173, v173, v11
    v_mul_f32 v174, v174, v11
    v_mul_f32 v175, v175, v11
    v_cvt_pk_bf16_f32 v100, v164, v165
    v_cvt_pk_bf16_f32 v101, v166, v167
    v_cvt_pk_bf16_f32 v102, v172, v173
    v_cvt_pk_bf16_f32 v103, v174, v175
    s_nop 1
    v_permlane16_swap_b32 v100, v102
    v_permlane16_swap_b32 v101, v103
    s_nop 0
    ds_write_b128 v12, v[100:103] offset:2048
    v_mul_f32 v176, v176, v10
    v_mul_f32 v177, v177, v10
    v_mul_f32 v178, v178, v10
    v_mul_f32 v179, v179, v10
    v_mul_f32 v184, v184, v10
    v_mul_f32 v185, v185, v10
    v_mul_f32 v186, v186, v10
    v_mul_f32 v187, v187, v10
    v_cvt_pk_bf16_f32 v96, v176, v177
    v_cvt_pk_bf16_f32 v97, v178, v179
    v_cvt_pk_bf16_f32 v98, v184, v185
    v_cvt_pk_bf16_f32 v99, v186, v187
    s_nop 1
    v_permlane16_swap_b32 v96, v98
    v_permlane16_swap_b32 v97, v99
    s_nop 0
    ds_write_b128 v13, v[96:99] offset:0
    v_mul_f32 v180, v180, v11
    v_mul_f32 v181, v181, v11
    v_mul_f32 v182, v182, v11
    v_mul_f32 v183, v183, v11
    v_mul_f32 v188, v188, v11
    v_mul_f32 v189, v189, v11
    v_mul_f32 v190, v190, v11
    v_mul_f32 v191, v191, v11
    v_cvt_pk_bf16_f32 v100, v180, v181
    v_cvt_pk_bf16_f32 v101, v182, v183
    v_cvt_pk_bf16_f32 v102, v188, v189
    v_cvt_pk_bf16_f32 v103, v190, v191
    s_nop 1
    v_permlane16_swap_b32 v100, v102
    v_permlane16_swap_b32 v101, v103
    s_nop 0
    ds_write_b128 v13, v[100:103] offset:2048
    s_waitcnt lgkmcnt(0)
    ds_read_b128 v[160:163], v15 offset:0
    ds_read_b128 v[164:167], v15 offset:1024
    ds_read_b128 v[168:171], v15 offset:2048
    ds_read_b128 v[172:175], v15 offset:3072
    s_waitcnt lgkmcnt(3)
    buffer_store_dwordx4 v[160:163], v233, s[52:55], s71 offen sc0 sc1
    s_add_u32 s71, s71, 123904
    s_waitcnt lgkmcnt(2)
    buffer_store_dwordx4 v[164:167], v233, s[52:55], s71 offen sc0 sc1
    s_add_u32 s71, s71, 123904
    s_waitcnt lgkmcnt(1)
    buffer_store_dwordx4 v[168:171], v233, s[52:55], s71 offen sc0 sc1
    s_add_u32 s71, s71, 123904
    s_waitcnt lgkmcnt(0)
    buffer_store_dwordx4 v[172:175], v233, s[52:55], s71 offen sc0 sc1
    s_nop 1
    v_mov_b64 v[128:129], 0
    v_mov_b64 v[130:131], 0
    v_mov_b64 v[132:133], 0
    v_mov_b64 v[134:135], 0
    v_mov_b64 v[136:137], 0
    v_mov_b64 v[138:139], 0
    v_mov_b64 v[140:141], 0
    v_mov_b64 v[142:143], 0
    v_mov_b64 v[144:145], 0
    v_mov_b64 v[146:147], 0
    v_mov_b64 v[148:149], 0
    v_mov_b64 v[150:151], 0
    v_mov_b64 v[152:153], 0
    v_mov_b64 v[154:155], 0
    v_mov_b64 v[156:157], 0
    v_mov_b64 v[158:159], 0
    v_mov_b64 v[160:161], 0
    v_mov_b64 v[162:163], 0
    v_mov_b64 v[164:165], 0
    v_mov_b64 v[166:167], 0
    v_mov_b64 v[168:169], 0
    v_mov_b64 v[170:171], 0
    v_mov_b64 v[172:173], 0
    v_mov_b64 v[174:175], 0
    v_mov_b64 v[176:177], 0
    v_mov_b64 v[178:179], 0
    v_mov_b64 v[180:181], 0
    v_mov_b64 v[182:183], 0
    v_mov_b64 v[184:185], 0
    v_mov_b64 v[186:187], 0
    v_mov_b64 v[188:189], 0
    v_mov_b64 v[190:191], 0
    v_mov_b64 v[8:9], 0
    v_mov_b64 v[224:225], 0
    v_mov_b64 v[226:227], 0
    v_mov_b64 v[228:229], 0
    v_mov_b64 v[230:231], 0
    s_mov_b32 s100, 1
Lnosw_315:
    s_nop 4
    s_sub_u32 s68, s66, s96
    s_cmp_gt_u32 s68, 1
    s_cbranch_scc1 Lnomask_316
    s_lshl_b32 s68, s68, 6
    v_subrev_u32 v14, s68, v232
    v_mov_b32 v15, 0xff800000
    v_cmp_le_i32 s[68:69], 0, v14
    v_cmp_le_i32 s[70:71], 1, v14
    v_cmp_le_i32 s[76:77], 2, v14
    v_cmp_le_i32 vcc, 3, v14
    v_cndmask_b32 v48, v15, v48, s[68:69]
    v_cndmask_b32 v49, v15, v49, s[70:71]
    v_cndmask_b32 v50, v15, v50, s[76:77]
    v_cndmask_b32 v51, v15, v51, vcc
    v_cmp_le_i32 s[68:69], -16, v14
    v_cmp_le_i32 s[70:71], -15, v14
    v_cmp_le_i32 s[76:77], -14, v14
    v_cmp_le_i32 vcc, -13, v14
    v_cndmask_b32 v52, v15, v52, s[68:69]
    v_cndmask_b32 v53, v15, v53, s[70:71]
    v_cndmask_b32 v54, v15, v54, s[76:77]
    v_cndmask_b32 v55, v15, v55, vcc
    v_cmp_le_i32 s[68:69], 16, v14
    v_cmp_le_i32 s[70:71], 17, v14
    v_cmp_le_i32 s[76:77], 18, v14
    v_cmp_le_i32 vcc, 19, v14
    v_cndmask_b32 v56, v15, v56, s[68:69]
    v_cndmask_b32 v57, v15, v57, s[70:71]
    v_cndmask_b32 v58, v15, v58, s[76:77]
    v_cndmask_b32 v59, v15, v59, vcc
    v_cmp_le_i32 s[68:69], 0, v14
    v_cmp_le_i32 s[70:71], 1, v14
    v_cmp_le_i32 s[76:77], 2, v14
    v_cmp_le_i32 vcc, 3, v14
    v_cndmask_b32 v60, v15, v60, s[68:69]
    v_cndmask_b32 v61, v15, v61, s[70:71]
    v_cndmask_b32 v62, v15, v62, s[76:77]
    v_cndmask_b32 v63, v15, v63, vcc
    v_cmp_le_i32 s[68:69], 32, v14
    v_cmp_le_i32 s[70:71], 33, v14
    v_cmp_le_i32 s[76:77], 34, v14
    v_cmp_le_i32 vcc, 35, v14
    v_cndmask_b32 v64, v15, v64, s[68:69]
    v_cndmask_b32 v65, v15, v65, s[70:71]
    v_cndmask_b32 v66, v15, v66, s[76:77]
    v_cndmask_b32 v67, v15, v67, vcc
    v_cmp_le_i32 s[68:69], 16, v14
    v_cmp_le_i32 s[70:71], 17, v14
    v_cmp_le_i32 s[76:77], 18, v14
    v_cmp_le_i32 vcc, 19, v14
    v_cndmask_b32 v68, v15, v68, s[68:69]
    v_cndmask_b32 v69, v15, v69, s[70:71]
    v_cndmask_b32 v70, v15, v70, s[76:77]
    v_cndmask_b32 v71, v15, v71, vcc
    v_cmp_le_i32 s[68:69], 48, v14
    v_cmp_le_i32 s[70:71], 49, v14
    v_cmp_le_i32 s[76:77], 50, v14
    v_cmp_le_i32 vcc, 51, v14
    v_cndmask_b32 v72, v15, v72, s[68:69]
    v_cndmask_b32 v73, v15, v73, s[70:71]
    v_cndmask_b32 v74, v15, v74, s[76:77]
    v_cndmask_b32 v75, v15, v75, vcc
    v_cmp_le_i32 s[68:69], 32, v14
    v_cmp_le_i32 s[70:71], 33, v14
    v_cmp_le_i32 s[76:77], 34, v14
    v_cmp_le_i32 vcc, 35, v14
    v_cndmask_b32 v76, v15, v76, s[68:69]
    v_cndmask_b32 v77, v15, v77, s[70:71]
    v_cndmask_b32 v78, v15, v78, s[76:77]
    v_cndmask_b32 v79, v15, v79, vcc
Lnomask_316:
    v_max3_f32 v12, v48, v49, v50
    v_max3_f32 v252, v51, v56, v57
    v_max3_f32 v12, v12, v58, v59
    v_max3_f32 v252, v252, v64, v65
    v_max3_f32 v12, v12, v66, v67
    v_max3_f32 v252, v252, v72, v73
    v_max3_f32 v12, v12, v74, v75
    v_max_f32 v12, v12, v252
    v_max3_f32 v13, v52, v53, v54
    v_max3_f32 v253, v55, v60, v61
    v_max3_f32 v13, v13, v62, v63
    v_max3_f32 v253, v253, v68, v69
    v_max3_f32 v13, v13, v70, v71
    v_max3_f32 v253, v253, v76, v77
    v_max3_f32 v13, v13, v78, v79
    v_max_f32 v13, v13, v253
    v_max_f32 v252, v12, v13
    v_cmp_lt_f32 vcc, 0x42000000, v252
    s_cmp_lg_u32 s100, 0
    s_cbranch_scc1 Lresc_318
    s_cbranch_vccz Lnoresc_317
Lresc_318:
    s_cselect_b32 s68, 0xff800000, 0
    v_mov_b32 v252, v12
    s_nop 1
    v_permlane16_swap_b32 v12, v252
    s_nop 0
    v_max_f32 v12, v12, v252
    v_mov_b32 v252, v12
    s_nop 1
    v_permlane32_swap_b32 v12, v252
    s_nop 0
    v_max_f32 v12, v12, v252
    v_max_f32 v236, s68, v12
    v_exp_f32 v234, -v236
    v_add_f32 v8, v8, v236
    s_nop 0
    v_min_f32 v234, 1.0, v234
    v_sub_f32 v48, v48, v236
    v_sub_f32 v49, v49, v236
    v_sub_f32 v50, v50, v236
    v_sub_f32 v51, v51, v236
    v_sub_f32 v56, v56, v236
    v_sub_f32 v57, v57, v236
    v_sub_f32 v58, v58, v236
    v_sub_f32 v59, v59, v236
    v_sub_f32 v64, v64, v236
    v_sub_f32 v65, v65, v236
    v_sub_f32 v66, v66, v236
    v_sub_f32 v67, v67, v236
    v_sub_f32 v72, v72, v236
    v_sub_f32 v73, v73, v236
    v_sub_f32 v74, v74, v236
    v_sub_f32 v75, v75, v236
    v_sub_f32 v244, 0, v8
    v_sub_f32 v245, 0, v8
    v_sub_f32 v246, 0, v8
    v_sub_f32 v247, 0, v8
    v_mul_f32 v224, v224, v234
    v_mul_f32 v225, v225, v234
    v_mul_f32 v226, v226, v234
    v_mul_f32 v227, v227, v234
    v_mov_b32 v252, v13
    s_nop 1
    v_permlane16_swap_b32 v13, v252
    s_nop 0
    v_max_f32 v13, v13, v252
    v_mov_b32 v252, v13
    s_nop 1
    v_permlane32_swap_b32 v13, v252
    s_nop 0
    v_max_f32 v13, v13, v252
    v_max_f32 v237, s68, v13
    v_exp_f32 v235, -v237
    v_add_f32 v9, v9, v237
    s_nop 0
    v_min_f32 v235, 1.0, v235
    v_sub_f32 v52, v52, v237
    v_sub_f32 v53, v53, v237
    v_sub_f32 v54, v54, v237
    v_sub_f32 v55, v55, v237
    v_sub_f32 v60, v60, v237
    v_sub_f32 v61, v61, v237
    v_sub_f32 v62, v62, v237
    v_sub_f32 v63, v63, v237
    v_sub_f32 v68, v68, v237
    v_sub_f32 v69, v69, v237
    v_sub_f32 v70, v70, v237
    v_sub_f32 v71, v71, v237
    v_sub_f32 v76, v76, v237
    v_sub_f32 v77, v77, v237
    v_sub_f32 v78, v78, v237
    v_sub_f32 v79, v79, v237
    v_sub_f32 v248, 0, v9
    v_sub_f32 v249, 0, v9
    v_sub_f32 v250, 0, v9
    v_sub_f32 v251, 0, v9
    v_mul_f32 v228, v228, v235
    v_mul_f32 v229, v229, v235
    v_mul_f32 v230, v230, v235
    v_mul_f32 v231, v231, v235
    s_cbranch_scc1 Lnoresc_317
    v_mul_f32 v128, v128, v234
    v_mul_f32 v129, v129, v234
    v_mul_f32 v130, v130, v234
    v_mul_f32 v131, v131, v234
    v_mul_f32 v132, v132, v235
    v_mul_f32 v133, v133, v235
    v_mul_f32 v134, v134, v235
    v_mul_f32 v135, v135, v235
    v_mul_f32 v136, v136, v234
    v_mul_f32 v137, v137, v234
    v_mul_f32 v138, v138, v234
    v_mul_f32 v139, v139, v234
    v_mul_f32 v140, v140, v235
    v_mul_f32 v141, v141, v235
    v_mul_f32 v142, v142, v235
    v_mul_f32 v143, v143, v235
    v_mul_f32 v144, v144, v234
    v_mul_f32 v145, v145, v234
    v_mul_f32 v146, v146, v234
    v_mul_f32 v147, v147, v234
    v_mul_f32 v148, v148, v235
    v_mul_f32 v149, v149, v235
    v_mul_f32 v150, v150, v235
    v_mul_f32 v151, v151, v235
    v_mul_f32 v152, v152, v234
    v_mul_f32 v153, v153, v234
    v_mul_f32 v154, v154, v234
    v_mul_f32 v155, v155, v234
    v_mul_f32 v156, v156, v235
    v_mul_f32 v157, v157, v235
    v_mul_f32 v158, v158, v235
    v_mul_f32 v159, v159, v235
    v_mul_f32 v160, v160, v234
    v_mul_f32 v161, v161, v234
    v_mul_f32 v162, v162, v234
    v_mul_f32 v163, v163, v234
    v_mul_f32 v164, v164, v235
    v_mul_f32 v165, v165, v235
    v_mul_f32 v166, v166, v235
    v_mul_f32 v167, v167, v235
    v_mul_f32 v168, v168, v234
    v_mul_f32 v169, v169, v234
    v_mul_f32 v170, v170, v234
    v_mul_f32 v171, v171, v234
    v_mul_f32 v172, v172, v235
    v_mul_f32 v173, v173, v235
    v_mul_f32 v174, v174, v235
    v_mul_f32 v175, v175, v235
    v_mul_f32 v176, v176, v234
    v_mul_f32 v177, v177, v234
    v_mul_f32 v178, v178, v234
    v_mul_f32 v179, v179, v234
    v_mul_f32 v180, v180, v235
    v_mul_f32 v181, v181, v235
    v_mul_f32 v182, v182, v235
    v_mul_f32 v183, v183, v235
    v_mul_f32 v184, v184, v234
    v_mul_f32 v185, v185, v234
    v_mul_f32 v186, v186, v234
    v_mul_f32 v187, v187, v234
    v_mul_f32 v188, v188, v235
    v_mul_f32 v189, v189, v235
    v_mul_f32 v190, v190, v235
    v_mul_f32 v191, v191, v235
Lnoresc_317:
    v_exp_f32 v48, v48
    v_exp_f32 v49, v49
    v_exp_f32 v50, v50
    v_exp_f32 v51, v51
    v_exp_f32 v52, v52
    v_exp_f32 v53, v53
    v_exp_f32 v54, v54
    v_exp_f32 v55, v55
    s_nop 0
    v_cvt_pk_bf16_f32 v80, v48, v49
    v_cvt_pk_bf16_f32 v81, v50, v51
    v_cvt_pk_bf16_f32 v84, v52, v53
    v_cvt_pk_bf16_f32 v85, v54, v55
    v_exp_f32 v56, v56
    v_exp_f32 v57, v57
    v_exp_f32 v58, v58
    v_exp_f32 v59, v59
    v_exp_f32 v60, v60
    v_exp_f32 v61, v61
    v_exp_f32 v62, v62
    v_exp_f32 v63, v63
    s_nop 0
    v_cvt_pk_bf16_f32 v82, v56, v57
    v_cvt_pk_bf16_f32 v83, v58, v59
    v_cvt_pk_bf16_f32 v86, v60, v61
    v_cvt_pk_bf16_f32 v87, v62, v63
    v_exp_f32 v64, v64
    v_exp_f32 v65, v65
    v_exp_f32 v66, v66
    v_exp_f32 v67, v67
    v_exp_f32 v68, v68
    v_exp_f32 v69, v69
    v_exp_f32 v70, v70
    v_exp_f32 v71, v71
    s_nop 0
    v_cvt_pk_bf16_f32 v88, v64, v65
    v_cvt_pk_bf16_f32 v89, v66, v67
    v_cvt_pk_bf16_f32 v92, v68, v69
    v_cvt_pk_bf16_f32 v93, v70, v71
    v_exp_f32 v72, v72
    v_exp_f32 v73, v73
    v_exp_f32 v74, v74
    v_exp_f32 v75, v75
    v_exp_f32 v76, v76
    v_exp_f32 v77, v77
    v_exp_f32 v78, v78
    v_exp_f32 v79, v79
    s_nop 0
    v_cvt_pk_bf16_f32 v90, v72, v73
    v_cvt_pk_bf16_f32 v91, v74, v75
    v_cvt_pk_bf16_f32 v94, v76, v77
    v_cvt_pk_bf16_f32 v95, v78, v79
    s_waitcnt vmcnt(0)
    s_barrier
    s_and_b32 s68, s2, 4
    s_cmp_eq_u32 s68, 0
    s_cbranch_scc1 Lnox_319
    s_lshr_b32 s69, s2, 3
    s_and_b32 s70, s69, 7
    s_and_b32 s68, s2, 1
    s_lshl_b32 s68, s68, 3
    s_add_u32 s70, s70, s68
    s_lshr_b32 s69, s69, 3
    s_and_b32 s68, s2, 2
    s_lshl_b32 s68, s68, 1
    s_add_u32 s69, s69, s68
    s_lshl_b32 s69, s69, 8
    s_and_b32 s68, s60, 1
    s_lshl_b32 s68, s68, 7
    s_add_u32 s69, s69, s68
    s_lshl_b32 s70, s70, 7
    s_and_b32 s68, s60, 2
    s_lshl_b32 s68, s68, 5
    s_add_u32 s70, s70, s68
    s_and_b32 s68, s60, 4
    s_lshl_b32 s68, s68, 3
    s_add_u32 s70, s70, s68
    s_lshl_b32 s70, s70, 11
    s_add_u32 s71, s70, s69
    s_add_u32 s70, s71, 32768
    s_add_u32 s56, s16, 0
    s_addc_u32 s57, s17, 0
    s_mov_b32 s58, 4194304
    s_and_b32 s57, s57, 0xffff
    s_mov_b32 s59, 0x00020000
    v_and_b32 v40, 15, v1
    v_lshlrev_b32 v40, 11, v40
    v_lshrrev_b32 v41, 4, v1
    v_lshlrev_b32 v41, 3, v41
    v_add_u32 v40, v40, v41
    buffer_load_dwordx2 v[16:17], v40, s[56:59], s71 offen offset:0
    buffer_load_dwordx2 v[18:19], v40, s[56:59], s71 offen offset:32
    buffer_load_dwordx2 v[20:21], v40, s[56:59], s71 offen offset:64
    buffer_load_dwordx2 v[22:23], v40, s[56:59], s71 offen offset:96
    buffer_load_dwordx2 v[24:25], v40, s[56:59], s70 offen offset:0
    buffer_load_dwordx2 v[26:27], v40, s[56:59], s70 offen offset:32
    buffer_load_dwordx2 v[28:29], v40, s[56:59], s70 offen offset:64
    buffer_load_dwordx2 v[30:31], v40, s[56:59], s70 offen offset:96
    s_add_u32 s56, s36, 0
    s_addc_u32 s57, s37, 0
    s_mov_b32 s58, 2048
    s_and_b32 s57, s57, 0xffff
    s_mov_b32 s59, 0x00020000
    buffer_load_dwordx2 v[32:33], v41, s[56:59], s69 offen offset:0
    buffer_load_dwordx2 v[34:35], v41, s[56:59], s69 offen offset:32
    buffer_load_dwordx2 v[36:37], v41, s[56:59], s69 offen offset:64
    buffer_load_dwordx2 v[38:39], v41, s[56:59], s69 offen offset:96
Lnox_319:
    ds_read_b128 v[96:99], v6 offset:0
    ds_read_b128 v[100:103], v6 offset:2176
    ds_read_b128 v[104:107], v6 offset:4352
    ds_read_b128 v[108:111], v6 offset:6528
    ds_read_b128 v[112:115], v7 offset:0
    ds_read_b128 v[116:119], v7 offset:2176
    ds_read_b128 v[120:123], v7 offset:4352
    ds_read_b128 v[124:127], v7 offset:6528
    s_waitcnt lgkmcnt(7)
    v_mfma_f32_16x16x32_bf16 v[128:131], v[96:99], v[80:83], v[128:131]
    v_mfma_f32_16x16x32_bf16 v[132:135], v[96:99], v[84:87], v[132:135]
    v_mfma_f32_16x16x32_bf16 v[224:227], v[240:243], v[80:83], v[224:227]
    v_mfma_f32_16x16x32_bf16 v[228:231], v[240:243], v[84:87], v[228:231]
    ds_read_b128 v[96:99], v6 offset:64
    s_waitcnt lgkmcnt(7)
    v_mfma_f32_16x16x32_bf16 v[136:139], v[100:103], v[80:83], v[136:139]
    v_mfma_f32_16x16x32_bf16 v[140:143], v[100:103], v[84:87], v[140:143]
    ds_read_b128 v[100:103], v6 offset:2240
    s_waitcnt lgkmcnt(7)
    v_mfma_f32_16x16x32_bf16 v[144:147], v[104:107], v[80:83], v[144:147]
    v_mfma_f32_16x16x32_bf16 v[148:151], v[104:107], v[84:87], v[148:151]
    ds_read_b128 v[104:107], v6 offset:4416
    s_waitcnt lgkmcnt(7)
    v_mfma_f32_16x16x32_bf16 v[152:155], v[108:111], v[80:83], v[152:155]
    v_mfma_f32_16x16x32_bf16 v[156:159], v[108:111], v[84:87], v[156:159]
    ds_read_b128 v[108:111], v6 offset:6592
    s_waitcnt lgkmcnt(7)
    v_mfma_f32_16x16x32_bf16 v[160:163], v[112:115], v[80:83], v[160:163]
    v_mfma_f32_16x16x32_bf16 v[164:167], v[112:115], v[84:87], v[164:167]
    ds_read_b128 v[112:115], v7 offset:64
    s_waitcnt lgkmcnt(7)
    v_mfma_f32_16x16x32_bf16 v[168:171], v[116:119], v[80:83], v[168:171]
    v_mfma_f32_16x16x32_bf16 v[172:175], v[116:119], v[84:87], v[172:175]
    ds_read_b128 v[116:119], v7 offset:2240
    s_waitcnt lgkmcnt(7)
    v_mfma_f32_16x16x32_bf16 v[176:179], v[120:123], v[80:83], v[176:179]
    v_mfma_f32_16x16x32_bf16 v[180:183], v[120:123], v[84:87], v[180:183]
    ds_read_b128 v[120:123], v7 offset:4416
    s_waitcnt lgkmcnt(7)
    v_mfma_f32_16x16x32_bf16 v[184:187], v[124:127], v[80:83], v[184:187]
    v_mfma_f32_16x16x32_bf16 v[188:191], v[124:127], v[84:87], v[188:191]
    ds_read_b128 v[124:127], v7 offset:6592
    s_waitcnt lgkmcnt(7)
    v_mfma_f32_16x16x32_bf16 v[128:131], v[96:99], v[88:91], v[128:131]
    v_mfma_f32_16x16x32_bf16 v[132:135], v[96:99], v[92:95], v[132:135]
    v_mfma_f32_16x16x32_bf16 v[224:227], v[240:243], v[88:91], v[224:227]
    v_mfma_f32_16x16x32_bf16 v[228:231], v[240:243], v[92:95], v[228:231]
    s_waitcnt lgkmcnt(6)
    v_mfma_f32_16x16x32_bf16 v[136:139], v[100:103], v[88:91], v[136:139]
    v_mfma_f32_16x16x32_bf16 v[140:143], v[100:103], v[92:95], v[140:143]
    s_waitcnt lgkmcnt(5)
    v_mfma_f32_16x16x32_bf16 v[144:147], v[104:107], v[88:91], v[144:147]
    v_mfma_f32_16x16x32_bf16 v[148:151], v[104:107], v[92:95], v[148:151]
    s_waitcnt lgkmcnt(4)
    v_mfma_f32_16x16x32_bf16 v[152:155], v[108:111], v[88:91], v[152:155]
    v_mfma_f32_16x16x32_bf16 v[156:159], v[108:111], v[92:95], v[156:159]
    s_waitcnt lgkmcnt(3)
    v_mfma_f32_16x16x32_bf16 v[160:163], v[112:115], v[88:91], v[160:163]
    v_mfma_f32_16x16x32_bf16 v[164:167], v[112:115], v[92:95], v[164:167]
    s_waitcnt lgkmcnt(2)
    v_mfma_f32_16x16x32_bf16 v[168:171], v[116:119], v[88:91], v[168:171]
    v_mfma_f32_16x16x32_bf16 v[172:175], v[116:119], v[92:95], v[172:175]
    s_waitcnt lgkmcnt(1)
    v_mfma_f32_16x16x32_bf16 v[176:179], v[120:123], v[88:91], v[176:179]
    v_mfma_f32_16x16x32_bf16 v[180:183], v[120:123], v[92:95], v[180:183]
    s_waitcnt lgkmcnt(0)
    v_mfma_f32_16x16x32_bf16 v[184:187], v[124:127], v[88:91], v[184:187]
    v_mfma_f32_16x16x32_bf16 v[188:191], v[124:127], v[92:95], v[188:191]
    s_cmp_lg_u32 s61, 0
    s_cbranch_scc1 attn_nostag2
    s_barrier
attn_nostag2:
    s_barrier
    s_nop 7
    v_mov_b32 v10, v224
    v_mov_b32 v11, v228
    s_mul_i32 s68, s62, 8704
    s_lshl_b32 s76, s62, 10
    s_mul_i32 s69, s61, 69632
    s_add_u32 s70, s68, s69
    s_sub_u32 s71, 69632, s69
    s_add_u32 s71, s71, s68
    v_lshlrev_b32 v12, 4, v1
    v_add_u32 v13, s71, v12
    s_lshl_b32 s77, s61, 12
    s_add_u32 s77, s77, s76
    s_add_u32 s77, s77, 139264
    v_add_u32 v14, s77, v12
    v_xor_b32 v15, 4096, v14
    v_add_u32 v12, s70, v12
    ds_write_b128 v12, v[160:163] offset:0
    ds_write_b128 v12, v[164:167] offset:1024
    ds_write_b128 v12, v[168:171] offset:2048
    ds_write_b128 v12, v[172:175] offset:3072
    ds_write_b128 v12, v[176:179] offset:4096
    ds_write_b128 v12, v[180:183] offset:5120
    ds_write_b128 v12, v[184:187] offset:6144
    ds_write_b128 v12, v[188:191] offset:7168
    ds_write_b128 v14, v[8:11]
    s_waitcnt lgkmcnt(0)
    s_barrier
    ds_read_b128 v[192:195], v13 offset:0
    ds_read_b128 v[196:199], v13 offset:1024
    ds_read_b128 v[200:203], v13 offset:2048
    ds_read_b128 v[204:207], v13 offset:3072
    ds_read_b128 v[208:211], v13 offset:4096
    ds_read_b128 v[212:215], v13 offset:5120
    ds_read_b128 v[216:219], v13 offset:6144
    ds_read_b128 v[220:223], v13 offset:7168
    ds_read_b128 v[96:99], v15
    s_waitcnt lgkmcnt(0)
    v_max_f32 v100, v8, v96
    v_sub_f32 v101, v8, v100
    v_sub_f32 v102, v96, v100
    v_exp_f32 v101, v101
    v_exp_f32 v102, v102
    s_nop 0
    v_mul_f32 v103, v10, v101
    v_fmac_f32 v103, v98, v102
    v_rcp_f32 v103, v103
    s_nop 0
    v_mul_f32 v234, v101, v103
    v_mul_f32 v236, v102, v103
    v_max_f32 v100, v9, v97
    v_sub_f32 v101, v9, v100
    v_sub_f32 v102, v97, v100
    v_exp_f32 v101, v101
    v_exp_f32 v102, v102
    s_nop 0
    v_mul_f32 v103, v11, v101
    v_fmac_f32 v103, v99, v102
    v_rcp_f32 v103, v103
    s_nop 0
    v_mul_f32 v235, v101, v103
    v_mul_f32 v237, v102, v103
    v_mul_f32 v128, v128, v234
    v_fmac_f32 v128, v192, v236
    v_mul_f32 v129, v129, v234
    v_fmac_f32 v129, v193, v236
    v_mul_f32 v130, v130, v234
    v_fmac_f32 v130, v194, v236
    v_mul_f32 v131, v131, v234
    v_fmac_f32 v131, v195, v236
    v_mul_f32 v132, v132, v235
    v_fmac_f32 v132, v196, v237
    v_mul_f32 v133, v133, v235
    v_fmac_f32 v133, v197, v237
    v_mul_f32 v134, v134, v235
    v_fmac_f32 v134, v198, v237
    v_mul_f32 v135, v135, v235
    v_fmac_f32 v135, v199, v237
    v_mul_f32 v136, v136, v234
    v_fmac_f32 v136, v200, v236
    v_mul_f32 v137, v137, v234
    v_fmac_f32 v137, v201, v236
    v_mul_f32 v138, v138, v234
    v_fmac_f32 v138, v202, v236
    v_mul_f32 v139, v139, v234
    v_fmac_f32 v139, v203, v236
    v_mul_f32 v140, v140, v235
    v_fmac_f32 v140, v204, v237
    v_mul_f32 v141, v141, v235
    v_fmac_f32 v141, v205, v237
    v_mul_f32 v142, v142, v235
    v_fmac_f32 v142, v206, v237
    v_mul_f32 v143, v143, v235
    v_fmac_f32 v143, v207, v237
    v_mul_f32 v144, v144, v234
    v_fmac_f32 v144, v208, v236
    v_mul_f32 v145, v145, v234
    v_fmac_f32 v145, v209, v236
    v_mul_f32 v146, v146, v234
    v_fmac_f32 v146, v210, v236
    v_mul_f32 v147, v147, v234
    v_fmac_f32 v147, v211, v236
    v_mul_f32 v148, v148, v235
    v_fmac_f32 v148, v212, v237
    v_mul_f32 v149, v149, v235
    v_fmac_f32 v149, v213, v237
    v_mul_f32 v150, v150, v235
    v_fmac_f32 v150, v214, v237
    v_mul_f32 v151, v151, v235
    v_fmac_f32 v151, v215, v237
    v_mul_f32 v152, v152, v234
    v_fmac_f32 v152, v216, v236
    v_mul_f32 v153, v153, v234
    v_fmac_f32 v153, v217, v236
    v_mul_f32 v154, v154, v234
    v_fmac_f32 v154, v218, v236
    v_mul_f32 v155, v155, v234
    v_fmac_f32 v155, v219, v236
    v_mul_f32 v156, v156, v235
    v_fmac_f32 v156, v220, v237
    v_mul_f32 v157, v157, v235
    v_fmac_f32 v157, v221, v237
    v_mul_f32 v158, v158, v235
    v_fmac_f32 v158, v222, v237
    v_mul_f32 v159, v159, v235
    v_fmac_f32 v159, v223, v237
    s_lshl_b32 s68, s74, 7
    s_mul_i32 s68, s68, 15488
    s_add_u32 s68, s68, s99
    s_lshl_b32 s69, s61, 7
    s_add_u32 s70, s68, s69
    s_sub_u32 s71, 128, s69
    s_add_u32 s71, s71, s68
    s_lshl_b32 s68, s60, 12
    s_add_u32 s68, s68, 34816
    v_and_b32 v12, 15, v1
    v_lshrrev_b32 v14, 4, v1
    v_and_b32 v13, 1, v14
    v_lshlrev_b32 v13, 1, v13
    v_lshrrev_b32 v14, 1, v14
    v_add_u32 v13, v13, v14
    v_and_b32 v14, 7, v1
    v_xor_b32 v13, v13, v14
    v_lshlrev_b32 v13, 4, v13
    v_lshlrev_b32 v12, 7, v12
    v_add3_u32 v12, v12, v13, s68
    v_xor_b32 v13, 64, v12
    v_lshrrev_b32 v14, 3, v1
    v_and_b32 v15, 7, v1
    v_xor_b32 v15, v15, v14
    v_lshlrev_b32 v15, 4, v15
    v_lshl_add_u32 v15, v14, 7, v15
    v_add_u32 v15, s68, v15
    v_cvt_pk_bf16_f32 v96, v128, v129
    v_cvt_pk_bf16_f32 v97, v130, v131
    v_cvt_pk_bf16_f32 v98, v136, v137
    v_cvt_pk_bf16_f32 v99, v138, v139
    s_nop 1
    v_permlane16_swap_b32 v96, v98
    v_permlane16_swap_b32 v97, v99
    s_nop 0
    ds_write_b128 v12, v[96:99] offset:0
    v_cvt_pk_bf16_f32 v100, v132, v133
    v_cvt_pk_bf16_f32 v101, v134, v135
    v_cvt_pk_bf16_f32 v102, v140, v141
    v_cvt_pk_bf16_f32 v103, v142, v143
    s_nop 1
    v_permlane16_swap_b32 v100, v102
    v_permlane16_swap_b32 v101, v103
    s_nop 0
    ds_write_b128 v12, v[100:103] offset:2048
    v_cvt_pk_bf16_f32 v96, v144, v145
    v_cvt_pk_bf16_f32 v97, v146, v147
    v_cvt_pk_bf16_f32 v98, v152, v153
    v_cvt_pk_bf16_f32 v99, v154, v155
    s_nop 1
    v_permlane16_swap_b32 v96, v98
    v_permlane16_swap_b32 v97, v99
    s_nop 0
    ds_write_b128 v13, v[96:99] offset:0
    v_cvt_pk_bf16_f32 v100, v148, v149
    v_cvt_pk_bf16_f32 v101, v150, v151
    v_cvt_pk_bf16_f32 v102, v156, v157
    v_cvt_pk_bf16_f32 v103, v158, v159
    s_nop 1
    v_permlane16_swap_b32 v100, v102
    v_permlane16_swap_b32 v101, v103
    s_nop 0
    ds_write_b128 v13, v[100:103] offset:2048
    s_waitcnt lgkmcnt(0)
    ds_read_b128 v[128:131], v15 offset:0
    ds_read_b128 v[132:135], v15 offset:1024
    ds_read_b128 v[136:139], v15 offset:2048
    ds_read_b128 v[140:143], v15 offset:3072
    s_waitcnt lgkmcnt(3)
    buffer_store_dwordx4 v[128:131], v233, s[52:55], s70 offen sc0 sc1
    s_add_u32 s70, s70, 123904
    s_waitcnt lgkmcnt(2)
    buffer_store_dwordx4 v[132:135], v233, s[52:55], s70 offen sc0 sc1
    s_add_u32 s70, s70, 123904
    s_waitcnt lgkmcnt(1)
    buffer_store_dwordx4 v[136:139], v233, s[52:55], s70 offen sc0 sc1
    s_add_u32 s70, s70, 123904
    s_waitcnt lgkmcnt(0)
    buffer_store_dwordx4 v[140:143], v233, s[52:55], s70 offen sc0 sc1
    s_nop 1
    s_mov_b32 s4, s72
    s_mov_b32 s5, s74
    s_mov_b32 s6, s75
    s_lshr_b32 s75, s60, 2
    s_bfe_u32 s61, s60, 0x10001
    s_and_b32 s62, s60, 1
    s_and_b32 s68, s2, 7
    s_lshr_b32 s82, s68, 2
    s_lshr_b32 s69, s2, 3
    s_and_b32 s72, s69, 7
    s_and_b32 s70, s68, 1
    s_lshl_b32 s70, s70, 3
    s_add_u32 s72, s72, s70
    s_lshr_b32 s73, s69, 3
    s_and_b32 s70, s68, 2
    s_lshl_b32 s70, s70, 1
    s_add_u32 s73, s73, s70
    s_lshl_b32 s83, s73, 4
    s_add_u32 s83, s83, s72
    v_and_b32 v124, 31, v1
    s_lshl_b32 s68, s72, 5
    v_add_u32 v124, s68, v124
    v_lshlrev_b32 v124, 7, v124
    v_add_u32 v124, 98304, v124
    v_and_b32 v125, 31, v1
    v_min_u32 v125, 27, v125
    v_lshlrev_b32 v125, 3, v125
    s_sub_u32 s68, 15, s72
    s_min_u32 s68, s68, s72
    v_add_u32 v125, s68, v125
    v_lshlrev_b32 v125, 7, v125
    v_add_u32 v125, 65536, v125
    v_mov_b32 v123, v124
    s_cmp_eq_u32 s82, 0
    s_cbranch_scc1 out_fo
    v_mov_b32 v124, v125
out_fo:
    s_mul_i32 s68, s72, 1982464
    s_add_u32 s68, s68, 54525952
    s_add_u32 s44, s42, s68
    s_addc_u32 s45, s43, 0
    s_sub_u32 s46, 86245376, s68
    s_and_b32 s45, s45, 0xffff
    s_mov_b32 s47, 0x00020000
    s_lshl_b32 s64, s82, 13
    s_cmp_eq_u32 s82, 0
    s_cselect_b32 s76, s26, s34
    s_cselect_b32 s77, s27, s35
    s_mov_b32 s78, 7340032
    s_cselect_b32 s78, 8388608, s78
    s_cselect_b32 s67, 64, 56
    s_cselect_b32 s7, -1, 56
    s_lshl_b32 s68, s73, 8
    s_add_u32 s48, s76, s68
    s_addc_u32 s49, s77, 0
    s_sub_u32 s50, s78, s68
    s_and_b32 s49, s49, 0xffff
    s_mov_b32 s51, 0x00020000
    s_add_u32 s8, s26, s68
    s_addc_u32 s9, s27, 0
    s_sub_u32 s10, 8388608, s68
    s_and_b32 s9, s9, 0xffff
    s_mov_b32 s11, 0x00020000
    s_mov_b32 s65, 0
    v_lshrrev_b32 v80, 3, v1
    v_lshrrev_b32 v81, 4, v1
    v_and_b32 v82, 7, v1
    v_xor_b32 v82, v82, v81
    v_lshlrev_b32 v82, 4, v82
    v_xor_b32 v83, 64, v82
    s_lshl_b32 s68, s60, 4
    v_add_u32 v80, s68, v80
    s_mov_b32 s69, 15488
    v_mul_lo_u32 v80, v80, s69
    v_add_u32 v8, v80, v82
    v_add_u32 v80, 123904, v80
    v_add_u32 v9, v80, v83
    v_and_b32 v82, 15, v1
    v_lshlrev_b32 v83, 1, v81
    v_xor_b32 v82, v82, v83
    s_and_b32 s68, s60, 1
    s_lshl_b32 s68, s68, 3
    v_xor_b32 v82, s68, v82
    v_lshlrev_b32 v82, 4, v82
    s_lshl_b32 s68, s60, 3
    v_add_u32 v80, s68, v81
    v_lshlrev_b32 v80, 11, v80
    v_add_u32 v10, v80, v82
    v_add_u32 v11, 8192, v10
    s_lshl_b32 s85, s60, 11
    s_add_u32 s78, s85, 163840
    s_mov_b32 s79, 32768
    v_and_b32 v80, 15, v1
    v_lshrrev_b32 v82, 1, v80
    s_lshl_b32 s68, s75, 2
    v_add_u32 v83, s68, v81
    v_xor_b32 v82, v82, v83
    v_lshlrev_b32 v82, 4, v82
    s_lshl_b32 s68, s61, 6
    v_add_u32 v83, s68, v80
    v_lshlrev_b32 v83, 7, v83
    v_add_u32 v83, v83, v82
    s_lshl_b32 s68, s75, 12
    s_sub_u32 s69, 4096, s68
    v_add_u32 v2, s68, v83
    v_add_u32 v3, s69, v83
    v_lshrrev_b32 v82, 2, v80
    v_lshlrev_b32 v83, 3, v81
    v_add_u32 v83, v83, v82
    s_lshl_b32 s68, s75, 5
    v_add_u32 v83, s68, v83
    v_lshlrev_b32 v83, 8, v83
    v_and_b32 v84, 3, v1
    v_lshlrev_b32 v84, 3, v84
    v_add_u32 v83, v83, v84
    v_and_b32 v84, 1, v81
    v_xor_b32 v84, s62, v84
    v_lshlrev_b32 v84, 7, v84
    v_add_u32 v83, v83, v84
    v_xor_b32 v84, 0, v82
    v_lshlrev_b32 v84, 5, v84
    v_add_u32 v4, v83, v84
    v_xor_b32 v84, 1, v82
    v_lshlrev_b32 v84, 5, v84
    v_add_u32 v5, v83, v84
    v_xor_b32 v84, 2, v82
    v_lshlrev_b32 v84, 5, v84
    v_add_u32 v6, v83, v84
    v_xor_b32 v84, 3, v82
    v_lshlrev_b32 v84, 5, v84
    v_add_u32 v7, v83, v84
    s_mov_b32 s84, 0
    v_mov_b64 v[128:129], 0
    v_mov_b64 v[130:131], 0
    v_mov_b64 v[132:133], 0
    v_mov_b64 v[134:135], 0
    v_mov_b64 v[136:137], 0
    v_mov_b64 v[138:139], 0
    v_mov_b64 v[140:141], 0
    v_mov_b64 v[142:143], 0
    v_mov_b64 v[144:145], 0
    v_mov_b64 v[146:147], 0
    v_mov_b64 v[148:149], 0
    v_mov_b64 v[150:151], 0
    v_mov_b64 v[152:153], 0
    v_mov_b64 v[154:155], 0
    v_mov_b64 v[156:157], 0
    v_mov_b64 v[158:159], 0
    v_mov_b64 v[160:161], 0
    v_mov_b64 v[162:163], 0
    v_mov_b64 v[164:165], 0
    v_mov_b64 v[166:167], 0
    v_mov_b64 v[168:169], 0
    v_mov_b64 v[170:171], 0
    v_mov_b64 v[172:173], 0
    v_mov_b64 v[174:175], 0
    v_mov_b64 v[176:177], 0
    v_mov_b64 v[178:179], 0
    v_mov_b64 v[180:181], 0
    v_mov_b64 v[182:183], 0
    v_mov_b64 v[184:185], 0
    v_mov_b64 v[186:187], 0
    v_mov_b64 v[188:189], 0
    v_mov_b64 v[190:191], 0
    s_waitcnt vmcnt(0)
    s_barrier
    s_cmp_lg_u32 s60, 0
    s_cbranch_scc1 Lnw0_320
    s_add_u32 s56, s42, 209715200
    s_addc_u32 s57, s43, 0
    s_mov_b32 s58, 262144
    s_and_b32 s57, s57, 0xffff
    s_mov_b32 s59, 0x00020000
    s_lshl_b32 s68, s5, 5
    s_add_u32 s68, s68, s4
    s_lshl_b32 s68, s68, 7
    s_add_u32 s68, s68, 98304
    v_mov_b32 v120, s12
    v_mov_b32 v121, s13
    v_mov_b32 v122, 0
    s_mov_b64 exec, 1
    buffer_store_dwordx2 v[120:121], v122, s[56:59], s68 offen sc0 sc1
    s_mov_b64 exec, -1
    s_lshl_b32 s68, s6, 5
    s_add_u32 s68, s68, s4
    s_lshl_b32 s68, s68, 7
    s_add_u32 s68, s68, 98304
    v_mov_b32 v120, s12
    v_mov_b32 v121, s13
    v_mov_b32 v122, 0
    s_mov_b64 exec, 1
    buffer_store_dwordx2 v[120:121], v122, s[56:59], s68 offen sc0 sc1
    s_mov_b64 exec, -1
Lnw0_320:
    s_cmp_eq_u32 s82, 0
    s_cbranch_scc1 out_noxi
    v_lshlrev_b32 v128, 16, v16
    v_and_b32 v129, 0xffff0000, v16
    v_lshlrev_b32 v86, 16, v32
    v_and_b32 v87, 0xffff0000, v32
    v_pk_add_f32 v[128:129], v[128:129], v[86:87]
    v_lshlrev_b32 v130, 16, v17
    v_and_b32 v131, 0xffff0000, v17
    v_lshlrev_b32 v86, 16, v33
    v_and_b32 v87, 0xffff0000, v33
    v_pk_add_f32 v[130:131], v[130:131], v[86:87]
    v_lshlrev_b32 v132, 16, v18
    v_and_b32 v133, 0xffff0000, v18
    v_lshlrev_b32 v86, 16, v34
    v_and_b32 v87, 0xffff0000, v34
    v_pk_add_f32 v[132:133], v[132:133], v[86:87]
    v_lshlrev_b32 v134, 16, v19
    v_and_b32 v135, 0xffff0000, v19
    v_lshlrev_b32 v86, 16, v35
    v_and_b32 v87, 0xffff0000, v35
    v_pk_add_f32 v[134:135], v[134:135], v[86:87]
    v_lshlrev_b32 v136, 16, v20
    v_and_b32 v137, 0xffff0000, v20
    v_lshlrev_b32 v86, 16, v36
    v_and_b32 v87, 0xffff0000, v36
    v_pk_add_f32 v[136:137], v[136:137], v[86:87]
    v_lshlrev_b32 v138, 16, v21
    v_and_b32 v139, 0xffff0000, v21
    v_lshlrev_b32 v86, 16, v37
    v_and_b32 v87, 0xffff0000, v37
    v_pk_add_f32 v[138:139], v[138:139], v[86:87]
    v_lshlrev_b32 v140, 16, v22
    v_and_b32 v141, 0xffff0000, v22
    v_lshlrev_b32 v86, 16, v38
    v_and_b32 v87, 0xffff0000, v38
    v_pk_add_f32 v[140:141], v[140:141], v[86:87]
    v_lshlrev_b32 v142, 16, v23
    v_and_b32 v143, 0xffff0000, v23
    v_lshlrev_b32 v86, 16, v39
    v_and_b32 v87, 0xffff0000, v39
    v_pk_add_f32 v[142:143], v[142:143], v[86:87]
    v_lshlrev_b32 v144, 16, v24
    v_and_b32 v145, 0xffff0000, v24
    v_lshlrev_b32 v86, 16, v32
    v_and_b32 v87, 0xffff0000, v32
    v_pk_add_f32 v[144:145], v[144:145], v[86:87]
    v_lshlrev_b32 v146, 16, v25
    v_and_b32 v147, 0xffff0000, v25
    v_lshlrev_b32 v86, 16, v33
    v_and_b32 v87, 0xffff0000, v33
    v_pk_add_f32 v[146:147], v[146:147], v[86:87]
    v_lshlrev_b32 v148, 16, v26
    v_and_b32 v149, 0xffff0000, v26
    v_lshlrev_b32 v86, 16, v34
    v_and_b32 v87, 0xffff0000, v34
    v_pk_add_f32 v[148:149], v[148:149], v[86:87]
    v_lshlrev_b32 v150, 16, v27
    v_and_b32 v151, 0xffff0000, v27
    v_lshlrev_b32 v86, 16, v35
    v_and_b32 v87, 0xffff0000, v35
    v_pk_add_f32 v[150:151], v[150:151], v[86:87]
    v_lshlrev_b32 v152, 16, v28
    v_and_b32 v153, 0xffff0000, v28
    v_lshlrev_b32 v86, 16, v36
    v_and_b32 v87, 0xffff0000, v36
    v_pk_add_f32 v[152:153], v[152:153], v[86:87]
    v_lshlrev_b32 v154, 16, v29
    v_and_b32 v155, 0xffff0000, v29
    v_lshlrev_b32 v86, 16, v37
    v_and_b32 v87, 0xffff0000, v37
    v_pk_add_f32 v[154:155], v[154:155], v[86:87]
    v_lshlrev_b32 v156, 16, v30
    v_and_b32 v157, 0xffff0000, v30
    v_lshlrev_b32 v86, 16, v38
    v_and_b32 v87, 0xffff0000, v38
    v_pk_add_f32 v[156:157], v[156:157], v[86:87]
    v_lshlrev_b32 v158, 16, v31
    v_and_b32 v159, 0xffff0000, v31
    v_lshlrev_b32 v86, 16, v39
    v_and_b32 v87, 0xffff0000, v39
    v_pk_add_f32 v[158:159], v[158:159], v[86:87]
out_noxi:
    s_add_u32 m0, s85, 16384
    s_nop 0
    buffer_load_dwordx4 v10, s[48:51], s65 offen lds
    s_add_u32 m0, s85, 17408
    s_nop 0
    buffer_load_dwordx4 v11, s[48:51], s65 offen lds
    s_add_u32 s65, s65, 131072
    s_add_u32 m0, s85, 49152
    s_nop 0
    buffer_load_dwordx4 v10, s[48:51], s65 offen lds
    s_add_u32 m0, s85, 50176
    s_nop 0
    buffer_load_dwordx4 v11, s[48:51], s65 offen lds
    s_add_u32 s65, s65, 131072
    s_add_u32 m0, s85, 81920
    s_nop 0
    buffer_load_dwordx4 v10, s[48:51], s65 offen lds
    s_add_u32 m0, s85, 82944
    s_nop 0
    buffer_load_dwordx4 v11, s[48:51], s65 offen lds
    s_add_u32 s65, s65, 131072
    s_add_u32 m0, s85, 114688
    s_nop 0
    buffer_load_dwordx4 v10, s[48:51], s65 offen lds
    s_add_u32 m0, s85, 115712
    s_nop 0
    buffer_load_dwordx4 v11, s[48:51], s65 offen lds
    s_add_u32 s65, s65, 131072
    s_add_u32 m0, s85, 147456
    s_nop 0
    buffer_load_dwordx4 v10, s[48:51], s65 offen lds
    s_add_u32 m0, s85, 148480
    s_nop 0
    buffer_load_dwordx4 v11, s[48:51], s65 offen lds
    s_add_u32 s65, s65, 131072
    s_cmp_lg_u32 s60, 0
    s_cbranch_scc1 Lnw0_321
    s_add_u32 s56, s42, 209715200
    s_addc_u32 s57, s43, 0
    s_mov_b32 s58, 262144
    s_and_b32 s57, s57, 0xffff
    s_mov_b32 s59, 0x00020000
    s_mov_b32 s14, 0x400000
Lld_324:
    buffer_load_dwordx2 v[126:127], v124, s[56:59], 0 offen sc0 sc1
    s_waitcnt vmcnt(0)
Lpoll_322:
    v_cmp_ne_u32 vcc, s12, v126
    v_cmp_ne_u32 s[68:69], s13, v127
    s_nop 3
    s_or_b64 vcc, vcc, s[68:69]
    s_cbranch_scc0 Lok_323
    s_sleep 1
    s_sub_u32 s14, s14, 1
    s_cmp_lg_u32 s14, 0
    s_cbranch_scc1 Lld_324
    s_mov_b64 vcc, 0
Lok_323:
Lnw0_321:
    s_barrier
    s_add_u32 m0, s85, 0
    s_nop 0
    buffer_load_dwordx4 v8, s[44:47], s64 offen lds
    s_add_u32 m0, s85, 1024
    s_nop 0
    buffer_load_dwordx4 v9, s[44:47], s64 offen lds
    s_add_u32 s64, s64, 128
    s_add_u32 m0, s85, 32768
    s_nop 0
    buffer_load_dwordx4 v8, s[44:47], s64 offen lds
    s_add_u32 m0, s85, 33792
    s_nop 0
    buffer_load_dwordx4 v9, s[44:47], s64 offen lds
    s_add_u32 s64, s64, 128
    s_add_u32 m0, s85, 65536
    s_nop 0
    buffer_load_dwordx4 v8, s[44:47], s64 offen lds
    s_add_u32 m0, s85, 66560
    s_nop 0
    buffer_load_dwordx4 v9, s[44:47], s64 offen lds
    s_add_u32 s64, s64, 128
    s_add_u32 m0, s85, 98304
    s_nop 0
    buffer_load_dwordx4 v8, s[44:47], s64 offen lds
    s_add_u32 m0, s85, 99328
    s_nop 0
    buffer_load_dwordx4 v9, s[44:47], s64 offen lds
    s_add_u32 s64, s64, 128
    s_add_u32 m0, s85, 131072
    s_nop 0
    buffer_load_dwordx4 v8, s[44:47], s64 offen lds
    s_add_u32 m0, s85, 132096
    s_nop 0
    buffer_load_dwordx4 v9, s[44:47], s64 offen lds
    s_add_u32 s64, s64, 128
    s_waitcnt vmcnt(8)
    s_barrier
    ds_read_b128 v[16:19], v2 offset:0
    ds_read_b64_tr_b16 v[32:33], v4 offset:16384
    ds_read_b64_tr_b16 v[34:35], v4 offset:17408
    ds_read_b128 v[20:23], v2 offset:2048
    ds_read_b64_tr_b16 v[36:37], v5 offset:16384
    ds_read_b64_tr_b16 v[38:39], v5 offset:17408
    ds_read_b128 v[24:27], v3 offset:0
    ds_read_b64_tr_b16 v[40:41], v6 offset:16384
    ds_read_b64_tr_b16 v[42:43], v6 offset:17408
    ds_read_b128 v[28:31], v3 offset:2048
    ds_read_b64_tr_b16 v[44:45], v7 offset:16384
    ds_read_b64_tr_b16 v[46:47], v7 offset:17408
    s_waitcnt lgkmcnt(0)
    v_mfma_f32_16x16x32_bf16 v[128:131], v[32:35], v[16:19], v[128:131]
    v_mfma_f32_16x16x32_bf16 v[132:135], v[36:39], v[16:19], v[132:135]
    s_add_u32 s84, s84, 32768
    s_cmp_ge_u32 s84, 163840
    s_cselect_b32 s76, 4294836224, s79
    s_cselect_b32 s84, 0, s84
    v_add_u32 v2, s76, v2
    v_add_u32 v3, s76, v3
    v_add_u32 v4, s76, v4
    v_add_u32 v5, s76, v5
    v_add_u32 v6, s76, v6
    v_add_u32 v7, s76, v7
    v_mfma_f32_16x16x32_bf16 v[136:139], v[40:43], v[16:19], v[136:139]
    v_mfma_f32_16x16x32_bf16 v[140:143], v[44:47], v[16:19], v[140:143]
    s_waitcnt vmcnt(6)
    s_barrier
    v_mfma_f32_16x16x32_bf16 v[144:147], v[32:35], v[20:23], v[144:147]
    ds_read_b128 v[48:51], v2 offset:0
    ds_read_b64_tr_b16 v[64:65], v4 offset:16384
    v_mfma_f32_16x16x32_bf16 v[148:151], v[36:39], v[20:23], v[148:151]
    ds_read_b64_tr_b16 v[66:67], v4 offset:17408
    ds_read_b128 v[52:55], v2 offset:2048
    v_mfma_f32_16x16x32_bf16 v[152:155], v[40:43], v[20:23], v[152:155]
    ds_read_b64_tr_b16 v[68:69], v5 offset:16384
    ds_read_b64_tr_b16 v[70:71], v5 offset:17408
    v_mfma_f32_16x16x32_bf16 v[156:159], v[44:47], v[20:23], v[156:159]
    ds_read_b128 v[56:59], v3 offset:0
    ds_read_b64_tr_b16 v[72:73], v6 offset:16384
    v_mfma_f32_16x16x32_bf16 v[160:163], v[32:35], v[24:27], v[160:163]
    ds_read_b64_tr_b16 v[74:75], v6 offset:17408
    ds_read_b128 v[60:63], v3 offset:2048
    v_mfma_f32_16x16x32_bf16 v[164:167], v[36:39], v[24:27], v[164:167]
    ds_read_b64_tr_b16 v[76:77], v7 offset:16384
    ds_read_b64_tr_b16 v[78:79], v7 offset:17408
    s_add_u32 m0, s85, 0
    s_nop 0
    buffer_load_dwordx4 v8, s[44:47], s64 offen  lds
    v_mfma_f32_16x16x32_bf16 v[168:171], v[40:43], v[24:27], v[168:171]
    s_add_u32 m0, s85, 1024
    s_nop 0
    buffer_load_dwordx4 v9, s[44:47], s64 offen  lds
    v_mfma_f32_16x16x32_bf16 v[172:175], v[44:47], v[24:27], v[172:175]
    s_add_u32 m0, s85, 16384
    s_nop 0
    buffer_load_dwordx4 v10, s[48:51], s65 offen  lds
    v_mfma_f32_16x16x32_bf16 v[176:179], v[32:35], v[28:31], v[176:179]
    s_add_u32 m0, s85, 17408
    s_nop 0
    buffer_load_dwordx4 v11, s[48:51], s65 offen  lds
    v_mfma_f32_16x16x32_bf16 v[180:183], v[36:39], v[28:31], v[180:183]
    v_mfma_f32_16x16x32_bf16 v[184:187], v[40:43], v[28:31], v[184:187]
    v_mfma_f32_16x16x32_bf16 v[188:191], v[44:47], v[28:31], v[188:191]
    s_add_u32 s64, s64, 128
    s_add_u32 s65, s65, 131072
    s_add_u32 s85, s85, 32768
    s_cmp_ge_u32 s85, s78
    s_cselect_b32 s77, 163840, 0
    s_sub_u32 s85, s85, s77
    s_waitcnt lgkmcnt(0)
    v_mfma_f32_16x16x32_bf16 v[128:131], v[64:67], v[48:51], v[128:131]
    v_mfma_f32_16x16x32_bf16 v[132:135], v[68:71], v[48:51], v[132:135]
    s_add_u32 s84, s84, 32768
    s_cmp_ge_u32 s84, 163840
    s_cselect_b32 s76, 4294836224, s79
    s_cselect_b32 s84, 0, s84
    v_add_u32 v2, s76, v2
    v_add_u32 v3, s76, v3
    v_add_u32 v4, s76, v4
    v_add_u32 v5, s76, v5
    v_add_u32 v6, s76, v6
    v_add_u32 v7, s76, v7
    v_mfma_f32_16x16x32_bf16 v[136:139], v[72:75], v[48:51], v[136:139]
    v_mfma_f32_16x16x32_bf16 v[140:143], v[76:79], v[48:51], v[140:143]
    s_waitcnt vmcnt(8)
    s_barrier
    v_mfma_f32_16x16x32_bf16 v[144:147], v[64:67], v[52:55], v[144:147]
    ds_read_b128 v[16:19], v2 offset:0
    ds_read_b64_tr_b16 v[32:33], v4 offset:16384
    v_mfma_f32_16x16x32_bf16 v[148:151], v[68:71], v[52:55], v[148:151]
    ds_read_b64_tr_b16 v[34:35], v4 offset:17408
    ds_read_b128 v[20:23], v2 offset:2048
    v_mfma_f32_16x16x32_bf16 v[152:155], v[72:75], v[52:55], v[152:155]
    ds_read_b64_tr_b16 v[36:37], v5 offset:16384
    ds_read_b64_tr_b16 v[38:39], v5 offset:17408
    v_mfma_f32_16x16x32_bf16 v[156:159], v[76:79], v[52:55], v[156:159]
    ds_read_b128 v[24:27], v3 offset:0
    ds_read_b64_tr_b16 v[40:41], v6 offset:16384
    v_mfma_f32_16x16x32_bf16 v[160:163], v[64:67], v[56:59], v[160:163]
    ds_read_b64_tr_b16 v[42:43], v6 offset:17408
    ds_read_b128 v[28:31], v3 offset:2048
    v_mfma_f32_16x16x32_bf16 v[164:167], v[68:71], v[56:59], v[164:167]
    ds_read_b64_tr_b16 v[44:45], v7 offset:16384
    ds_read_b64_tr_b16 v[46:47], v7 offset:17408
    s_add_u32 m0, s85, 0
    s_nop 0
    buffer_load_dwordx4 v8, s[44:47], s64 offen  lds
    v_mfma_f32_16x16x32_bf16 v[168:171], v[72:75], v[56:59], v[168:171]
    s_add_u32 m0, s85, 1024
    s_nop 0
    buffer_load_dwordx4 v9, s[44:47], s64 offen  lds
    v_mfma_f32_16x16x32_bf16 v[172:175], v[76:79], v[56:59], v[172:175]
    s_add_u32 m0, s85, 16384
    s_nop 0
    buffer_load_dwordx4 v10, s[48:51], s65 offen  lds
    v_mfma_f32_16x16x32_bf16 v[176:179], v[64:67], v[60:63], v[176:179]
    s_add_u32 m0, s85, 17408
    s_nop 0
    buffer_load_dwordx4 v11, s[48:51], s65 offen  lds
    v_mfma_f32_16x16x32_bf16 v[180:183], v[68:71], v[60:63], v[180:183]
    v_mfma_f32_16x16x32_bf16 v[184:187], v[72:75], v[60:63], v[184:187]
    v_mfma_f32_16x16x32_bf16 v[188:191], v[76:79], v[60:63], v[188:191]
    s_add_u32 s64, s64, 128
    s_add_u32 s65, s65, 131072
    s_add_u32 s85, s85, 32768
    s_cmp_ge_u32 s85, s78
    s_cselect_b32 s77, 163840, 0
    s_sub_u32 s85, s85, s77
    s_waitcnt lgkmcnt(0)
    v_mfma_f32_16x16x32_bf16 v[128:131], v[32:35], v[16:19], v[128:131]
    v_mfma_f32_16x16x32_bf16 v[132:135], v[36:39], v[16:19], v[132:135]
    s_add_u32 s84, s84, 32768
    s_cmp_ge_u32 s84, 163840
    s_cselect_b32 s76, 4294836224, s79
    s_cselect_b32 s84, 0, s84
    v_add_u32 v2, s76, v2
    v_add_u32 v3, s76, v3
    v_add_u32 v4, s76, v4
    v_add_u32 v5, s76, v5
    v_add_u32 v6, s76, v6
    v_add_u32 v7, s76, v7
    v_mfma_f32_16x16x32_bf16 v[136:139], v[40:43], v[16:19], v[136:139]
    v_mfma_f32_16x16x32_bf16 v[140:143], v[44:47], v[16:19], v[140:143]
    s_waitcnt vmcnt(10)
    s_barrier
    v_mfma_f32_16x16x32_bf16 v[144:147], v[32:35], v[20:23], v[144:147]
    ds_read_b128 v[48:51], v2 offset:0
    ds_read_b64_tr_b16 v[64:65], v4 offset:16384
    v_mfma_f32_16x16x32_bf16 v[148:151], v[36:39], v[20:23], v[148:151]
    ds_read_b64_tr_b16 v[66:67], v4 offset:17408
    ds_read_b128 v[52:55], v2 offset:2048
    v_mfma_f32_16x16x32_bf16 v[152:155], v[40:43], v[20:23], v[152:155]
    ds_read_b64_tr_b16 v[68:69], v5 offset:16384
    ds_read_b64_tr_b16 v[70:71], v5 offset:17408
    v_mfma_f32_16x16x32_bf16 v[156:159], v[44:47], v[20:23], v[156:159]
    ds_read_b128 v[56:59], v3 offset:0
    ds_read_b64_tr_b16 v[72:73], v6 offset:16384
    v_mfma_f32_16x16x32_bf16 v[160:163], v[32:35], v[24:27], v[160:163]
    ds_read_b64_tr_b16 v[74:75], v6 offset:17408
    ds_read_b128 v[60:63], v3 offset:2048
    v_mfma_f32_16x16x32_bf16 v[164:167], v[36:39], v[24:27], v[164:167]
    ds_read_b64_tr_b16 v[76:77], v7 offset:16384
    ds_read_b64_tr_b16 v[78:79], v7 offset:17408
    s_add_u32 m0, s85, 0
    s_nop 0
    buffer_load_dwordx4 v8, s[44:47], s64 offen  lds
    v_mfma_f32_16x16x32_bf16 v[168:171], v[40:43], v[24:27], v[168:171]
    s_add_u32 m0, s85, 1024
    s_nop 0
    buffer_load_dwordx4 v9, s[44:47], s64 offen  lds
    v_mfma_f32_16x16x32_bf16 v[172:175], v[44:47], v[24:27], v[172:175]
    s_add_u32 m0, s85, 16384
    s_nop 0
    buffer_load_dwordx4 v10, s[48:51], s65 offen  lds
    v_mfma_f32_16x16x32_bf16 v[176:179], v[32:35], v[28:31], v[176:179]
    s_add_u32 m0, s85, 17408
    s_nop 0
    buffer_load_dwordx4 v11, s[48:51], s65 offen  lds
    v_mfma_f32_16x16x32_bf16 v[180:183], v[36:39], v[28:31], v[180:183]
    v_mfma_f32_16x16x32_bf16 v[184:187], v[40:43], v[28:31], v[184:187]
    v_mfma_f32_16x16x32_bf16 v[188:191], v[44:47], v[28:31], v[188:191]
    s_add_u32 s64, s64, 128
    s_add_u32 s65, s65, 131072
    s_add_u32 s85, s85, 32768
    s_cmp_ge_u32 s85, s78
    s_cselect_b32 s77, 163840, 0
    s_sub_u32 s85, s85, s77
    s_waitcnt lgkmcnt(0)
    v_mfma_f32_16x16x32_bf16 v[128:131], v[64:67], v[48:51], v[128:131]
    v_mfma_f32_16x16x32_bf16 v[132:135], v[68:71], v[48:51], v[132:135]
    s_add_u32 s84, s84, 32768
    s_cmp_ge_u32 s84, 163840
    s_cselect_b32 s76, 4294836224, s79
    s_cselect_b32 s84, 0, s84
    v_add_u32 v2, s76, v2
    v_add_u32 v3, s76, v3
    v_add_u32 v4, s76, v4
    v_add_u32 v5, s76, v5
    v_add_u32 v6, s76, v6
    v_add_u32 v7, s76, v7
    v_mfma_f32_16x16x32_bf16 v[136:139], v[72:75], v[48:51], v[136:139]
    v_mfma_f32_16x16x32_bf16 v[140:143], v[76:79], v[48:51], v[140:143]
    s_waitcnt vmcnt(12)
    s_barrier
    v_mfma_f32_16x16x32_bf16 v[144:147], v[64:67], v[52:55], v[144:147]
    ds_read_b128 v[16:19], v2 offset:0
    ds_read_b64_tr_b16 v[32:33], v4 offset:16384
    v_mfma_f32_16x16x32_bf16 v[148:151], v[68:71], v[52:55], v[148:151]
    ds_read_b64_tr_b16 v[34:35], v4 offset:17408
    ds_read_b128 v[20:23], v2 offset:2048
    v_mfma_f32_16x16x32_bf16 v[152:155], v[72:75], v[52:55], v[152:155]
    ds_read_b64_tr_b16 v[36:37], v5 offset:16384
    ds_read_b64_tr_b16 v[38:39], v5 offset:17408
    v_mfma_f32_16x16x32_bf16 v[156:159], v[76:79], v[52:55], v[156:159]
    ds_read_b128 v[24:27], v3 offset:0
    ds_read_b64_tr_b16 v[40:41], v6 offset:16384
    v_mfma_f32_16x16x32_bf16 v[160:163], v[64:67], v[56:59], v[160:163]
    ds_read_b64_tr_b16 v[42:43], v6 offset:17408
    ds_read_b128 v[28:31], v3 offset:2048
    v_mfma_f32_16x16x32_bf16 v[164:167], v[68:71], v[56:59], v[164:167]
    ds_read_b64_tr_b16 v[44:45], v7 offset:16384
    ds_read_b64_tr_b16 v[46:47], v7 offset:17408
    s_add_u32 m0, s85, 0
    s_nop 0
    buffer_load_dwordx4 v8, s[44:47], s64 offen  lds
    v_mfma_f32_16x16x32_bf16 v[168:171], v[72:75], v[56:59], v[168:171]
    s_add_u32 m0, s85, 1024
    s_nop 0
    buffer_load_dwordx4 v9, s[44:47], s64 offen  lds
    v_mfma_f32_16x16x32_bf16 v[172:175], v[76:79], v[56:59], v[172:175]
    s_add_u32 m0, s85, 16384
    s_nop 0
    buffer_load_dwordx4 v10, s[48:51], s65 offen  lds
    v_mfma_f32_16x16x32_bf16 v[176:179], v[64:67], v[60:63], v[176:179]
    s_add_u32 m0, s85, 17408
    s_nop 0
    buffer_load_dwordx4 v11, s[48:51], s65 offen  lds
    v_mfma_f32_16x16x32_bf16 v[180:183], v[68:71], v[60:63], v[180:183]
    v_mfma_f32_16x16x32_bf16 v[184:187], v[72:75], v[60:63], v[184:187]
    v_mfma_f32_16x16x32_bf16 v[188:191], v[76:79], v[60:63], v[188:191]
    s_add_u32 s64, s64, 128
    s_add_u32 s65, s65, 131072
    s_add_u32 s85, s85, 32768
    s_cmp_ge_u32 s85, s78
    s_cselect_b32 s77, 163840, 0
    s_sub_u32 s85, s85, s77
    s_sub_u32 s67, s67, 10
    s_lshr_b32 s67, s67, 1
out_loop:
    s_waitcnt lgkmcnt(0)
    v_mfma_f32_16x16x32_bf16 v[128:131], v[32:35], v[16:19], v[128:131]
    v_mfma_f32_16x16x32_bf16 v[132:135], v[36:39], v[16:19], v[132:135]
    s_add_u32 s84, s84, 32768
    s_cmp_ge_u32 s84, 163840
    s_cselect_b32 s76, 4294836224, s79
    s_cselect_b32 s84, 0, s84
    v_add_u32 v2, s76, v2
    v_add_u32 v3, s76, v3
    v_add_u32 v4, s76, v4
    v_add_u32 v5, s76, v5
    v_add_u32 v6, s76, v6
    v_add_u32 v7, s76, v7
    v_mfma_f32_16x16x32_bf16 v[136:139], v[40:43], v[16:19], v[136:139]
    v_mfma_f32_16x16x32_bf16 v[140:143], v[44:47], v[16:19], v[140:143]
    s_waitcnt vmcnt(12)
    s_barrier
    v_mfma_f32_16x16x32_bf16 v[144:147], v[32:35], v[20:23], v[144:147]
    ds_read_b128 v[48:51], v2 offset:0
    ds_read_b64_tr_b16 v[64:65], v4 offset:16384
    v_mfma_f32_16x16x32_bf16 v[148:151], v[36:39], v[20:23], v[148:151]
    ds_read_b64_tr_b16 v[66:67], v4 offset:17408
    ds_read_b128 v[52:55], v2 offset:2048
    v_mfma_f32_16x16x32_bf16 v[152:155], v[40:43], v[20:23], v[152:155]
    ds_read_b64_tr_b16 v[68:69], v5 offset:16384
    ds_read_b64_tr_b16 v[70:71], v5 offset:17408
    v_mfma_f32_16x16x32_bf16 v[156:159], v[44:47], v[20:23], v[156:159]
    ds_read_b128 v[56:59], v3 offset:0
    ds_read_b64_tr_b16 v[72:73], v6 offset:16384
    v_mfma_f32_16x16x32_bf16 v[160:163], v[32:35], v[24:27], v[160:163]
    ds_read_b64_tr_b16 v[74:75], v6 offset:17408
    ds_read_b128 v[60:63], v3 offset:2048
    v_mfma_f32_16x16x32_bf16 v[164:167], v[36:39], v[24:27], v[164:167]
    ds_read_b64_tr_b16 v[76:77], v7 offset:16384
    ds_read_b64_tr_b16 v[78:79], v7 offset:17408
    s_add_u32 m0, s85, 0
    s_nop 0
    buffer_load_dwordx4 v8, s[44:47], s64 offen  lds
    v_mfma_f32_16x16x32_bf16 v[168:171], v[40:43], v[24:27], v[168:171]
    s_add_u32 m0, s85, 1024
    s_nop 0
    buffer_load_dwordx4 v9, s[44:47], s64 offen  lds
    v_mfma_f32_16x16x32_bf16 v[172:175], v[44:47], v[24:27], v[172:175]
    s_add_u32 m0, s85, 16384
    s_nop 0
    buffer_load_dwordx4 v10, s[48:51], s65 offen  lds
    v_mfma_f32_16x16x32_bf16 v[176:179], v[32:35], v[28:31], v[176:179]
    s_add_u32 m0, s85, 17408
    s_nop 0
    buffer_load_dwordx4 v11, s[48:51], s65 offen  lds
    v_mfma_f32_16x16x32_bf16 v[180:183], v[36:39], v[28:31], v[180:183]
    v_mfma_f32_16x16x32_bf16 v[184:187], v[40:43], v[28:31], v[184:187]
    v_mfma_f32_16x16x32_bf16 v[188:191], v[44:47], v[28:31], v[188:191]
    s_add_u32 s64, s64, 128
    s_add_u32 s65, s65, 131072
    s_add_u32 s85, s85, 32768
    s_cmp_ge_u32 s85, s78
    s_cselect_b32 s77, 163840, 0
    s_sub_u32 s85, s85, s77
    s_waitcnt lgkmcnt(0)
    v_mfma_f32_16x16x32_bf16 v[128:131], v[64:67], v[48:51], v[128:131]
    v_mfma_f32_16x16x32_bf16 v[132:135], v[68:71], v[48:51], v[132:135]
    s_add_u32 s84, s84, 32768
    s_cmp_ge_u32 s84, 163840
    s_cselect_b32 s76, 4294836224, s79
    s_cselect_b32 s84, 0, s84
    v_add_u32 v2, s76, v2
    v_add_u32 v3, s76, v3
    v_add_u32 v4, s76, v4
    v_add_u32 v5, s76, v5
    v_add_u32 v6, s76, v6
    v_add_u32 v7, s76, v7
    v_mfma_f32_16x16x32_bf16 v[136:139], v[72:75], v[48:51], v[136:139]
    v_mfma_f32_16x16x32_bf16 v[140:143], v[76:79], v[48:51], v[140:143]
    s_waitcnt vmcnt(12)
    s_barrier
    v_mfma_f32_16x16x32_bf16 v[144:147], v[64:67], v[52:55], v[144:147]
    ds_read_b128 v[16:19], v2 offset:0
    ds_read_b64_tr_b16 v[32:33], v4 offset:16384
    v_mfma_f32_16x16x32_bf16 v[148:151], v[68:71], v[52:55], v[148:151]
    ds_read_b64_tr_b16 v[34:35], v4 offset:17408
    ds_read_b128 v[20:23], v2 offset:2048
    v_mfma_f32_16x16x32_bf16 v[152:155], v[72:75], v[52:55], v[152:155]
    ds_read_b64_tr_b16 v[36:37], v5 offset:16384
    ds_read_b64_tr_b16 v[38:39], v5 offset:17408
    v_mfma_f32_16x16x32_bf16 v[156:159], v[76:79], v[52:55], v[156:159]
    ds_read_b128 v[24:27], v3 offset:0
    ds_read_b64_tr_b16 v[40:41], v6 offset:16384
    v_mfma_f32_16x16x32_bf16 v[160:163], v[64:67], v[56:59], v[160:163]
    ds_read_b64_tr_b16 v[42:43], v6 offset:17408
    ds_read_b128 v[28:31], v3 offset:2048
    v_mfma_f32_16x16x32_bf16 v[164:167], v[68:71], v[56:59], v[164:167]
    ds_read_b64_tr_b16 v[44:45], v7 offset:16384
    ds_read_b64_tr_b16 v[46:47], v7 offset:17408
    s_add_u32 m0, s85, 0
    s_nop 0
    buffer_load_dwordx4 v8, s[44:47], s64 offen  lds
    v_mfma_f32_16x16x32_bf16 v[168:171], v[72:75], v[56:59], v[168:171]
    s_add_u32 m0, s85, 1024
    s_nop 0
    buffer_load_dwordx4 v9, s[44:47], s64 offen  lds
    v_mfma_f32_16x16x32_bf16 v[172:175], v[76:79], v[56:59], v[172:175]
    s_add_u32 m0, s85, 16384
    s_nop 0
    buffer_load_dwordx4 v10, s[48:51], s65 offen  lds
    v_mfma_f32_16x16x32_bf16 v[176:179], v[64:67], v[60:63], v[176:179]
    s_add_u32 m0, s85, 17408
    s_nop 0
    buffer_load_dwordx4 v11, s[48:51], s65 offen  lds
    v_mfma_f32_16x16x32_bf16 v[180:183], v[68:71], v[60:63], v[180:183]
    v_mfma_f32_16x16x32_bf16 v[184:187], v[72:75], v[60:63], v[184:187]
    v_mfma_f32_16x16x32_bf16 v[188:191], v[76:79], v[60:63], v[188:191]
    s_add_u32 s64, s64, 128
    s_add_u32 s65, s65, 131072
    s_add_u32 s85, s85, 32768
    s_cmp_ge_u32 s85, s78
    s_cselect_b32 s77, 163840, 0
    s_sub_u32 s85, s85, s77
    s_sub_u32 s67, s67, 1
    s_cmp_lg_u32 s67, 0
    s_cbranch_scc1 out_loop
    s_lshl_b32 s68, s83, 16
    s_add_u32 s68, s68, 88080384
    s_add_u32 s96, s42, s68
    s_addc_u32 s97, s43, 0
    s_sub_u32 s98, 96468992, s68
    s_and_b32 s97, s97, 0xffff
    s_mov_b32 s99, 0x00020000
    v_lshlrev_b32 v94, 4, v1
    s_lshl_b32 s4, s60, 13
    s_add_u32 s5, s4, 4096
    s_lshl_b32 s6, s83, 7
    s_add_u32 s6, s6, 163840
    v_mov_b32 v90, s6
    s_waitcnt lgkmcnt(0)
    v_mfma_f32_16x16x32_bf16 v[128:131], v[32:35], v[16:19], v[128:131]
    v_mfma_f32_16x16x32_bf16 v[132:135], v[36:39], v[16:19], v[132:135]
    s_add_u32 s84, s84, 32768
    s_cmp_ge_u32 s84, 163840
    s_cselect_b32 s76, 4294836224, s79
    s_cselect_b32 s84, 0, s84
    v_add_u32 v2, s76, v2
    v_add_u32 v3, s76, v3
    v_add_u32 v4, s76, v4
    v_add_u32 v5, s76, v5
    v_add_u32 v6, s76, v6
    v_add_u32 v7, s76, v7
    v_mfma_f32_16x16x32_bf16 v[136:139], v[40:43], v[16:19], v[136:139]
    v_mfma_f32_16x16x32_bf16 v[140:143], v[44:47], v[16:19], v[140:143]
    s_waitcnt vmcnt(12)
    s_barrier
    v_mfma_f32_16x16x32_bf16 v[144:147], v[32:35], v[20:23], v[144:147]
    ds_read_b128 v[48:51], v2 offset:0
    ds_read_b64_tr_b16 v[64:65], v4 offset:16384
    v_mfma_f32_16x16x32_bf16 v[148:151], v[36:39], v[20:23], v[148:151]
    ds_read_b64_tr_b16 v[66:67], v4 offset:17408
    ds_read_b128 v[52:55], v2 offset:2048
    v_mfma_f32_16x16x32_bf16 v[152:155], v[40:43], v[20:23], v[152:155]
    ds_read_b64_tr_b16 v[68:69], v5 offset:16384
    ds_read_b64_tr_b16 v[70:71], v5 offset:17408
    v_mfma_f32_16x16x32_bf16 v[156:159], v[44:47], v[20:23], v[156:159]
    ds_read_b128 v[56:59], v3 offset:0
    ds_read_b64_tr_b16 v[72:73], v6 offset:16384
    v_mfma_f32_16x16x32_bf16 v[160:163], v[32:35], v[24:27], v[160:163]
    ds_read_b64_tr_b16 v[74:75], v6 offset:17408
    ds_read_b128 v[60:63], v3 offset:2048
    v_mfma_f32_16x16x32_bf16 v[164:167], v[36:39], v[24:27], v[164:167]
    ds_read_b64_tr_b16 v[76:77], v7 offset:16384
    ds_read_b64_tr_b16 v[78:79], v7 offset:17408
    s_add_u32 m0, s85, 0
    s_nop 0
    buffer_load_dwordx4 v8, s[44:47], s64 offen  lds
    v_mfma_f32_16x16x32_bf16 v[168:171], v[40:43], v[24:27], v[168:171]
    s_add_u32 m0, s85, 1024
    s_nop 0
    buffer_load_dwordx4 v9, s[44:47], s64 offen  lds
    v_mfma_f32_16x16x32_bf16 v[172:175], v[44:47], v[24:27], v[172:175]
    s_add_u32 m0, s85, 16384
    s_nop 0
    buffer_load_dwordx4 v10, s[48:51], s65 offen  lds
    v_mfma_f32_16x16x32_bf16 v[176:179], v[32:35], v[28:31], v[176:179]
    s_add_u32 m0, s85, 17408
    s_nop 0
    buffer_load_dwordx4 v11, s[48:51], s65 offen  lds
    v_mfma_f32_16x16x32_bf16 v[180:183], v[36:39], v[28:31], v[180:183]
    v_mfma_f32_16x16x32_bf16 v[184:187], v[40:43], v[28:31], v[184:187]
    v_mfma_f32_16x16x32_bf16 v[188:191], v[44:47], v[28:31], v[188:191]
    s_add_u32 s64, s64, 128
    s_add_u32 s65, s65, 131072
    s_add_u32 s85, s85, 32768
    s_cmp_ge_u32 s85, s78
    s_cselect_b32 s77, 163840, 0
    s_sub_u32 s85, s85, s77
    s_waitcnt lgkmcnt(0)
    v_mfma_f32_16x16x32_bf16 v[128:131], v[64:67], v[48:51], v[128:131]
    v_mfma_f32_16x16x32_bf16 v[132:135], v[68:71], v[48:51], v[132:135]
    s_add_u32 s84, s84, 32768
    s_cmp_ge_u32 s84, 163840
    s_cselect_b32 s76, 4294836224, s79
    s_cselect_b32 s84, 0, s84
    v_add_u32 v2, s76, v2
    v_add_u32 v3, s76, v3
    v_add_u32 v4, s76, v4
    v_add_u32 v5, s76, v5
    v_add_u32 v6, s76, v6
    v_add_u32 v7, s76, v7
    v_mfma_f32_16x16x32_bf16 v[136:139], v[72:75], v[48:51], v[136:139]
    v_mfma_f32_16x16x32_bf16 v[140:143], v[76:79], v[48:51], v[140:143]
    s_waitcnt vmcnt(12)
    s_barrier
    v_mfma_f32_16x16x32_bf16 v[144:147], v[64:67], v[52:55], v[144:147]
    ds_read_b128 v[16:19], v2 offset:0
    ds_read_b64_tr_b16 v[32:33], v4 offset:16384
    v_mfma_f32_16x16x32_bf16 v[148:151], v[68:71], v[52:55], v[148:151]
    ds_read_b64_tr_b16 v[34:35], v4 offset:17408
    ds_read_b128 v[20:23], v2 offset:2048
    v_mfma_f32_16x16x32_bf16 v[152:155], v[72:75], v[52:55], v[152:155]
    ds_read_b64_tr_b16 v[36:37], v5 offset:16384
    ds_read_b64_tr_b16 v[38:39], v5 offset:17408
    v_mfma_f32_16x16x32_bf16 v[156:159], v[76:79], v[52:55], v[156:159]
    ds_read_b128 v[24:27], v3 offset:0
    ds_read_b64_tr_b16 v[40:41], v6 offset:16384
    v_mfma_f32_16x16x32_bf16 v[160:163], v[64:67], v[56:59], v[160:163]
    ds_read_b64_tr_b16 v[42:43], v6 offset:17408
    ds_read_b128 v[28:31], v3 offset:2048
    v_mfma_f32_16x16x32_bf16 v[164:167], v[68:71], v[56:59], v[164:167]
    ds_read_b64_tr_b16 v[44:45], v7 offset:16384
    ds_read_b64_tr_b16 v[46:47], v7 offset:17408
    v_mfma_f32_16x16x32_bf16 v[168:171], v[72:75], v[56:59], v[168:171]
    v_mfma_f32_16x16x32_bf16 v[172:175], v[76:79], v[56:59], v[172:175]
    v_mfma_f32_16x16x32_bf16 v[176:179], v[64:67], v[60:63], v[176:179]
    v_mfma_f32_16x16x32_bf16 v[180:183], v[68:71], v[60:63], v[180:183]
    v_mfma_f32_16x16x32_bf16 v[184:187], v[72:75], v[60:63], v[184:187]
    v_mfma_f32_16x16x32_bf16 v[188:191], v[76:79], v[60:63], v[188:191]
    s_waitcnt lgkmcnt(0)
    v_mfma_f32_16x16x32_bf16 v[128:131], v[32:35], v[16:19], v[128:131]
    v_mfma_f32_16x16x32_bf16 v[132:135], v[36:39], v[16:19], v[132:135]
    s_add_u32 s84, s84, 32768
    s_cmp_ge_u32 s84, 163840
    s_cselect_b32 s76, 4294836224, s79
    s_cselect_b32 s84, 0, s84
    v_add_u32 v2, s76, v2
    v_add_u32 v3, s76, v3
    v_add_u32 v4, s76, v4
    v_add_u32 v5, s76, v5
    v_add_u32 v6, s76, v6
    v_add_u32 v7, s76, v7
    v_mfma_f32_16x16x32_bf16 v[136:139], v[40:43], v[16:19], v[136:139]
    v_mfma_f32_16x16x32_bf16 v[140:143], v[44:47], v[16:19], v[140:143]
    s_waitcnt vmcnt(8)
    s_barrier
    v_mfma_f32_16x16x32_bf16 v[144:147], v[32:35], v[20:23], v[144:147]
    ds_read_b128 v[48:51], v2 offset:0
    ds_read_b64_tr_b16 v[64:65], v4 offset:16384
    v_mfma_f32_16x16x32_bf16 v[148:151], v[36:39], v[20:23], v[148:151]
    ds_read_b64_tr_b16 v[66:67], v4 offset:17408
    ds_read_b128 v[52:55], v2 offset:2048
    v_mfma_f32_16x16x32_bf16 v[152:155], v[40:43], v[20:23], v[152:155]
    ds_read_b64_tr_b16 v[68:69], v5 offset:16384
    ds_read_b64_tr_b16 v[70:71], v5 offset:17408
    v_mfma_f32_16x16x32_bf16 v[156:159], v[44:47], v[20:23], v[156:159]
    ds_read_b128 v[56:59], v3 offset:0
    ds_read_b64_tr_b16 v[72:73], v6 offset:16384
    v_mfma_f32_16x16x32_bf16 v[160:163], v[32:35], v[24:27], v[160:163]
    ds_read_b64_tr_b16 v[74:75], v6 offset:17408
    ds_read_b128 v[60:63], v3 offset:2048
    v_mfma_f32_16x16x32_bf16 v[164:167], v[36:39], v[24:27], v[164:167]
    ds_read_b64_tr_b16 v[76:77], v7 offset:16384
    ds_read_b64_tr_b16 v[78:79], v7 offset:17408
    v_mfma_f32_16x16x32_bf16 v[168:171], v[40:43], v[24:27], v[168:171]
    v_mfma_f32_16x16x32_bf16 v[172:175], v[44:47], v[24:27], v[172:175]
    v_mfma_f32_16x16x32_bf16 v[176:179], v[32:35], v[28:31], v[176:179]
    v_mfma_f32_16x16x32_bf16 v[180:183], v[36:39], v[28:31], v[180:183]
    v_mfma_f32_16x16x32_bf16 v[184:187], v[40:43], v[28:31], v[184:187]
    v_mfma_f32_16x16x32_bf16 v[188:191], v[44:47], v[28:31], v[188:191]
    s_waitcnt lgkmcnt(0)
    v_mfma_f32_16x16x32_bf16 v[128:131], v[64:67], v[48:51], v[128:131]
    v_mfma_f32_16x16x32_bf16 v[132:135], v[68:71], v[48:51], v[132:135]
    s_add_u32 s84, s84, 32768
    s_cmp_ge_u32 s84, 163840
    s_cselect_b32 s76, 4294836224, s79
    s_cselect_b32 s84, 0, s84
    v_add_u32 v2, s76, v2
    v_add_u32 v3, s76, v3
    v_add_u32 v4, s76, v4
    v_add_u32 v5, s76, v5
    v_add_u32 v6, s76, v6
    v_add_u32 v7, s76, v7
    v_mfma_f32_16x16x32_bf16 v[136:139], v[72:75], v[48:51], v[136:139]
    v_mfma_f32_16x16x32_bf16 v[140:143], v[76:79], v[48:51], v[140:143]
    s_waitcnt vmcnt(4)
    s_barrier
    v_mfma_f32_16x16x32_bf16 v[144:147], v[64:67], v[52:55], v[144:147]
    ds_read_b128 v[16:19], v2 offset:0
    ds_read_b64_tr_b16 v[32:33], v4 offset:16384
    v_mfma_f32_16x16x32_bf16 v[148:151], v[68:71], v[52:55], v[148:151]
    ds_read_b64_tr_b16 v[34:35], v4 offset:17408
    ds_read_b128 v[20:23], v2 offset:2048
    v_mfma_f32_16x16x32_bf16 v[152:155], v[72:75], v[52:55], v[152:155]
    ds_read_b64_tr_b16 v[36:37], v5 offset:16384
    ds_read_b64_tr_b16 v[38:39], v5 offset:17408
    v_mfma_f32_16x16x32_bf16 v[156:159], v[76:79], v[52:55], v[156:159]
    ds_read_b128 v[24:27], v3 offset:0
    ds_read_b64_tr_b16 v[40:41], v6 offset:16384
    v_mfma_f32_16x16x32_bf16 v[160:163], v[64:67], v[56:59], v[160:163]
    ds_read_b64_tr_b16 v[42:43], v6 offset:17408
    ds_read_b128 v[28:31], v3 offset:2048
    v_mfma_f32_16x16x32_bf16 v[164:167], v[68:71], v[56:59], v[164:167]
    ds_read_b64_tr_b16 v[44:45], v7 offset:16384
    ds_read_b64_tr_b16 v[46:47], v7 offset:17408
    v_mfma_f32_16x16x32_bf16 v[168:171], v[72:75], v[56:59], v[168:171]
    v_mfma_f32_16x16x32_bf16 v[172:175], v[76:79], v[56:59], v[172:175]
    v_mfma_f32_16x16x32_bf16 v[176:179], v[64:67], v[60:63], v[176:179]
    v_mfma_f32_16x16x32_bf16 v[180:183], v[68:71], v[60:63], v[180:183]
    v_mfma_f32_16x16x32_bf16 v[184:187], v[72:75], v[60:63], v[184:187]
    v_mfma_f32_16x16x32_bf16 v[188:191], v[76:79], v[60:63], v[188:191]
    s_waitcnt lgkmcnt(0)
    v_mfma_f32_16x16x32_bf16 v[128:131], v[32:35], v[16:19], v[128:131]
    v_mfma_f32_16x16x32_bf16 v[132:135], v[36:39], v[16:19], v[132:135]
    s_add_u32 s84, s84, 32768
    s_cmp_ge_u32 s84, 163840
    s_cselect_b32 s76, 4294836224, s79
    s_cselect_b32 s84, 0, s84
    v_add_u32 v2, s76, v2
    v_add_u32 v3, s76, v3
    v_add_u32 v4, s76, v4
    v_add_u32 v5, s76, v5
    v_add_u32 v6, s76, v6
    v_add_u32 v7, s76, v7
    v_mfma_f32_16x16x32_bf16 v[136:139], v[40:43], v[16:19], v[136:139]
    v_mfma_f32_16x16x32_bf16 v[140:143], v[44:47], v[16:19], v[140:143]
    s_waitcnt vmcnt(0)
    s_add_u32 s68, s60, s82
    s_cmp_lg_u32 s68, 0
    s_cbranch_scc1 Lnpc_325
    s_add_u32 s52, s42, 209715200
    s_addc_u32 s53, s43, 0
    s_mov_b32 s54, 262144
    s_and_b32 s53, s53, 0xffff
    s_mov_b32 s55, 0x00020000
    s_mov_b32 s14, 0x400000
Lld_328:
    buffer_load_dwordx2 v[92:93], v90, s[52:55], 0 offen sc0 sc1
    s_waitcnt vmcnt(0)
Lpoll_326:
    v_cmp_ne_u32 vcc, s12, v92
    v_cmp_ne_u32 s[68:69], s13, v93
    s_nop 3
    s_or_b64 vcc, vcc, s[68:69]
    s_cbranch_scc0 Lok_327
    s_sleep 1
    s_sub_u32 s14, s14, 1
    s_cmp_lg_u32 s14, 0
    s_cbranch_scc1 Lld_328
    s_mov_b64 vcc, 0
Lok_327:
Lnpc_325:
    s_barrier
    s_cmp_lg_u32 s82, 0
    s_cbranch_scc1 Lnpl_329
    buffer_load_dwordx4 v[224:227], v94, s[96:99], s4 offen offset:0 sc0 sc1
    buffer_load_dwordx4 v[228:231], v94, s[96:99], s4 offen offset:1024 sc0 sc1
    buffer_load_dwordx4 v[232:235], v94, s[96:99], s4 offen offset:2048 sc0 sc1
    buffer_load_dwordx4 v[236:239], v94, s[96:99], s4 offen offset:3072 sc0 sc1
    buffer_load_dwordx4 v[240:243], v94, s[96:99], s5 offen offset:0 sc0 sc1
    buffer_load_dwordx4 v[244:247], v94, s[96:99], s5 offen offset:1024 sc0 sc1
    buffer_load_dwordx4 v[248:251], v94, s[96:99], s5 offen offset:2048 sc0 sc1
    buffer_load_dwordx4 v[252:255], v94, s[96:99], s5 offen offset:3072 sc0 sc1
Lnpl_329:
    v_mfma_f32_16x16x32_bf16 v[144:147], v[32:35], v[20:23], v[144:147]
    ds_read_b128 v[48:51], v2 offset:0
    ds_read_b64_tr_b16 v[64:65], v4 offset:16384
    v_mfma_f32_16x16x32_bf16 v[148:151], v[36:39], v[20:23], v[148:151]
    ds_read_b64_tr_b16 v[66:67], v4 offset:17408
    ds_read_b128 v[52:55], v2 offset:2048
    v_mfma_f32_16x16x32_bf16 v[152:155], v[40:43], v[20:23], v[152:155]
    ds_read_b64_tr_b16 v[68:69], v5 offset:16384
    ds_read_b64_tr_b16 v[70:71], v5 offset:17408
    v_mfma_f32_16x16x32_bf16 v[156:159], v[44:47], v[20:23], v[156:159]
    ds_read_b128 v[56:59], v3 offset:0
    ds_read_b64_tr_b16 v[72:73], v6 offset:16384
    v_mfma_f32_16x16x32_bf16 v[160:163], v[32:35], v[24:27], v[160:163]
    ds_read_b64_tr_b16 v[74:75], v6 offset:17408
    ds_read_b128 v[60:63], v3 offset:2048
    v_mfma_f32_16x16x32_bf16 v[164:167], v[36:39], v[24:27], v[164:167]
    ds_read_b64_tr_b16 v[76:77], v7 offset:16384
    ds_read_b64_tr_b16 v[78:79], v7 offset:17408
    v_mfma_f32_16x16x32_bf16 v[168:171], v[40:43], v[24:27], v[168:171]
    v_mfma_f32_16x16x32_bf16 v[172:175], v[44:47], v[24:27], v[172:175]
    v_mfma_f32_16x16x32_bf16 v[176:179], v[32:35], v[28:31], v[176:179]
    v_mfma_f32_16x16x32_bf16 v[180:183], v[36:39], v[28:31], v[180:183]
    v_mfma_f32_16x16x32_bf16 v[184:187], v[40:43], v[28:31], v[184:187]
    v_mfma_f32_16x16x32_bf16 v[188:191], v[44:47], v[28:31], v[188:191]
    s_waitcnt lgkmcnt(0)
    v_mfma_f32_16x16x32_bf16 v[128:131], v[64:67], v[48:51], v[128:131]
    v_mfma_f32_16x16x32_bf16 v[132:135], v[68:71], v[48:51], v[132:135]
    v_mfma_f32_16x16x32_bf16 v[136:139], v[72:75], v[48:51], v[136:139]
    v_mfma_f32_16x16x32_bf16 v[140:143], v[76:79], v[48:51], v[140:143]
    v_mfma_f32_16x16x32_bf16 v[144:147], v[64:67], v[52:55], v[144:147]
    v_mfma_f32_16x16x32_bf16 v[148:151], v[68:71], v[52:55], v[148:151]
    v_mfma_f32_16x16x32_bf16 v[152:155], v[72:75], v[52:55], v[152:155]
    v_mfma_f32_16x16x32_bf16 v[156:159], v[76:79], v[52:55], v[156:159]
    v_mfma_f32_16x16x32_bf16 v[160:163], v[64:67], v[56:59], v[160:163]
    v_mfma_f32_16x16x32_bf16 v[164:167], v[68:71], v[56:59], v[164:167]
    v_mfma_f32_16x16x32_bf16 v[168:171], v[72:75], v[56:59], v[168:171]
    v_mfma_f32_16x16x32_bf16 v[172:175], v[76:79], v[56:59], v[172:175]
    v_mfma_f32_16x16x32_bf16 v[176:179], v[64:67], v[60:63], v[176:179]
    v_mfma_f32_16x16x32_bf16 v[180:183], v[68:71], v[60:63], v[180:183]
    v_mfma_f32_16x16x32_bf16 v[184:187], v[72:75], v[60:63], v[184:187]
    v_mfma_f32_16x16x32_bf16 v[188:191], v[76:79], v[60:63], v[188:191]
    s_nop 7
    s_nop 1
    s_barrier
    s_xor_b32 s69, s4, 32768
    v_add_u32 v81, s69, v94
    v_add_u32 v80, s4, v94
    ds_write_b128 v80, v[160:163] offset:0
    ds_write_b128 v80, v[164:167] offset:1024
    ds_write_b128 v80, v[168:171] offset:2048
    ds_write_b128 v80, v[172:175] offset:3072
    ds_write_b128 v80, v[176:179] offset:4096
    ds_write_b128 v80, v[180:183] offset:5120
    ds_write_b128 v80, v[184:187] offset:6144
    ds_write_b128 v80, v[188:191] offset:7168
    s_waitcnt lgkmcnt(0)
    s_barrier
    ds_read_b128 v[192:195], v81 offset:0
    ds_read_b128 v[196:199], v81 offset:1024
    ds_read_b128 v[200:203], v81 offset:2048
    ds_read_b128 v[204:207], v81 offset:3072
    ds_read_b128 v[208:211], v81 offset:4096
    ds_read_b128 v[212:215], v81 offset:5120
    ds_read_b128 v[216:219], v81 offset:6144
    ds_read_b128 v[220:223], v81 offset:7168
    s_cmp_eq_u32 s82, 0
    s_cbranch_scc1 out_consumer
    s_waitcnt lgkmcnt(7)
    v_pk_add_f32 v[128:129], v[128:129], v[192:193]
    v_pk_add_f32 v[130:131], v[130:131], v[194:195]
    buffer_store_dwordx4 v[128:131], v94, s[96:99], s4 offen offset:0 sc0 sc1
    s_waitcnt lgkmcnt(6)
    v_pk_add_f32 v[132:133], v[132:133], v[196:197]
    v_pk_add_f32 v[134:135], v[134:135], v[198:199]
    buffer_store_dwordx4 v[132:135], v94, s[96:99], s4 offen offset:1024 sc0 sc1
    s_waitcnt lgkmcnt(5)
    v_pk_add_f32 v[136:137], v[136:137], v[200:201]
    v_pk_add_f32 v[138:139], v[138:139], v[202:203]
    buffer_store_dwordx4 v[136:139], v94, s[96:99], s4 offen offset:2048 sc0 sc1
    s_waitcnt lgkmcnt(4)
    v_pk_add_f32 v[140:141], v[140:141], v[204:205]
    v_pk_add_f32 v[142:143], v[142:143], v[206:207]
    buffer_store_dwordx4 v[140:143], v94, s[96:99], s4 offen offset:3072 sc0 sc1
    s_waitcnt lgkmcnt(3)
    v_pk_add_f32 v[144:145], v[144:145], v[208:209]
    v_pk_add_f32 v[146:147], v[146:147], v[210:211]
    buffer_store_dwordx4 v[144:147], v94, s[96:99], s5 offen offset:0 sc0 sc1
    s_waitcnt lgkmcnt(2)
    v_pk_add_f32 v[148:149], v[148:149], v[212:213]
    v_pk_add_f32 v[150:151], v[150:151], v[214:215]
    buffer_store_dwordx4 v[148:151], v94, s[96:99], s5 offen offset:1024 sc0 sc1
    s_waitcnt lgkmcnt(1)
    v_pk_add_f32 v[152:153], v[152:153], v[216:217]
    v_pk_add_f32 v[154:155], v[154:155], v[218:219]
    buffer_store_dwordx4 v[152:155], v94, s[96:99], s5 offen offset:2048 sc0 sc1
    s_waitcnt lgkmcnt(0)
    v_pk_add_f32 v[156:157], v[156:157], v[220:221]
    v_pk_add_f32 v[158:159], v[158:159], v[222:223]
    buffer_store_dwordx4 v[156:159], v94, s[96:99], s5 offen offset:3072 sc0 sc1
    s_waitcnt vmcnt(0)
    s_barrier
    s_cmp_lg_u32 s60, 0
    s_cbranch_scc1 out_fin
    s_add_u32 s52, s42, 209715200
    s_addc_u32 s53, s43, 0
    s_mov_b32 s54, 262144
    s_and_b32 s53, s53, 0xffff
    s_mov_b32 s55, 0x00020000
    v_mov_b32 v82, s12
    v_mov_b32 v83, s13
    v_mov_b32 v84, 0
    s_mov_b64 exec, 1
    buffer_store_dwordx2 v[82:83], v84, s[52:55], s6 offen sc0 sc1
    s_mov_b64 exec, -1
    s_branch out_fin
out_consumer:
    s_lshl_b32 s69, s73, 8
    s_lshl_b32 s70, s62, 7
    s_add_u32 s69, s69, s70
    s_lshl_b32 s70, s72, 7
    s_lshl_b32 s71, s61, 6
    s_add_u32 s70, s70, s71
    s_lshl_b32 s71, s75, 5
    s_add_u32 s70, s70, s71
    s_lshl_b32 s70, s70, 11
    s_add_u32 s71, s70, s69
    s_add_u32 s70, s71, 32768
    s_add_u32 s52, s38, 0
    s_addc_u32 s53, s39, 0
    s_mov_b32 s54, 4194304
    s_and_b32 s53, s53, 0xffff
    s_mov_b32 s55, 0x00020000
    v_and_b32 v80, 15, v1
    v_lshlrev_b32 v80, 11, v80
    v_lshrrev_b32 v81, 4, v1
    v_and_b32 v82, 1, v81
    v_lshlrev_b32 v82, 5, v82
    v_lshrrev_b32 v81, 1, v81
    v_lshlrev_b32 v81, 4, v81
    v_add3_u32 v88, v80, v81, v82
    s_waitcnt vmcnt(0)
    v_pk_add_f32 v[128:129], v[128:129], v[224:225]
    v_pk_add_f32 v[130:131], v[130:131], v[226:227]
    v_pk_add_f32 v[132:133], v[132:133], v[228:229]
    v_pk_add_f32 v[134:135], v[134:135], v[230:231]
    v_pk_add_f32 v[136:137], v[136:137], v[232:233]
    v_pk_add_f32 v[138:139], v[138:139], v[234:235]
    v_pk_add_f32 v[140:141], v[140:141], v[236:237]
    v_pk_add_f32 v[142:143], v[142:143], v[238:239]
    v_pk_add_f32 v[144:145], v[144:145], v[240:241]
    v_pk_add_f32 v[146:147], v[146:147], v[242:243]
    v_pk_add_f32 v[148:149], v[148:149], v[244:245]
    v_pk_add_f32 v[150:151], v[150:151], v[246:247]
    v_pk_add_f32 v[152:153], v[152:153], v[248:249]
    v_pk_add_f32 v[154:155], v[154:155], v[250:251]
    v_pk_add_f32 v[156:157], v[156:157], v[252:253]
    v_pk_add_f32 v[158:159], v[158:159], v[254:255]
    s_waitcnt lgkmcnt(0)
    v_pk_add_f32 v[128:129], v[128:129], v[192:193]
    v_pk_add_f32 v[130:131], v[130:131], v[194:195]
    v_pk_add_f32 v[132:133], v[132:133], v[196:197]
    v_pk_add_f32 v[134:135], v[134:135], v[198:199]
    v_pk_add_f32 v[136:137], v[136:137], v[200:201]
    v_pk_add_f32 v[138:139], v[138:139], v[202:203]
    v_pk_add_f32 v[140:141], v[140:141], v[204:205]
    v_pk_add_f32 v[142:143], v[142:143], v[206:207]
    v_pk_add_f32 v[144:145], v[144:145], v[208:209]
    v_pk_add_f32 v[146:147], v[146:147], v[210:211]
    v_pk_add_f32 v[148:149], v[148:149], v[212:213]
    v_pk_add_f32 v[150:151], v[150:151], v[214:215]
    v_pk_add_f32 v[152:153], v[152:153], v[216:217]
    v_pk_add_f32 v[154:155], v[154:155], v[218:219]
    v_pk_add_f32 v[156:157], v[156:157], v[220:221]
    v_pk_add_f32 v[158:159], v[158:159], v[222:223]
    v_and_b32 v84, 8, v1
    s_mov_b32 s68, 2040
    v_mul_lo_u32 v84, v84, s68
    v_sub_u32 v88, v88, v84
    v_add_u32 v89, 16384, v88
    v_cvt_pk_bf16_f32 v96, v128, v129
    v_cvt_pk_bf16_f32 v97, v130, v131
    v_cvt_pk_bf16_f32 v98, v132, v133
    v_cvt_pk_bf16_f32 v99, v134, v135
    s_nop 1
    v_permlane16_swap_b32 v96, v98
    v_permlane16_swap_b32 v97, v99
    s_nop 0
    v_cvt_pk_bf16_f32 v100, v136, v137
    v_cvt_pk_bf16_f32 v101, v138, v139
    v_cvt_pk_bf16_f32 v102, v140, v141
    v_cvt_pk_bf16_f32 v103, v142, v143
    s_nop 1
    v_permlane16_swap_b32 v100, v102
    v_permlane16_swap_b32 v101, v103
    s_nop 0
    v_mov_b32 v128, v100
    v_mov_b32 v129, v101
    v_mov_b32 v130, v102
    v_mov_b32 v131, v103
    v_mov_b32_dpp v100, v96 row_ror:8 row_mask:0xf bank_mask:0x3
    v_mov_b32_dpp v101, v97 row_ror:8 row_mask:0xf bank_mask:0x3
    v_mov_b32_dpp v102, v98 row_ror:8 row_mask:0xf bank_mask:0x3
    v_mov_b32_dpp v103, v99 row_ror:8 row_mask:0xf bank_mask:0x3
    v_mov_b32_dpp v96, v128 row_ror:8 row_mask:0xf bank_mask:0xc
    v_mov_b32_dpp v97, v129 row_ror:8 row_mask:0xf bank_mask:0xc
    v_mov_b32_dpp v98, v130 row_ror:8 row_mask:0xf bank_mask:0xc
    v_mov_b32_dpp v99, v131 row_ror:8 row_mask:0xf bank_mask:0xc
    buffer_store_dwordx4 v[96:99], v88, s[52:55], s71 offen
    buffer_store_dwordx4 v[100:103], v89, s[52:55], s71 offen
    v_cvt_pk_bf16_f32 v104, v144, v145
    v_cvt_pk_bf16_f32 v105, v146, v147
    v_cvt_pk_bf16_f32 v106, v148, v149
    v_cvt_pk_bf16_f32 v107, v150, v151
    s_nop 1
    v_permlane16_swap_b32 v104, v106
    v_permlane16_swap_b32 v105, v107
    s_nop 0
    v_cvt_pk_bf16_f32 v108, v152, v153
    v_cvt_pk_bf16_f32 v109, v154, v155
    v_cvt_pk_bf16_f32 v110, v156, v157
    v_cvt_pk_bf16_f32 v111, v158, v159
    s_nop 1
    v_permlane16_swap_b32 v108, v110
    v_permlane16_swap_b32 v109, v111
    s_nop 0
    v_mov_b32 v144, v108
    v_mov_b32 v145, v109
    v_mov_b32 v146, v110
    v_mov_b32 v147, v111
    v_mov_b32_dpp v108, v104 row_ror:8 row_mask:0xf bank_mask:0x3
    v_mov_b32_dpp v109, v105 row_ror:8 row_mask:0xf bank_mask:0x3
    v_mov_b32_dpp v110, v106 row_ror:8 row_mask:0xf bank_mask:0x3
    v_mov_b32_dpp v111, v107 row_ror:8 row_mask:0xf bank_mask:0x3
    v_mov_b32_dpp v104, v144 row_ror:8 row_mask:0xf bank_mask:0xc
    v_mov_b32_dpp v105, v145 row_ror:8 row_mask:0xf bank_mask:0xc
    v_mov_b32_dpp v106, v146 row_ror:8 row_mask:0xf bank_mask:0xc
    v_mov_b32_dpp v107, v147 row_ror:8 row_mask:0xf bank_mask:0xc
    buffer_store_dwordx4 v[104:107], v88, s[52:55], s70 offen
    buffer_store_dwordx4 v[108:111], v89, s[52:55], s70 offen
out_fin:
fused_end:
    s_endpgm
text_end:

.section .rodata,"a"
.p2align 6
.amdhsa_kernel parallel_sum__compressed_kv_cla__dense_activation_gelu__prompt_kernel
  .amdhsa_next_free_vgpr 256
  .amdhsa_next_free_sgpr 102
  .amdhsa_accum_offset 256
  .amdhsa_group_segment_fixed_size 0
  .amdhsa_kernarg_size 112
  .amdhsa_user_sgpr_count 2
  .amdhsa_user_sgpr_kernarg_segment_ptr 1
  .amdhsa_system_sgpr_workgroup_id_x 1
  .amdhsa_float_denorm_mode_32 3
  .amdhsa_float_denorm_mode_16_64 3
.end_amdhsa_kernel
```
